```python
import torch

def _softmax(x, axis=-1):
    return torch.softmax(x, dim=axis)
def _gelu(x):
    return torch.nn.functional.gelu(x, approximate="tanh")
def _silu(x):
    return torch.nn.functional.silu(x)
def _sigmoid(x):
    return torch.sigmoid(x)
def _layernorm(x, axis=-1, eps=1e-5):
    m = x.mean(dim=axis, keepdim=True)
    v = x.var(dim=axis, keepdim=True, unbiased=False)
    return (x - m) / torch.sqrt(v + eps)
def _scatter_add(tgt, idx, src, axis=0):
    return tgt.clone().index_add_(axis, idx, src)
def _segment_sum(src, seg, n):
    out = torch.zeros((n,) + src.shape[1:], dtype=src.dtype)
    return out.index_add_(0, seg, src)
def _pad(x, pw):
    flat = tuple(v for pair in reversed(pw) for v in pair)
    return torch.nn.functional.pad(x, flat)

kernel_name = 'interleave_layers__sliding_block__sliding_local_dilated__prompt'

def setup_inputs():

    _w = (lambda a: (lambda t: t.to(torch.bfloat16) if t.is_floating_point() else t)(torch.as_tensor(a)))
    def _A_setup():
        B, S, D = 1, 2048, 1024
        return {
            "x": _w((lambda *s: torch.randn(*s, dtype=torch.bfloat16) * 0.05)(B, S, D)),
            "wqkv": _w((lambda *s: torch.randn(*s, dtype=torch.bfloat16) * 0.05)(D, 3 * D)),
            "wo": _w((lambda *s: torch.randn(*s, dtype=torch.bfloat16) * 0.05)(D, D)),
        }
    _A_in = _A_setup()

    def _B_setup():
        B, S, D = 1, 2048, 1024
        return {
            "x": _w((lambda *s: torch.randn(*s, dtype=torch.bfloat16) * 0.05)(B, S, D)),
            "wqkv": _w((lambda *s: torch.randn(*s, dtype=torch.bfloat16) * 0.05)(D, 3 * D)),
            "wo": _w((lambda *s: torch.randn(*s, dtype=torch.bfloat16) * 0.05)(D, D)),
        }
    _B_in = _B_setup()

    return {
        "A_x": _A_in["x"],
        "A_wqkv": _A_in["wqkv"],
        "A_wo": _A_in["wo"],
        "B_x": _B_in["x"],
        "B_wqkv": _B_in["wqkv"],
        "B_wo": _B_in["wo"],
    }

def reference(A_x, A_wqkv, A_wo, B_x, B_wqkv, B_wo):
    def _A_ref(x, wqkv, wo):
        B, S, D = x.shape
        H = 32; Dh = D // H; W = 256
        qkv = (lambda x, *d: x.permute(*d))((x @ wqkv).reshape(B, S, 3, H, Dh), 2, 0, 3, 1, 4)
        q, k, v = qkv[0], qkv[1], qkv[2]
        scores = torch.einsum("bhqd,bhkd->bhqk", q, k) * (Dh ** -0.5)
        idx = torch.arange(S)
        mask = (idx[:, None] - idx[None, :] >= 0) & (idx[:, None] - idx[None, :] < W)
        scores = torch.where(mask[None, None], scores, -1e9)
        p = _softmax(scores, axis=-1)
        o = torch.einsum("bhqk,bhkd->bhqd", p, v)
        return (lambda x, *d: x.permute(*d))(o, 0, 2, 1, 3).reshape(B, S, D) @ wo

    def _B_ref(x, wqkv, wo):
        B, S, D = x.shape
        H = 32; Dh = D // H
        W, dil = 8, 2
        qkv = (lambda x, *d: x.permute(*d))((x @ wqkv).reshape(B, S, 3, H, Dh), 2, 0, 3, 1, 4)
        q, k, v = qkv[0], qkv[1], qkv[2]
        scale = Dh ** -0.5
        pos = torch.arange(S)
        off = torch.arange(W) * dil
        idx = pos[:, None] - off[None, :]
        mask = idx >= 0
        idx_c = torch.where(mask, idx, 0).reshape(-1)
        kg = k[:, :, idx_c, :].reshape(B, H, S, W, Dh)
        vg = v[:, :, idx_c, :].reshape(B, H, S, W, Dh)
        logits = torch.einsum("bhsd,bhswd->bhsw", q, kg) * scale
        logits = torch.where(mask[None, None, :, :], logits, -1e9)
        attn = _softmax(logits, axis=-1)
        o = torch.einsum("bhsw,bhswd->bhsd", attn, vg)
        return (lambda x, *d: x.permute(*d))(o, 0, 2, 1, 3).reshape(B, S, D) @ wo

    x = A_x
    x = x + _A_ref(_layernorm(x, axis=-1), A_wqkv, A_wo)
    x = x + _B_ref(_layernorm(x, axis=-1), B_wqkv, B_wo)
    x = x + _A_ref(_layernorm(x, axis=-1), A_wqkv, A_wo)
    x = x + _B_ref(_layernorm(x, axis=-1), B_wqkv, B_wo)
    return x
```

```asm
; @launch grid=(256,1,1) block=(512,1,1) lds=163840
.amdgcn_target "amdgcn-amd-amdhsa--gfx950"
.text
.globl interleave_layers__sliding_block__sliding_local_dilated__prompt_kernel
.p2align 8
.type interleave_layers__sliding_block__sliding_local_dilated__prompt_kernel,@function
interleave_layers__sliding_block__sliding_local_dilated__prompt_kernel:
    s_cmp_ge_u32 s2, 256
    s_cbranch_scc1 L_end
    s_load_dwordx16 s[48:63], s[0:1], 0
    s_load_dwordx2 s[64:65], s[0:1], 64
    v_lshrrev_b32 v1, 6, v0
    s_nop 0
    v_readfirstlane_b32 s3, v1
    v_and_b32 v1, 63, v0
    v_lshlrev_b32 v0, 4, v1
    s_and_b32 s27, s2, 7
    s_lshl_b32 s20, s27, 1
    s_bfe_u32 s27, s2, 0x10003
    s_add_u32 s20, s20, s27
    s_lshr_b32 s21, s2, 4
    s_mov_b32 s22, 0
    s_cmp_lt_u32 s3, 4
    s_cbranch_scc1 L_cstart
    s_sub_u32 s87, s3, 4
    s_lshl_b32 s78, s87, 12
    s_lshl_b32 s79, s87, 11
    s_lshr_b32 s27, s20, 1
    s_lshl_b32 s27, s27, 3
    s_mov_b32 s28, 3013775744
    s_mov_b32 s29, 4159100356
    s_lshr_b64 s[74:75], s[28:29], s27
    s_sub_u32 s27, 64, s27
    s_lshl_b64 s[28:29], s[28:29], s27
    s_or_b64 s[74:75], s[74:75], s[28:29]
    s_mov_b32 s77, 7
    v_lshrrev_b32 v14, 3, v1
    v_and_b32 v15, 6, v14
    v_and_b32 v16, 7, v1
    v_xor_b32 v15, v15, v16
    v_and_b32 v16, 4, v14
    v_add_u32 v14, v14, v16
    s_lshr_b32 s27, s87, 1
    s_lshl_b32 s27, s27, 5
    s_and_b32 s28, s87, 1
    s_lshl_b32 s28, s28, 2
    s_add_u32 s27, s27, s28
    s_mul_i32 s27, s27, 6144
    s_lshl_b32 s28, s21, 7
    s_add_u32 s27, s27, s28
    v_mul_u32_u24 v14, 6144, v14
    v_lshlrev_b32 v15, 4, v15
    v_add3_u32 v12, v14, v15, s27
    v_add_u32 v13, 97280, v12
    v_add_u32 v14, 2048, v12
    v_add_u32 v15, 99328, v12
    v_add_u32 v16, 4096, v12
    v_add_u32 v17, 101376, v12
    s_lshl_b32 s27, s20, 2
    s_add_u32 s27, s27, s87
    s_lshl_b32 s27, s27, 16
    v_lshrrev_b32 v9, 4, v1
    v_and_b32 v10, 7, v1
    v_xor_b32 v9, v9, v10
    v_lshlrev_b32 v9, 4, v9
    v_lshrrev_b32 v10, 3, v1
    v_lshlrev_b32 v10, 11, v10
    v_add3_u32 v8, v9, v10, s27
    v_xor_b32 v9, 64, v8
    v_add_u32 v10, 30720, v8
    v_add_u32 v11, 46080, v9
    v_add_u32 v9, 15360, v9
    s_bfe_u32 s27, s74, 262144
    s_lshl_b32 s84, s27, s77
    s_mul_i32 s85, s27, 393216
    s_waitcnt lgkmcnt(0)
    s_mov_b32 s4, s50
    s_mov_b32 s5, s51
    s_mov_b32 s6, 6291456
    s_mov_b32 s7, 0x00020000
    s_mov_b32 s88, s48
    s_mov_b32 s89, s49
    s_mov_b32 s90, 4194304
    s_mov_b32 s91, 0x00020000
    s_add_u32 m0, s79, 81920
    s_nop 0
    buffer_load_dwordx4 v12, s[4:7], s85 offen offset:0 lds
    buffer_load_dwordx4 v13, s[4:7], s85 offen offset:1024 lds
    s_add_u32 m0, s79, 49152
    s_nop 0
    buffer_load_dwordx4 v14, s[4:7], s85 offen offset:0 lds
    buffer_load_dwordx4 v15, s[4:7], s85 offen offset:1024 lds
    s_add_u32 m0, s79, 57344
    s_nop 0
    buffer_load_dwordx4 v16, s[4:7], s85 offen offset:0 lds
    buffer_load_dwordx4 v17, s[4:7], s85 offen offset:1024 lds
    s_add_u32 m0, s78, 32768
    s_nop 0
    buffer_load_dwordx4 v8, s[88:91], s84 offen offset:0 sc1 lds
    buffer_load_dwordx4 v9, s[88:91], s84 offen offset:1024 sc1 lds
    buffer_load_dwordx4 v10, s[88:91], s84 offen offset:2048 sc1 lds
    buffer_load_dwordx4 v11, s[88:91], s84 offen offset:3072 sc1 lds
    s_mov_b32 s12, s64
    s_mov_b32 s13, s65
    s_mov_b32 s14, 75497472
    s_mov_b32 s15, 0x00020000
    v_mov_b32 v28, 671744
    buffer_load_dwordx2 v[26:27], v28, s[12:15], 0 offen sc1
    s_lshr_b32 s27, s4, 7
    s_sub_u32 s27, 3, s27
    s_and_b32 s27, s27, 7
    s_and_b32 s28, s21, 8
    s_add_u32 s27, s27, s28
    s_bfe_u32 s28, s2, 0x40003
    s_lshl_b32 s28, s28, 2
    s_add_u32 s28, s28, s87
    s_mul_i32 s28, s28, 6144
    s_lshl_b32 s46, s27, 7
    s_add_u32 s46, s46, s28
    s_mov_b64 s[44:45], s[74:75]
    s_bfe_u32 s37, s44, 262148
    s_mul_i32 s37, s37, 393216
    s_add_u32 s37, s37, s46
    s_buffer_load_dwordx2 s[38:39], s[4:7], s37 offset:60
    s_buffer_load_dwordx2 s[38:39], s[4:7], s37 offset:2108
    s_buffer_load_dwordx2 s[38:39], s[4:7], s37 offset:4156
    s_bfe_u32 s37, s44, 262152
    s_mul_i32 s37, s37, 393216
    s_add_u32 s37, s37, s46
    s_buffer_load_dwordx2 s[38:39], s[4:7], s37 offset:60
    s_buffer_load_dwordx2 s[38:39], s[4:7], s37 offset:2108
    s_buffer_load_dwordx2 s[38:39], s[4:7], s37 offset:4156
    s_bfe_u32 s37, s44, 262156
    s_mul_i32 s37, s37, 393216
    s_add_u32 s37, s37, s46
    s_buffer_load_dwordx2 s[38:39], s[4:7], s37 offset:60
    s_buffer_load_dwordx2 s[38:39], s[4:7], s37 offset:2108
    s_buffer_load_dwordx2 s[38:39], s[4:7], s37 offset:4156
    s_bfe_u32 s27, s74, 262148
    s_lshl_b32 s84, s27, s77
    s_mul_i32 s85, s27, 393216
    s_add_u32 m0, s78, 0
    s_nop 0
    buffer_load_dwordx4 v8, s[88:91], s84 offen offset:0 sc1 lds
    buffer_load_dwordx4 v9, s[88:91], s84 offen offset:1024 sc1 lds
    buffer_load_dwordx4 v10, s[88:91], s84 offen offset:2048 sc1 lds
    buffer_load_dwordx4 v11, s[88:91], s84 offen offset:3072 sc1 lds
    s_add_u32 m0, s79, 65536
    s_nop 0
    buffer_load_dwordx4 v12, s[4:7], s85 offen offset:0 lds
    buffer_load_dwordx4 v13, s[4:7], s85 offen offset:1024 lds
    s_add_u32 m0, s79, 98304
    s_nop 0
    buffer_load_dwordx4 v14, s[4:7], s85 offen offset:0 lds
    buffer_load_dwordx4 v15, s[4:7], s85 offen offset:1024 lds
    s_add_u32 m0, s79, 106496
    s_nop 0
    buffer_load_dwordx4 v16, s[4:7], s85 offen offset:0 lds
    buffer_load_dwordx4 v17, s[4:7], s85 offen offset:1024 lds
    s_bfe_u32 s27, s74, 262152
    s_lshl_b32 s84, s27, s77
    s_mul_i32 s85, s27, 393216
    s_add_u32 m0, s78, 16384
    s_nop 0
    buffer_load_dwordx4 v8, s[88:91], s84 offen offset:0 sc1 lds
    buffer_load_dwordx4 v9, s[88:91], s84 offen offset:1024 sc1 lds
    buffer_load_dwordx4 v10, s[88:91], s84 offen offset:2048 sc1 lds
    buffer_load_dwordx4 v11, s[88:91], s84 offen offset:3072 sc1 lds
    s_add_u32 m0, s79, 73728
    s_nop 0
    buffer_load_dwordx4 v12, s[4:7], s85 offen offset:0 lds
    buffer_load_dwordx4 v13, s[4:7], s85 offen offset:1024 lds
    s_add_u32 m0, s79, 114688
    s_nop 0
    buffer_load_dwordx4 v14, s[4:7], s85 offen offset:0 lds
    buffer_load_dwordx4 v15, s[4:7], s85 offen offset:1024 lds
    s_add_u32 m0, s79, 122880
    s_nop 0
    buffer_load_dwordx4 v16, s[4:7], s85 offen offset:0 lds
    buffer_load_dwordx4 v17, s[4:7], s85 offen offset:1024 lds
    s_mov_b32 s12, s64
    s_mov_b32 s13, s65
    s_mov_b32 s14, 75497472
    s_mov_b32 s15, 0x00020000
    s_mov_b32 s8, s52
    s_mov_b32 s9, s53
    s_mov_b32 s10, 2097152
    s_mov_b32 s11, 0x00020000
    s_mov_b32 s40, s60
    s_mov_b32 s41, s61
    s_mov_b32 s42, 4194304
    s_mov_b32 s43, 0x00020000
    s_add_u32 s16, s64, 18874368
    s_addc_u32 s17, s65, 0
    s_mov_b32 s18, 4194304
    s_mov_b32 s19, 0x00020000
    s_mov_b32 s92, s56
    s_mov_b32 s93, s57
    s_mov_b32 s94, 6291456
    s_mov_b32 s95, 0x00020000
    s_mov_b32 s23, 0
    v_mov_b32 v6, 0
    v_mov_b32 v7, 0
    v_mov_b32 v206, 1073741824
    s_lshl_b32 s97, s20, 20
    s_add_u32 s97, s97, 2097152
    s_lshl_b32 s99, s21, 17
    s_lshl_b32 s27, s3, 2
    s_lshr_b32 s27, 1983009808, s27
    s_and_b32 s28, s27, 4
    s_lshl_b32 s28, s28, 2
    s_and_b32 s27, s27, 3
    s_or_b32 s27, s27, s28
    s_lshl_b32 s27, s27, 16
    s_xor_b32 s76, s99, s27
    v_bfe_u32 v28, v1, 2, 3
    v_bfe_u32 v29, v1, 1, 1
    v_and_b32 v30, 6, v28
    v_xor_b32 v29, v29, v30
    v_lshlrev_b32 v29, 4, v29
    v_lshlrev_b32 v28, 7, v28
    v_and_b32 v30, 1, v1
    v_lshlrev_b32 v30, 3, v30
    v_add3_u32 v28, v28, v29, v30
    v_lshrrev_b32 v29, 5, v1
    v_lshl_add_u32 v2, v29, 10, v28
    v_lshrrev_b32 v28, 3, v1
    v_and_b32 v29, 6, v28
    v_and_b32 v30, 7, v1
    v_xor_b32 v29, v29, v30
    v_lshlrev_b32 v29, 4, v29
    v_lshlrev_b32 v28, 11, v28
    s_lshl_b32 s27, s21, 7
    v_add3_u32 v3, v28, v29, s27
    v_and_b32 v212, 3, v1
    v_cmp_eq_u32 vcc, 0, v212
    v_mov_b32 v213, 0x3f803f80
    s_nop 0
    v_cndmask_b32 v212, 0, v213, vcc
    v_mov_b32 v213, v212
    v_mov_b32 v214, v212
    v_mov_b32 v215, v212
    s_and_b32 s27, s3, 2
    s_lshr_b32 s28, s3, 2
    s_add_u32 s71, s27, s28
    s_and_b32 s27, s3, 1
    s_lshl_b32 s28, s71, 1
    s_add_u32 s28, s28, s27
    s_lshl_b32 s28, s28, 12
    s_add_u32 s54, s28, 98304
    s_lshl_b32 s28, s21, 1
    s_add_u32 s27, s27, s28
    s_lshl_b32 s27, s27, 11
    s_lshl_b32 s28, s71, 16
    s_add_u32 s27, s27, s28
    s_lshl_b32 s28, s20, 18
    s_add_u32 s62, s27, s28
    s_add_u32 s27, s71, 1
    s_cmp_lt_u32 s20, 2
    s_cselect_b32 s98, s27, 99
    s_cmp_eq_u32 s20, 0
    s_cselect_b32 s27, 0, 1048576
    s_sub_u32 s27, s97, s27
    s_lshl_b32 s28, s21, 3
    s_add_u32 s28, s28, s3
    s_lshl_b32 s28, s28, 12
    s_add_u32 s27, s27, s28
    s_add_u32 s55, s27, 524288
    s_lshr_b32 s27, s20, 1
    s_lshl_b32 s27, s27, 3
    s_mov_b32 s28, 1262102808
    s_mov_b32 s29, 259943772
    s_lshr_b64 s[100:101], s[28:29], s27
    s_sub_u32 s27, 60, s27
    s_lshl_b64 s[28:29], s[28:29], s27
    s_or_b64 s[100:101], s[100:101], s[28:29]
    s_lshl_b64 s[100:101], s[100:101], 4
    s_mul_i32 s27, s21, 0x11111111
    s_xor_b32 s100, s100, s27
    s_xor_b32 s101, s101, s27
    s_lshl_b32 s27, s87, 14
    v_add_u32 v20, s27, v3
    v_and_b32 v72, 15, v1
    v_lshrrev_b32 v73, 4, v1
    s_lshl_b32 s27, s22, 4
    s_add_u32 s27, s27, s20
    s_lshl_b32 s28, s27, 7
    s_add_u32 s28, s28, 655360
    v_lshl_add_u32 v188, v72, 3, s28
    s_lshl_b32 s29, s21, 3
    s_add_u32 s28, s28, s29
    v_mov_b32 v190, s28
    s_lshl_b32 s27, s27, 11
    s_add_u32 s27, s27, 917504
    s_lshl_b32 s28, s87, 5
    v_and_b32 v74, 31, v1
    v_add_u32 v74, s28, v74
    v_lshl_add_u32 v189, v74, 4, s27
    v_lshlrev_b32 v192, 2, v74
    s_lshl_b32 s28, s21, 7
    s_add_u32 s27, s27, s28
    v_and_b32 v74, 3, v1
    v_lshrrev_b32 v75, 5, v1
    v_lshl_add_u32 v74, v74, 1, v75
    v_lshl_add_u32 v202, v74, 4, s27
    v_and_b32 v74, 28, v1
    v_lshl_add_u32 v202, v74, 26, v202
    s_lshl_b32 s27, s20, 4
    s_add_u32 s27, s27, s21
    s_lshl_b32 s27, s27, 10
    v_add_u32 v191, s27, v0
    s_lshl_b32 s27, s22, 2
    s_add_u32 s27, s27, s87
    s_lshl_b32 s27, s27, 4
    s_add_u32 s27, s27, s21
    s_lshl_b32 s27, s27, 7
    s_add_u32 s27, s27, 688128
    v_lshl_add_u32 v200, v72, 3, s27
    s_lshl_b32 s28, s20, 3
    s_add_u32 s27, s27, s28
    v_mov_b32 v201, s27
    s_lshl_b32 s27, s22, 4
    s_add_u32 s27, s27, s21
    s_mul_i32 s27, s27, 12288
    s_mul_i32 s28, s87, 192
    s_add_u32 s27, s27, s28
    s_add_u32 s27, s27, 262144
    v_min_u32 v74, 11, v72
    v_lshlrev_b32 v74, 4, v74
    v_add_u32 v194, s28, v74
    v_mul_u32_u24 v75, 3072, v73
    v_add3_u32 v193, v74, v75, s27
    s_mul_i32 s28, s20, 768
    s_add_u32 s27, s27, s28
    v_lshl_add_u32 v199, v1, 2, s27
    v_cmp_gt_u32 vcc, 48, v1
    v_mov_b32 v74, 1073741824
    s_nop 0
    v_cndmask_b32 v199, v74, v199, vcc
    v_add_u32 v195, s78, v0
    s_and_b32 s86, s20, 1
    s_add_u32 s86, s86, 3
    s_add_u32 s27, s20, s22
    s_cmp_eq_u32 s27, 16
    s_cselect_b32 s86, 0, s86
    s_cmp_eq_u32 s86, 4
    s_mov_b32 s28, 81920
    s_cselect_b32 s28, 65536, s28
    s_mov_b32 s29, 40960
    s_cselect_b32 s29, 90112, s29
    s_mul_i32 s27, s87, 3
    s_add_u32 s27, s27, 0
    s_and_b32 s30, s27, 3
    s_lshl_b32 s30, s30, 5
    v_xor_b32 v196, s30, v2
    s_lshr_b32 s27, s27, 2
    s_lshl_b32 s30, s27, 13
    s_add_u32 s30, s30, s29
    s_cmp_eq_u32 s27, 0
    s_cselect_b32 s30, s28, s30
    v_add_u32 v196, s30, v196
    s_mul_i32 s27, s87, 3
    s_add_u32 s27, s27, 1
    s_and_b32 s30, s27, 3
    s_lshl_b32 s30, s30, 5
    v_xor_b32 v197, s30, v2
    s_lshr_b32 s27, s27, 2
    s_lshl_b32 s30, s27, 13
    s_add_u32 s30, s30, s29
    s_cmp_eq_u32 s27, 0
    s_cselect_b32 s30, s28, s30
    v_add_u32 v197, s30, v197
    s_mul_i32 s27, s87, 3
    s_add_u32 s27, s27, 2
    s_and_b32 s30, s27, 3
    s_lshl_b32 s30, s30, 5
    v_xor_b32 v198, s30, v2
    s_lshr_b32 s27, s27, 2
    s_lshl_b32 s30, s27, 13
    s_add_u32 s30, s30, s29
    s_cmp_eq_u32 s27, 0
    s_cselect_b32 s30, s28, s30
    v_add_u32 v198, s30, v198
    v_mov_b32 v124, -1
    v_mov_b32 v125, -1
    v_mov_b32 v126, -1
    v_mov_b32 v127, -1
    v_mov_b32 v128, 0
    v_mov_b32 v129, 0
    v_mov_b32 v130, 0
    v_mov_b32 v131, 0
    s_lshl_b32 s27, s20, 2
    s_add_u32 s27, s27, s87
    s_lshl_b32 s27, s27, 4
    s_add_u32 s27, s27, s21
    s_lshl_b32 s47, s27, 12
    s_bfe_u32 s37, s44, 262160
    s_mul_i32 s37, s37, 393216
    s_add_u32 s37, s37, s46
    s_buffer_load_dwordx2 s[38:39], s[4:7], s37 offset:60
    s_buffer_load_dwordx2 s[38:39], s[4:7], s37 offset:2108
    s_buffer_load_dwordx2 s[38:39], s[4:7], s37 offset:4156
    s_bfe_u32 s37, s44, 262164
    s_mul_i32 s37, s37, 393216
    s_add_u32 s37, s37, s46
    s_buffer_load_dwordx2 s[38:39], s[4:7], s37 offset:60
    s_buffer_load_dwordx2 s[38:39], s[4:7], s37 offset:2108
    s_buffer_load_dwordx2 s[38:39], s[4:7], s37 offset:4156
    s_bfe_u32 s37, s44, 262168
    s_mul_i32 s37, s37, 393216
    s_add_u32 s37, s37, s46
    s_buffer_load_dwordx2 s[38:39], s[4:7], s37 offset:60
    s_buffer_load_dwordx2 s[38:39], s[4:7], s37 offset:2108
    s_buffer_load_dwordx2 s[38:39], s[4:7], s37 offset:4156
    s_bfe_u32 s37, s44, 262172
    s_mul_i32 s37, s37, 393216
    s_add_u32 s37, s37, s46
    s_buffer_load_dwordx2 s[38:39], s[4:7], s37 offset:60
    s_buffer_load_dwordx2 s[38:39], s[4:7], s37 offset:2108
    s_buffer_load_dwordx2 s[38:39], s[4:7], s37 offset:4156
    s_bfe_u32 s37, s45, 262144
    s_mul_i32 s37, s37, 393216
    s_add_u32 s37, s37, s46
    s_buffer_load_dwordx2 s[38:39], s[4:7], s37 offset:60
    s_buffer_load_dwordx2 s[38:39], s[4:7], s37 offset:2108
    s_buffer_load_dwordx2 s[38:39], s[4:7], s37 offset:4156
    s_waitcnt vmcnt(20)
    v_readfirstlane_b32 s24, v26
    v_readfirstlane_b32 s25, v27
    s_add_u32 s24, s24, 1
    s_add_u32 s25, s25, 16
    s_and_b32 s25, s25, 0xfffffff0
    s_getreg_b32 s27, hwreg(HW_REG_XCC_ID, 0, 4)
    s_or_b32 s25, s25, s27
    s_barrier
    s_cmp_eq_u32 s87, 0
    s_cbranch_scc0 Lif_1
    v_mov_b32 v240, s24
    v_mov_b32 v241, s25
    s_mov_b64 exec, 1
    buffer_store_dwordx2 v[240:241], v190, s[12:15], 0 offen sc1
    s_mov_b64 exec, -1
Lif_1:
L_lbody:
    s_cmp_lg_u32 s22, 0
    s_cbranch_scc0 Lif_2
    s_bfe_u32 s27, s74, 262148
    s_lshl_b32 s84, s27, s77
    s_add_u32 m0, s78, 0
    s_nop 0
    buffer_load_dwordx4 v8, s[88:91], s84 offen offset:0 sc1 lds
    buffer_load_dwordx4 v9, s[88:91], s84 offen offset:1024 sc1 lds
    buffer_load_dwordx4 v10, s[88:91], s84 offen offset:2048 sc1 lds
    buffer_load_dwordx4 v11, s[88:91], s84 offen offset:3072 sc1 lds
    s_bfe_u32 s27, s74, 262152
    s_lshl_b32 s84, s27, s77
    s_mul_i32 s85, s27, 393216
    s_add_u32 m0, s78, 16384
    s_nop 0
    buffer_load_dwordx4 v8, s[88:91], s84 offen offset:0 sc1 lds
    buffer_load_dwordx4 v9, s[88:91], s84 offen offset:1024 sc1 lds
    buffer_load_dwordx4 v10, s[88:91], s84 offen offset:2048 sc1 lds
    buffer_load_dwordx4 v11, s[88:91], s84 offen offset:3072 sc1 lds
    s_waitcnt vmcnt(4)
    ds_read_b128 v[24:27], v195 offset:0
    ds_read_b128 v[28:31], v195 offset:1024
    ds_read_b128 v[32:35], v195 offset:2048
    ds_read_b128 v[36:39], v195 offset:3072
    s_add_u32 m0, s79, 73728
    s_nop 0
    buffer_load_dwordx4 v12, s[4:7], s85 offen offset:0 lds
    buffer_load_dwordx4 v13, s[4:7], s85 offen offset:1024 lds
    s_waitcnt lgkmcnt(0)
    v_bitop3_b32 v25, v24, v28, v32 bitop3:0x80
    v_bitop3_b32 v25, v25, v36, 1 bitop3:0x80
    v_cmp_eq_u32 vcc, 0, v25
    s_nop 0
    s_cbranch_vccnz Lrt_3
Lok_4:
    s_cmp_eq_u32 s86, 0
    s_cbranch_scc0 Lif_5
    s_call_b64 s[72:73], L_colsum
Lif_5:
Lif_2:
    s_waitcnt vmcnt(10)
    s_barrier
    s_cmp_lg_u32 s22, 0
    s_cbranch_scc0 Lon_7
    s_cmp_eq_u32 s87, 0
    s_cbranch_scc0 Lon_6
    v_mov_b32 v240, s24
    v_mov_b32 v241, s25
    s_mov_b64 exec, 1
    s_cmp_eq_u32 s23, 0
    s_cbranch_scc1 Lwt_461006
    buffer_store_dwordx2 v[240:241], v190, s[12:15], 0 offen
Lwt_461007:
    s_mov_b64 exec, -1
Lon_6:
    s_add_u32 m0, s79, 114688
    s_nop 0
    buffer_load_dwordx4 v14, s[4:7], s85 offen offset:0 lds
    buffer_load_dwordx4 v15, s[4:7], s85 offen offset:1024 lds
    s_add_u32 m0, s79, 122880
    s_nop 0
    buffer_load_dwordx4 v16, s[4:7], s85 offen offset:0 lds
    buffer_load_dwordx4 v17, s[4:7], s85 offen offset:1024 lds
Lon_7:
    s_bfe_u32 s27, s74, 262156
    s_lshl_b32 s84, s27, s77
    s_mul_i32 s85, s27, 393216
    s_add_u32 m0, s78, 32768
    s_nop 0
    buffer_load_dwordx4 v8, s[88:91], s84 offen offset:0 sc1 lds
    buffer_load_dwordx4 v9, s[88:91], s84 offen offset:1024 sc1 lds
    buffer_load_dwordx4 v10, s[88:91], s84 offen offset:2048 sc1 lds
    buffer_load_dwordx4 v11, s[88:91], s84 offen offset:3072 sc1 lds
    s_cmp_lg_u32 s22, 0
    s_cbranch_scc0 Lif_8
    s_waitcnt vmcnt(10)
    ds_read_b128 v[24:27], v195 offset:16384
    ds_read_b128 v[28:31], v195 offset:17408
    ds_read_b128 v[32:35], v195 offset:18432
    ds_read_b128 v[36:39], v195 offset:19456
Lif_8:
    s_add_u32 m0, s79, 81920
    s_nop 0
    buffer_load_dwordx4 v12, s[4:7], s85 offen offset:0 lds
    buffer_load_dwordx4 v13, s[4:7], s85 offen offset:1024 lds
    s_add_u32 m0, s79, 49152
    s_nop 0
    buffer_load_dwordx4 v14, s[4:7], s85 offen offset:0 lds
    buffer_load_dwordx4 v15, s[4:7], s85 offen offset:1024 lds
    s_add_u32 m0, s79, 57344
    s_nop 0
    buffer_load_dwordx4 v16, s[4:7], s85 offen offset:0 lds
    buffer_load_dwordx4 v17, s[4:7], s85 offen offset:1024 lds
    s_cmp_lg_u32 s22, 0
    s_cbranch_scc0 Lif_10
    s_waitcnt lgkmcnt(0)
    v_bitop3_b32 v25, v24, v28, v32 bitop3:0x80
    v_bitop3_b32 v25, v25, v36, 1 bitop3:0x80
    v_cmp_eq_u32 vcc, 0, v25
    s_nop 0
    s_cbranch_vccnz Lrt_11
Lok_12:
Lif_10:
    s_waitcnt vmcnt(10)
    s_barrier
    buffer_load_dwordx2 v[244:245], v188, s[12:15], 0 offen sc1
    s_bfe_u32 s27, s74, 262160
    s_lshl_b32 s84, s27, s77
    s_mul_i32 s85, s27, 393216
    s_add_u32 m0, s78, 0
    s_nop 0
    buffer_load_dwordx4 v8, s[88:91], s84 offen offset:0 sc1 lds
    buffer_load_dwordx4 v9, s[88:91], s84 offen offset:1024 sc1 lds
    buffer_load_dwordx4 v10, s[88:91], s84 offen offset:2048 sc1 lds
    buffer_load_dwordx4 v11, s[88:91], s84 offen offset:3072 sc1 lds
    s_cmp_lg_u32 s22, 0
    s_cbranch_scc0 Lif_14
    s_waitcnt vmcnt(11)
    ds_read_b128 v[24:27], v195 offset:32768
    ds_read_b128 v[28:31], v195 offset:33792
    ds_read_b128 v[32:35], v195 offset:34816
    ds_read_b128 v[36:39], v195 offset:35840
Lif_14:
    s_add_u32 m0, s79, 65536
    s_nop 0
    buffer_load_dwordx4 v12, s[4:7], s85 offen offset:0 lds
    buffer_load_dwordx4 v13, s[4:7], s85 offen offset:1024 lds
    s_add_u32 m0, s79, 98304
    s_nop 0
    buffer_load_dwordx4 v14, s[4:7], s85 offen offset:0 lds
    buffer_load_dwordx4 v15, s[4:7], s85 offen offset:1024 lds
    s_add_u32 m0, s79, 106496
    s_nop 0
    buffer_load_dwordx4 v16, s[4:7], s85 offen offset:0 lds
    buffer_load_dwordx4 v17, s[4:7], s85 offen offset:1024 lds
    s_cmp_lg_u32 s22, 0
    s_cbranch_scc0 Lif_16
    s_waitcnt lgkmcnt(0)
    v_bitop3_b32 v25, v24, v28, v32 bitop3:0x80
    v_bitop3_b32 v25, v25, v36, 1 bitop3:0x80
    v_cmp_eq_u32 vcc, 0, v25
    s_nop 0
    s_cbranch_vccnz Lrt_17
Lok_18:
Lif_16:
    s_waitcnt vmcnt(11)
    s_barrier
    s_waitcnt vmcnt(10)
    v_xor_b32 v246, s24, v244
    v_xor_b32 v247, s25, v245
    v_lshrrev_b32 v247, 4, v247
    v_or_b32 v246, v246, v247
    v_cmp_ne_u32 vcc, 0, v246
    s_nop 0
    s_cbranch_vccnz Lpoll_21
Lok_22:
    s_cmp_eq_u32 s22, 0
    s_cbranch_scc0 Lif_23
    v_cmp_ne_u32 vcc, s25, v245
    s_nop 0
    s_cmp_eq_u64 vcc, 0
    s_cselect_b32 s23, 1, 0
Lif_23:
    s_cmp_eq_u32 s23, 0
    s_cbranch_scc0 Lif_24
    buffer_inv sc1
    s_waitcnt vmcnt(0)
Lif_24:
    s_bfe_u32 s27, s74, 262164
    s_lshl_b32 s84, s27, s77
    s_mul_i32 s85, s27, 393216
    s_add_u32 m0, s78, 16384
    s_nop 0
    buffer_load_dwordx4 v8, s[88:91], s84 offen offset:0 sc1 lds
    buffer_load_dwordx4 v9, s[88:91], s84 offen offset:1024 sc1 lds
    buffer_load_dwordx4 v10, s[88:91], s84 offen offset:2048 sc1 lds
    buffer_load_dwordx4 v11, s[88:91], s84 offen offset:3072 sc1 lds
    s_cmp_lg_u32 s22, 0
    s_cbranch_scc0 Lif_25
    s_waitcnt vmcnt(10)
    ds_read_b128 v[24:27], v195 offset:0
    ds_read_b128 v[28:31], v195 offset:1024
    ds_read_b128 v[32:35], v195 offset:2048
    ds_read_b128 v[36:39], v195 offset:3072
Lif_25:
    s_add_u32 m0, s79, 73728
    s_nop 0
    buffer_load_dwordx4 v12, s[4:7], s85 offen offset:0 lds
    buffer_load_dwordx4 v13, s[4:7], s85 offen offset:1024 lds
    s_add_u32 m0, s79, 114688
    s_nop 0
    buffer_load_dwordx4 v14, s[4:7], s85 offen offset:0 lds
    buffer_load_dwordx4 v15, s[4:7], s85 offen offset:1024 lds
    s_add_u32 m0, s79, 122880
    s_nop 0
    buffer_load_dwordx4 v16, s[4:7], s85 offen offset:0 lds
    buffer_load_dwordx4 v17, s[4:7], s85 offen offset:1024 lds
    s_cmp_lg_u32 s22, 0
    s_cbranch_scc0 Lif_27
    s_waitcnt lgkmcnt(0)
    v_bitop3_b32 v25, v24, v28, v32 bitop3:0x80
    v_bitop3_b32 v25, v25, v36, 1 bitop3:0x80
    v_cmp_eq_u32 vcc, 0, v25
    s_nop 0
    s_cbranch_vccnz Lrt_28
Lok_29:
Lif_27:
    s_cmp_eq_u32 s86, 3
    s_cbranch_scc0 Lif_30
    s_call_b64 s[72:73], L_colsum
Lif_30:
    s_cmp_eq_u32 s22, 0
    s_cbranch_scc0 Lif_31
    s_cmp_eq_u32 s23, 0
    s_cbranch_scc1 Lwt_32
    buffer_store_dwordx4 v[124:127], v0, s[40:43], s47 offen offset:0
Lwt_33:
    s_lshl_b32 s27, s21, 2
    s_add_u32 s27, s27, s87
    s_lshl_b32 s27, s27, 10
    s_add_u32 s27, s27, s97
    s_add_u32 s27, s27, 0
    buffer_store_dwordx4 v[124:127], v0, s[12:15], s27 offen sc1
Lif_31:
    s_waitcnt vmcnt(12)
    s_bitcmp1_b32 1, s22
    s_cbranch_scc1 Lvm_34
    s_waitcnt vmcnt(10)
Lvm_34:
    s_barrier
    s_cmp_eq_u32 s87, 3
    s_cbranch_scc0 Lon_35
    buffer_load_dwordx4 v[72:75], v191, s[12:15], 0 offen sc1
Lon_35:
    s_bfe_u32 s27, s74, 262168
    s_lshl_b32 s84, s27, s77
    s_mul_i32 s85, s27, 393216
    s_add_u32 m0, s78, 32768
    s_nop 0
    buffer_load_dwordx4 v8, s[88:91], s84 offen offset:0 sc1 lds
    buffer_load_dwordx4 v9, s[88:91], s84 offen offset:1024 sc1 lds
    buffer_load_dwordx4 v10, s[88:91], s84 offen offset:2048 sc1 lds
    buffer_load_dwordx4 v11, s[88:91], s84 offen offset:3072 sc1 lds
    s_add_u32 m0, s79, 81920
    s_nop 0
    buffer_load_dwordx4 v12, s[4:7], s85 offen offset:0 lds
    buffer_load_dwordx4 v13, s[4:7], s85 offen offset:1024 lds
    s_add_u32 m0, s79, 49152
    s_nop 0
    buffer_load_dwordx4 v14, s[4:7], s85 offen offset:0 lds
    buffer_load_dwordx4 v15, s[4:7], s85 offen offset:1024 lds
    s_add_u32 m0, s79, 57344
    s_nop 0
    buffer_load_dwordx4 v16, s[4:7], s85 offen offset:0 lds
    buffer_load_dwordx4 v17, s[4:7], s85 offen offset:1024 lds
    s_cmp_eq_u32 s86, 4
    s_cbranch_scc0 Lif_36
    s_call_b64 s[72:73], L_colsum
Lif_36:
    s_cmp_eq_u32 s22, 0
    s_cbranch_scc0 Lif_37
    s_cmp_eq_u32 s23, 0
    s_cbranch_scc1 Lwt_38
    buffer_store_dwordx4 v[124:127], v0, s[40:43], s47 offen offset:1024
Lwt_39:
    s_lshl_b32 s27, s21, 2
    s_add_u32 s27, s27, s87
    s_lshl_b32 s27, s27, 10
    s_add_u32 s27, s27, s97
    s_add_u32 s27, s27, 65536
    buffer_store_dwordx4 v[124:127], v0, s[12:15], s27 offen sc1
Lif_37:
    s_waitcnt vmcnt(14)
    s_bitcmp1_b32 1, s22
    s_cbranch_scc1 Lvm_40
    s_waitcnt vmcnt(10)
Lvm_40:
    s_barrier
    s_bfe_u32 s27, s74, 262172
    s_lshl_b32 s84, s27, s77
    s_mul_i32 s85, s27, 393216
    s_add_u32 m0, s78, 0
    s_nop 0
    buffer_load_dwordx4 v8, s[88:91], s84 offen offset:0 sc1 lds
    buffer_load_dwordx4 v9, s[88:91], s84 offen offset:1024 sc1 lds
    buffer_load_dwordx4 v10, s[88:91], s84 offen offset:2048 sc1 lds
    buffer_load_dwordx4 v11, s[88:91], s84 offen offset:3072 sc1 lds
    s_lshr_b32 s27, s8, 7
    s_sub_u32 s27, 3, s27
    s_and_b32 s27, s27, 7
    s_and_b32 s28, s21, 8
    s_add_u32 s27, s27, s28
    s_bfe_u32 s28, s2, 0x40003
    s_lshl_b32 s28, s28, 2
    s_add_u32 s28, s28, s87
    s_lshl_b32 s27, s27, 7
    s_lshl_b32 s28, s28, 15
    s_add_u32 s35, s27, s28
    s_add_u32 m0, s79, 65536
    s_buffer_load_dwordx2 s[38:39], s[8:11], s35 offset:60
    s_buffer_load_dwordx2 s[38:39], s[8:11], s35 offset:12348
    s_buffer_load_dwordx2 s[38:39], s[8:11], s35 offset:24636
    s_bfe_u32 s37, s45, 262148
    s_mul_i32 s37, s37, 393216
    buffer_load_dwordx4 v12, s[4:7], s85 offen offset:0 lds
    buffer_load_dwordx4 v13, s[4:7], s85 offen offset:1024 lds
    s_add_u32 m0, s79, 98304
    s_add_u32 s37, s37, s46
    s_buffer_load_dwordx2 s[38:39], s[4:7], s37 offset:60
    s_buffer_load_dwordx2 s[38:39], s[4:7], s37 offset:2108
    s_buffer_load_dwordx2 s[38:39], s[4:7], s37 offset:4156
    s_lshl_b32 s27, s22, 4
    buffer_load_dwordx4 v14, s[4:7], s85 offen offset:0 lds
    buffer_load_dwordx4 v15, s[4:7], s85 offen offset:1024 lds
    s_add_u32 m0, s79, 106496
    s_add_u32 s27, s27, s20
    s_lshl_b32 s27, s27, 4
    s_add_u32 s27, s27, s21
    s_lshl_b32 s27, s27, 7
    s_buffer_load_dwordx2 s[38:39], s[12:15], s27 offset:917564
    buffer_load_dwordx4 v16, s[4:7], s85 offen offset:0 lds
    buffer_load_dwordx4 v17, s[4:7], s85 offen offset:1024 lds
    s_cmp_eq_u32 s22, 0
    s_cbranch_scc0 Lif_41
    s_cmp_eq_u32 s23, 0
    s_cbranch_scc1 Lwt_42
    buffer_store_dwordx4 v[124:127], v0, s[40:43], s47 offen offset:2048
Lwt_43:
Lif_41:
    s_waitcnt vmcnt(13)
    s_bitcmp1_b32 1, s22
    s_cbranch_scc1 Lvm_44
    s_waitcnt vmcnt(10)
Lvm_44:
    s_barrier
    s_bfe_u32 s27, s75, 262144
    s_lshl_b32 s84, s27, s77
    s_mul_i32 s85, s27, 393216
    s_add_u32 m0, s78, 16384
    s_nop 0
    buffer_load_dwordx4 v8, s[88:91], s84 offen offset:0 sc1 lds
    buffer_load_dwordx4 v9, s[88:91], s84 offen offset:1024 sc1 lds
    buffer_load_dwordx4 v10, s[88:91], s84 offen offset:2048 sc1 lds
    buffer_load_dwordx4 v11, s[88:91], s84 offen offset:3072 sc1 lds
    s_cmp_eq_u32 s87, 3
    s_cbranch_scc0 Lon_45
    v_add_f32_dpp v72, v72, v72 row_ror:4 row_mask:0xf bank_mask:0xf
    v_add_f32_dpp v73, v73, v73 row_ror:4 row_mask:0xf bank_mask:0xf
    v_add_f32_dpp v74, v74, v74 row_ror:4 row_mask:0xf bank_mask:0xf
    v_add_f32_dpp v75, v75, v75 row_ror:4 row_mask:0xf bank_mask:0xf
    v_add_f32_dpp v72, v72, v72 row_ror:8 row_mask:0xf bank_mask:0xf
    v_add_f32_dpp v73, v73, v73 row_ror:8 row_mask:0xf bank_mask:0xf
    v_add_f32_dpp v74, v74, v74 row_ror:8 row_mask:0xf bank_mask:0xf
    v_add_f32_dpp v75, v75, v75 row_ror:8 row_mask:0xf bank_mask:0xf
    s_nop 0
    v_permlane32_swap_b32 v72, v74
    v_permlane32_swap_b32 v73, v75
    v_pk_add_f32 v[72:73], v[72:73], v[74:75]
    v_mov_b32 v74, v72
    v_mov_b32 v75, v73
    s_nop 0
    v_permlane16_swap_b32 v72, v74
    v_permlane16_swap_b32 v73, v75
    v_pk_add_f32 v[72:73], v[72:73], v[74:75]
    v_mul_f32 v77, 0xba800000, v72
    v_mul_f32 v73, 0x3a800000, v73
    v_fma_f32 v73, -v77, v77, v73
    v_max_f32 v73, 0, v73
    v_add_f32 v73, 0x3727c5ac, v73
    v_rsq_f32 v76, v73
    v_mov_b32 v78, s24
    v_mov_b32 v79, s25
    v_mul_f32 v77, v77, v76
    s_cmp_eq_u32 s23, 0
    s_cbranch_scc1 Lwt_738045
    buffer_store_dwordx4 v[76:79], v202, s[12:15], 0 offen
Lwt_738046:
Lon_45:
    s_add_u32 m0, s79, 73728
    s_buffer_load_dwordx2 s[38:39], s[8:11], s35 offset:2108
    s_buffer_load_dwordx2 s[38:39], s[8:11], s35 offset:14396
    s_buffer_load_dwordx2 s[38:39], s[8:11], s35 offset:26684
    buffer_load_dwordx4 v12, s[4:7], s85 offen offset:0 lds
    buffer_load_dwordx4 v13, s[4:7], s85 offen offset:1024 lds
    s_add_u32 m0, s79, 114688
    s_bfe_u32 s37, s45, 262152
    s_mul_i32 s37, s37, 393216
    s_add_u32 s37, s37, s46
    buffer_load_dwordx4 v14, s[4:7], s85 offen offset:0 lds
    buffer_load_dwordx4 v15, s[4:7], s85 offen offset:1024 lds
    s_add_u32 m0, s79, 122880
    s_buffer_load_dwordx2 s[38:39], s[4:7], s37 offset:60
    s_buffer_load_dwordx2 s[38:39], s[4:7], s37 offset:2108
    s_buffer_load_dwordx2 s[38:39], s[4:7], s37 offset:4156
    buffer_load_dwordx4 v16, s[4:7], s85 offen offset:0 lds
    buffer_load_dwordx4 v17, s[4:7], s85 offen offset:1024 lds
    s_cmp_eq_u32 s22, 0
    s_cbranch_scc0 Lif_46
    s_cmp_eq_u32 s23, 0
    s_cbranch_scc1 Lwt_47
    buffer_store_dwordx4 v[124:127], v0, s[40:43], s47 offen offset:3072
Lwt_48:
Lif_46:
    s_waitcnt vmcnt(12)
    s_bitcmp1_b32 1, s22
    s_cbranch_scc1 Lvm_49
    s_waitcnt vmcnt(10)
Lvm_49:
    s_barrier
    s_bfe_u32 s27, s75, 262148
    s_lshl_b32 s84, s27, s77
    s_mul_i32 s85, s27, 393216
    s_add_u32 m0, s78, 32768
    s_nop 0
    buffer_load_dwordx4 v8, s[88:91], s84 offen offset:0 sc1 lds
    buffer_load_dwordx4 v9, s[88:91], s84 offen offset:1024 sc1 lds
    buffer_load_dwordx4 v10, s[88:91], s84 offen offset:2048 sc1 lds
    buffer_load_dwordx4 v11, s[88:91], s84 offen offset:3072 sc1 lds
    s_add_u32 m0, s79, 81920
    s_buffer_load_dwordx2 s[38:39], s[8:11], s35 offset:4156
    s_buffer_load_dwordx2 s[38:39], s[8:11], s35 offset:16444
    s_buffer_load_dwordx2 s[38:39], s[8:11], s35 offset:28732
    buffer_load_dwordx4 v12, s[4:7], s85 offen offset:0 lds
    buffer_load_dwordx4 v13, s[4:7], s85 offen offset:1024 lds
    s_add_u32 m0, s79, 49152
    s_bfe_u32 s37, s45, 262156
    s_mul_i32 s37, s37, 393216
    s_add_u32 s37, s37, s46
    buffer_load_dwordx4 v14, s[4:7], s85 offen offset:0 lds
    buffer_load_dwordx4 v15, s[4:7], s85 offen offset:1024 lds
    s_add_u32 m0, s79, 57344
    s_buffer_load_dwordx2 s[38:39], s[4:7], s37 offset:60
    s_buffer_load_dwordx2 s[38:39], s[4:7], s37 offset:2108
    s_buffer_load_dwordx2 s[38:39], s[4:7], s37 offset:4156
    buffer_load_dwordx4 v16, s[4:7], s85 offen offset:0 lds
    buffer_load_dwordx4 v17, s[4:7], s85 offen offset:1024 lds
    s_cmp_eq_u32 s22, 0
    s_cbranch_scc0 Lif_50
    s_cmp_eq_u32 s23, 0
    s_cbranch_scc1 Lwt_51
    buffer_store_dwordx4 v[128:131], v0, s[16:19], s47 offen offset:0
Lwt_52:
Lif_50:
    s_cmp_lt_u32 s22, 2
    s_cbranch_scc0 Lon_53
    v_mov_b32 v240, s24
    v_mov_b32 v241, s25
    s_mov_b64 exec, 1
    buffer_store_dwordx2 v[240:241], v201, s[12:15], 0 offen sc1
    s_mov_b64 exec, -1
Lon_53:
    s_cmp_eq_u32 s22, 1
    s_cbranch_scc0 Lif_54
    s_or_b32 s27, s2, s87
    s_cmp_lg_u32 s27, 0
    s_cbranch_scc1 Lif_54
    v_mov_b32 v242, 671744
    v_mov_b32 v240, s24
    v_mov_b32 v241, s25
    s_mov_b64 exec, 1
    buffer_store_dwordx2 v[240:241], v242, s[12:15], 0 offen sc1
    s_mov_b64 exec, -1
Lif_54:
    s_waitcnt vmcnt(13)
    s_bitcmp1_b32 1, s22
    s_cbranch_scc1 Lvm_55
    s_waitcnt vmcnt(11)
    s_bitcmp1_b32 2, s22
    s_cbranch_scc1 Lvm_55
    s_waitcnt vmcnt(10)
Lvm_55:
    s_barrier
    s_bfe_u32 s27, s75, 262152
    s_lshl_b32 s84, s27, s77
    s_mul_i32 s85, s27, 393216
    s_add_u32 m0, s78, 0
    s_nop 0
    buffer_load_dwordx4 v8, s[88:91], s84 offen offset:0 sc1 lds
    buffer_load_dwordx4 v9, s[88:91], s84 offen offset:1024 sc1 lds
    buffer_load_dwordx4 v10, s[88:91], s84 offen offset:2048 sc1 lds
    buffer_load_dwordx4 v11, s[88:91], s84 offen offset:3072 sc1 lds
    s_add_u32 m0, s79, 65536
    s_buffer_load_dwordx2 s[38:39], s[8:11], s35 offset:6204
    s_buffer_load_dwordx2 s[38:39], s[8:11], s35 offset:18492
    s_buffer_load_dwordx2 s[38:39], s[8:11], s35 offset:30780
    s_bfe_u32 s37, s45, 262160
    s_mul_i32 s37, s37, 393216
    buffer_load_dwordx4 v12, s[4:7], s85 offen offset:0 lds
    buffer_load_dwordx4 v13, s[4:7], s85 offen offset:1024 lds
    s_add_u32 m0, s79, 98304
    s_add_u32 s37, s37, s46
    s_buffer_load_dwordx2 s[38:39], s[4:7], s37 offset:60
    s_buffer_load_dwordx2 s[38:39], s[4:7], s37 offset:2108
    s_buffer_load_dwordx2 s[38:39], s[4:7], s37 offset:4156
    s_lshl_b32 s27, s22, 4
    buffer_load_dwordx4 v14, s[4:7], s85 offen offset:0 lds
    buffer_load_dwordx4 v15, s[4:7], s85 offen offset:1024 lds
    s_add_u32 m0, s79, 106496
    s_add_u32 s27, s27, s20
    s_lshl_b32 s27, s27, 7
    s_buffer_load_dwordx2 s[38:39], s[12:15], s27 offset:663612
    buffer_load_dwordx4 v16, s[4:7], s85 offen offset:0 lds
    buffer_load_dwordx4 v17, s[4:7], s85 offen offset:1024 lds
    s_cmp_eq_u32 s22, 0
    s_cbranch_scc0 Lif_56
    s_cmp_eq_u32 s23, 0
    s_cbranch_scc1 Lwt_57
    buffer_store_dwordx4 v[128:131], v0, s[16:19], s47 offen offset:1024
Lwt_58:
Lif_56:
    s_waitcnt vmcnt(13)
    s_bitcmp1_b32 1, s22
    s_cbranch_scc1 Lvm_59
    s_waitcnt vmcnt(11)
    s_bitcmp1_b32 2, s22
    s_cbranch_scc1 Lvm_59
    s_waitcnt vmcnt(10)
Lvm_59:
    s_barrier
    buffer_load_dwordx4 v[72:75], v189, s[12:15], 0 offen sc1
    s_bfe_u32 s27, s75, 262156
    s_lshl_b32 s84, s27, s77
    s_mul_i32 s85, s27, 393216
    s_add_u32 m0, s78, 16384
    s_nop 0
    buffer_load_dwordx4 v8, s[88:91], s84 offen offset:0 sc1 lds
    buffer_load_dwordx4 v9, s[88:91], s84 offen offset:1024 sc1 lds
    buffer_load_dwordx4 v10, s[88:91], s84 offen offset:2048 sc1 lds
    buffer_load_dwordx4 v11, s[88:91], s84 offen offset:3072 sc1 lds
    s_add_u32 m0, s79, 73728
    s_buffer_load_dwordx2 s[38:39], s[8:11], s35 offset:8252
    s_buffer_load_dwordx2 s[38:39], s[8:11], s35 offset:20540
    s_bfe_u32 s37, s45, 262164
    buffer_load_dwordx4 v12, s[4:7], s85 offen offset:0 lds
    buffer_load_dwordx4 v13, s[4:7], s85 offen offset:1024 lds
    s_add_u32 m0, s79, 114688
    s_mul_i32 s37, s37, 393216
    s_add_u32 s37, s37, s46
    s_buffer_load_dwordx2 s[38:39], s[4:7], s37 offset:60
    buffer_load_dwordx4 v14, s[4:7], s85 offen offset:0 lds
    buffer_load_dwordx4 v15, s[4:7], s85 offen offset:1024 lds
    s_add_u32 m0, s79, 122880
    s_buffer_load_dwordx2 s[38:39], s[4:7], s37 offset:2108
    s_buffer_load_dwordx2 s[38:39], s[4:7], s37 offset:4156
    buffer_load_dwordx4 v16, s[4:7], s85 offen offset:0 lds
    buffer_load_dwordx4 v17, s[4:7], s85 offen offset:1024 lds
    s_cmp_eq_u32 s22, 0
    s_cbranch_scc0 Lif_60
    s_cmp_eq_u32 s23, 0
    s_cbranch_scc1 Lwt_61
    buffer_store_dwordx4 v[128:131], v0, s[16:19], s47 offen offset:2048
Lwt_62:
Lif_60:
    s_waitcnt vmcnt(13)
    s_bitcmp1_b32 1, s22
    s_cbranch_scc1 Lvm_63
    s_waitcnt vmcnt(11)
Lvm_63:
    s_barrier
    s_cmp_lt_u32 s22, 2
    s_cbranch_scc0 Lon_64
    buffer_load_dwordx2 v[244:245], v200, s[12:15], 0 offen sc1
Lon_64:
    s_bfe_u32 s27, s75, 262160
    s_lshl_b32 s84, s27, s77
    s_mul_i32 s85, s27, 393216
    s_add_u32 m0, s78, 32768
    s_nop 0
    buffer_load_dwordx4 v8, s[88:91], s84 offen offset:0 sc1 lds
    buffer_load_dwordx4 v9, s[88:91], s84 offen offset:1024 sc1 lds
    buffer_load_dwordx4 v10, s[88:91], s84 offen offset:2048 sc1 lds
    buffer_load_dwordx4 v11, s[88:91], s84 offen offset:3072 sc1 lds
    s_add_u32 m0, s79, 81920
    s_buffer_load_dwordx2 s[38:39], s[8:11], s35 offset:10300
    s_buffer_load_dwordx2 s[38:39], s[8:11], s35 offset:22588
    s_bfe_u32 s37, s45, 262168
    buffer_load_dwordx4 v12, s[4:7], s85 offen offset:0 lds
    buffer_load_dwordx4 v13, s[4:7], s85 offen offset:1024 lds
    s_add_u32 m0, s79, 49152
    s_mul_i32 s37, s37, 393216
    s_add_u32 s37, s37, s46
    s_buffer_load_dwordx2 s[38:39], s[4:7], s37 offset:60
    buffer_load_dwordx4 v14, s[4:7], s85 offen offset:0 lds
    buffer_load_dwordx4 v15, s[4:7], s85 offen offset:1024 lds
    s_add_u32 m0, s79, 57344
    s_buffer_load_dwordx2 s[38:39], s[4:7], s37 offset:2108
    s_buffer_load_dwordx2 s[38:39], s[4:7], s37 offset:4156
    buffer_load_dwordx4 v16, s[4:7], s85 offen offset:0 lds
    buffer_load_dwordx4 v17, s[4:7], s85 offen offset:1024 lds
    s_cmp_eq_u32 s22, 0
    s_cbranch_scc0 Lif_65
    s_cmp_eq_u32 s23, 0
    s_cbranch_scc1 Lwt_66
    buffer_store_dwordx4 v[128:131], v0, s[16:19], s47 offen offset:3072
Lwt_67:
Lif_65:
    s_waitcnt vmcnt(13)
    s_bitcmp1_b32 1, s22
    s_cbranch_scc1 Lvm_68
    s_waitcnt vmcnt(11)
    s_bitcmp1_b32 2, s22
    s_cbranch_scc1 Lvm_68
    s_waitcnt vmcnt(10)
Lvm_68:
    s_barrier
    s_cmp_lt_u32 s22, 2
    s_cbranch_scc0 Lif_69
    s_waitcnt vmcnt(11)
    s_bitcmp1_b32 1, s22
    s_cbranch_scc1 Lvm_70
    s_waitcnt vmcnt(10)
Lvm_70:
    v_xor_b32 v246, s24, v244
    v_xor_b32 v247, s25, v245
    v_lshrrev_b32 v247, 4, v247
    v_or_b32 v246, v246, v247
    v_cmp_ne_u32 vcc, 0, v246
    s_nop 0
    s_cbranch_vccnz Lpoll_71
Lok_72:
    buffer_load_dwordx4 v[88:91], v193, s[12:15], 0 offen offset:0 sc1
    buffer_load_dwordx4 v[92:95], v193, s[12:15], 0 offen offset:768 sc1
    buffer_load_dwordx4 v[96:99], v193, s[12:15], 0 offen offset:1536 sc1
    buffer_load_dwordx4 v[100:103], v193, s[12:15], 0 offen offset:2304 sc1
Lif_69:
    s_bfe_u32 s27, s75, 262164
    s_lshl_b32 s84, s27, s77
    s_mul_i32 s85, s27, 393216
    s_add_u32 m0, s78, 0
    s_nop 0
    buffer_load_dwordx4 v8, s[88:91], s84 offen offset:0 sc1 lds
    buffer_load_dwordx4 v9, s[88:91], s84 offen offset:1024 sc1 lds
    buffer_load_dwordx4 v10, s[88:91], s84 offen offset:2048 sc1 lds
    buffer_load_dwordx4 v11, s[88:91], s84 offen offset:3072 sc1 lds
    v_xor_b32 v76, s24, v74
    v_xor_b32 v77, s25, v75
    v_lshrrev_b32 v77, 4, v77
    v_or_b32 v76, v76, v77
    v_cmp_ne_u32 vcc, 0, v76
    s_nop 0
    s_cbranch_vccnz Lrt_73
Lok_74:
    s_add_u32 m0, s79, 65536
    v_add_u32 v76, 90112, v192
    v_add_u32 v77, v76, v192
    ds_write_b32 v76, v72
    ds_write_b32 v76, v73 offset:512
    buffer_load_dwordx4 v12, s[4:7], s85 offen offset:0 lds
    buffer_load_dwordx4 v13, s[4:7], s85 offen offset:1024 lds
    s_add_u32 m0, s79, 98304
    ds_write_b64 v77, v[72:73] offset:1024
    s_bfe_u32 s37, s45, 262172
    s_mul_i32 s37, s37, 393216
    s_add_u32 s37, s37, s46
    buffer_load_dwordx4 v14, s[4:7], s85 offen offset:0 lds
    buffer_load_dwordx4 v15, s[4:7], s85 offen offset:1024 lds
    s_add_u32 m0, s79, 106496
    s_buffer_load_dwordx2 s[38:39], s[4:7], s37 offset:60
    s_buffer_load_dwordx2 s[38:39], s[4:7], s37 offset:2108
    s_buffer_load_dwordx2 s[38:39], s[4:7], s37 offset:4156
    buffer_load_dwordx4 v16, s[4:7], s85 offen offset:0 lds
    buffer_load_dwordx4 v17, s[4:7], s85 offen offset:1024 lds
    s_waitcnt vmcnt(15)
    s_bitcmp1_b32 1, s22
    s_cbranch_scc1 Lvm_75
    s_waitcnt vmcnt(14)
    s_bitcmp1_b32 2, s22
    s_cbranch_scc1 Lvm_75
    s_waitcnt vmcnt(10)
Lvm_75:
    s_barrier
    s_bfe_u32 s27, s75, 262168
    s_lshl_b32 s84, s27, s77
    s_mul_i32 s85, s27, 393216
    s_add_u32 m0, s78, 16384
    s_nop 0
    buffer_load_dwordx4 v8, s[88:91], s84 offen offset:0 sc1 lds
    buffer_load_dwordx4 v9, s[88:91], s84 offen offset:1024 sc1 lds
    buffer_load_dwordx4 v10, s[88:91], s84 offen offset:2048 sc1 lds
    buffer_load_dwordx4 v11, s[88:91], s84 offen offset:3072 sc1 lds
    s_add_u32 m0, s79, 73728
    s_nop 0
    buffer_load_dwordx4 v12, s[4:7], s85 offen offset:0 lds
    buffer_load_dwordx4 v13, s[4:7], s85 offen offset:1024 lds
    s_add_u32 m0, s79, 114688
    s_nop 0
    buffer_load_dwordx4 v14, s[4:7], s85 offen offset:0 lds
    buffer_load_dwordx4 v15, s[4:7], s85 offen offset:1024 lds
    s_add_u32 m0, s79, 122880
    s_nop 0
    buffer_load_dwordx4 v16, s[4:7], s85 offen offset:0 lds
    buffer_load_dwordx4 v17, s[4:7], s85 offen offset:1024 lds
    s_waitcnt vmcnt(10)
    s_barrier
    s_bfe_u32 s27, s75, 262172
    s_lshl_b32 s84, s27, s77
    s_mul_i32 s85, s27, 393216
    s_add_u32 m0, s78, 32768
    s_nop 0
    buffer_load_dwordx4 v8, s[88:91], s84 offen offset:0 sc1 lds
    buffer_load_dwordx4 v9, s[88:91], s84 offen offset:1024 sc1 lds
    buffer_load_dwordx4 v10, s[88:91], s84 offen offset:2048 sc1 lds
    buffer_load_dwordx4 v11, s[88:91], s84 offen offset:3072 sc1 lds
    s_cmp_lt_u32 s22, 2
    s_cbranch_scc0 Lif_77
    v_pk_add_f32 v[88:89], v[88:89], v[96:97]
    v_pk_add_f32 v[90:91], v[90:91], v[98:99]
    v_pk_add_f32 v[92:93], v[92:93], v[100:101]
    v_pk_add_f32 v[94:95], v[94:95], v[102:103]
    v_pk_add_f32 v[232:233], v[88:89], v[92:93]
    v_pk_add_f32 v[234:235], v[90:91], v[94:95]
    v_mov_b32 v88, v232
    v_mov_b32 v89, v233
    v_mov_b32 v90, v234
    v_mov_b32 v91, v235
    v_permlane16_swap_b32 v232, v88
    v_permlane16_swap_b32 v233, v89
    v_permlane16_swap_b32 v234, v90
    v_permlane16_swap_b32 v235, v91
    v_pk_add_f32 v[232:233], v[232:233], v[88:89]
    v_pk_add_f32 v[234:235], v[234:235], v[90:91]
    v_mov_b32 v88, v232
    v_mov_b32 v89, v233
    v_mov_b32 v90, v234
    v_mov_b32 v91, v235
    v_permlane32_swap_b32 v232, v88
    v_permlane32_swap_b32 v233, v89
    v_permlane32_swap_b32 v234, v90
    v_permlane32_swap_b32 v235, v91
    v_pk_add_f32 v[232:233], v[232:233], v[88:89]
    v_pk_add_f32 v[234:235], v[234:235], v[90:91]
Lif_77:
    v_add_u32 v76, 92160, v194
    v_mov_b32 v77, s23
    v_mov_b32 v78, 92928
    ds_write_b128 v76, v[232:235]
    ds_write_b32 v78, v77
    s_add_u32 m0, s79, 81920
    s_nop 0
    buffer_load_dwordx4 v12, s[4:7], s85 offen offset:0 lds
    buffer_load_dwordx4 v13, s[4:7], s85 offen offset:1024 lds
    s_add_u32 m0, s79, 49152
    s_nop 0
    buffer_load_dwordx4 v14, s[4:7], s85 offen offset:0 lds
    buffer_load_dwordx4 v15, s[4:7], s85 offen offset:1024 lds
    s_add_u32 m0, s79, 57344
    s_nop 0
    buffer_load_dwordx4 v16, s[4:7], s85 offen offset:0 lds
    buffer_load_dwordx4 v17, s[4:7], s85 offen offset:1024 lds
    s_waitcnt lgkmcnt(0)
    s_bitcmp1_b32 s22, 0
    s_cbranch_scc1 L_lB
    s_and_b32 s27, s20, 1
    s_lshl_b32 s27, s27, 2
    s_add_u32 s27, s27, s87
    s_lshl_b32 s27, s27, 13
    s_lshl_b32 s28, s21, 7
    s_add_u32 s27, s27, s28
    s_add_u32 s35, s27, s99
    s_xor_b32 s27, s35, 0
    s_buffer_load_dwordx2 s[38:39], s[8:11], s27 offset:60
    s_buffer_load_dwordx2 s[38:39], s[8:11], s27 offset:2108
    s_buffer_load_dwordx2 s[38:39], s[8:11], s27 offset:4156
    s_buffer_load_dwordx2 s[38:39], s[8:11], s27 offset:6204
    s_cmp_eq_u32 s22, 0
    s_cbranch_scc0 Lif_78
    s_mov_b64 s[88:89], s[40:41]
    v_lshrrev_b32 v14, 3, v1
    v_and_b32 v15, 6, v14
    v_and_b32 v16, 7, v1
    v_xor_b32 v15, v15, v16
    s_lshl_b32 s27, s87, 4
    s_mul_i32 s27, s27, 6144
    s_lshl_b32 s28, s21, 7
    s_add_u32 s27, s27, s28
    v_mul_u32_u24 v14, 6144, v14
    v_lshlrev_b32 v15, 4, v15
    v_add3_u32 v12, v14, v15, s27
    v_add_u32 v13, 48128, v12
    v_add_u32 v14, 2048, v12
    v_add_u32 v15, 50176, v12
    v_add_u32 v16, 4096, v12
    v_add_u32 v17, 52224, v12
Lif_78:
    s_waitcnt vmcnt(10)
    s_barrier
    s_xor_b32 s27, s35, 65536
    s_buffer_load_dwordx2 s[38:39], s[8:11], s27 offset:60
    s_buffer_load_dwordx2 s[38:39], s[8:11], s27 offset:2108
    s_buffer_load_dwordx2 s[38:39], s[8:11], s27 offset:4156
    s_buffer_load_dwordx2 s[38:39], s[8:11], s27 offset:6204
    s_waitcnt vmcnt(0)
    s_barrier
    v_add_u32 v188, 8192, v188
    v_add_u32 v190, 8192, v190
    s_cmp_eq_u32 s87, 0
    s_cbranch_scc0 Lif_81
    v_mov_b32 v240, s24
    v_mov_b32 v241, s25
    s_mov_b64 exec, 1
    s_cmp_eq_u32 s23, 0
    s_cbranch_scc1 Lwt_82
    buffer_store_dwordx2 v[240:241], v190, s[12:15], 0 offen
Lwt_83:
    s_mov_b64 exec, -1
Lif_81:
    s_xor_b32 s27, s35, 1048576
    s_buffer_load_dwordx2 s[38:39], s[8:11], s27 offset:60
    s_buffer_load_dwordx2 s[38:39], s[8:11], s27 offset:2108
    s_buffer_load_dwordx2 s[38:39], s[8:11], s27 offset:4156
    s_buffer_load_dwordx2 s[38:39], s[8:11], s27 offset:6204
    s_barrier
    v_swap_b32 v232, v236
    v_swap_b32 v233, v237
    v_swap_b32 v234, v238
    v_swap_b32 v235, v239
    v_and_b32 v224, 15, v1
    v_lshrrev_b32 v225, 4, v1
    v_lshlrev_b32 v225, 2, v225
    v_sub_u32 v224, v224, v225
    s_cmp_lt_u32 s20, 2
    s_cselect_b32 s27, 0, -1
    v_subrev_u32 v216, 0, v224
    v_subrev_u32 v217, 1, v224
    v_subrev_u32 v218, 2, v224
    v_subrev_u32 v219, 3, v224
    v_ashrrev_i32 v216, 31, v216
    v_ashrrev_i32 v217, 31, v217
    v_ashrrev_i32 v218, 31, v218
    v_ashrrev_i32 v219, 31, v219
    v_and_b32 v216, 4048155338, v216
    v_and_b32 v217, 4048155338, v217
    v_and_b32 v218, 4048155338, v218
    v_and_b32 v219, 4048155338, v219
    v_and_b32 v220, s27, v216
    v_and_b32 v221, s27, v217
    v_and_b32 v222, s27, v218
    v_and_b32 v223, s27, v219
    v_xor_b32 v220, 4048155338, v220
    v_xor_b32 v221, 4048155338, v221
    v_xor_b32 v222, 4048155338, v222
    v_xor_b32 v223, 4048155338, v223
    v_mov_b32 v224, 0
    v_mov_b32 v225, 0
    v_mov_b32 v226, 0
    v_mov_b32 v227, 0
    v_add_u32 v128, s54, v0
    s_and_b32 s28, s54, 4096
    s_add_u32 s28, s28, 32768
    v_add_u32 v129, s28, v0
    s_lshl_b32 s28, s3, 12
    s_add_u32 s28, s28, 32768
    v_add_u32 v130, s28, v0
    v_add_u32 v4, 15360, v3
    v_add_u32 v5, 30720, v3
    v_add_u32 v211, 46080, v3
    s_xor_b32 s27, s35, 1114112
    s_buffer_load_dwordx2 s[38:39], s[8:11], s27 offset:60
    s_buffer_load_dwordx2 s[38:39], s[8:11], s27 offset:2108
    s_buffer_load_dwordx2 s[38:39], s[8:11], s27 offset:4156
    s_buffer_load_dwordx2 s[38:39], s[8:11], s27 offset:6204
    s_xor_b32 s27, s35, 131072
    s_buffer_load_dwordx2 s[38:39], s[8:11], s27 offset:60
    s_buffer_load_dwordx2 s[38:39], s[8:11], s27 offset:2108
    s_buffer_load_dwordx2 s[38:39], s[8:11], s27 offset:4156
    s_buffer_load_dwordx2 s[38:39], s[8:11], s27 offset:6204
    s_xor_b32 s27, s35, 196608
    s_buffer_load_dwordx2 s[38:39], s[8:11], s27 offset:60
    s_buffer_load_dwordx2 s[38:39], s[8:11], s27 offset:2108
    s_buffer_load_dwordx2 s[38:39], s[8:11], s27 offset:4156
    s_buffer_load_dwordx2 s[38:39], s[8:11], s27 offset:6204
    s_xor_b32 s27, s35, 1179648
    s_buffer_load_dwordx2 s[38:39], s[8:11], s27 offset:60
    s_buffer_load_dwordx2 s[38:39], s[8:11], s27 offset:2108
    s_buffer_load_dwordx2 s[38:39], s[8:11], s27 offset:4156
    s_buffer_load_dwordx2 s[38:39], s[8:11], s27 offset:6204
    s_xor_b32 s27, s35, 1245184
    s_buffer_load_dwordx2 s[38:39], s[8:11], s27 offset:60
    s_buffer_load_dwordx2 s[38:39], s[8:11], s27 offset:2108
    s_buffer_load_dwordx2 s[38:39], s[8:11], s27 offset:4156
    s_buffer_load_dwordx2 s[38:39], s[8:11], s27 offset:6204
    s_xor_b32 s27, s35, 262144
    s_buffer_load_dwordx2 s[38:39], s[8:11], s27 offset:60
    s_buffer_load_dwordx2 s[38:39], s[8:11], s27 offset:2108
    s_buffer_load_dwordx2 s[38:39], s[8:11], s27 offset:4156
    s_buffer_load_dwordx2 s[38:39], s[8:11], s27 offset:6204
    s_xor_b32 s27, s35, 327680
    s_buffer_load_dwordx2 s[38:39], s[8:11], s27 offset:60
    s_buffer_load_dwordx2 s[38:39], s[8:11], s27 offset:2108
    s_buffer_load_dwordx2 s[38:39], s[8:11], s27 offset:4156
    s_buffer_load_dwordx2 s[38:39], s[8:11], s27 offset:6204
    s_xor_b32 s27, s35, 1310720
    s_buffer_load_dwordx2 s[38:39], s[8:11], s27 offset:60
    s_buffer_load_dwordx2 s[38:39], s[8:11], s27 offset:2108
    s_buffer_load_dwordx2 s[38:39], s[8:11], s27 offset:4156
    s_buffer_load_dwordx2 s[38:39], s[8:11], s27 offset:6204
    s_lshl_b32 s27, s22, 4
    s_add_u32 s27, s27, s21
    s_lshl_b32 s27, s27, 11
    s_add_u32 s27, s27, 786432
    v_bfe_u32 v73, v1, 2, 1
    v_add_u32 v73, s20, v73
    v_subrev_u32 v73, 2, v73
    v_min_u32 v73, s20, v73
    v_and_b32 v74, 3, v1
    v_lshl_add_u32 v73, v73, 4, v74
    v_lshl_add_u32 v73, v73, 3, s27
    v_cmp_gt_u32 vcc, 16, v1
    s_nop 1
    v_cndmask_b32 v73, v188, v73, vcc
    s_cmp_lt_u32 s20, 2
    s_cselect_b32 s27, 0, 2097152
    s_sub_u32 s27, s97, s27
    s_lshl_b32 s28, s21, 15
    s_add_u32 s27, s27, s28
    s_lshl_b32 s28, s87, 13
    s_add_u32 s27, s27, s28
    s_add_u32 s29, s27, 524288
    s_add_u32 s30, s27, 528384
    buffer_load_dwordx2 v[74:75], v73, s[12:15], 0 offen sc1
    s_waitcnt vmcnt(0)
    v_xor_b32 v76, s24, v74
    v_xor_b32 v77, s25, v75
    v_lshrrev_b32 v77, 4, v77
    v_or_b32 v76, v76, v77
    v_cmp_ne_u32 vcc, 0, v76
    s_nop 0
    s_cbranch_vccnz Lpoll_84
Lok_85:
    s_cmp_eq_u32 s23, 0
    s_cbranch_scc0 Lif_86
    buffer_inv sc1
    s_waitcnt vmcnt(0)
Lif_86:
    s_add_u32 m0, s28, 98304
    s_nop 0
    buffer_load_dwordx4 v0, s[12:15], s29 offen offset:0 sc1 lds
    buffer_load_dwordx4 v0, s[12:15], s29 offen offset:1024 sc1 lds
    buffer_load_dwordx4 v0, s[12:15], s29 offen offset:2048 sc1 lds
    buffer_load_dwordx4 v0, s[12:15], s29 offen offset:3072 sc1 lds
    s_add_u32 m0, s28, 102400
    s_nop 0
    buffer_load_dwordx4 v0, s[12:15], s30 offen offset:0 sc1 lds
    buffer_load_dwordx4 v0, s[12:15], s30 offen offset:1024 sc1 lds
    buffer_load_dwordx4 v0, s[12:15], s30 offen offset:2048 sc1 lds
    buffer_load_dwordx4 v0, s[12:15], s30 offen offset:3072 sc1 lds
    s_waitcnt vmcnt(0)
    s_setprio 1
    s_branch L_attA
L_lB:
    s_waitcnt vmcnt(10)
    s_barrier
    s_lshl_b32 m0, s87, 10
    s_add_u32 m0, m0, 0
    s_xor_b32 s36, s99, 0
    buffer_load_dwordx4 v20, s[8:11], s36 offen lds
    s_lshl_b32 m0, s87, 10
    s_add_u32 m0, m0, 4096
    s_xor_b32 s36, s99, 65536
    buffer_load_dwordx4 v20, s[8:11], s36 offen lds
    s_lshl_b32 m0, s87, 10
    s_add_u32 m0, m0, 8192
    s_xor_b32 s36, s99, 1048576
    buffer_load_dwordx4 v20, s[8:11], s36 offen lds
    s_lshl_b32 m0, s87, 10
    s_add_u32 m0, m0, 12288
    s_xor_b32 s36, s99, 1114112
    buffer_load_dwordx4 v20, s[8:11], s36 offen lds
    s_lshl_b32 m0, s87, 10
    s_add_u32 m0, m0, 65536
    s_xor_b32 s36, s99, 262144
    buffer_load_dwordx4 v20, s[8:11], s36 offen lds
    s_lshl_b32 m0, s87, 10
    s_add_u32 m0, m0, 69632
    s_xor_b32 s36, s99, 327680
    buffer_load_dwordx4 v20, s[8:11], s36 offen lds
    s_lshl_b32 m0, s87, 10
    s_add_u32 m0, m0, 98304
    s_xor_b32 s36, s99, 524288
    buffer_load_dwordx4 v20, s[8:11], s36 offen lds
    s_lshl_b32 m0, s87, 10
    s_add_u32 m0, m0, 102400
    s_xor_b32 s36, s99, 589824
    buffer_load_dwordx4 v20, s[8:11], s36 offen lds
    s_lshl_b32 m0, s87, 10
    s_add_u32 m0, m0, 106496
    s_xor_b32 s36, s99, 1572864
    buffer_load_dwordx4 v20, s[8:11], s36 offen lds
    s_lshl_b32 m0, s87, 10
    s_add_u32 m0, m0, 110592
    s_xor_b32 s36, s99, 1638400
    buffer_load_dwordx4 v20, s[8:11], s36 offen lds
    s_waitcnt vmcnt(10)
    s_barrier
    v_add_u32 v188, 8192, v188
    v_add_u32 v190, 8192, v190
    s_cmp_eq_u32 s87, 0
    s_cbranch_scc0 Lif_89
    v_mov_b32 v240, s24
    v_mov_b32 v241, s25
    s_mov_b64 exec, 1
    s_cmp_eq_u32 s23, 0
    s_cbranch_scc1 Lwt_90
    buffer_store_dwordx2 v[240:241], v190, s[12:15], 0 offen
Lwt_91:
    s_mov_b64 exec, -1
Lif_89:
    s_lshl_b32 m0, s87, 10
    s_add_u32 m0, m0, 16384
    s_xor_b32 s36, s99, 131072
    buffer_load_dwordx4 v20, s[8:11], s36 offen lds
    s_lshl_b32 m0, s87, 10
    s_add_u32 m0, m0, 20480
    s_xor_b32 s36, s99, 196608
    buffer_load_dwordx4 v20, s[8:11], s36 offen lds
    s_lshl_b32 m0, s87, 10
    s_add_u32 m0, m0, 24576
    s_xor_b32 s36, s99, 1179648
    buffer_load_dwordx4 v20, s[8:11], s36 offen lds
    s_lshl_b32 m0, s87, 10
    s_add_u32 m0, m0, 28672
    s_xor_b32 s36, s99, 1245184
    buffer_load_dwordx4 v20, s[8:11], s36 offen lds
    s_lshl_b32 m0, s87, 10
    s_add_u32 m0, m0, 73728
    s_xor_b32 s36, s99, 1310720
    buffer_load_dwordx4 v20, s[8:11], s36 offen lds
    s_lshl_b32 m0, s87, 10
    s_add_u32 m0, m0, 77824
    s_xor_b32 s36, s99, 1376256
    buffer_load_dwordx4 v20, s[8:11], s36 offen lds
    s_lshl_b32 m0, s87, 10
    s_add_u32 m0, m0, 114688
    s_xor_b32 s36, s99, 655360
    buffer_load_dwordx4 v20, s[8:11], s36 offen lds
    s_lshl_b32 m0, s87, 10
    s_add_u32 m0, m0, 118784
    s_xor_b32 s36, s99, 720896
    buffer_load_dwordx4 v20, s[8:11], s36 offen lds
    s_lshl_b32 m0, s87, 10
    s_add_u32 m0, m0, 122880
    s_xor_b32 s36, s99, 1703936
    buffer_load_dwordx4 v20, s[8:11], s36 offen lds
    s_lshl_b32 m0, s87, 10
    s_add_u32 m0, m0, 126976
    s_xor_b32 s36, s99, 1769472
    buffer_load_dwordx4 v20, s[8:11], s36 offen lds
    s_barrier
    s_lshl_b32 m0, s87, 10
    s_add_u32 m0, m0, 81920
    s_xor_b32 s36, s99, 393216
    buffer_load_dwordx4 v20, s[8:11], s36 offen lds
    s_lshl_b32 m0, s87, 10
    s_add_u32 m0, m0, 86016
    s_xor_b32 s36, s99, 458752
    buffer_load_dwordx4 v20, s[8:11], s36 offen lds
    s_lshl_b32 m0, s87, 10
    s_add_u32 m0, m0, 131072
    s_xor_b32 s36, s99, 786432
    buffer_load_dwordx4 v20, s[8:11], s36 offen lds
    s_lshl_b32 m0, s87, 10
    s_add_u32 m0, m0, 135168
    s_xor_b32 s36, s99, 851968
    buffer_load_dwordx4 v20, s[8:11], s36 offen lds
    s_lshl_b32 m0, s87, 10
    s_add_u32 m0, m0, 139264
    s_xor_b32 s36, s99, 1835008
    buffer_load_dwordx4 v20, s[8:11], s36 offen lds
    s_lshl_b32 m0, s87, 10
    s_add_u32 m0, m0, 143360
    s_xor_b32 s36, s99, 1900544
    buffer_load_dwordx4 v20, s[8:11], s36 offen lds
    s_lshl_b32 m0, s87, 10
    s_add_u32 m0, m0, 147456
    s_xor_b32 s36, s99, 917504
    buffer_load_dwordx4 v20, s[8:11], s36 offen lds
    s_lshl_b32 m0, s87, 10
    s_add_u32 m0, m0, 151552
    s_xor_b32 s36, s99, 983040
    buffer_load_dwordx4 v20, s[8:11], s36 offen lds
    s_lshl_b32 m0, s87, 10
    s_add_u32 m0, m0, 155648
    s_xor_b32 s36, s99, 1966080
    buffer_load_dwordx4 v20, s[8:11], s36 offen lds
    s_lshl_b32 m0, s87, 10
    s_add_u32 m0, m0, 159744
    s_xor_b32 s36, s99, 2031616
    buffer_load_dwordx4 v20, s[8:11], s36 offen lds
    v_swap_b32 v232, v236
    v_swap_b32 v233, v237
    v_swap_b32 v234, v238
    v_swap_b32 v235, v239
    buffer_load_dwordx2 v[244:245], v188, s[12:15], 0 offen sc1
    s_lshl_b32 s27, s87, 10
    s_add_u32 s28, s27, 49152
    v_add_u32 v72, s28, v0
    v_mov_b32 v32, 0
    v_mov_b32 v33, 0
    v_mov_b32 v34, 0
    v_mov_b32 v35, 0
    s_cmp_lg_u32 s20, 0
    s_cbranch_scc0 Lif_92
    s_lshr_b32 s28, s22, 1
    s_lshl_b32 s28, s28, 4
    s_add_u32 s28, s28, s21
    s_lshl_b32 s28, s28, 12
    s_add_u32 s27, s27, s28
    s_add_u32 s27, s27, s97
    s_sub_u32 s27, s27, 1048576
    buffer_load_dwordx4 v[32:35], v0, s[12:15], s27 offen sc1
    s_waitcnt vmcnt(0)
    v_cmp_eq_u32 vcc, -1, v32
    s_nop 0
    s_cbranch_vccnz Lrt_93
Lok_94:
Lif_92:
    ds_write_b128 v72, v[32:35]
    s_waitcnt vmcnt(0)
    v_xor_b32 v246, s24, v244
    v_xor_b32 v247, s25, v245
    v_lshrrev_b32 v247, 4, v247
    v_or_b32 v246, v246, v247
    v_cmp_ne_u32 vcc, 0, v246
    s_nop 0
    s_cbranch_vccnz Lpoll_95
Lok_96:
    s_cmp_eq_u32 s23, 0
    s_cbranch_scc0 Lif_97
    buffer_inv sc1
    s_waitcnt vmcnt(0)
Lif_97:
    s_waitcnt lgkmcnt(0)
    s_barrier
    s_lshl_b32 m0, s87, 10
    s_add_u32 m0, m0, 90112
    s_xor_b32 s36, s99, 1441792
    buffer_load_dwordx4 v20, s[8:11], s36 offen lds
    s_lshl_b32 m0, s87, 10
    s_add_u32 m0, m0, 94208
    s_xor_b32 s36, s99, 1507328
    buffer_load_dwordx4 v20, s[8:11], s36 offen lds
    s_branch L_lnext
L_lnext:
    s_add_u32 s22, s22, 1
    s_setprio 0
    s_cmp_eq_u32 s22, 4
    s_cbranch_scc1 L_lfinal
    s_bitcmp1_b32 s22, 0
    s_cselect_b32 s8, s58, s52
    s_cselect_b32 s9, s59, s53
    s_cselect_b32 s4, s56, s50
    s_cselect_b32 s5, s57, s51
    s_cselect_b32 s92, s50, s56
    s_cselect_b32 s93, s51, s57
    s_xor_b64 s[88:89], s[88:89], s[16:17]
    s_xor_b64 s[16:17], s[88:89], s[16:17]
    s_xor_b64 s[88:89], s[88:89], s[16:17]
    s_bfe_u32 s27, s100, 262144
    s_lshl_b32 s27, s27, 2
    s_add_u32 s27, s27, s87
    s_lshl_b32 s27, s27, 1
    s_and_b32 s28, s20, 1
    s_add_u32 s27, s27, s28
    s_mul_i32 s27, s27, 49152
    s_lshl_b32 s28, s21, 7
    s_add_u32 s27, s27, s28
    s_buffer_load_dwordx2 s[38:39], s[4:7], s27 offset:60
    s_buffer_load_dwordx2 s[38:39], s[4:7], s27 offset:2108
    s_buffer_load_dwordx2 s[38:39], s[4:7], s27 offset:4156
    s_buffer_load_dwordx2 s[38:39], s[4:7], s27 offset:6204
    s_buffer_load_dwordx2 s[38:39], s[4:7], s27 offset:8252
    s_buffer_load_dwordx2 s[38:39], s[4:7], s27 offset:10300
    s_buffer_load_dwordx2 s[38:39], s[4:7], s27 offset:12348
    s_buffer_load_dwordx2 s[38:39], s[4:7], s27 offset:14396
    s_buffer_load_dwordx2 s[38:39], s[4:7], s27 offset:16444
    s_buffer_load_dwordx2 s[38:39], s[4:7], s27 offset:18492
    s_buffer_load_dwordx2 s[38:39], s[4:7], s27 offset:20540
    s_buffer_load_dwordx2 s[38:39], s[4:7], s27 offset:22588
    s_buffer_load_dwordx2 s[38:39], s[4:7], s27 offset:24636
    s_buffer_load_dwordx2 s[38:39], s[4:7], s27 offset:26684
    s_buffer_load_dwordx2 s[38:39], s[4:7], s27 offset:28732
    s_buffer_load_dwordx2 s[38:39], s[4:7], s27 offset:30780
    s_buffer_load_dwordx2 s[38:39], s[4:7], s27 offset:32828
    s_buffer_load_dwordx2 s[38:39], s[4:7], s27 offset:34876
    s_buffer_load_dwordx2 s[38:39], s[4:7], s27 offset:36924
    s_buffer_load_dwordx2 s[38:39], s[4:7], s27 offset:38972
    s_buffer_load_dwordx2 s[38:39], s[4:7], s27 offset:41020
    s_buffer_load_dwordx2 s[38:39], s[4:7], s27 offset:43068
    s_buffer_load_dwordx2 s[38:39], s[4:7], s27 offset:45116
    s_buffer_load_dwordx2 s[38:39], s[4:7], s27 offset:47164
    v_add_u32 v188, 4294961152, v188
    v_add_u32 v190, 4294961152, v190
    v_add_u32 v189, 32768, v189
    v_add_u32 v202, 32768, v202
    s_mov_b32 s86, 99
    s_cmp_eq_u32 s22, 1
    s_cbranch_scc0 Lif_98
    v_add_u32 v200, 8192, v200
    v_add_u32 v201, 8192, v201
    v_add_u32 v193, 196608, v193
    v_add_u32 v199, 196608, v199
    s_and_b32 s86, s20, 1
    s_add_u32 s86, s86, 3
    s_add_u32 s27, s20, s22
    s_cmp_eq_u32 s27, 16
    s_cselect_b32 s86, 0, s86
    s_cmp_eq_u32 s86, 4
    s_mov_b32 s28, 81920
    s_cselect_b32 s28, 65536, s28
    s_mov_b32 s29, 40960
    s_cselect_b32 s29, 90112, s29
    s_mul_i32 s27, s87, 3
    s_add_u32 s27, s27, 0
    s_and_b32 s30, s27, 3
    s_lshl_b32 s30, s30, 5
    v_xor_b32 v196, s30, v2
    s_lshr_b32 s27, s27, 2
    s_lshl_b32 s30, s27, 13
    s_add_u32 s30, s30, s29
    s_cmp_eq_u32 s27, 0
    s_cselect_b32 s30, s28, s30
    v_add_u32 v196, s30, v196
    s_mul_i32 s27, s87, 3
    s_add_u32 s27, s27, 1
    s_and_b32 s30, s27, 3
    s_lshl_b32 s30, s30, 5
    v_xor_b32 v197, s30, v2
    s_lshr_b32 s27, s27, 2
    s_lshl_b32 s30, s27, 13
    s_add_u32 s30, s30, s29
    s_cmp_eq_u32 s27, 0
    s_cselect_b32 s30, s28, s30
    v_add_u32 v197, s30, v197
    s_mul_i32 s27, s87, 3
    s_add_u32 s27, s27, 2
    s_and_b32 s30, s27, 3
    s_lshl_b32 s30, s30, 5
    v_xor_b32 v198, s30, v2
    s_lshr_b32 s27, s27, 2
    s_lshl_b32 s30, s27, 13
    s_add_u32 s30, s30, s29
    s_cmp_eq_u32 s27, 0
    s_cselect_b32 s30, s28, s30
    v_add_u32 v198, s30, v198
    s_lshl_b32 s27, s20, 2
    s_add_u32 s27, s27, s87
    s_lshl_b32 s27, s27, 16
    v_add_u32 v8, s27, v0
    v_add_u32 v9, s27, v0
    v_add_u32 v10, s27, v0
    v_add_u32 v11, s27, v0
    s_mov_b64 s[74:75], s[100:101]
    s_mov_b32 s77, 12
Lif_98:
    s_lshr_b32 s27, s4, 7
    s_sub_u32 s27, 3, s27
    s_and_b32 s27, s27, 7
    s_and_b32 s28, s21, 8
    s_add_u32 s27, s27, s28
    s_bfe_u32 s28, s2, 0x40003
    s_lshl_b32 s28, s28, 2
    s_add_u32 s28, s28, s87
    s_mul_i32 s28, s28, 6144
    s_lshl_b32 s46, s27, 7
    s_add_u32 s46, s46, s28
    s_xor_b32 s27, s27, s21
    s_mul_i32 s27, s27, 0x11111111
    s_xor_b32 s44, s74, s27
    s_xor_b32 s45, s75, s27
    s_waitcnt vmcnt(0)
    s_barrier
    s_bfe_u32 s37, s44, 262152
    s_mul_i32 s37, s37, 393216
    s_add_u32 s37, s37, s46
    s_buffer_load_dwordx2 s[38:39], s[4:7], s37 offset:60
    s_buffer_load_dwordx2 s[38:39], s[4:7], s37 offset:2108
    s_buffer_load_dwordx2 s[38:39], s[4:7], s37 offset:4156
    s_bfe_u32 s37, s44, 262156
    s_mul_i32 s37, s37, 393216
    s_add_u32 s37, s37, s46
    s_buffer_load_dwordx2 s[38:39], s[4:7], s37 offset:60
    s_buffer_load_dwordx2 s[38:39], s[4:7], s37 offset:2108
    s_buffer_load_dwordx2 s[38:39], s[4:7], s37 offset:4156
    s_bfe_u32 s37, s44, 262160
    s_mul_i32 s37, s37, 393216
    s_add_u32 s37, s37, s46
    s_buffer_load_dwordx2 s[38:39], s[4:7], s37 offset:60
    s_buffer_load_dwordx2 s[38:39], s[4:7], s37 offset:2108
    s_buffer_load_dwordx2 s[38:39], s[4:7], s37 offset:4156
    s_bfe_u32 s37, s44, 262164
    s_mul_i32 s37, s37, 393216
    s_add_u32 s37, s37, s46
    s_buffer_load_dwordx2 s[38:39], s[4:7], s37 offset:60
    s_buffer_load_dwordx2 s[38:39], s[4:7], s37 offset:2108
    s_buffer_load_dwordx2 s[38:39], s[4:7], s37 offset:4156
    s_bfe_u32 s37, s44, 262168
    s_mul_i32 s37, s37, 393216
    s_add_u32 s37, s37, s46
    s_buffer_load_dwordx2 s[38:39], s[4:7], s37 offset:60
    s_buffer_load_dwordx2 s[38:39], s[4:7], s37 offset:2108
    s_buffer_load_dwordx2 s[38:39], s[4:7], s37 offset:4156
    s_bfe_u32 s37, s44, 262172
    s_mul_i32 s37, s37, 393216
    s_add_u32 s37, s37, s46
    s_buffer_load_dwordx2 s[38:39], s[4:7], s37 offset:60
    s_buffer_load_dwordx2 s[38:39], s[4:7], s37 offset:2108
    s_buffer_load_dwordx2 s[38:39], s[4:7], s37 offset:4156
    s_bfe_u32 s37, s45, 262144
    s_mul_i32 s37, s37, 393216
    s_add_u32 s37, s37, s46
    s_buffer_load_dwordx2 s[38:39], s[4:7], s37 offset:60
    s_buffer_load_dwordx2 s[38:39], s[4:7], s37 offset:2108
    s_buffer_load_dwordx2 s[38:39], s[4:7], s37 offset:4156
    s_bfe_u32 s27, s100, 262148
    s_lshl_b32 s27, s27, 2
    s_add_u32 s27, s27, s87
    s_lshl_b32 s27, s27, 1
    s_and_b32 s28, s20, 1
    s_add_u32 s27, s27, s28
    s_mul_i32 s27, s27, 49152
    s_lshl_b32 s28, s21, 7
    s_add_u32 s27, s27, s28
    s_buffer_load_dwordx2 s[38:39], s[4:7], s27 offset:60
    s_buffer_load_dwordx2 s[38:39], s[4:7], s27 offset:2108
    s_buffer_load_dwordx2 s[38:39], s[4:7], s27 offset:4156
    s_buffer_load_dwordx2 s[38:39], s[4:7], s27 offset:6204
    s_buffer_load_dwordx2 s[38:39], s[4:7], s27 offset:8252
    s_buffer_load_dwordx2 s[38:39], s[4:7], s27 offset:10300
    s_buffer_load_dwordx2 s[38:39], s[4:7], s27 offset:12348
    s_buffer_load_dwordx2 s[38:39], s[4:7], s27 offset:14396
    s_buffer_load_dwordx2 s[38:39], s[4:7], s27 offset:16444
    s_buffer_load_dwordx2 s[38:39], s[4:7], s27 offset:18492
    s_buffer_load_dwordx2 s[38:39], s[4:7], s27 offset:20540
    s_buffer_load_dwordx2 s[38:39], s[4:7], s27 offset:22588
    s_buffer_load_dwordx2 s[38:39], s[4:7], s27 offset:24636
    s_buffer_load_dwordx2 s[38:39], s[4:7], s27 offset:26684
    s_buffer_load_dwordx2 s[38:39], s[4:7], s27 offset:28732
    s_buffer_load_dwordx2 s[38:39], s[4:7], s27 offset:30780
    s_buffer_load_dwordx2 s[38:39], s[4:7], s27 offset:32828
    s_buffer_load_dwordx2 s[38:39], s[4:7], s27 offset:34876
    s_buffer_load_dwordx2 s[38:39], s[4:7], s27 offset:36924
    s_buffer_load_dwordx2 s[38:39], s[4:7], s27 offset:38972
    s_buffer_load_dwordx2 s[38:39], s[4:7], s27 offset:41020
    s_buffer_load_dwordx2 s[38:39], s[4:7], s27 offset:43068
    s_buffer_load_dwordx2 s[38:39], s[4:7], s27 offset:45116
    s_buffer_load_dwordx2 s[38:39], s[4:7], s27 offset:47164
    v_add_u32 v72, s79, v0
    v_add_u32 v73, 65536, v72
    s_barrier
    s_bfe_u32 s27, s74, 262144
    s_mul_i32 s85, s27, 393216
    s_add_u32 m0, s79, 81920
    s_nop 0
    buffer_load_dwordx4 v12, s[4:7], s85 offen offset:0 lds
    buffer_load_dwordx4 v13, s[4:7], s85 offen offset:1024 lds
    s_add_u32 m0, s79, 49152
    s_nop 0
    buffer_load_dwordx4 v14, s[4:7], s85 offen offset:0 lds
    buffer_load_dwordx4 v15, s[4:7], s85 offen offset:1024 lds
    s_add_u32 m0, s79, 57344
    s_nop 0
    buffer_load_dwordx4 v16, s[4:7], s85 offen offset:0 lds
    buffer_load_dwordx4 v17, s[4:7], s85 offen offset:1024 lds
    s_bfe_u32 s27, s74, 262148
    s_mul_i32 s85, s27, 393216
    s_add_u32 m0, s79, 65536
    s_nop 0
    buffer_load_dwordx4 v12, s[4:7], s85 offen offset:0 lds
    buffer_load_dwordx4 v13, s[4:7], s85 offen offset:1024 lds
    s_add_u32 m0, s79, 98304
    s_nop 0
    buffer_load_dwordx4 v14, s[4:7], s85 offen offset:0 lds
    buffer_load_dwordx4 v15, s[4:7], s85 offen offset:1024 lds
    s_add_u32 m0, s79, 106496
    s_nop 0
    buffer_load_dwordx4 v16, s[4:7], s85 offen offset:0 lds
    buffer_load_dwordx4 v17, s[4:7], s85 offen offset:1024 lds
    s_waitcnt vmcnt(6)
    s_barrier
    s_branch L_lbody
L_lfinal:
    s_waitcnt vmcnt(0)
    s_barrier
    s_lshr_b32 s27, s2, 3
    s_add_u32 s27, s27, s87
    s_cmp_eq_u32 s27, 0
    s_cbranch_scc0 Lif_99
    buffer_wbl2 sc1
Lif_99:
    s_barrier
    s_branch L_out
L_colsum:
    ds_read_b64_tr_b16 v[40:41], v196 offset:0
    ds_read_b64_tr_b16 v[42:43], v196 offset:2048
    ds_read_b64_tr_b16 v[44:45], v196 offset:4096
    ds_read_b64_tr_b16 v[46:47], v196 offset:6144
    ds_read_b64_tr_b16 v[48:49], v197 offset:0
    ds_read_b64_tr_b16 v[50:51], v197 offset:2048
    ds_read_b64_tr_b16 v[52:53], v197 offset:4096
    ds_read_b64_tr_b16 v[54:55], v197 offset:6144
    ds_read_b64_tr_b16 v[56:57], v198 offset:0
    ds_read_b64_tr_b16 v[58:59], v198 offset:2048
    ds_read_b64_tr_b16 v[60:61], v198 offset:4096
    ds_read_b64_tr_b16 v[62:63], v198 offset:6144
    v_and_b32 v88, 15, v1
    v_cmp_eq_u32 vcc, 0, v88
    v_mov_b32 v89, 0x3f803f80
    s_nop 0
    v_cndmask_b32 v88, 0, v89, vcc
    v_mov_b32 v89, v88
    v_mov_b32 v90, v88
    v_mov_b32 v91, v88
    v_and_b32 v92, 15, v1
    v_cmp_eq_u32 vcc, 4, v92
    v_mov_b32 v93, 0x3f803f80
    s_nop 0
    v_cndmask_b32 v92, 0, v93, vcc
    v_mov_b32 v93, v92
    v_mov_b32 v94, v92
    v_mov_b32 v95, v92
    v_and_b32 v96, 15, v1
    v_cmp_eq_u32 vcc, 8, v96
    v_mov_b32 v97, 0x3f803f80
    s_nop 0
    v_cndmask_b32 v96, 0, v97, vcc
    v_mov_b32 v97, v96
    v_mov_b32 v98, v96
    v_mov_b32 v99, v96
    s_waitcnt lgkmcnt(0)
    v_mfma_f32_16x16x32_bf16 v[100:103], v[88:91], v[40:43], 0
    v_mfma_f32_16x16x32_bf16 v[100:103], v[88:91], v[44:47], v[100:103]
    v_mfma_f32_16x16x32_bf16 v[100:103], v[92:95], v[48:51], v[100:103]
    v_mfma_f32_16x16x32_bf16 v[100:103], v[92:95], v[52:55], v[100:103]
    v_mfma_f32_16x16x32_bf16 v[100:103], v[96:99], v[56:59], v[100:103]
    v_mfma_f32_16x16x32_bf16 v[100:103], v[96:99], v[60:63], v[100:103]
    s_nop 7
    buffer_store_dword v100, v199, s[12:15], 0 offen sc1
    s_setpc_b64 s[72:73]
L_cstart:
    s_cmp_eq_u32 s3, 3
    s_cbranch_scc0 Lif_100
    s_getpc_b64 s[40:41]
L_pc:
    s_sub_u32 s40, s40, L_pc - interleave_layers__sliding_block__sliding_local_dilated__prompt_kernel
    s_subb_u32 s41, s41, 0
    s_lshr_b32 s27, s2, 3
    s_mul_i32 s27, s27, 1664
    v_lshlrev_b32 v28, 7, v1
    v_add_u32 v28, s27, v28
    s_mov_b32 s27, L_last - interleave_layers__sliding_block__sliding_local_dilated__prompt_kernel
    v_min_u32 v28, s27, v28
    v_mov_b32 v29, s41
    v_add_co_u32 v28, vcc, s40, v28
    s_nop 1
    v_addc_co_u32 v29, vcc, 0, v29, vcc
    s_mov_b64 exec, 8191
    global_load_dword v255, v[28:29], off
    s_mov_b64 exec, -1
Lif_100:
    s_lshl_b32 s27, s20, 2
    s_add_u32 s27, s27, s3
    s_lshl_b32 s27, s27, 16
    s_lshl_b32 s28, s21, 7
    s_add_u32 s27, s27, s28
    v_and_b32 v24, 15, v1
    v_lshlrev_b32 v24, 11, v24
    v_bfe_u32 v25, v1, 4, 1
    v_lshl_add_u32 v24, v25, 5, v24
    v_lshrrev_b32 v25, 5, v1
    v_lshlrev_b32 v25, 4, v25
    v_add3_u32 v24, v24, v25, s27
    v_add_u32 v25, 32768, v24
    s_waitcnt lgkmcnt(0)
    s_mov_b32 s88, s48
    s_mov_b32 s89, s49
    s_mov_b32 s90, 4194304
    s_mov_b32 s91, 0x00020000
    buffer_load_dwordx4 v[8:11], v24, s[88:91], 0 offen offset:0
    buffer_load_dwordx4 v[12:15], v24, s[88:91], 0 offen offset:64
    buffer_load_dwordx4 v[16:19], v25, s[88:91], 0 offen offset:0
    buffer_load_dwordx4 v[20:23], v25, s[88:91], 0 offen offset:64
    s_mov_b32 s12, s64
    s_mov_b32 s13, s65
    s_mov_b32 s14, 75497472
    s_mov_b32 s15, 0x00020000
    v_mov_b32 v28, 671744
    buffer_load_dwordx2 v[26:27], v28, s[12:15], 0 offen sc1
    s_mov_b32 s12, s64
    s_mov_b32 s13, s65
    s_mov_b32 s14, 75497472
    s_mov_b32 s15, 0x00020000
    s_mov_b32 s8, s52
    s_mov_b32 s9, s53
    s_mov_b32 s10, 2097152
    s_mov_b32 s11, 0x00020000
    s_mov_b32 s40, s60
    s_mov_b32 s41, s61
    s_mov_b32 s42, 4194304
    s_mov_b32 s43, 0x00020000
    s_add_u32 s16, s64, 18874368
    s_addc_u32 s17, s65, 0
    s_mov_b32 s18, 4194304
    s_mov_b32 s19, 0x00020000
    s_mov_b32 s92, s56
    s_mov_b32 s93, s57
    s_mov_b32 s94, 6291456
    s_mov_b32 s95, 0x00020000
    s_mov_b32 s23, 0
    v_mov_b32 v6, 0
    v_mov_b32 v7, 0
    v_mov_b32 v206, 1073741824
    s_lshl_b32 s97, s20, 20
    s_add_u32 s97, s97, 2097152
    s_lshl_b32 s99, s21, 17
    s_lshl_b32 s27, s3, 2
    s_lshr_b32 s27, 1983009808, s27
    s_and_b32 s28, s27, 4
    s_lshl_b32 s28, s28, 2
    s_and_b32 s27, s27, 3
    s_or_b32 s27, s27, s28
    s_lshl_b32 s27, s27, 16
    s_xor_b32 s76, s99, s27
    v_bfe_u32 v28, v1, 2, 3
    v_bfe_u32 v29, v1, 1, 1
    v_and_b32 v30, 6, v28
    v_xor_b32 v29, v29, v30
    v_lshlrev_b32 v29, 4, v29
    v_lshlrev_b32 v28, 7, v28
    v_and_b32 v30, 1, v1
    v_lshlrev_b32 v30, 3, v30
    v_add3_u32 v28, v28, v29, v30
    v_lshrrev_b32 v29, 5, v1
    v_lshl_add_u32 v2, v29, 10, v28
    v_lshrrev_b32 v28, 3, v1
    v_and_b32 v29, 6, v28
    v_and_b32 v30, 7, v1
    v_xor_b32 v29, v29, v30
    v_lshlrev_b32 v29, 4, v29
    v_lshlrev_b32 v28, 11, v28
    s_lshl_b32 s27, s21, 7
    v_add3_u32 v3, v28, v29, s27
    v_and_b32 v212, 3, v1
    v_cmp_eq_u32 vcc, 0, v212
    v_mov_b32 v213, 0x3f803f80
    s_nop 0
    v_cndmask_b32 v212, 0, v213, vcc
    v_mov_b32 v213, v212
    v_mov_b32 v214, v212
    v_mov_b32 v215, v212
    s_and_b32 s27, s3, 2
    s_lshr_b32 s28, s3, 2
    s_add_u32 s71, s27, s28
    s_and_b32 s27, s3, 1
    s_lshl_b32 s28, s71, 1
    s_add_u32 s28, s28, s27
    s_lshl_b32 s28, s28, 12
    s_add_u32 s54, s28, 98304
    s_lshl_b32 s28, s21, 1
    s_add_u32 s27, s27, s28
    s_lshl_b32 s27, s27, 11
    s_lshl_b32 s28, s71, 16
    s_add_u32 s27, s27, s28
    s_lshl_b32 s28, s20, 18
    s_add_u32 s62, s27, s28
    s_add_u32 s27, s71, 1
    s_cmp_lt_u32 s20, 2
    s_cselect_b32 s98, s27, 99
    s_cmp_eq_u32 s20, 0
    s_cselect_b32 s27, 0, 1048576
    s_sub_u32 s27, s97, s27
    s_lshl_b32 s28, s21, 3
    s_add_u32 s28, s28, s3
    s_lshl_b32 s28, s28, 12
    s_add_u32 s27, s27, s28
    s_add_u32 s55, s27, 524288
    s_mov_b32 s4, s50
    s_mov_b32 s5, s51
    s_mov_b32 s6, 6291456
    s_mov_b32 s7, 0x00020000
    s_lshr_b32 s27, s3, 1
    s_lshl_b32 s27, s27, 13
    v_and_b32 v200, 15, v1
    v_bfe_u32 v201, v1, 1, 3
    v_lshrrev_b32 v202, 4, v1
    v_xor_b32 v201, v201, v202
    v_lshlrev_b32 v200, 7, v200
    v_lshlrev_b32 v201, 4, v201
    v_add3_u32 v200, v200, v201, s27
    v_xor_b32 v201, 64, v200
    s_and_b32 s27, s3, 1
    s_lshl_b32 s28, s27, 6
    v_xor_b32 v202, s28, v2
    v_xor_b32 v203, 32, v202
    v_add_u32 v204, 98304, v202
    v_add_u32 v205, 98304, v203
    v_add_u32 v202, 49152, v202
    v_add_u32 v203, 49152, v203
    v_and_b32 v24, 15, v1
    v_lshrrev_b32 v25, 4, v1
    s_lshl_b32 s27, s27, 7
    s_add_u32 s27, s27, 92160
    v_lshl_add_u32 v209, v25, 4, s27
    v_lshl_add_u32 v210, v24, 2, s27
    s_lshr_b32 s27, s3, 1
    s_lshl_b32 s27, s27, 8
    s_add_u32 s28, s27, 90112
    v_lshl_add_u32 v208, v25, 4, s28
    s_add_u32 s28, s28, s27
    v_lshl_add_u32 v207, v24, 3, s28
    s_lshl_b32 s27, s20, 2
    s_add_u32 s27, s27, s3
    s_lshl_b32 s27, s27, 4
    s_add_u32 s27, s27, s21
    s_lshl_b32 s0, s27, 12
    s_lshr_b32 s27, s27, 4
    s_lshl_b32 s1, s27, 16
    s_lshl_b32 s27, s27, 12
    s_lshl_b32 s28, s21, 6
    s_add_u32 s27, s27, s28
    v_and_b32 v28, 7, v24
    v_lshl_add_u32 v206, v28, 3, s27
    v_lshrrev_b32 v28, 3, v24
    v_lshl_add_u32 v206, v28, 10, v206
    v_lshrrev_b32 v24, 2, v24
    v_cmp_eq_u32 vcc, v24, v25
    v_mov_b32 v24, 1073741824
    s_nop 0
    v_cndmask_b32 v206, v24, v206, vcc
    s_mov_b32 s84, 0xaaaaaaaa
    s_mov_b32 s86, 0xcccccccc
    s_mov_b32 s85, 0xaaaaaaaa
    s_mov_b32 s87, 0xcccccccc
    s_sub_u32 s27, s54, 98304
    s_add_u32 s48, s27, 131072
    s_lshl_b32 s28, s21, 15
    s_add_u32 s27, s27, s28
    s_add_u32 s27, s27, s97
    s_add_u32 s63, s27, 524288
    s_lshl_b32 s27, s21, 1
    s_add_u32 s27, s27, s3
    s_sub_u32 s27, s27, 2
    s_lshl_b32 s27, s27, 11
    s_add_u32 s27, s27, s97
    s_cmp_ge_u32 s3, 2
    s_cselect_b32 s49, s27, 1073741824
    v_and_b32 v224, 15, v1
    v_lshrrev_b32 v225, 4, v1
    v_lshlrev_b32 v225, 2, v225
    v_sub_u32 v224, v224, v225
    s_cmp_lt_u32 s20, 2
    s_cselect_b32 s27, 0, -1
    v_subrev_u32 v216, 0, v224
    v_subrev_u32 v217, 1, v224
    v_subrev_u32 v218, 2, v224
    v_subrev_u32 v219, 3, v224
    v_ashrrev_i32 v216, 31, v216
    v_ashrrev_i32 v217, 31, v217
    v_ashrrev_i32 v218, 31, v218
    v_ashrrev_i32 v219, 31, v219
    v_and_b32 v216, 4048155338, v216
    v_and_b32 v217, 4048155338, v217
    v_and_b32 v218, 4048155338, v218
    v_and_b32 v219, 4048155338, v219
    v_and_b32 v220, s27, v216
    v_and_b32 v221, s27, v217
    v_and_b32 v222, s27, v218
    v_and_b32 v223, s27, v219
    v_xor_b32 v220, 4048155338, v220
    v_xor_b32 v221, 4048155338, v221
    v_xor_b32 v222, 4048155338, v222
    v_xor_b32 v223, 4048155338, v223
    v_mov_b32 v224, 0
    v_mov_b32 v225, 0
    v_mov_b32 v226, 0
    v_mov_b32 v227, 0
    s_mov_b64 s[88:89], s[16:17]
    s_mov_b64 s[16:17], s[40:41]
    s_waitcnt vmcnt(0)
    v_readfirstlane_b32 s24, v26
    v_readfirstlane_b32 s25, v27
    s_add_u32 s24, s24, 1
    s_add_u32 s25, s25, 16
    s_and_b32 s25, s25, 0xfffffff0
    s_getreg_b32 s27, hwreg(HW_REG_XCC_ID, 0, 4)
    s_or_b32 s25, s25, s27
    v_permlane16_swap_b32 v8, v10
    v_permlane16_swap_b32 v9, v11
    v_permlane16_swap_b32 v12, v14
    v_permlane16_swap_b32 v13, v15
    v_permlane16_swap_b32 v16, v18
    v_permlane16_swap_b32 v17, v19
    v_permlane16_swap_b32 v20, v22
    v_permlane16_swap_b32 v21, v23
    v_mfma_f32_16x16x32_bf16 v[232:235], v[8:11], v[8:11], 0
    v_mfma_f32_16x16x32_bf16 v[236:239], v[212:215], v[8:11], 0
    v_mfma_f32_16x16x32_bf16 v[240:243], v[16:19], v[16:19], 0
    v_mfma_f32_16x16x32_bf16 v[244:247], v[212:215], v[16:19], 0
    v_mfma_f32_16x16x32_bf16 v[232:235], v[12:15], v[12:15], v[232:235]
    v_mfma_f32_16x16x32_bf16 v[236:239], v[212:215], v[12:15], v[236:239]
    v_mfma_f32_16x16x32_bf16 v[240:243], v[20:23], v[20:23], v[240:243]
    v_mfma_f32_16x16x32_bf16 v[244:247], v[212:215], v[20:23], v[244:247]
    s_nop 4
    v_cndmask_b32 v232, v232, v233, s[84:85]
    v_cndmask_b32 v234, v234, v235, s[84:85]
    v_cndmask_b32 v240, v240, v241, s[84:85]
    v_cndmask_b32 v242, v242, v243, s[84:85]
    v_cndmask_b32 v237, v232, v234, s[86:87]
    v_cndmask_b32 v245, v240, v242, s[86:87]
    s_cmp_eq_u32 s23, 0
    s_cbranch_scc1 Lwt_101
    buffer_store_dwordx2 v[236:237], v206, s[12:15], 0 offen offset:0
    buffer_store_dwordx2 v[244:245], v206, s[12:15], 0 offen offset:2048
Lwt_102:
    v_or_b32 v206, 2147483648, v206
    s_waitcnt vmcnt(0)
    s_branch L_cfirst
L_centry:
    v_mfma_f32_16x16x32_bf16 v[232:235], v[8:11], v[8:11], 0
    v_mfma_f32_16x16x32_bf16 v[236:239], v[212:215], v[8:11], 0
    v_mfma_f32_16x16x32_bf16 v[240:243], v[16:19], v[16:19], 0
    v_mfma_f32_16x16x32_bf16 v[244:247], v[212:215], v[16:19], 0
    v_mfma_f32_16x16x32_bf16 v[232:235], v[12:15], v[12:15], v[232:235]
    v_mfma_f32_16x16x32_bf16 v[236:239], v[212:215], v[12:15], v[236:239]
    v_mfma_f32_16x16x32_bf16 v[240:243], v[20:23], v[20:23], v[240:243]
    v_mfma_f32_16x16x32_bf16 v[244:247], v[212:215], v[20:23], v[244:247]
    s_waitcnt lgkmcnt(0)
L_cfirst:
    s_barrier
    ds_read_b128 v[120:123], v200 offset:32768
    ds_read_b64_tr_b16 v[136:137], v202 offset:32768
    ds_read_b64_tr_b16 v[138:139], v202 offset:34816
    ds_read_b128 v[124:127], v200 offset:34816
    ds_read_b128 v[128:131], v200 offset:36864
    ds_read_b128 v[132:135], v200 offset:38912
    ds_read_b64_tr_b16 v[140:141], v203 offset:32768
    ds_read_b64_tr_b16 v[142:143], v203 offset:34816
    ds_read_b64_tr_b16 v[144:145], v202 offset:0
    ds_read_b64_tr_b16 v[146:147], v202 offset:2048
    ds_read_b64_tr_b16 v[148:149], v203 offset:0
    ds_read_b64_tr_b16 v[150:151], v203 offset:2048
    ds_read_b64_tr_b16 v[152:153], v202 offset:8192
    ds_read_b64_tr_b16 v[154:155], v202 offset:10240
    ds_read_b64_tr_b16 v[156:157], v203 offset:8192
    ds_read_b64_tr_b16 v[158:159], v203 offset:10240
    v_cndmask_b32 v232, v232, v233, s[84:85]
    v_cndmask_b32 v234, v234, v235, s[84:85]
    v_cndmask_b32 v240, v240, v241, s[84:85]
    v_cndmask_b32 v242, v242, v243, s[84:85]
    v_cndmask_b32 v237, v232, v234, s[86:87]
    v_cndmask_b32 v245, v240, v242, s[86:87]
    s_cmp_eq_u32 s23, 0
    s_cbranch_scc1 Lwt_103
    buffer_store_dwordx2 v[236:237], v206, s[12:15], 0 offen offset:0
    buffer_store_dwordx2 v[244:245], v206, s[12:15], 0 offen offset:2048
Lwt_104:
    s_waitcnt lgkmcnt(13)
    v_mfma_f32_16x16x32_bf16 v[24:27], v[136:139], v[120:123], 0
    ds_read_b128 v[160:163], v201 offset:32768
    s_waitcnt lgkmcnt(13)
    v_mfma_f32_16x16x32_bf16 v[28:31], v[136:139], v[124:127], 0
    ds_read_b64_tr_b16 v[176:177], v202 offset:36864
    s_waitcnt lgkmcnt(13)
    v_mfma_f32_16x16x32_bf16 v[32:35], v[136:139], v[128:131], 0
    ds_read_b64_tr_b16 v[178:179], v202 offset:38912
    s_waitcnt lgkmcnt(13)
    v_mfma_f32_16x16x32_bf16 v[36:39], v[136:139], v[132:135], 0
    ds_read_b128 v[164:167], v201 offset:34816
    s_waitcnt lgkmcnt(12)
    v_mfma_f32_16x16x32_bf16 v[52:55], v[140:143], v[132:135], 0
    ds_read_b128 v[168:171], v201 offset:36864
    v_mfma_f32_16x16x32_bf16 v[48:51], v[140:143], v[128:131], 0
    ds_read_b128 v[172:175], v201 offset:38912
    v_mfma_f32_16x16x32_bf16 v[44:47], v[140:143], v[124:127], 0
    ds_read_b64_tr_b16 v[180:181], v203 offset:36864
    v_mfma_f32_16x16x32_bf16 v[40:43], v[140:143], v[120:123], 0
    ds_read_b64_tr_b16 v[182:183], v203 offset:38912
    s_waitcnt lgkmcnt(5)
    v_mfma_f32_16x16x32_bf16 v[56:59], v[144:147], v[120:123], 0
    ds_read_b64_tr_b16 v[184:185], v202 offset:4096
    v_mfma_f32_16x16x32_bf16 v[60:63], v[144:147], v[124:127], 0
    ds_read_b64_tr_b16 v[186:187], v202 offset:6144
    v_mfma_f32_16x16x32_bf16 v[64:67], v[144:147], v[128:131], 0
    ds_read_b64_tr_b16 v[188:189], v203 offset:4096
    v_mfma_f32_16x16x32_bf16 v[68:71], v[144:147], v[132:135], 0
    ds_read_b64_tr_b16 v[190:191], v203 offset:6144
    v_mfma_f32_16x16x32_bf16 v[84:87], v[148:151], v[132:135], 0
    ds_read_b64_tr_b16 v[192:193], v202 offset:12288
    v_mfma_f32_16x16x32_bf16 v[80:83], v[148:151], v[128:131], 0
    ds_read_b64_tr_b16 v[194:195], v202 offset:14336
    v_mfma_f32_16x16x32_bf16 v[76:79], v[148:151], v[124:127], 0
    ds_read_b64_tr_b16 v[196:197], v203 offset:12288
    v_mfma_f32_16x16x32_bf16 v[72:75], v[148:151], v[120:123], 0
    ds_read_b64_tr_b16 v[198:199], v203 offset:14336
    v_mfma_f32_16x16x32_bf16 v[88:91], v[120:123], v[152:155], 0
    s_mov_b32 s96, 0
    v_mfma_f32_16x16x32_bf16 v[92:95], v[124:127], v[152:155], 0
    s_xor_b64 s[88:89], s[88:89], s[16:17]
    v_mfma_f32_16x16x32_bf16 v[96:99], v[128:131], v[152:155], 0
    s_xor_b64 s[16:17], s[88:89], s[16:17]
    v_mfma_f32_16x16x32_bf16 v[100:103], v[132:135], v[152:155], 0
    s_xor_b64 s[88:89], s[88:89], s[16:17]
    v_mfma_f32_16x16x32_bf16 v[116:119], v[132:135], v[156:159], 0
    v_mfma_f32_16x16x32_bf16 v[112:115], v[128:131], v[156:159], 0
    v_mfma_f32_16x16x32_bf16 v[108:111], v[124:127], v[156:159], 0
    v_mfma_f32_16x16x32_bf16 v[104:107], v[120:123], v[156:159], 0
    v_mfma_f32_16x16x32_bf16 v[24:27], v[176:179], v[160:163], v[24:27]
    s_waitcnt lgkmcnt(0)
    v_mfma_f32_16x16x32_bf16 v[28:31], v[176:179], v[164:167], v[28:31]
    v_mfma_f32_16x16x32_bf16 v[32:35], v[176:179], v[168:171], v[32:35]
    v_mfma_f32_16x16x32_bf16 v[36:39], v[176:179], v[172:175], v[36:39]
    v_mfma_f32_16x16x32_bf16 v[52:55], v[180:183], v[172:175], v[52:55]
    v_mfma_f32_16x16x32_bf16 v[48:51], v[180:183], v[168:171], v[48:51]
    v_mfma_f32_16x16x32_bf16 v[44:47], v[180:183], v[164:167], v[44:47]
    v_mfma_f32_16x16x32_bf16 v[40:43], v[180:183], v[160:163], v[40:43]
    s_waitcnt vmcnt(0)
    s_barrier
    v_mfma_f32_16x16x32_bf16 v[56:59], v[184:187], v[160:163], v[56:59]
    ds_read_b128 v[120:123], v200 offset:0
    ds_read_b64_tr_b16 v[136:137], v202 offset:16384
    v_mfma_f32_16x16x32_bf16 v[60:63], v[184:187], v[164:167], v[60:63]
    ds_read_b64_tr_b16 v[138:139], v202 offset:18432
    v_mfma_f32_16x16x32_bf16 v[64:67], v[184:187], v[168:171], v[64:67]
    ds_read_b128 v[124:127], v200 offset:2048
    v_mfma_f32_16x16x32_bf16 v[68:71], v[184:187], v[172:175], v[68:71]
    ds_read_b128 v[128:131], v200 offset:4096
    ds_read_b128 v[132:135], v200 offset:6144
    v_mfma_f32_16x16x32_bf16 v[84:87], v[188:191], v[172:175], v[84:87]
    ds_read_b64_tr_b16 v[140:141], v203 offset:16384
    v_mfma_f32_16x16x32_bf16 v[80:83], v[188:191], v[168:171], v[80:83]
    ds_read_b64_tr_b16 v[142:143], v203 offset:18432
    v_mfma_f32_16x16x32_bf16 v[76:79], v[188:191], v[164:167], v[76:79]
    ds_read_b64_tr_b16 v[144:145], v204 offset:0
    ds_read_b64_tr_b16 v[146:147], v204 offset:2048
    v_mfma_f32_16x16x32_bf16 v[72:75], v[188:191], v[160:163], v[72:75]
    ds_read_b64_tr_b16 v[148:149], v205 offset:0
    v_mfma_f32_16x16x32_bf16 v[88:91], v[160:163], v[192:195], v[88:91]
    ds_read_b64_tr_b16 v[150:151], v205 offset:2048
    v_mfma_f32_16x16x32_bf16 v[92:95], v[164:167], v[192:195], v[92:95]
    ds_read_b64_tr_b16 v[152:153], v204 offset:8192
    ds_read_b64_tr_b16 v[154:155], v204 offset:10240
    v_mfma_f32_16x16x32_bf16 v[96:99], v[168:171], v[192:195], v[96:99]
    ds_read_b64_tr_b16 v[156:157], v205 offset:8192
    v_mfma_f32_16x16x32_bf16 v[100:103], v[172:175], v[192:195], v[100:103]
    ds_read_b64_tr_b16 v[158:159], v205 offset:10240
    v_mfma_f32_16x16x32_bf16 v[116:119], v[172:175], v[196:199], v[116:119]
    v_mfma_f32_16x16x32_bf16 v[112:115], v[168:171], v[196:199], v[112:115]
    v_mfma_f32_16x16x32_bf16 v[108:111], v[164:167], v[196:199], v[108:111]
    v_mfma_f32_16x16x32_bf16 v[104:107], v[160:163], v[196:199], v[104:107]
L_cloop:
    s_waitcnt lgkmcnt(0)
    v_mfma_f32_16x16x32_bf16 v[24:27], v[136:139], v[120:123], v[24:27]
    ds_read_b128 v[160:163], v201 offset:0
    v_mfma_f32_16x16x32_bf16 v[28:31], v[136:139], v[124:127], v[28:31]
    ds_read_b64_tr_b16 v[176:177], v202 offset:20480
    v_mfma_f32_16x16x32_bf16 v[32:35], v[136:139], v[128:131], v[32:35]
    ds_read_b64_tr_b16 v[178:179], v202 offset:22528
    v_mfma_f32_16x16x32_bf16 v[36:39], v[136:139], v[132:135], v[36:39]
    ds_read_b128 v[164:167], v201 offset:2048
    v_mfma_f32_16x16x32_bf16 v[52:55], v[140:143], v[132:135], v[52:55]
    ds_read_b128 v[168:171], v201 offset:4096
    v_mfma_f32_16x16x32_bf16 v[48:51], v[140:143], v[128:131], v[48:51]
    ds_read_b128 v[172:175], v201 offset:6144
    v_mfma_f32_16x16x32_bf16 v[44:47], v[140:143], v[124:127], v[44:47]
    ds_read_b64_tr_b16 v[180:181], v203 offset:20480
    v_mfma_f32_16x16x32_bf16 v[40:43], v[140:143], v[120:123], v[40:43]
    ds_read_b64_tr_b16 v[182:183], v203 offset:22528
    v_mfma_f32_16x16x32_bf16 v[56:59], v[144:147], v[120:123], v[56:59]
    ds_read_b64_tr_b16 v[184:185], v204 offset:4096
    v_mfma_f32_16x16x32_bf16 v[60:63], v[144:147], v[124:127], v[60:63]
    ds_read_b64_tr_b16 v[186:187], v204 offset:6144
    v_mfma_f32_16x16x32_bf16 v[64:67], v[144:147], v[128:131], v[64:67]
    ds_read_b64_tr_b16 v[188:189], v205 offset:4096
    v_mfma_f32_16x16x32_bf16 v[68:71], v[144:147], v[132:135], v[68:71]
    ds_read_b64_tr_b16 v[190:191], v205 offset:6144
    v_mfma_f32_16x16x32_bf16 v[84:87], v[148:151], v[132:135], v[84:87]
    ds_read_b64_tr_b16 v[192:193], v204 offset:12288
    v_mfma_f32_16x16x32_bf16 v[80:83], v[148:151], v[128:131], v[80:83]
    ds_read_b64_tr_b16 v[194:195], v204 offset:14336
    v_mfma_f32_16x16x32_bf16 v[76:79], v[148:151], v[124:127], v[76:79]
    ds_read_b64_tr_b16 v[196:197], v205 offset:12288
    v_mfma_f32_16x16x32_bf16 v[72:75], v[148:151], v[120:123], v[72:75]
    ds_read_b64_tr_b16 v[198:199], v205 offset:14336
    v_mfma_f32_16x16x32_bf16 v[88:91], v[120:123], v[152:155], v[88:91]
    v_mfma_f32_16x16x32_bf16 v[92:95], v[124:127], v[152:155], v[92:95]
    v_mfma_f32_16x16x32_bf16 v[96:99], v[128:131], v[152:155], v[96:99]
    v_mfma_f32_16x16x32_bf16 v[100:103], v[132:135], v[152:155], v[100:103]
    v_mfma_f32_16x16x32_bf16 v[116:119], v[132:135], v[156:159], v[116:119]
    v_mfma_f32_16x16x32_bf16 v[112:115], v[128:131], v[156:159], v[112:115]
    v_mfma_f32_16x16x32_bf16 v[108:111], v[124:127], v[156:159], v[108:111]
    v_mfma_f32_16x16x32_bf16 v[104:107], v[120:123], v[156:159], v[104:107]
    s_waitcnt lgkmcnt(0)
    v_mfma_f32_16x16x32_bf16 v[24:27], v[176:179], v[160:163], v[24:27]
    v_mfma_f32_16x16x32_bf16 v[28:31], v[176:179], v[164:167], v[28:31]
    s_barrier
    v_mfma_f32_16x16x32_bf16 v[32:35], v[176:179], v[168:171], v[32:35]
    ds_read_b128 v[120:123], v200 offset:16384
    v_mfma_f32_16x16x32_bf16 v[36:39], v[176:179], v[172:175], v[36:39]
    ds_read_b64_tr_b16 v[136:137], v202 offset:24576
    v_mfma_f32_16x16x32_bf16 v[52:55], v[180:183], v[172:175], v[52:55]
    ds_read_b64_tr_b16 v[138:139], v202 offset:26624
    v_mfma_f32_16x16x32_bf16 v[48:51], v[180:183], v[168:171], v[48:51]
    ds_read_b128 v[124:127], v200 offset:18432
    v_mfma_f32_16x16x32_bf16 v[44:47], v[180:183], v[164:167], v[44:47]
    ds_read_b128 v[128:131], v200 offset:20480
    v_mfma_f32_16x16x32_bf16 v[40:43], v[180:183], v[160:163], v[40:43]
    ds_read_b128 v[132:135], v200 offset:22528
    v_mfma_f32_16x16x32_bf16 v[56:59], v[184:187], v[160:163], v[56:59]
    ds_read_b64_tr_b16 v[140:141], v203 offset:24576
    v_mfma_f32_16x16x32_bf16 v[60:63], v[184:187], v[164:167], v[60:63]
    ds_read_b64_tr_b16 v[142:143], v203 offset:26624
    v_mfma_f32_16x16x32_bf16 v[64:67], v[184:187], v[168:171], v[64:67]
    ds_read_b64_tr_b16 v[144:145], v204 offset:16384
    v_mfma_f32_16x16x32_bf16 v[68:71], v[184:187], v[172:175], v[68:71]
    ds_read_b64_tr_b16 v[146:147], v204 offset:18432
    v_mfma_f32_16x16x32_bf16 v[84:87], v[188:191], v[172:175], v[84:87]
    ds_read_b64_tr_b16 v[148:149], v205 offset:16384
    v_mfma_f32_16x16x32_bf16 v[80:83], v[188:191], v[168:171], v[80:83]
    ds_read_b64_tr_b16 v[150:151], v205 offset:18432
    v_mfma_f32_16x16x32_bf16 v[76:79], v[188:191], v[164:167], v[76:79]
    ds_read_b64_tr_b16 v[152:153], v204 offset:24576
    v_mfma_f32_16x16x32_bf16 v[72:75], v[188:191], v[160:163], v[72:75]
    ds_read_b64_tr_b16 v[154:155], v204 offset:26624
    v_mfma_f32_16x16x32_bf16 v[88:91], v[160:163], v[192:195], v[88:91]
    ds_read_b64_tr_b16 v[156:157], v205 offset:24576
    v_mfma_f32_16x16x32_bf16 v[92:95], v[164:167], v[192:195], v[92:95]
    ds_read_b64_tr_b16 v[158:159], v205 offset:26624
    v_mfma_f32_16x16x32_bf16 v[96:99], v[168:171], v[192:195], v[96:99]
    v_mfma_f32_16x16x32_bf16 v[100:103], v[172:175], v[192:195], v[100:103]
    v_mfma_f32_16x16x32_bf16 v[116:119], v[172:175], v[196:199], v[116:119]
    v_mfma_f32_16x16x32_bf16 v[112:115], v[168:171], v[196:199], v[112:115]
    v_mfma_f32_16x16x32_bf16 v[108:111], v[164:167], v[196:199], v[108:111]
    v_mfma_f32_16x16x32_bf16 v[104:107], v[160:163], v[196:199], v[104:107]
    s_waitcnt lgkmcnt(0)
    v_mfma_f32_16x16x32_bf16 v[24:27], v[136:139], v[120:123], v[24:27]
    ds_read_b128 v[160:163], v201 offset:16384
    v_mfma_f32_16x16x32_bf16 v[28:31], v[136:139], v[124:127], v[28:31]
    ds_read_b64_tr_b16 v[176:177], v202 offset:28672
    v_mfma_f32_16x16x32_bf16 v[32:35], v[136:139], v[128:131], v[32:35]
    ds_read_b64_tr_b16 v[178:179], v202 offset:30720
    v_mfma_f32_16x16x32_bf16 v[36:39], v[136:139], v[132:135], v[36:39]
    ds_read_b128 v[164:167], v201 offset:18432
    v_mfma_f32_16x16x32_bf16 v[52:55], v[140:143], v[132:135], v[52:55]
    ds_read_b128 v[168:171], v201 offset:20480
    v_mfma_f32_16x16x32_bf16 v[48:51], v[140:143], v[128:131], v[48:51]
    ds_read_b128 v[172:175], v201 offset:22528
    v_mfma_f32_16x16x32_bf16 v[44:47], v[140:143], v[124:127], v[44:47]
    ds_read_b64_tr_b16 v[180:181], v203 offset:28672
    v_mfma_f32_16x16x32_bf16 v[40:43], v[140:143], v[120:123], v[40:43]
    ds_read_b64_tr_b16 v[182:183], v203 offset:30720
    v_mfma_f32_16x16x32_bf16 v[56:59], v[144:147], v[120:123], v[56:59]
    ds_read_b64_tr_b16 v[184:185], v204 offset:20480
    v_mfma_f32_16x16x32_bf16 v[60:63], v[144:147], v[124:127], v[60:63]
    ds_read_b64_tr_b16 v[186:187], v204 offset:22528
    v_mfma_f32_16x16x32_bf16 v[64:67], v[144:147], v[128:131], v[64:67]
    ds_read_b64_tr_b16 v[188:189], v205 offset:20480
    v_mfma_f32_16x16x32_bf16 v[68:71], v[144:147], v[132:135], v[68:71]
    ds_read_b64_tr_b16 v[190:191], v205 offset:22528
    v_mfma_f32_16x16x32_bf16 v[84:87], v[148:151], v[132:135], v[84:87]
    ds_read_b64_tr_b16 v[192:193], v204 offset:28672
    v_mfma_f32_16x16x32_bf16 v[80:83], v[148:151], v[128:131], v[80:83]
    ds_read_b64_tr_b16 v[194:195], v204 offset:30720
    v_mfma_f32_16x16x32_bf16 v[76:79], v[148:151], v[124:127], v[76:79]
    ds_read_b64_tr_b16 v[196:197], v205 offset:28672
    v_mfma_f32_16x16x32_bf16 v[72:75], v[148:151], v[120:123], v[72:75]
    ds_read_b64_tr_b16 v[198:199], v205 offset:30720
    v_mfma_f32_16x16x32_bf16 v[88:91], v[120:123], v[152:155], v[88:91]
    v_mfma_f32_16x16x32_bf16 v[92:95], v[124:127], v[152:155], v[92:95]
    v_mfma_f32_16x16x32_bf16 v[96:99], v[128:131], v[152:155], v[96:99]
    v_mfma_f32_16x16x32_bf16 v[100:103], v[132:135], v[152:155], v[100:103]
    v_mfma_f32_16x16x32_bf16 v[116:119], v[132:135], v[156:159], v[116:119]
    v_mfma_f32_16x16x32_bf16 v[112:115], v[128:131], v[156:159], v[112:115]
    v_mfma_f32_16x16x32_bf16 v[108:111], v[124:127], v[156:159], v[108:111]
    v_mfma_f32_16x16x32_bf16 v[104:107], v[120:123], v[156:159], v[104:107]
    s_waitcnt lgkmcnt(0)
    v_mfma_f32_16x16x32_bf16 v[24:27], v[176:179], v[160:163], v[24:27]
    v_mfma_f32_16x16x32_bf16 v[28:31], v[176:179], v[164:167], v[28:31]
    s_waitcnt vmcnt(0)
    s_barrier
    v_mfma_f32_16x16x32_bf16 v[32:35], v[176:179], v[168:171], v[32:35]
    ds_read_b128 v[120:123], v200 offset:32768
    v_mfma_f32_16x16x32_bf16 v[36:39], v[176:179], v[172:175], v[36:39]
    ds_read_b64_tr_b16 v[136:137], v202 offset:32768
    v_mfma_f32_16x16x32_bf16 v[52:55], v[180:183], v[172:175], v[52:55]
    ds_read_b64_tr_b16 v[138:139], v202 offset:34816
    v_mfma_f32_16x16x32_bf16 v[48:51], v[180:183], v[168:171], v[48:51]
    ds_read_b128 v[124:127], v200 offset:34816
    v_mfma_f32_16x16x32_bf16 v[44:47], v[180:183], v[164:167], v[44:47]
    ds_read_b128 v[128:131], v200 offset:36864
    v_mfma_f32_16x16x32_bf16 v[40:43], v[180:183], v[160:163], v[40:43]
    ds_read_b128 v[132:135], v200 offset:38912
    v_mfma_f32_16x16x32_bf16 v[56:59], v[184:187], v[160:163], v[56:59]
    ds_read_b64_tr_b16 v[140:141], v203 offset:32768
    v_mfma_f32_16x16x32_bf16 v[60:63], v[184:187], v[164:167], v[60:63]
    ds_read_b64_tr_b16 v[142:143], v203 offset:34816
    v_mfma_f32_16x16x32_bf16 v[64:67], v[184:187], v[168:171], v[64:67]
    ds_read_b64_tr_b16 v[144:145], v202 offset:0
    v_mfma_f32_16x16x32_bf16 v[68:71], v[184:187], v[172:175], v[68:71]
    ds_read_b64_tr_b16 v[146:147], v202 offset:2048
    v_mfma_f32_16x16x32_bf16 v[84:87], v[188:191], v[172:175], v[84:87]
    ds_read_b64_tr_b16 v[148:149], v203 offset:0
    v_mfma_f32_16x16x32_bf16 v[80:83], v[188:191], v[168:171], v[80:83]
    ds_read_b64_tr_b16 v[150:151], v203 offset:2048
    v_mfma_f32_16x16x32_bf16 v[76:79], v[188:191], v[164:167], v[76:79]
    ds_read_b64_tr_b16 v[152:153], v202 offset:8192
    v_mfma_f32_16x16x32_bf16 v[72:75], v[188:191], v[160:163], v[72:75]
    ds_read_b64_tr_b16 v[154:155], v202 offset:10240
    v_mfma_f32_16x16x32_bf16 v[88:91], v[160:163], v[192:195], v[88:91]
    ds_read_b64_tr_b16 v[156:157], v203 offset:8192
    v_mfma_f32_16x16x32_bf16 v[92:95], v[164:167], v[192:195], v[92:95]
    ds_read_b64_tr_b16 v[158:159], v203 offset:10240
    v_mfma_f32_16x16x32_bf16 v[96:99], v[168:171], v[192:195], v[96:99]
    v_mfma_f32_16x16x32_bf16 v[100:103], v[172:175], v[192:195], v[100:103]
    v_mfma_f32_16x16x32_bf16 v[116:119], v[172:175], v[196:199], v[116:119]
    v_mfma_f32_16x16x32_bf16 v[112:115], v[168:171], v[196:199], v[112:115]
    v_mfma_f32_16x16x32_bf16 v[108:111], v[164:167], v[196:199], v[108:111]
    v_mfma_f32_16x16x32_bf16 v[104:107], v[160:163], v[196:199], v[104:107]
    s_waitcnt lgkmcnt(0)
    v_mfma_f32_16x16x32_bf16 v[24:27], v[136:139], v[120:123], v[24:27]
    ds_read_b128 v[160:163], v201 offset:32768
    v_mfma_f32_16x16x32_bf16 v[28:31], v[136:139], v[124:127], v[28:31]
    ds_read_b64_tr_b16 v[176:177], v202 offset:36864
    v_mfma_f32_16x16x32_bf16 v[32:35], v[136:139], v[128:131], v[32:35]
    ds_read_b64_tr_b16 v[178:179], v202 offset:38912
    v_mfma_f32_16x16x32_bf16 v[36:39], v[136:139], v[132:135], v[36:39]
    ds_read_b128 v[164:167], v201 offset:34816
    v_mfma_f32_16x16x32_bf16 v[52:55], v[140:143], v[132:135], v[52:55]
    ds_read_b128 v[168:171], v201 offset:36864
    v_mfma_f32_16x16x32_bf16 v[48:51], v[140:143], v[128:131], v[48:51]
    ds_read_b128 v[172:175], v201 offset:38912
    v_mfma_f32_16x16x32_bf16 v[44:47], v[140:143], v[124:127], v[44:47]
    ds_read_b64_tr_b16 v[180:181], v203 offset:36864
    v_mfma_f32_16x16x32_bf16 v[40:43], v[140:143], v[120:123], v[40:43]
    ds_read_b64_tr_b16 v[182:183], v203 offset:38912
    v_mfma_f32_16x16x32_bf16 v[56:59], v[144:147], v[120:123], v[56:59]
    ds_read_b64_tr_b16 v[184:185], v202 offset:4096
    v_mfma_f32_16x16x32_bf16 v[60:63], v[144:147], v[124:127], v[60:63]
    ds_read_b64_tr_b16 v[186:187], v202 offset:6144
    v_mfma_f32_16x16x32_bf16 v[64:67], v[144:147], v[128:131], v[64:67]
    ds_read_b64_tr_b16 v[188:189], v203 offset:4096
    v_mfma_f32_16x16x32_bf16 v[68:71], v[144:147], v[132:135], v[68:71]
    ds_read_b64_tr_b16 v[190:191], v203 offset:6144
    v_mfma_f32_16x16x32_bf16 v[84:87], v[148:151], v[132:135], v[84:87]
    ds_read_b64_tr_b16 v[192:193], v202 offset:12288
    v_mfma_f32_16x16x32_bf16 v[80:83], v[148:151], v[128:131], v[80:83]
    ds_read_b64_tr_b16 v[194:195], v202 offset:14336
    v_mfma_f32_16x16x32_bf16 v[76:79], v[148:151], v[124:127], v[76:79]
    ds_read_b64_tr_b16 v[196:197], v203 offset:12288
    v_mfma_f32_16x16x32_bf16 v[72:75], v[148:151], v[120:123], v[72:75]
    ds_read_b64_tr_b16 v[198:199], v203 offset:14336
    v_mfma_f32_16x16x32_bf16 v[88:91], v[120:123], v[152:155], v[88:91]
    v_mfma_f32_16x16x32_bf16 v[92:95], v[124:127], v[152:155], v[92:95]
    v_mfma_f32_16x16x32_bf16 v[96:99], v[128:131], v[152:155], v[96:99]
    v_mfma_f32_16x16x32_bf16 v[100:103], v[132:135], v[152:155], v[100:103]
    v_mfma_f32_16x16x32_bf16 v[116:119], v[132:135], v[156:159], v[116:119]
    v_mfma_f32_16x16x32_bf16 v[112:115], v[128:131], v[156:159], v[112:115]
    v_mfma_f32_16x16x32_bf16 v[108:111], v[124:127], v[156:159], v[108:111]
    v_mfma_f32_16x16x32_bf16 v[104:107], v[120:123], v[156:159], v[104:107]
    s_waitcnt lgkmcnt(0)
    v_mfma_f32_16x16x32_bf16 v[24:27], v[176:179], v[160:163], v[24:27]
    v_mfma_f32_16x16x32_bf16 v[28:31], v[176:179], v[164:167], v[28:31]
    s_barrier
    v_mfma_f32_16x16x32_bf16 v[32:35], v[176:179], v[168:171], v[32:35]
    ds_read_b128 v[120:123], v200 offset:0
    v_mfma_f32_16x16x32_bf16 v[36:39], v[176:179], v[172:175], v[36:39]
    ds_read_b64_tr_b16 v[136:137], v202 offset:16384
    v_mfma_f32_16x16x32_bf16 v[52:55], v[180:183], v[172:175], v[52:55]
    ds_read_b64_tr_b16 v[138:139], v202 offset:18432
    v_mfma_f32_16x16x32_bf16 v[48:51], v[180:183], v[168:171], v[48:51]
    ds_read_b128 v[124:127], v200 offset:2048
    v_mfma_f32_16x16x32_bf16 v[44:47], v[180:183], v[164:167], v[44:47]
    ds_read_b128 v[128:131], v200 offset:4096
    v_mfma_f32_16x16x32_bf16 v[40:43], v[180:183], v[160:163], v[40:43]
    ds_read_b128 v[132:135], v200 offset:6144
    v_mfma_f32_16x16x32_bf16 v[56:59], v[184:187], v[160:163], v[56:59]
    ds_read_b64_tr_b16 v[140:141], v203 offset:16384
    v_mfma_f32_16x16x32_bf16 v[60:63], v[184:187], v[164:167], v[60:63]
    ds_read_b64_tr_b16 v[142:143], v203 offset:18432
    v_mfma_f32_16x16x32_bf16 v[64:67], v[184:187], v[168:171], v[64:67]
    ds_read_b64_tr_b16 v[144:145], v204 offset:0
    v_mfma_f32_16x16x32_bf16 v[68:71], v[184:187], v[172:175], v[68:71]
    ds_read_b64_tr_b16 v[146:147], v204 offset:2048
    v_mfma_f32_16x16x32_bf16 v[84:87], v[188:191], v[172:175], v[84:87]
    ds_read_b64_tr_b16 v[148:149], v205 offset:0
    v_mfma_f32_16x16x32_bf16 v[80:83], v[188:191], v[168:171], v[80:83]
    ds_read_b64_tr_b16 v[150:151], v205 offset:2048
    v_mfma_f32_16x16x32_bf16 v[76:79], v[188:191], v[164:167], v[76:79]
    ds_read_b64_tr_b16 v[152:153], v204 offset:8192
    v_mfma_f32_16x16x32_bf16 v[72:75], v[188:191], v[160:163], v[72:75]
    ds_read_b64_tr_b16 v[154:155], v204 offset:10240
    v_mfma_f32_16x16x32_bf16 v[88:91], v[160:163], v[192:195], v[88:91]
    ds_read_b64_tr_b16 v[156:157], v205 offset:8192
    v_mfma_f32_16x16x32_bf16 v[92:95], v[164:167], v[192:195], v[92:95]
    ds_read_b64_tr_b16 v[158:159], v205 offset:10240
    v_mfma_f32_16x16x32_bf16 v[96:99], v[168:171], v[192:195], v[96:99]
    s_add_u32 s96, s96, 3
    v_mfma_f32_16x16x32_bf16 v[100:103], v[172:175], v[192:195], v[100:103]
    s_cmp_lt_u32 s96, 12
    v_mfma_f32_16x16x32_bf16 v[116:119], v[172:175], v[196:199], v[116:119]
    v_mfma_f32_16x16x32_bf16 v[112:115], v[168:171], v[196:199], v[112:115]
    v_mfma_f32_16x16x32_bf16 v[108:111], v[164:167], v[196:199], v[108:111]
    v_mfma_f32_16x16x32_bf16 v[104:107], v[160:163], v[196:199], v[104:107]
    s_cbranch_scc1 L_cloop
    s_bitcmp1_b32 s22, 0
    s_cbranch_scc1 L_ctailB
    s_waitcnt lgkmcnt(0)
    v_mfma_f32_16x16x32_bf16 v[24:27], v[136:139], v[120:123], v[24:27]
    ds_read_b128 v[160:163], v201 offset:0
    v_mfma_f32_16x16x32_bf16 v[28:31], v[136:139], v[124:127], v[28:31]
    ds_read_b64_tr_b16 v[184:185], v204 offset:4096
    v_mfma_f32_16x16x32_bf16 v[32:35], v[136:139], v[128:131], v[32:35]
    ds_read_b64_tr_b16 v[186:187], v204 offset:6144
    v_mfma_f32_16x16x32_bf16 v[36:39], v[136:139], v[132:135], v[36:39]
    ds_read_b128 v[164:167], v201 offset:2048
    v_mfma_f32_16x16x32_bf16 v[52:55], v[140:143], v[132:135], v[52:55]
    ds_read_b128 v[168:171], v201 offset:4096
    v_mfma_f32_16x16x32_bf16 v[48:51], v[140:143], v[128:131], v[48:51]
    ds_read_b128 v[172:175], v201 offset:6144
    v_mfma_f32_16x16x32_bf16 v[44:47], v[140:143], v[124:127], v[44:47]
    ds_read_b64_tr_b16 v[188:189], v205 offset:4096
    v_mfma_f32_16x16x32_bf16 v[40:43], v[140:143], v[120:123], v[40:43]
    ds_read_b64_tr_b16 v[190:191], v205 offset:6144
    v_mfma_f32_16x16x32_bf16 v[56:59], v[144:147], v[120:123], v[56:59]
    ds_read_b64_tr_b16 v[192:193], v204 offset:12288
    v_mfma_f32_16x16x32_bf16 v[60:63], v[144:147], v[124:127], v[60:63]
    ds_read_b64_tr_b16 v[194:195], v204 offset:14336
    v_mfma_f32_16x16x32_bf16 v[64:67], v[144:147], v[128:131], v[64:67]
    ds_read_b64_tr_b16 v[196:197], v205 offset:12288
    v_mfma_f32_16x16x32_bf16 v[68:71], v[144:147], v[132:135], v[68:71]
    ds_read_b64_tr_b16 v[198:199], v205 offset:14336
    v_mfma_f32_16x16x32_bf16 v[84:87], v[148:151], v[132:135], v[84:87]
    v_mfma_f32_16x16x32_bf16 v[80:83], v[148:151], v[128:131], v[80:83]
    v_mfma_f32_16x16x32_bf16 v[76:79], v[148:151], v[124:127], v[76:79]
    v_mfma_f32_16x16x32_bf16 v[72:75], v[148:151], v[120:123], v[72:75]
    v_mfma_f32_16x16x32_bf16 v[88:91], v[120:123], v[152:155], v[88:91]
    v_mfma_f32_16x16x32_bf16 v[92:95], v[124:127], v[152:155], v[92:95]
    v_mfma_f32_16x16x32_bf16 v[96:99], v[128:131], v[152:155], v[96:99]
    v_mfma_f32_16x16x32_bf16 v[100:103], v[132:135], v[152:155], v[100:103]
    v_mfma_f32_16x16x32_bf16 v[116:119], v[132:135], v[156:159], v[116:119]
    v_mfma_f32_16x16x32_bf16 v[112:115], v[128:131], v[156:159], v[112:115]
    v_mfma_f32_16x16x32_bf16 v[108:111], v[124:127], v[156:159], v[108:111]
    v_mfma_f32_16x16x32_bf16 v[104:107], v[120:123], v[156:159], v[104:107]
    s_waitcnt lgkmcnt(0)
    s_barrier
    v_mfma_f32_16x16x32_bf16 v[56:59], v[184:187], v[160:163], v[56:59]
    ds_read_b128 v[120:123], v200 offset:16384
    v_mfma_f32_16x16x32_bf16 v[60:63], v[184:187], v[164:167], v[60:63]
    ds_read_b64_tr_b16 v[144:145], v204 offset:16384
    v_mfma_f32_16x16x32_bf16 v[64:67], v[184:187], v[168:171], v[64:67]
    ds_read_b64_tr_b16 v[146:147], v204 offset:18432
    v_mfma_f32_16x16x32_bf16 v[68:71], v[184:187], v[172:175], v[68:71]
    ds_read_b128 v[124:127], v200 offset:18432
    v_mfma_f32_16x16x32_bf16 v[84:87], v[188:191], v[172:175], v[84:87]
    ds_read_b128 v[128:131], v200 offset:20480
    v_mfma_f32_16x16x32_bf16 v[80:83], v[188:191], v[168:171], v[80:83]
    ds_read_b128 v[132:135], v200 offset:22528
    v_mfma_f32_16x16x32_bf16 v[76:79], v[188:191], v[164:167], v[76:79]
    ds_read_b64_tr_b16 v[148:149], v205 offset:16384
    v_mfma_f32_16x16x32_bf16 v[72:75], v[188:191], v[160:163], v[72:75]
    ds_read_b64_tr_b16 v[150:151], v205 offset:18432
    v_mfma_f32_16x16x32_bf16 v[88:91], v[160:163], v[192:195], v[88:91]
    ds_read_b64_tr_b16 v[152:153], v204 offset:24576
    v_mfma_f32_16x16x32_bf16 v[92:95], v[164:167], v[192:195], v[92:95]
    ds_read_b64_tr_b16 v[154:155], v204 offset:26624
    v_mfma_f32_16x16x32_bf16 v[96:99], v[168:171], v[192:195], v[96:99]
    ds_read_b64_tr_b16 v[156:157], v205 offset:24576
    v_mfma_f32_16x16x32_bf16 v[100:103], v[172:175], v[192:195], v[100:103]
    ds_read_b64_tr_b16 v[158:159], v205 offset:26624
    v_mfma_f32_16x16x32_bf16 v[116:119], v[172:175], v[196:199], v[116:119]
    v_mfma_f32_16x16x32_bf16 v[112:115], v[168:171], v[196:199], v[112:115]
    v_mfma_f32_16x16x32_bf16 v[108:111], v[164:167], v[196:199], v[108:111]
    v_mfma_f32_16x16x32_bf16 v[104:107], v[160:163], v[196:199], v[104:107]
    s_waitcnt lgkmcnt(1)
    v_mfma_f32_16x16x32_bf16 v[56:59], v[144:147], v[120:123], v[56:59]
    ds_read_b128 v[160:163], v201 offset:16384
    v_mfma_f32_16x16x32_bf16 v[60:63], v[144:147], v[124:127], v[60:63]
    ds_read_b64_tr_b16 v[184:185], v204 offset:20480
    v_mfma_f32_16x16x32_bf16 v[64:67], v[144:147], v[128:131], v[64:67]
    ds_read_b64_tr_b16 v[186:187], v204 offset:22528
    v_mfma_f32_16x16x32_bf16 v[68:71], v[144:147], v[132:135], v[68:71]
    ds_read_b128 v[164:167], v201 offset:18432
    v_mfma_f32_16x16x32_bf16 v[84:87], v[148:151], v[132:135], v[84:87]
    ds_read_b128 v[168:171], v201 offset:20480
    v_mfma_f32_16x16x32_bf16 v[80:83], v[148:151], v[128:131], v[80:83]
    ds_read_b128 v[172:175], v201 offset:22528
    v_mfma_f32_16x16x32_bf16 v[76:79], v[148:151], v[124:127], v[76:79]
    ds_read_b64_tr_b16 v[188:189], v205 offset:20480
    v_mfma_f32_16x16x32_bf16 v[72:75], v[148:151], v[120:123], v[72:75]
    ds_read_b64_tr_b16 v[190:191], v205 offset:22528
    v_mfma_f32_16x16x32_bf16 v[88:91], v[120:123], v[152:155], v[88:91]
    ds_read_b64_tr_b16 v[192:193], v204 offset:28672
    v_mfma_f32_16x16x32_bf16 v[92:95], v[124:127], v[152:155], v[92:95]
    ds_read_b64_tr_b16 v[194:195], v204 offset:30720
    v_mfma_f32_16x16x32_bf16 v[96:99], v[128:131], v[152:155], v[96:99]
    ds_read_b64_tr_b16 v[196:197], v205 offset:28672
    v_mfma_f32_16x16x32_bf16 v[100:103], v[132:135], v[152:155], v[100:103]
    ds_read_b64_tr_b16 v[198:199], v205 offset:30720
    s_waitcnt lgkmcnt(5)
    v_mfma_f32_16x16x32_bf16 v[116:119], v[132:135], v[156:159], v[116:119]
    v_mfma_f32_16x16x32_bf16 v[112:115], v[128:131], v[156:159], v[112:115]
    v_mfma_f32_16x16x32_bf16 v[108:111], v[124:127], v[156:159], v[108:111]
    v_mfma_f32_16x16x32_bf16 v[104:107], v[120:123], v[156:159], v[104:107]
    s_waitcnt lgkmcnt(0)
    s_barrier
    v_mfma_f32_16x16x32_bf16 v[56:59], v[184:187], v[160:163], v[56:59]
    ds_read_b128 v[120:123], v200 offset:32768
    v_mfma_f32_16x16x32_bf16 v[60:63], v[184:187], v[164:167], v[60:63]
    ds_read_b64_tr_b16 v[144:145], v202 offset:0
    v_mfma_f32_16x16x32_bf16 v[64:67], v[184:187], v[168:171], v[64:67]
    ds_read_b64_tr_b16 v[146:147], v202 offset:2048
    v_mfma_f32_16x16x32_bf16 v[68:71], v[184:187], v[172:175], v[68:71]
    ds_read_b128 v[124:127], v200 offset:34816
    v_mfma_f32_16x16x32_bf16 v[84:87], v[188:191], v[172:175], v[84:87]
    ds_read_b128 v[128:131], v200 offset:36864
    v_mfma_f32_16x16x32_bf16 v[80:83], v[188:191], v[168:171], v[80:83]
    ds_read_b128 v[132:135], v200 offset:38912
    v_mfma_f32_16x16x32_bf16 v[76:79], v[188:191], v[164:167], v[76:79]
    ds_read_b64_tr_b16 v[148:149], v203 offset:0
    v_mfma_f32_16x16x32_bf16 v[72:75], v[188:191], v[160:163], v[72:75]
    ds_read_b64_tr_b16 v[150:151], v203 offset:2048
    v_mfma_f32_16x16x32_bf16 v[88:91], v[160:163], v[192:195], v[88:91]
    ds_read_b64_tr_b16 v[152:153], v202 offset:8192
    v_mfma_f32_16x16x32_bf16 v[92:95], v[164:167], v[192:195], v[92:95]
    ds_read_b64_tr_b16 v[154:155], v202 offset:10240
    v_mfma_f32_16x16x32_bf16 v[96:99], v[168:171], v[192:195], v[96:99]
    ds_read_b64_tr_b16 v[156:157], v203 offset:8192
    v_mfma_f32_16x16x32_bf16 v[100:103], v[172:175], v[192:195], v[100:103]
    ds_read_b64_tr_b16 v[158:159], v203 offset:10240
    v_mfma_f32_16x16x32_bf16 v[116:119], v[172:175], v[196:199], v[116:119]
    v_mfma_f32_16x16x32_bf16 v[112:115], v[168:171], v[196:199], v[112:115]
    v_mfma_f32_16x16x32_bf16 v[108:111], v[164:167], v[196:199], v[108:111]
    v_mfma_f32_16x16x32_bf16 v[104:107], v[160:163], v[196:199], v[104:107]
    s_waitcnt lgkmcnt(1)
    v_mfma_f32_16x16x32_bf16 v[56:59], v[144:147], v[120:123], v[56:59]
    ds_read_b128 v[160:163], v201 offset:32768
    v_mfma_f32_16x16x32_bf16 v[60:63], v[144:147], v[124:127], v[60:63]
    ds_read_b64_tr_b16 v[184:185], v202 offset:4096
    v_mfma_f32_16x16x32_bf16 v[64:67], v[144:147], v[128:131], v[64:67]
    ds_read_b64_tr_b16 v[186:187], v202 offset:6144
    v_mfma_f32_16x16x32_bf16 v[68:71], v[144:147], v[132:135], v[68:71]
    ds_read_b128 v[164:167], v201 offset:34816
    v_mfma_f32_16x16x32_bf16 v[84:87], v[148:151], v[132:135], v[84:87]
    ds_read_b128 v[168:171], v201 offset:36864
    v_mfma_f32_16x16x32_bf16 v[80:83], v[148:151], v[128:131], v[80:83]
    ds_read_b128 v[172:175], v201 offset:38912
    v_mfma_f32_16x16x32_bf16 v[76:79], v[148:151], v[124:127], v[76:79]
    ds_read_b64_tr_b16 v[188:189], v203 offset:4096
    v_mfma_f32_16x16x32_bf16 v[72:75], v[148:151], v[120:123], v[72:75]
    ds_read_b64_tr_b16 v[190:191], v203 offset:6144
    v_mfma_f32_16x16x32_bf16 v[88:91], v[120:123], v[152:155], v[88:91]
    ds_read_b64_tr_b16 v[192:193], v202 offset:12288
    v_mfma_f32_16x16x32_bf16 v[92:95], v[124:127], v[152:155], v[92:95]
    ds_read_b64_tr_b16 v[194:195], v202 offset:14336
    v_mfma_f32_16x16x32_bf16 v[96:99], v[128:131], v[152:155], v[96:99]
    ds_read_b64_tr_b16 v[196:197], v203 offset:12288
    v_mfma_f32_16x16x32_bf16 v[100:103], v[132:135], v[152:155], v[100:103]
    ds_read_b64_tr_b16 v[198:199], v203 offset:14336
    s_waitcnt lgkmcnt(5)
    v_mfma_f32_16x16x32_bf16 v[116:119], v[132:135], v[156:159], v[116:119]
    v_add_u32 v176, s48, v0
    v_mfma_f32_16x16x32_bf16 v[112:115], v[128:131], v[156:159], v[112:115]
    s_add_u32 s27, s63, 8192
    v_mfma_f32_16x16x32_bf16 v[108:111], v[124:127], v[156:159], v[108:111]
    v_mov_b32 v255, 92928
    v_mfma_f32_16x16x32_bf16 v[104:107], v[120:123], v[156:159], v[104:107]
    s_waitcnt lgkmcnt(0)
    s_barrier
    v_mfma_f32_16x16x32_bf16 v[56:59], v[184:187], v[160:163], v[56:59]
    ds_read_b32 v255, v255
    ds_read_b128 v[152:155], v209 offset:256
    v_mfma_f32_16x16x32_bf16 v[60:63], v[184:187], v[164:167], v[60:63]
    ds_read_b128 v[156:159], v209 offset:320
    ds_read_b64 v[236:237], v207 offset:1280
    v_mfma_f32_16x16x32_bf16 v[64:67], v[184:187], v[168:171], v[64:67]
    ds_read_b64 v[238:239], v207 offset:1408
    v_mfma_f32_16x16x32_bf16 v[68:71], v[184:187], v[172:175], v[68:71]
    ds_read_b64 v[232:233], v207 offset:1024
    ds_read_b64 v[234:235], v207 offset:1152
    v_mfma_f32_16x16x32_bf16 v[84:87], v[188:191], v[172:175], v[84:87]
    ds_read_b32 v248, v210 offset:512
    v_mfma_f32_16x16x32_bf16 v[80:83], v[188:191], v[168:171], v[80:83]
    ds_read_b32 v249, v210 offset:576
    ds_read_b128 v[128:131], v208 offset:128
    v_mfma_f32_16x16x32_bf16 v[76:79], v[188:191], v[164:167], v[76:79]
    ds_read_b128 v[144:147], v208 offset:640
    ds_read_b128 v[132:135], v208 offset:192
    v_mfma_f32_16x16x32_bf16 v[72:75], v[188:191], v[160:163], v[72:75]
    ds_read_b128 v[148:151], v208 offset:704
    v_mfma_f32_16x16x32_bf16 v[88:91], v[160:163], v[192:195], v[88:91]
    ds_read_b128 v[120:123], v208 offset:0
    ds_read_b128 v[136:139], v208 offset:512
    v_mfma_f32_16x16x32_bf16 v[92:95], v[164:167], v[192:195], v[92:95]
    ds_read_b128 v[124:127], v208 offset:64
    v_mfma_f32_16x16x32_bf16 v[96:99], v[168:171], v[192:195], v[96:99]
    ds_read_b128 v[140:143], v208 offset:576
    ds_read_b128 v[240:243], v209 offset:0
    v_mfma_f32_16x16x32_bf16 v[100:103], v[172:175], v[192:195], v[100:103]
    ds_read_b128 v[244:247], v209 offset:64
    v_mfma_f32_16x16x32_bf16 v[116:119], v[172:175], v[196:199], v[116:119]
    v_mfma_f32_16x16x32_bf16 v[112:115], v[168:171], v[196:199], v[112:115]
    v_mfma_f32_16x16x32_bf16 v[108:111], v[164:167], v[196:199], v[108:111]
    v_mfma_f32_16x16x32_bf16 v[104:107], v[160:163], v[196:199], v[104:107]
    v_mov_b32 v199, v176
    s_waitcnt lgkmcnt(1)
    v_readfirstlane_b32 s23, v255
    v_pk_mul_f32 v[250:251], v[236:237], v[152:153] op_sel:[1,0] op_sel_hi:[1,1]
    v_pk_fma_f32 v[250:251], v[64:65], v[236:237], v[250:251] op_sel_hi:[1,0,1]
    v_pk_mul_f32 v[252:253], v[236:237], v[154:155] op_sel:[1,0] op_sel_hi:[1,1]
    v_cvt_pk_bf16_f32 v64, v250, v251
    v_pk_fma_f32 v[252:253], v[66:67], v[236:237], v[252:253] op_sel_hi:[1,0,1]
    v_pk_mul_f32 v[254:255], v[236:237], v[156:157] op_sel:[1,0] op_sel_hi:[1,1]
    v_cvt_pk_bf16_f32 v65, v252, v253
    v_pk_fma_f32 v[254:255], v[80:81], v[236:237], v[254:255] op_sel_hi:[1,0,1]
    v_pk_mul_f32 v[250:251], v[236:237], v[158:159] op_sel:[1,0] op_sel_hi:[1,1]
    v_cvt_pk_bf16_f32 v66, v254, v255
    v_pk_fma_f32 v[250:251], v[82:83], v[236:237], v[250:251] op_sel_hi:[1,0,1]
    v_pk_mul_f32 v[252:253], v[238:239], v[152:153] op_sel:[1,0] op_sel_hi:[1,1]
    v_cvt_pk_bf16_f32 v67, v250, v251
    v_pk_fma_f32 v[252:253], v[68:69], v[238:239], v[252:253] op_sel_hi:[1,0,1]
    v_pk_mul_f32 v[254:255], v[238:239], v[154:155] op_sel:[1,0] op_sel_hi:[1,1]
    buffer_store_dwordx4 v[64:67], v0, s[12:15], s27 offen offset:0 sc1
    ds_write_b128 v199, v[64:67] offset:8192
    v_cvt_pk_bf16_f32 v68, v252, v253
    v_pk_fma_f32 v[254:255], v[70:71], v[238:239], v[254:255] op_sel_hi:[1,0,1]
    v_pk_mul_f32 v[250:251], v[238:239], v[156:157] op_sel:[1,0] op_sel_hi:[1,1]
    v_cvt_pk_bf16_f32 v69, v254, v255
    v_pk_fma_f32 v[250:251], v[84:85], v[238:239], v[250:251] op_sel_hi:[1,0,1]
    v_pk_mul_f32 v[252:253], v[238:239], v[158:159] op_sel:[1,0] op_sel_hi:[1,1]
    v_cvt_pk_bf16_f32 v70, v250, v251
    v_pk_fma_f32 v[252:253], v[86:87], v[238:239], v[252:253] op_sel_hi:[1,0,1]
    v_pk_mul_f32 v[254:255], v[144:145], v[248:249] op_sel_hi:[1,0]
    v_cvt_pk_bf16_f32 v71, v252, v253
    v_pk_fma_f32 v[254:255], v[96:97], v[128:129], v[254:255]
    v_pk_mul_f32 v[250:251], v[146:147], v[248:249] op_sel_hi:[1,0]
    buffer_store_dwordx4 v[68:71], v0, s[12:15], s27 offen offset:1024 sc1
    ds_write_b128 v199, v[68:71] offset:9216
    v_cvt_pk_bf16_f32 v96, v254, v255
    v_pk_fma_f32 v[250:251], v[98:99], v[130:131], v[250:251]
    v_pk_mul_f32 v[252:253], v[148:149], v[248:249] op_sel_hi:[1,0]
    v_cvt_pk_bf16_f32 v97, v250, v251
    v_pk_fma_f32 v[252:253], v[100:101], v[132:133], v[252:253]
    v_pk_mul_f32 v[254:255], v[150:151], v[248:249] op_sel_hi:[1,0]
    v_cvt_pk_bf16_f32 v98, v252, v253
    v_pk_fma_f32 v[254:255], v[102:103], v[134:135], v[254:255]
    v_pk_mul_f32 v[250:251], v[248:249], v[144:145] op_sel:[1,0] op_sel_hi:[1,1]
    v_cvt_pk_bf16_f32 v99, v254, v255
    v_pk_fma_f32 v[250:251], v[112:113], v[128:129], v[250:251]
    v_pk_mul_f32 v[252:253], v[248:249], v[146:147] op_sel:[1,0] op_sel_hi:[1,1]
    buffer_store_dwordx4 v[96:99], v0, s[12:15], s27 offen offset:2048 sc1
    ds_write_b128 v199, v[96:99] offset:10240
    v_cvt_pk_bf16_f32 v112, v250, v251
    v_pk_fma_f32 v[252:253], v[114:115], v[130:131], v[252:253]
    v_pk_mul_f32 v[254:255], v[248:249], v[148:149] op_sel:[1,0] op_sel_hi:[1,1]
    v_cvt_pk_bf16_f32 v113, v252, v253
    v_pk_fma_f32 v[254:255], v[116:117], v[132:133], v[254:255]
    v_pk_mul_f32 v[250:251], v[248:249], v[150:151] op_sel:[1,0] op_sel_hi:[1,1]
    v_cvt_pk_bf16_f32 v114, v254, v255
    v_pk_fma_f32 v[250:251], v[118:119], v[134:135], v[250:251]
    v_pk_mul_f32 v[252:253], v[232:233], v[152:153] op_sel:[1,0] op_sel_hi:[1,1]
    v_cvt_pk_bf16_f32 v115, v250, v251
    v_pk_fma_f32 v[252:253], v[56:57], v[232:233], v[252:253] op_sel_hi:[1,0,1]
    v_pk_mul_f32 v[254:255], v[232:233], v[154:155] op_sel:[1,0] op_sel_hi:[1,1]
    buffer_store_dwordx4 v[112:115], v0, s[12:15], s27 offen offset:3072 sc1
    ds_write_b128 v199, v[112:115] offset:11264
    v_cvt_pk_bf16_f32 v56, v252, v253
    v_pk_fma_f32 v[254:255], v[58:59], v[232:233], v[254:255] op_sel_hi:[1,0,1]
    v_pk_mul_f32 v[250:251], v[232:233], v[156:157] op_sel:[1,0] op_sel_hi:[1,1]
    v_cvt_pk_bf16_f32 v57, v254, v255
    v_pk_fma_f32 v[250:251], v[72:73], v[232:233], v[250:251] op_sel_hi:[1,0,1]
    v_pk_mul_f32 v[252:253], v[232:233], v[158:159] op_sel:[1,0] op_sel_hi:[1,1]
    v_cvt_pk_bf16_f32 v58, v250, v251
    v_pk_fma_f32 v[252:253], v[74:75], v[232:233], v[252:253] op_sel_hi:[1,0,1]
    v_pk_mul_f32 v[254:255], v[234:235], v[152:153] op_sel:[1,0] op_sel_hi:[1,1]
    v_cvt_pk_bf16_f32 v59, v252, v253
    v_pk_fma_f32 v[254:255], v[60:61], v[234:235], v[254:255] op_sel_hi:[1,0,1]
    v_pk_mul_f32 v[250:251], v[234:235], v[154:155] op_sel:[1,0] op_sel_hi:[1,1]
    buffer_store_dwordx4 v[56:59], v0, s[12:15], s63 offen offset:0 sc1
    ds_write_b128 v199, v[56:59] offset:0
    v_cvt_pk_bf16_f32 v60, v254, v255
    v_pk_fma_f32 v[250:251], v[62:63], v[234:235], v[250:251] op_sel_hi:[1,0,1]
    v_pk_mul_f32 v[252:253], v[234:235], v[156:157] op_sel:[1,0] op_sel_hi:[1,1]
    v_cvt_pk_bf16_f32 v61, v250, v251
    v_pk_fma_f32 v[252:253], v[76:77], v[234:235], v[252:253] op_sel_hi:[1,0,1]
    v_pk_mul_f32 v[254:255], v[234:235], v[158:159] op_sel:[1,0] op_sel_hi:[1,1]
    v_cvt_pk_bf16_f32 v62, v252, v253
    v_pk_fma_f32 v[254:255], v[78:79], v[234:235], v[254:255] op_sel_hi:[1,0,1]
    v_pk_mul_f32 v[250:251], v[136:137], v[248:249] op_sel_hi:[1,0]
    v_cvt_pk_bf16_f32 v63, v254, v255
    v_pk_fma_f32 v[250:251], v[88:89], v[120:121], v[250:251]
    v_pk_mul_f32 v[252:253], v[138:139], v[248:249] op_sel_hi:[1,0]
    buffer_store_dwordx4 v[60:63], v0, s[12:15], s63 offen offset:1024 sc1
    ds_write_b128 v199, v[60:63] offset:1024
    ds_read_b128 v[160:163], v201 offset:0
    ds_read_b64_tr_b16 v[176:177], v202 offset:20480
    ds_read_b64_tr_b16 v[178:179], v202 offset:22528
    ds_read_b128 v[164:167], v201 offset:2048
    ds_read_b128 v[168:171], v201 offset:4096
    ds_read_b128 v[172:175], v201 offset:6144
    ds_read_b64_tr_b16 v[180:181], v203 offset:20480
    ds_read_b64_tr_b16 v[182:183], v203 offset:22528
    v_cvt_pk_bf16_f32 v88, v250, v251
    v_pk_fma_f32 v[252:253], v[90:91], v[122:123], v[252:253]
    v_pk_mul_f32 v[254:255], v[140:141], v[248:249] op_sel_hi:[1,0]
    v_cvt_pk_bf16_f32 v89, v252, v253
    v_pk_fma_f32 v[254:255], v[92:93], v[124:125], v[254:255]
    v_pk_mul_f32 v[250:251], v[142:143], v[248:249] op_sel_hi:[1,0]
    v_cvt_pk_bf16_f32 v90, v254, v255
    v_pk_fma_f32 v[250:251], v[94:95], v[126:127], v[250:251]
    v_pk_mul_f32 v[252:253], v[248:249], v[136:137] op_sel:[1,0] op_sel_hi:[1,1]
    v_cvt_pk_bf16_f32 v91, v250, v251
    v_pk_fma_f32 v[252:253], v[104:105], v[120:121], v[252:253]
    v_pk_mul_f32 v[254:255], v[248:249], v[138:139] op_sel:[1,0] op_sel_hi:[1,1]
    buffer_store_dwordx4 v[88:91], v0, s[12:15], s63 offen offset:2048 sc1
    ds_write_b128 v199, v[88:91] offset:2048
    v_cvt_pk_bf16_f32 v104, v252, v253
    v_pk_fma_f32 v[254:255], v[106:107], v[122:123], v[254:255]
    v_pk_mul_f32 v[250:251], v[248:249], v[140:141] op_sel:[1,0] op_sel_hi:[1,1]
    v_cvt_pk_bf16_f32 v105, v254, v255
    v_pk_fma_f32 v[250:251], v[108:109], v[124:125], v[250:251]
    v_pk_mul_f32 v[252:253], v[248:249], v[142:143] op_sel:[1,0] op_sel_hi:[1,1]
    v_cvt_pk_bf16_f32 v106, v250, v251
    v_pk_fma_f32 v[252:253], v[110:111], v[126:127], v[252:253]
    v_cvt_pk_bf16_f32 v107, v252, v253
    buffer_store_dwordx4 v[104:107], v0, s[12:15], s63 offen offset:3072 sc1
    ds_write_b128 v199, v[104:107] offset:3072
    s_waitcnt lgkmcnt(2)
    v_mfma_f32_16x16x32_bf16 v[24:27], v[176:179], v[160:163], v[24:27]
    ds_read_b128 v[120:123], v200 offset:16384
    v_mfma_f32_16x16x32_bf16 v[28:31], v[176:179], v[164:167], v[28:31]
    ds_read_b64_tr_b16 v[136:137], v202 offset:24576
    v_mfma_f32_16x16x32_bf16 v[32:35], v[176:179], v[168:171], v[32:35]
    ds_read_b64_tr_b16 v[138:139], v202 offset:26624
    v_mfma_f32_16x16x32_bf16 v[36:39], v[176:179], v[172:175], v[36:39]
    ds_read_b128 v[124:127], v200 offset:18432
    v_mfma_f32_16x16x32_bf16 v[52:55], v[180:183], v[172:175], v[52:55]
    ds_read_b128 v[128:131], v200 offset:20480
    v_mfma_f32_16x16x32_bf16 v[48:51], v[180:183], v[168:171], v[48:51]
    ds_read_b128 v[132:135], v200 offset:22528
    v_mfma_f32_16x16x32_bf16 v[44:47], v[180:183], v[164:167], v[44:47]
    ds_read_b64_tr_b16 v[140:141], v203 offset:24576
    v_mfma_f32_16x16x32_bf16 v[40:43], v[180:183], v[160:163], v[40:43]
    ds_read_b64_tr_b16 v[142:143], v203 offset:26624
    s_waitcnt lgkmcnt(5)
    v_mfma_f32_16x16x32_bf16 v[24:27], v[136:139], v[120:123], v[24:27]
    ds_read_b128 v[160:163], v201 offset:16384
    s_waitcnt lgkmcnt(5)
    v_mfma_f32_16x16x32_bf16 v[28:31], v[136:139], v[124:127], v[28:31]
    ds_read_b64_tr_b16 v[176:177], v202 offset:28672
    s_waitcnt lgkmcnt(5)
    v_mfma_f32_16x16x32_bf16 v[32:35], v[136:139], v[128:131], v[32:35]
    ds_read_b64_tr_b16 v[178:179], v202 offset:30720
    s_waitcnt lgkmcnt(5)
    v_mfma_f32_16x16x32_bf16 v[36:39], v[136:139], v[132:135], v[36:39]
    ds_read_b128 v[164:167], v201 offset:18432
    s_waitcnt lgkmcnt(4)
    v_mfma_f32_16x16x32_bf16 v[52:55], v[140:143], v[132:135], v[52:55]
    ds_read_b128 v[168:171], v201 offset:20480
    v_mfma_f32_16x16x32_bf16 v[48:51], v[140:143], v[128:131], v[48:51]
    ds_read_b128 v[172:175], v201 offset:22528
    v_mfma_f32_16x16x32_bf16 v[44:47], v[140:143], v[124:127], v[44:47]
    ds_read_b64_tr_b16 v[180:181], v203 offset:28672
    v_mfma_f32_16x16x32_bf16 v[40:43], v[140:143], v[120:123], v[40:43]
    ds_read_b64_tr_b16 v[182:183], v203 offset:30720
    s_waitcnt lgkmcnt(5)
    v_mfma_f32_16x16x32_bf16 v[24:27], v[176:179], v[160:163], v[24:27]
    ds_read_b128 v[120:123], v200 offset:32768
    s_waitcnt lgkmcnt(5)
    v_mfma_f32_16x16x32_bf16 v[28:31], v[176:179], v[164:167], v[28:31]
    ds_read_b64_tr_b16 v[136:137], v202 offset:32768
    s_waitcnt lgkmcnt(5)
    v_mfma_f32_16x16x32_bf16 v[32:35], v[176:179], v[168:171], v[32:35]
    ds_read_b64_tr_b16 v[138:139], v202 offset:34816
    s_waitcnt lgkmcnt(5)
    v_mfma_f32_16x16x32_bf16 v[36:39], v[176:179], v[172:175], v[36:39]
    ds_read_b128 v[124:127], v200 offset:34816
    s_waitcnt lgkmcnt(4)
    v_mfma_f32_16x16x32_bf16 v[52:55], v[180:183], v[172:175], v[52:55]
    ds_read_b128 v[128:131], v200 offset:36864
    v_mfma_f32_16x16x32_bf16 v[48:51], v[180:183], v[168:171], v[48:51]
    ds_read_b128 v[132:135], v200 offset:38912
    v_mfma_f32_16x16x32_bf16 v[44:47], v[180:183], v[164:167], v[44:47]
    ds_read_b64_tr_b16 v[140:141], v203 offset:32768
    v_mfma_f32_16x16x32_bf16 v[40:43], v[180:183], v[160:163], v[40:43]
    ds_read_b64_tr_b16 v[142:143], v203 offset:34816
    s_waitcnt lgkmcnt(5)
    v_mfma_f32_16x16x32_bf16 v[24:27], v[136:139], v[120:123], v[24:27]
    ds_read_b128 v[160:163], v201 offset:32768
    s_waitcnt lgkmcnt(5)
    v_mfma_f32_16x16x32_bf16 v[28:31], v[136:139], v[124:127], v[28:31]
    ds_read_b64_tr_b16 v[176:177], v202 offset:36864
    s_waitcnt lgkmcnt(5)
    v_mfma_f32_16x16x32_bf16 v[32:35], v[136:139], v[128:131], v[32:35]
    ds_read_b64_tr_b16 v[178:179], v202 offset:38912
    s_waitcnt lgkmcnt(5)
    v_mfma_f32_16x16x32_bf16 v[36:39], v[136:139], v[132:135], v[36:39]
    ds_read_b128 v[164:167], v201 offset:34816
    s_waitcnt lgkmcnt(4)
    v_mfma_f32_16x16x32_bf16 v[52:55], v[140:143], v[132:135], v[52:55]
    ds_read_b128 v[168:171], v201 offset:36864
    v_mfma_f32_16x16x32_bf16 v[48:51], v[140:143], v[128:131], v[48:51]
    ds_read_b128 v[172:175], v201 offset:38912
    v_mfma_f32_16x16x32_bf16 v[44:47], v[140:143], v[124:127], v[44:47]
    ds_read_b64_tr_b16 v[180:181], v203 offset:36864
    v_mfma_f32_16x16x32_bf16 v[40:43], v[140:143], v[120:123], v[40:43]
    ds_read_b64_tr_b16 v[182:183], v203 offset:38912
    s_waitcnt lgkmcnt(3)
    v_mfma_f32_16x16x32_bf16 v[32:35], v[176:179], v[168:171], v[32:35]
    v_mul_f32 v232, 1048744942, v232
    v_mul_f32 v233, 1048744942, v233
    s_waitcnt lgkmcnt(0)
    v_mfma_f32_16x16x32_bf16 v[48:51], v[180:183], v[168:171], v[48:51]
    v_mul_f32 v234, 1048744942, v234
    v_mul_f32 v235, 1048744942, v235
    v_mfma_f32_16x16x32_bf16 v[52:55], v[180:183], v[172:175], v[52:55]
    v_mul_f32 v236, 1048744942, v236
    v_mul_f32 v237, 1048744942, v237
    v_mfma_f32_16x16x32_bf16 v[36:39], v[176:179], v[172:175], v[36:39]
    v_mul_f32 v238, 1048744942, v238
    v_mul_f32 v239, 1048744942, v239
    v_mfma_f32_16x16x32_bf16 v[24:27], v[176:179], v[160:163], v[24:27]
    s_lshl_b32 s27, s3, 12
    s_add_u32 s27, s27, 49152
    v_mfma_f32_16x16x32_bf16 v[40:43], v[180:183], v[160:163], v[40:43]
    v_add_u32 v199, s27, v0
    v_mfma_f32_16x16x32_bf16 v[44:47], v[180:183], v[164:167], v[44:47]
    v_mfma_f32_16x16x32_bf16 v[28:31], v[176:179], v[164:167], v[28:31]
    s_lshl_b32 s28, s22, 4
    s_add_u32 s28, s28, s21
    s_lshl_b32 s28, s28, 4
    s_add_u32 s28, s28, s20
    s_lshl_b32 s28, s28, 4
    s_add_u32 s28, s28, s3
    s_lshl_b32 s28, s28, 3
    s_add_u32 s28, s28, 786432
    v_mov_b32 v184, s28
    s_waitcnt vmcnt(0)
    v_mov_b32 v186, s24
    v_mov_b32 v187, s25
    s_mov_b64 exec, 1
    buffer_store_dwordx2 v[186:187], v184, s[12:15], 0 offen sc1
    s_mov_b64 exec, -1
    v_add_u32 v128, s54, v0
    s_and_b32 s28, s54, 4096
    s_add_u32 s28, s28, 32768
    v_add_u32 v129, s28, v0
    s_lshl_b32 s28, s3, 12
    s_add_u32 s28, s28, 32768
    v_add_u32 v130, s28, v0
    v_add_u32 v4, 15360, v3
    v_add_u32 v5, 30720, v3
    v_add_u32 v211, 46080, v3
    v_pk_mul_f32 v[250:251], v[236:237], v[240:241] op_sel:[1,0] op_sel_hi:[1,1]
    v_pk_fma_f32 v[250:251], v[32:33], v[236:237], v[250:251] op_sel_hi:[1,0,1]
    v_pk_mul_f32 v[252:253], v[236:237], v[242:243] op_sel:[1,0] op_sel_hi:[1,1]
    v_cvt_pk_bf16_f32 v32, v250, v251
    v_pk_fma_f32 v[252:253], v[34:35], v[236:237], v[252:253] op_sel_hi:[1,0,1]
    v_pk_mul_f32 v[254:255], v[236:237], v[244:245] op_sel:[1,0] op_sel_hi:[1,1]
    v_cvt_pk_bf16_f32 v33, v252, v253
    v_pk_fma_f32 v[254:255], v[48:49], v[236:237], v[254:255] op_sel_hi:[1,0,1]
    v_pk_mul_f32 v[250:251], v[236:237], v[246:247] op_sel:[1,0] op_sel_hi:[1,1]
    v_cvt_pk_bf16_f32 v34, v254, v255
    v_pk_fma_f32 v[250:251], v[50:51], v[236:237], v[250:251] op_sel_hi:[1,0,1]
    v_pk_mul_f32 v[252:253], v[238:239], v[240:241] op_sel:[1,0] op_sel_hi:[1,1]
    v_cvt_pk_bf16_f32 v35, v250, v251
    v_pk_fma_f32 v[252:253], v[36:37], v[238:239], v[252:253] op_sel_hi:[1,0,1]
    v_pk_mul_f32 v[254:255], v[238:239], v[242:243] op_sel:[1,0] op_sel_hi:[1,1]
    ds_write_b128 v199, v[32:35]
    v_cvt_pk_bf16_f32 v36, v252, v253
    v_pk_fma_f32 v[254:255], v[38:39], v[238:239], v[254:255] op_sel_hi:[1,0,1]
    v_pk_mul_f32 v[250:251], v[238:239], v[244:245] op_sel:[1,0] op_sel_hi:[1,1]
    v_cvt_pk_bf16_f32 v37, v254, v255
    v_pk_fma_f32 v[250:251], v[52:53], v[238:239], v[250:251] op_sel_hi:[1,0,1]
    v_pk_mul_f32 v[252:253], v[238:239], v[246:247] op_sel:[1,0] op_sel_hi:[1,1]
    v_cvt_pk_bf16_f32 v38, v250, v251
    v_pk_fma_f32 v[252:253], v[54:55], v[238:239], v[252:253] op_sel_hi:[1,0,1]
    v_pk_mul_f32 v[254:255], v[232:233], v[240:241] op_sel:[1,0] op_sel_hi:[1,1]
    v_cvt_pk_bf16_f32 v39, v252, v253
    v_pk_fma_f32 v[254:255], v[24:25], v[232:233], v[254:255] op_sel_hi:[1,0,1]
    v_pk_mul_f32 v[250:251], v[232:233], v[242:243] op_sel:[1,0] op_sel_hi:[1,1]
    ds_write_b128 v199, v[36:39] offset:1024
    v_cvt_pk_bf16_f32 v24, v254, v255
    v_pk_fma_f32 v[250:251], v[26:27], v[232:233], v[250:251] op_sel_hi:[1,0,1]
    v_pk_mul_f32 v[252:253], v[232:233], v[244:245] op_sel:[1,0] op_sel_hi:[1,1]
    v_cvt_pk_bf16_f32 v25, v250, v251
    v_pk_fma_f32 v[252:253], v[40:41], v[232:233], v[252:253] op_sel_hi:[1,0,1]
    v_pk_mul_f32 v[254:255], v[232:233], v[246:247] op_sel:[1,0] op_sel_hi:[1,1]
    v_cvt_pk_bf16_f32 v26, v252, v253
    v_pk_fma_f32 v[254:255], v[42:43], v[232:233], v[254:255] op_sel_hi:[1,0,1]
    v_pk_mul_f32 v[250:251], v[234:235], v[240:241] op_sel:[1,0] op_sel_hi:[1,1]
    v_cvt_pk_bf16_f32 v27, v254, v255
    v_pk_fma_f32 v[250:251], v[28:29], v[234:235], v[250:251] op_sel_hi:[1,0,1]
    v_pk_mul_f32 v[252:253], v[234:235], v[242:243] op_sel:[1,0] op_sel_hi:[1,1]
    v_cvt_pk_bf16_f32 v28, v250, v251
    v_pk_fma_f32 v[252:253], v[30:31], v[234:235], v[252:253] op_sel_hi:[1,0,1]
    v_pk_mul_f32 v[254:255], v[234:235], v[244:245] op_sel:[1,0] op_sel_hi:[1,1]
    v_cvt_pk_bf16_f32 v29, v252, v253
    v_pk_fma_f32 v[254:255], v[44:45], v[234:235], v[254:255] op_sel_hi:[1,0,1]
    v_pk_mul_f32 v[250:251], v[234:235], v[246:247] op_sel:[1,0] op_sel_hi:[1,1]
    v_cvt_pk_bf16_f32 v30, v254, v255
    v_pk_fma_f32 v[250:251], v[46:47], v[234:235], v[250:251] op_sel_hi:[1,0,1]
    v_cvt_pk_bf16_f32 v31, v250, v251
    s_branch L_attA
L_ctailB:
    s_waitcnt lgkmcnt(0)
    v_mfma_f32_16x16x32_bf16 v[24:27], v[136:139], v[120:123], v[24:27]
    ds_read_b128 v[160:163], v201 offset:0
    v_mfma_f32_16x16x32_bf16 v[28:31], v[136:139], v[124:127], v[28:31]
    ds_read_b64_tr_b16 v[176:177], v202 offset:20480
    v_mfma_f32_16x16x32_bf16 v[32:35], v[136:139], v[128:131], v[32:35]
    ds_read_b64_tr_b16 v[178:179], v202 offset:22528
    v_mfma_f32_16x16x32_bf16 v[36:39], v[136:139], v[132:135], v[36:39]
    ds_read_b128 v[164:167], v201 offset:2048
    v_mfma_f32_16x16x32_bf16 v[52:55], v[140:143], v[132:135], v[52:55]
    ds_read_b128 v[168:171], v201 offset:4096
    v_mfma_f32_16x16x32_bf16 v[48:51], v[140:143], v[128:131], v[48:51]
    ds_read_b128 v[172:175], v201 offset:6144
    v_mfma_f32_16x16x32_bf16 v[44:47], v[140:143], v[124:127], v[44:47]
    ds_read_b64_tr_b16 v[180:181], v203 offset:20480
    v_mfma_f32_16x16x32_bf16 v[40:43], v[140:143], v[120:123], v[40:43]
    ds_read_b64_tr_b16 v[182:183], v203 offset:22528
    v_mfma_f32_16x16x32_bf16 v[56:59], v[144:147], v[120:123], v[56:59]
    ds_read_b64_tr_b16 v[184:185], v204 offset:4096
    v_mfma_f32_16x16x32_bf16 v[60:63], v[144:147], v[124:127], v[60:63]
    ds_read_b64_tr_b16 v[186:187], v204 offset:6144
    v_mfma_f32_16x16x32_bf16 v[64:67], v[144:147], v[128:131], v[64:67]
    ds_read_b64_tr_b16 v[188:189], v205 offset:4096
    v_mfma_f32_16x16x32_bf16 v[68:71], v[144:147], v[132:135], v[68:71]
    ds_read_b64_tr_b16 v[190:191], v205 offset:6144
    v_mfma_f32_16x16x32_bf16 v[84:87], v[148:151], v[132:135], v[84:87]
    ds_read_b64_tr_b16 v[192:193], v204 offset:12288
    v_mfma_f32_16x16x32_bf16 v[80:83], v[148:151], v[128:131], v[80:83]
    ds_read_b64_tr_b16 v[194:195], v204 offset:14336
    v_mfma_f32_16x16x32_bf16 v[76:79], v[148:151], v[124:127], v[76:79]
    ds_read_b64_tr_b16 v[196:197], v205 offset:12288
    v_mfma_f32_16x16x32_bf16 v[72:75], v[148:151], v[120:123], v[72:75]
    ds_read_b64_tr_b16 v[198:199], v205 offset:14336
    v_mfma_f32_16x16x32_bf16 v[88:91], v[120:123], v[152:155], v[88:91]
    v_mfma_f32_16x16x32_bf16 v[92:95], v[124:127], v[152:155], v[92:95]
    v_mfma_f32_16x16x32_bf16 v[96:99], v[128:131], v[152:155], v[96:99]
    v_mfma_f32_16x16x32_bf16 v[100:103], v[132:135], v[152:155], v[100:103]
    v_mfma_f32_16x16x32_bf16 v[116:119], v[132:135], v[156:159], v[116:119]
    v_mfma_f32_16x16x32_bf16 v[112:115], v[128:131], v[156:159], v[112:115]
    v_mfma_f32_16x16x32_bf16 v[108:111], v[124:127], v[156:159], v[108:111]
    v_mfma_f32_16x16x32_bf16 v[104:107], v[120:123], v[156:159], v[104:107]
    s_waitcnt lgkmcnt(0)
    v_mfma_f32_16x16x32_bf16 v[24:27], v[176:179], v[160:163], v[24:27]
    v_mfma_f32_16x16x32_bf16 v[28:31], v[176:179], v[164:167], v[28:31]
    s_barrier
    v_mfma_f32_16x16x32_bf16 v[32:35], v[176:179], v[168:171], v[32:35]
    ds_read_b128 v[120:123], v200 offset:16384
    v_mfma_f32_16x16x32_bf16 v[36:39], v[176:179], v[172:175], v[36:39]
    ds_read_b64_tr_b16 v[136:137], v202 offset:24576
    v_mfma_f32_16x16x32_bf16 v[52:55], v[180:183], v[172:175], v[52:55]
    ds_read_b64_tr_b16 v[138:139], v202 offset:26624
    v_mfma_f32_16x16x32_bf16 v[48:51], v[180:183], v[168:171], v[48:51]
    ds_read_b128 v[124:127], v200 offset:18432
    v_mfma_f32_16x16x32_bf16 v[44:47], v[180:183], v[164:167], v[44:47]
    ds_read_b128 v[128:131], v200 offset:20480
    v_mfma_f32_16x16x32_bf16 v[40:43], v[180:183], v[160:163], v[40:43]
    ds_read_b128 v[132:135], v200 offset:22528
    v_mfma_f32_16x16x32_bf16 v[56:59], v[184:187], v[160:163], v[56:59]
    ds_read_b64_tr_b16 v[140:141], v203 offset:24576
    v_mfma_f32_16x16x32_bf16 v[60:63], v[184:187], v[164:167], v[60:63]
    ds_read_b64_tr_b16 v[142:143], v203 offset:26624
    v_mfma_f32_16x16x32_bf16 v[64:67], v[184:187], v[168:171], v[64:67]
    ds_read_b64_tr_b16 v[144:145], v204 offset:16384
    v_mfma_f32_16x16x32_bf16 v[68:71], v[184:187], v[172:175], v[68:71]
    ds_read_b64_tr_b16 v[146:147], v204 offset:18432
    v_mfma_f32_16x16x32_bf16 v[84:87], v[188:191], v[172:175], v[84:87]
    ds_read_b64_tr_b16 v[148:149], v205 offset:16384
    v_mfma_f32_16x16x32_bf16 v[80:83], v[188:191], v[168:171], v[80:83]
    ds_read_b64_tr_b16 v[150:151], v205 offset:18432
    v_mfma_f32_16x16x32_bf16 v[76:79], v[188:191], v[164:167], v[76:79]
    ds_read_b64_tr_b16 v[152:153], v204 offset:24576
    v_mfma_f32_16x16x32_bf16 v[72:75], v[188:191], v[160:163], v[72:75]
    ds_read_b64_tr_b16 v[154:155], v204 offset:26624
    v_mfma_f32_16x16x32_bf16 v[88:91], v[160:163], v[192:195], v[88:91]
    ds_read_b64_tr_b16 v[156:157], v205 offset:24576
    v_mfma_f32_16x16x32_bf16 v[92:95], v[164:167], v[192:195], v[92:95]
    ds_read_b64_tr_b16 v[158:159], v205 offset:26624
    v_mfma_f32_16x16x32_bf16 v[96:99], v[168:171], v[192:195], v[96:99]
    v_mfma_f32_16x16x32_bf16 v[100:103], v[172:175], v[192:195], v[100:103]
    v_mfma_f32_16x16x32_bf16 v[116:119], v[172:175], v[196:199], v[116:119]
    v_mfma_f32_16x16x32_bf16 v[112:115], v[168:171], v[196:199], v[112:115]
    v_mfma_f32_16x16x32_bf16 v[108:111], v[164:167], v[196:199], v[108:111]
    v_mfma_f32_16x16x32_bf16 v[104:107], v[160:163], v[196:199], v[104:107]
    s_waitcnt lgkmcnt(0)
    v_mfma_f32_16x16x32_bf16 v[24:27], v[136:139], v[120:123], v[24:27]
    ds_read_b128 v[160:163], v201 offset:16384
    v_mfma_f32_16x16x32_bf16 v[28:31], v[136:139], v[124:127], v[28:31]
    ds_read_b64_tr_b16 v[176:177], v202 offset:28672
    v_mfma_f32_16x16x32_bf16 v[32:35], v[136:139], v[128:131], v[32:35]
    ds_read_b64_tr_b16 v[178:179], v202 offset:30720
    v_mfma_f32_16x16x32_bf16 v[36:39], v[136:139], v[132:135], v[36:39]
    ds_read_b128 v[164:167], v201 offset:18432
    v_mfma_f32_16x16x32_bf16 v[52:55], v[140:143], v[132:135], v[52:55]
    ds_read_b128 v[168:171], v201 offset:20480
    v_mfma_f32_16x16x32_bf16 v[48:51], v[140:143], v[128:131], v[48:51]
    ds_read_b128 v[172:175], v201 offset:22528
    v_mfma_f32_16x16x32_bf16 v[44:47], v[140:143], v[124:127], v[44:47]
    ds_read_b64_tr_b16 v[180:181], v203 offset:28672
    v_mfma_f32_16x16x32_bf16 v[40:43], v[140:143], v[120:123], v[40:43]
    ds_read_b64_tr_b16 v[182:183], v203 offset:30720
    v_mfma_f32_16x16x32_bf16 v[56:59], v[144:147], v[120:123], v[56:59]
    ds_read_b64_tr_b16 v[184:185], v204 offset:20480
    v_mfma_f32_16x16x32_bf16 v[60:63], v[144:147], v[124:127], v[60:63]
    ds_read_b64_tr_b16 v[186:187], v204 offset:22528
    v_mfma_f32_16x16x32_bf16 v[64:67], v[144:147], v[128:131], v[64:67]
    ds_read_b64_tr_b16 v[188:189], v205 offset:20480
    v_mfma_f32_16x16x32_bf16 v[68:71], v[144:147], v[132:135], v[68:71]
    ds_read_b64_tr_b16 v[190:191], v205 offset:22528
    v_mfma_f32_16x16x32_bf16 v[84:87], v[148:151], v[132:135], v[84:87]
    ds_read_b64_tr_b16 v[192:193], v204 offset:28672
    v_mfma_f32_16x16x32_bf16 v[80:83], v[148:151], v[128:131], v[80:83]
    ds_read_b64_tr_b16 v[194:195], v204 offset:30720
    v_mfma_f32_16x16x32_bf16 v[76:79], v[148:151], v[124:127], v[76:79]
    ds_read_b64_tr_b16 v[196:197], v205 offset:28672
    v_mfma_f32_16x16x32_bf16 v[72:75], v[148:151], v[120:123], v[72:75]
    ds_read_b64_tr_b16 v[198:199], v205 offset:30720
    v_mfma_f32_16x16x32_bf16 v[88:91], v[120:123], v[152:155], v[88:91]
    v_mfma_f32_16x16x32_bf16 v[92:95], v[124:127], v[152:155], v[92:95]
    v_mfma_f32_16x16x32_bf16 v[96:99], v[128:131], v[152:155], v[96:99]
    v_mfma_f32_16x16x32_bf16 v[100:103], v[132:135], v[152:155], v[100:103]
    v_mfma_f32_16x16x32_bf16 v[116:119], v[132:135], v[156:159], v[116:119]
    v_mfma_f32_16x16x32_bf16 v[112:115], v[128:131], v[156:159], v[112:115]
    v_mfma_f32_16x16x32_bf16 v[108:111], v[124:127], v[156:159], v[108:111]
    v_mfma_f32_16x16x32_bf16 v[104:107], v[120:123], v[156:159], v[104:107]
    s_waitcnt lgkmcnt(0)
    v_mfma_f32_16x16x32_bf16 v[24:27], v[176:179], v[160:163], v[24:27]
    v_mfma_f32_16x16x32_bf16 v[28:31], v[176:179], v[164:167], v[28:31]
    s_barrier
    v_mfma_f32_16x16x32_bf16 v[32:35], v[176:179], v[168:171], v[32:35]
    ds_read_b128 v[120:123], v200 offset:32768
    v_mfma_f32_16x16x32_bf16 v[36:39], v[176:179], v[172:175], v[36:39]
    ds_read_b64_tr_b16 v[136:137], v202 offset:32768
    v_mfma_f32_16x16x32_bf16 v[52:55], v[180:183], v[172:175], v[52:55]
    ds_read_b64_tr_b16 v[138:139], v202 offset:34816
    v_mfma_f32_16x16x32_bf16 v[48:51], v[180:183], v[168:171], v[48:51]
    ds_read_b128 v[124:127], v200 offset:34816
    v_mfma_f32_16x16x32_bf16 v[44:47], v[180:183], v[164:167], v[44:47]
    ds_read_b128 v[128:131], v200 offset:36864
    v_mfma_f32_16x16x32_bf16 v[40:43], v[180:183], v[160:163], v[40:43]
    ds_read_b128 v[132:135], v200 offset:38912
    v_mfma_f32_16x16x32_bf16 v[56:59], v[184:187], v[160:163], v[56:59]
    ds_read_b64_tr_b16 v[140:141], v203 offset:32768
    v_mfma_f32_16x16x32_bf16 v[60:63], v[184:187], v[164:167], v[60:63]
    ds_read_b64_tr_b16 v[142:143], v203 offset:34816
    v_mfma_f32_16x16x32_bf16 v[64:67], v[184:187], v[168:171], v[64:67]
    ds_read_b64_tr_b16 v[144:145], v202 offset:0
    v_mfma_f32_16x16x32_bf16 v[68:71], v[184:187], v[172:175], v[68:71]
    ds_read_b64_tr_b16 v[146:147], v202 offset:2048
    v_mfma_f32_16x16x32_bf16 v[84:87], v[188:191], v[172:175], v[84:87]
    ds_read_b64_tr_b16 v[148:149], v203 offset:0
    v_mfma_f32_16x16x32_bf16 v[80:83], v[188:191], v[168:171], v[80:83]
    ds_read_b64_tr_b16 v[150:151], v203 offset:2048
    v_mfma_f32_16x16x32_bf16 v[76:79], v[188:191], v[164:167], v[76:79]
    ds_read_b64_tr_b16 v[152:153], v202 offset:8192
    v_mfma_f32_16x16x32_bf16 v[72:75], v[188:191], v[160:163], v[72:75]
    ds_read_b64_tr_b16 v[154:155], v202 offset:10240
    v_mfma_f32_16x16x32_bf16 v[88:91], v[160:163], v[192:195], v[88:91]
    ds_read_b64_tr_b16 v[156:157], v203 offset:8192
    v_mfma_f32_16x16x32_bf16 v[92:95], v[164:167], v[192:195], v[92:95]
    ds_read_b64_tr_b16 v[158:159], v203 offset:10240
    v_mfma_f32_16x16x32_bf16 v[96:99], v[168:171], v[192:195], v[96:99]
    v_mfma_f32_16x16x32_bf16 v[100:103], v[172:175], v[192:195], v[100:103]
    v_mfma_f32_16x16x32_bf16 v[116:119], v[172:175], v[196:199], v[116:119]
    v_mfma_f32_16x16x32_bf16 v[112:115], v[168:171], v[196:199], v[112:115]
    v_mfma_f32_16x16x32_bf16 v[108:111], v[164:167], v[196:199], v[108:111]
    v_mfma_f32_16x16x32_bf16 v[104:107], v[160:163], v[196:199], v[104:107]
    s_waitcnt lgkmcnt(0)
    v_mfma_f32_16x16x32_bf16 v[24:27], v[136:139], v[120:123], v[24:27]
    ds_read_b128 v[160:163], v201 offset:32768
    v_mfma_f32_16x16x32_bf16 v[28:31], v[136:139], v[124:127], v[28:31]
    ds_read_b64_tr_b16 v[176:177], v202 offset:36864
    v_mfma_f32_16x16x32_bf16 v[32:35], v[136:139], v[128:131], v[32:35]
    ds_read_b64_tr_b16 v[178:179], v202 offset:38912
    v_mfma_f32_16x16x32_bf16 v[36:39], v[136:139], v[132:135], v[36:39]
    ds_read_b128 v[164:167], v201 offset:34816
    v_mfma_f32_16x16x32_bf16 v[52:55], v[140:143], v[132:135], v[52:55]
    ds_read_b128 v[168:171], v201 offset:36864
    v_mfma_f32_16x16x32_bf16 v[48:51], v[140:143], v[128:131], v[48:51]
    ds_read_b128 v[172:175], v201 offset:38912
    v_mfma_f32_16x16x32_bf16 v[44:47], v[140:143], v[124:127], v[44:47]
    ds_read_b64_tr_b16 v[180:181], v203 offset:36864
    v_mfma_f32_16x16x32_bf16 v[40:43], v[140:143], v[120:123], v[40:43]
    ds_read_b64_tr_b16 v[182:183], v203 offset:38912
    v_mfma_f32_16x16x32_bf16 v[56:59], v[144:147], v[120:123], v[56:59]
    ds_read_b64_tr_b16 v[184:185], v202 offset:4096
    v_mfma_f32_16x16x32_bf16 v[60:63], v[144:147], v[124:127], v[60:63]
    ds_read_b64_tr_b16 v[186:187], v202 offset:6144
    v_mfma_f32_16x16x32_bf16 v[64:67], v[144:147], v[128:131], v[64:67]
    ds_read_b64_tr_b16 v[188:189], v203 offset:4096
    v_mfma_f32_16x16x32_bf16 v[68:71], v[144:147], v[132:135], v[68:71]
    ds_read_b64_tr_b16 v[190:191], v203 offset:6144
    v_mfma_f32_16x16x32_bf16 v[84:87], v[148:151], v[132:135], v[84:87]
    ds_read_b64_tr_b16 v[192:193], v202 offset:12288
    v_mfma_f32_16x16x32_bf16 v[80:83], v[148:151], v[128:131], v[80:83]
    ds_read_b64_tr_b16 v[194:195], v202 offset:14336
    v_mfma_f32_16x16x32_bf16 v[76:79], v[148:151], v[124:127], v[76:79]
    ds_read_b64_tr_b16 v[196:197], v203 offset:12288
    v_mfma_f32_16x16x32_bf16 v[72:75], v[148:151], v[120:123], v[72:75]
    ds_read_b64_tr_b16 v[198:199], v203 offset:14336
    v_mfma_f32_16x16x32_bf16 v[88:91], v[120:123], v[152:155], v[88:91]
    v_mov_b32 v255, 92928
    v_mfma_f32_16x16x32_bf16 v[92:95], v[124:127], v[152:155], v[92:95]
    s_lshl_b32 s27, s3, 11
    v_mfma_f32_16x16x32_bf16 v[96:99], v[128:131], v[152:155], v[96:99]
    s_add_u32 s27, s27, 49152
    v_mfma_f32_16x16x32_bf16 v[100:103], v[132:135], v[152:155], v[100:103]
    v_add_u32 v4, s27, v0
    v_mfma_f32_16x16x32_bf16 v[116:119], v[132:135], v[156:159], v[116:119]
    v_add_u32 v5, s49, v0
    v_mfma_f32_16x16x32_bf16 v[112:115], v[128:131], v[156:159], v[112:115]
    s_add_u32 s49, s49, 65536
    v_mfma_f32_16x16x32_bf16 v[108:111], v[124:127], v[156:159], v[108:111]
    v_mfma_f32_16x16x32_bf16 v[104:107], v[120:123], v[156:159], v[104:107]
    s_waitcnt lgkmcnt(0)
    s_barrier
    v_mfma_f32_16x16x32_bf16 v[68:71], v[184:187], v[172:175], v[68:71]
    ds_read_b128 v[152:155], v209 offset:256
    v_mfma_f32_16x16x32_bf16 v[84:87], v[188:191], v[172:175], v[84:87]
    ds_read_b128 v[156:159], v209 offset:320
    v_mfma_f32_16x16x32_bf16 v[100:103], v[172:175], v[192:195], v[100:103]
    ds_read_b64 v[238:239], v207 offset:1408
    v_mfma_f32_16x16x32_bf16 v[116:119], v[172:175], v[196:199], v[116:119]
    ds_read_b32 v248, v210 offset:512
    v_mfma_f32_16x16x32_bf16 v[112:115], v[168:171], v[196:199], v[112:115]
    ds_read_b32 v249, v210 offset:576
    v_mfma_f32_16x16x32_bf16 v[108:111], v[164:167], v[196:199], v[108:111]
    ds_read_b128 v[132:135], v208 offset:192
    v_mfma_f32_16x16x32_bf16 v[104:107], v[160:163], v[196:199], v[104:107]
    ds_read_b128 v[148:151], v208 offset:704
    v_mfma_f32_16x16x32_bf16 v[88:91], v[160:163], v[192:195], v[88:91]
    ds_read_b32 v255, v255
    v_mfma_f32_16x16x32_bf16 v[92:95], v[164:167], v[192:195], v[92:95]
    ds_read_b64 v[236:237], v207 offset:1280
    v_mfma_f32_16x16x32_bf16 v[96:99], v[168:171], v[192:195], v[96:99]
    ds_read_b64 v[234:235], v207 offset:1152
    v_mfma_f32_16x16x32_bf16 v[80:83], v[188:191], v[168:171], v[80:83]
    ds_read_b128 v[128:131], v208 offset:128
    v_mfma_f32_16x16x32_bf16 v[76:79], v[188:191], v[164:167], v[76:79]
    ds_read_b128 v[144:147], v208 offset:640
    v_mfma_f32_16x16x32_bf16 v[72:75], v[188:191], v[160:163], v[72:75]
    ds_read_b128 v[124:127], v208 offset:64
    v_mfma_f32_16x16x32_bf16 v[56:59], v[184:187], v[160:163], v[56:59]
    ds_read_b128 v[140:143], v208 offset:576
    v_mfma_f32_16x16x32_bf16 v[60:63], v[184:187], v[164:167], v[60:63]
    ds_read_b128 v[240:243], v209 offset:0
    v_mfma_f32_16x16x32_bf16 v[64:67], v[184:187], v[168:171], v[64:67]
    ds_read_b128 v[244:247], v209 offset:64
    v_mfma_f32_16x16x32_bf16 v[24:27], v[176:179], v[160:163], v[24:27]
    ds_read_b64 v[232:233], v207 offset:1024
    v_mfma_f32_16x16x32_bf16 v[28:31], v[176:179], v[164:167], v[28:31]
    ds_read_b128 v[120:123], v208 offset:0
    v_mfma_f32_16x16x32_bf16 v[32:35], v[176:179], v[168:171], v[32:35]
    ds_read_b128 v[136:139], v208 offset:512
    v_mfma_f32_16x16x32_bf16 v[36:39], v[176:179], v[172:175], v[36:39]
    v_mfma_f32_16x16x32_bf16 v[52:55], v[180:183], v[172:175], v[52:55]
    v_mfma_f32_16x16x32_bf16 v[48:51], v[180:183], v[168:171], v[48:51]
    v_mfma_f32_16x16x32_bf16 v[44:47], v[180:183], v[164:167], v[44:47]
    v_mfma_f32_16x16x32_bf16 v[40:43], v[180:183], v[160:163], v[40:43]
    s_waitcnt lgkmcnt(0)
    v_readfirstlane_b32 s23, v255
    v_pk_mul_f32 v[250:251], v[238:239], v[152:153] op_sel:[1,0] op_sel_hi:[1,1]
    v_pk_fma_f32 v[250:251], v[68:69], v[238:239], v[250:251] op_sel_hi:[1,0,1]
    v_pk_mul_f32 v[252:253], v[238:239], v[154:155] op_sel:[1,0] op_sel_hi:[1,1]
    v_cvt_pk_bf16_f32 v68, v250, v251
    v_pk_fma_f32 v[252:253], v[70:71], v[238:239], v[252:253] op_sel_hi:[1,0,1]
    v_pk_mul_f32 v[254:255], v[238:239], v[156:157] op_sel:[1,0] op_sel_hi:[1,1]
    v_cvt_pk_bf16_f32 v69, v252, v253
    v_pk_fma_f32 v[254:255], v[84:85], v[238:239], v[254:255] op_sel_hi:[1,0,1]
    v_pk_mul_f32 v[250:251], v[238:239], v[158:159] op_sel:[1,0] op_sel_hi:[1,1]
    v_cvt_pk_bf16_f32 v70, v254, v255
    v_pk_fma_f32 v[250:251], v[86:87], v[238:239], v[250:251] op_sel_hi:[1,0,1]
    v_pk_mul_f32 v[252:253], v[148:149], v[248:249] op_sel_hi:[1,0]
    v_cvt_pk_bf16_f32 v71, v250, v251
    v_pk_fma_f32 v[252:253], v[100:101], v[132:133], v[252:253]
    v_pk_mul_f32 v[254:255], v[150:151], v[248:249] op_sel_hi:[1,0]
    v_min_u32 v68, -2, v68
    buffer_store_dwordx4 v[68:71], v5, s[12:15], 0 offen offset:0 sc1
    ds_write_b128 v4, v[68:71] offset:4096
    v_mul_f32 v238, 1048744942, v238
    v_mul_f32 v239, 1048744942, v239
    v_cvt_pk_bf16_f32 v100, v252, v253
    v_pk_fma_f32 v[254:255], v[102:103], v[134:135], v[254:255]
    v_pk_mul_f32 v[250:251], v[248:249], v[148:149] op_sel:[1,0] op_sel_hi:[1,1]
    v_cvt_pk_bf16_f32 v101, v254, v255
    v_pk_fma_f32 v[250:251], v[116:117], v[132:133], v[250:251]
    v_pk_mul_f32 v[252:253], v[248:249], v[150:151] op_sel:[1,0] op_sel_hi:[1,1]
    v_cvt_pk_bf16_f32 v102, v250, v251
    v_pk_fma_f32 v[252:253], v[118:119], v[134:135], v[252:253]
    v_pk_mul_f32 v[254:255], v[236:237], v[152:153] op_sel:[1,0] op_sel_hi:[1,1]
    v_cvt_pk_bf16_f32 v103, v252, v253
    v_pk_fma_f32 v[254:255], v[64:65], v[236:237], v[254:255] op_sel_hi:[1,0,1]
    v_pk_mul_f32 v[250:251], v[236:237], v[154:155] op_sel:[1,0] op_sel_hi:[1,1]
    v_min_u32 v100, -2, v100
    buffer_store_dwordx4 v[100:103], v5, s[12:15], 0 offen offset:1024 sc1
    ds_write_b128 v4, v[100:103] offset:5120
    v_mov_b32 v168, v100
    v_mov_b32 v169, v101
    v_mov_b32 v178, v102
    v_mov_b32 v179, v103
    v_cvt_pk_bf16_f32 v64, v254, v255
    v_pk_fma_f32 v[250:251], v[66:67], v[236:237], v[250:251] op_sel_hi:[1,0,1]
    v_pk_mul_f32 v[252:253], v[236:237], v[156:157] op_sel:[1,0] op_sel_hi:[1,1]
    v_cvt_pk_bf16_f32 v65, v250, v251
    v_pk_fma_f32 v[252:253], v[80:81], v[236:237], v[252:253] op_sel_hi:[1,0,1]
    v_pk_mul_f32 v[254:255], v[236:237], v[158:159] op_sel:[1,0] op_sel_hi:[1,1]
    v_cvt_pk_bf16_f32 v66, v252, v253
    v_pk_fma_f32 v[254:255], v[82:83], v[236:237], v[254:255] op_sel_hi:[1,0,1]
    v_pk_mul_f32 v[250:251], v[234:235], v[152:153] op_sel:[1,0] op_sel_hi:[1,1]
    v_cvt_pk_bf16_f32 v67, v254, v255
    v_pk_fma_f32 v[250:251], v[60:61], v[234:235], v[250:251] op_sel_hi:[1,0,1]
    v_pk_mul_f32 v[252:253], v[234:235], v[154:155] op_sel:[1,0] op_sel_hi:[1,1]
    v_mul_f32 v236, 1048744942, v236
    v_mul_f32 v237, 1048744942, v237
    v_cvt_pk_bf16_f32 v60, v250, v251
    v_pk_fma_f32 v[252:253], v[62:63], v[234:235], v[252:253] op_sel_hi:[1,0,1]
    v_pk_mul_f32 v[254:255], v[234:235], v[156:157] op_sel:[1,0] op_sel_hi:[1,1]
    v_cvt_pk_bf16_f32 v61, v252, v253
    v_pk_fma_f32 v[254:255], v[76:77], v[234:235], v[254:255] op_sel_hi:[1,0,1]
    v_pk_mul_f32 v[250:251], v[234:235], v[158:159] op_sel:[1,0] op_sel_hi:[1,1]
    v_cvt_pk_bf16_f32 v62, v254, v255
    v_pk_fma_f32 v[250:251], v[78:79], v[234:235], v[250:251] op_sel_hi:[1,0,1]
    v_pk_mul_f32 v[252:253], v[238:239], v[240:241] op_sel:[1,0] op_sel_hi:[1,1]
    v_cvt_pk_bf16_f32 v63, v250, v251
    v_pk_fma_f32 v[252:253], v[36:37], v[238:239], v[252:253] op_sel_hi:[1,0,1]
    v_pk_mul_f32 v[254:255], v[238:239], v[242:243] op_sel:[1,0] op_sel_hi:[1,1]
    v_mul_f32 v234, 1048744942, v234
    v_mul_f32 v235, 1048744942, v235
    v_cvt_pk_bf16_f32 v36, v252, v253
    v_pk_fma_f32 v[254:255], v[38:39], v[238:239], v[254:255] op_sel_hi:[1,0,1]
    v_pk_mul_f32 v[250:251], v[238:239], v[244:245] op_sel:[1,0] op_sel_hi:[1,1]
    v_cvt_pk_bf16_f32 v37, v254, v255
    v_pk_fma_f32 v[250:251], v[52:53], v[238:239], v[250:251] op_sel_hi:[1,0,1]
    v_pk_mul_f32 v[252:253], v[238:239], v[246:247] op_sel:[1,0] op_sel_hi:[1,1]
    v_cvt_pk_bf16_f32 v38, v250, v251
    v_pk_fma_f32 v[252:253], v[54:55], v[238:239], v[252:253] op_sel_hi:[1,0,1]
    v_pk_mul_f32 v[254:255], v[236:237], v[240:241] op_sel:[1,0] op_sel_hi:[1,1]
    v_cvt_pk_bf16_f32 v39, v252, v253
    v_pk_fma_f32 v[254:255], v[32:33], v[236:237], v[254:255] op_sel_hi:[1,0,1]
    v_pk_mul_f32 v[250:251], v[236:237], v[242:243] op_sel:[1,0] op_sel_hi:[1,1]
    v_cvt_pk_bf16_f32 v32, v254, v255
    v_pk_fma_f32 v[250:251], v[34:35], v[236:237], v[250:251] op_sel_hi:[1,0,1]
    v_pk_mul_f32 v[252:253], v[236:237], v[244:245] op_sel:[1,0] op_sel_hi:[1,1]
    v_cvt_pk_bf16_f32 v33, v250, v251
    v_pk_fma_f32 v[252:253], v[48:49], v[236:237], v[252:253] op_sel_hi:[1,0,1]
    v_pk_mul_f32 v[254:255], v[236:237], v[246:247] op_sel:[1,0] op_sel_hi:[1,1]
    v_cvt_pk_bf16_f32 v34, v252, v253
    v_pk_fma_f32 v[254:255], v[50:51], v[236:237], v[254:255] op_sel_hi:[1,0,1]
    v_pk_mul_f32 v[250:251], v[144:145], v[248:249] op_sel_hi:[1,0]
    v_cvt_pk_bf16_f32 v35, v254, v255
    v_pk_fma_f32 v[250:251], v[96:97], v[128:129], v[250:251]
    v_pk_mul_f32 v[252:253], v[146:147], v[248:249] op_sel_hi:[1,0]
    v_cvt_pk_bf16_f32 v166, v250, v251
    v_pk_fma_f32 v[252:253], v[98:99], v[130:131], v[252:253]
    v_pk_mul_f32 v[254:255], v[248:249], v[144:145] op_sel:[1,0] op_sel_hi:[1,1]
    v_cvt_pk_bf16_f32 v167, v252, v253
    v_pk_fma_f32 v[254:255], v[112:113], v[128:129], v[254:255]
    v_pk_mul_f32 v[250:251], v[248:249], v[146:147] op_sel:[1,0] op_sel_hi:[1,1]
    v_cvt_pk_bf16_f32 v176, v254, v255
    v_pk_fma_f32 v[250:251], v[114:115], v[130:131], v[250:251]
    v_pk_mul_f32 v[252:253], v[140:141], v[248:249] op_sel_hi:[1,0]
    v_cvt_pk_bf16_f32 v177, v250, v251
    v_pk_fma_f32 v[252:253], v[92:93], v[124:125], v[252:253]
    v_pk_mul_f32 v[254:255], v[142:143], v[248:249] op_sel_hi:[1,0]
    v_cvt_pk_bf16_f32 v164, v252, v253
    v_pk_fma_f32 v[254:255], v[94:95], v[126:127], v[254:255]
    v_pk_mul_f32 v[250:251], v[248:249], v[140:141] op_sel:[1,0] op_sel_hi:[1,1]
    v_cvt_pk_bf16_f32 v165, v254, v255
    v_pk_fma_f32 v[250:251], v[108:109], v[124:125], v[250:251]
    v_pk_mul_f32 v[252:253], v[248:249], v[142:143] op_sel:[1,0] op_sel_hi:[1,1]
    v_cvt_pk_bf16_f32 v174, v250, v251
    v_pk_fma_f32 v[252:253], v[110:111], v[126:127], v[252:253]
    v_cvt_pk_bf16_f32 v175, v252, v253
    s_waitcnt lgkmcnt(0)
    s_add_u32 s27, s62, 65536
    v_mfma_f32_16x16x32_bf16 v[184:187], v[68:71], v[36:39], v[216:219]
    v_mfma_f32_16x16x32_bf16 v[188:191], v[64:67], v[36:39], v[220:223]
    v_mfma_f32_16x16x32_bf16 v[192:195], v[64:67], v[32:35], v[216:219]
    v_mfma_f32_16x16x32_bf16 v[196:199], v[60:63], v[32:35], v[220:223]
    v_pk_mul_f32 v[250:251], v[232:233], v[152:153] op_sel:[1,0] op_sel_hi:[1,1]
    v_pk_fma_f32 v[250:251], v[56:57], v[232:233], v[250:251] op_sel_hi:[1,0,1]
    v_pk_mul_f32 v[252:253], v[232:233], v[154:155] op_sel:[1,0] op_sel_hi:[1,1]
    v_cvt_pk_bf16_f32 v56, v250, v251
    v_pk_fma_f32 v[252:253], v[58:59], v[232:233], v[252:253] op_sel_hi:[1,0,1]
    v_pk_mul_f32 v[254:255], v[232:233], v[156:157] op_sel:[1,0] op_sel_hi:[1,1]
    v_max3_f32 v84, v184, v185, v188
    v_cvt_pk_bf16_f32 v57, v252, v253
    v_max3_f32 v100, v192, v193, v196
    v_max3_f32 v85, v186, v187, v190
    v_max3_f32 v101, v194, v195, v198
    v_max_f32 v84, v84, v189
    v_max_f32 v100, v100, v197
    v_max_f32 v85, v85, v191
    v_max_f32 v101, v101, v199
    v_max_f32 v86, v84, v85
    v_max_f32 v102, v100, v101
    v_pk_fma_f32 v[254:255], v[72:73], v[232:233], v[254:255] op_sel_hi:[1,0,1]
    v_pk_mul_f32 v[250:251], v[232:233], v[158:159] op_sel:[1,0] op_sel_hi:[1,1]
    v_permlane16_swap_b32 v86, v102
    v_cvt_pk_bf16_f32 v58, v254, v255
    v_max_f32 v86, v86, v102
    v_pk_fma_f32 v[250:251], v[74:75], v[232:233], v[250:251] op_sel_hi:[1,0,1]
    v_mov_b32 v102, v86
    v_pk_mul_f32 v[252:253], v[136:137], v[248:249] op_sel_hi:[1,0]
    v_cvt_pk_bf16_f32 v59, v250, v251
    v_permlane32_swap_b32 v86, v102
    v_pk_fma_f32 v[252:253], v[88:89], v[120:121], v[252:253]
    v_max_f32 v86, v86, v102
    v_pk_mul_f32 v[254:255], v[138:139], v[248:249] op_sel_hi:[1,0]
    v_mov_b32 v102, v86
    v_mul_f32 v232, 1048744942, v232
    v_mul_f32 v233, 1048744942, v233
    v_permlane16_swap_b32 v86, v102
    v_cvt_pk_bf16_f32 v162, v252, v253
    v_sub_f32 v84, v84, v86
    v_sub_f32 v100, v100, v102
    v_sub_f32 v85, v85, v86
    v_sub_f32 v101, v101, v102
    v_exp_f32 v84, v84
    v_exp_f32 v100, v100
    v_exp_f32 v85, v85
    v_exp_f32 v101, v101
    v_cvt_pk_bf16_f32 v84, v84, v84
    v_cvt_pk_bf16_f32 v100, v100, v100
    v_cvt_pk_bf16_f32 v85, v85, v85
    v_cvt_pk_bf16_f32 v101, v101, v101
    v_and_b32 v48, v84, v224
    v_and_b32 v52, v100, v224
    v_and_b32 v49, v85, v225
    v_and_b32 v53, v101, v225
    v_and_b32 v50, v84, v226
    v_and_b32 v54, v100, v226
    v_and_b32 v51, v85, v227
    v_and_b32 v55, v101, v227
    v_pk_fma_f32 v[254:255], v[90:91], v[122:123], v[254:255]
    v_mfma_f32_16x16x32_bf16 v[108:111], v[212:215], v[48:51], 0
    v_mfma_f32_16x16x32_bf16 v[76:79], v[166:169], v[48:51], 0
    v_mfma_f32_16x16x32_bf16 v[80:83], v[176:179], v[48:51], 0
    v_mfma_f32_16x16x32_bf16 v[112:115], v[212:215], v[52:55], 0
    v_mfma_f32_16x16x32_bf16 v[92:95], v[164:167], v[52:55], 0
    v_mfma_f32_16x16x32_bf16 v[96:99], v[174:177], v[52:55], 0
    v_pk_mul_f32 v[250:251], v[248:249], v[136:137] op_sel:[1,0] op_sel_hi:[1,1]
    v_cvt_pk_bf16_f32 v163, v254, v255
    v_pk_fma_f32 v[250:251], v[104:105], v[120:121], v[250:251]
    v_rcp_f32 v84, v108
    v_pk_mul_f32 v[252:253], v[248:249], v[138:139] op_sel:[1,0] op_sel_hi:[1,1]
    v_cvt_pk_bf16_f32 v172, v250, v251
    v_rcp_f32 v100, v112
    v_pk_mul_f32 v[76:77], v[76:77], v[84:85] op_sel_hi:[1,0]
    v_pk_mul_f32 v[92:93], v[92:93], v[100:101] op_sel_hi:[1,0]
    v_pk_mul_f32 v[78:79], v[78:79], v[84:85] op_sel_hi:[1,0]
    v_pk_mul_f32 v[94:95], v[94:95], v[100:101] op_sel_hi:[1,0]
    v_pk_mul_f32 v[80:81], v[80:81], v[84:85] op_sel_hi:[1,0]
    v_pk_mul_f32 v[96:97], v[96:97], v[100:101] op_sel_hi:[1,0]
    v_pk_mul_f32 v[82:83], v[82:83], v[84:85] op_sel_hi:[1,0]
    v_pk_mul_f32 v[98:99], v[98:99], v[100:101] op_sel_hi:[1,0]
    v_add_u32 v76, 0x8000, v76
    v_add_u32 v92, 0x8000, v92
    v_cvt_pk_bf16_f32 v76, v76, v77
    v_cvt_pk_bf16_f32 v92, v92, v93
    v_cvt_pk_bf16_f32 v77, v78, v79
    v_cvt_pk_bf16_f32 v93, v94, v95
    v_cvt_pk_bf16_f32 v78, v80, v81
    v_cvt_pk_bf16_f32 v94, v96, v97
    v_cvt_pk_bf16_f32 v79, v82, v83
    v_cvt_pk_bf16_f32 v95, v98, v99
    v_and_b32 v76, -2, v76
    v_and_b32 v92, -2, v92
    v_pk_fma_f32 v[252:253], v[106:107], v[122:123], v[252:253]
    v_pk_mul_f32 v[254:255], v[234:235], v[240:241] op_sel:[1,0] op_sel_hi:[1,1]
    v_cvt_pk_bf16_f32 v173, v252, v253
    v_pk_fma_f32 v[254:255], v[28:29], v[234:235], v[254:255] op_sel_hi:[1,0,1]
    v_pk_mul_f32 v[250:251], v[234:235], v[242:243] op_sel:[1,0] op_sel_hi:[1,1]
    v_cvt_pk_bf16_f32 v28, v254, v255
    v_pk_fma_f32 v[250:251], v[30:31], v[234:235], v[250:251] op_sel_hi:[1,0,1]
    v_pk_mul_f32 v[252:253], v[234:235], v[244:245] op_sel:[1,0] op_sel_hi:[1,1]
    v_cvt_pk_bf16_f32 v29, v250, v251
    v_pk_fma_f32 v[252:253], v[44:45], v[234:235], v[252:253] op_sel_hi:[1,0,1]
    v_pk_mul_f32 v[254:255], v[234:235], v[246:247] op_sel:[1,0] op_sel_hi:[1,1]
    v_cvt_pk_bf16_f32 v30, v252, v253
    v_pk_fma_f32 v[254:255], v[46:47], v[234:235], v[254:255] op_sel_hi:[1,0,1]
    v_pk_mul_f32 v[250:251], v[232:233], v[240:241] op_sel:[1,0] op_sel_hi:[1,1]
    v_cvt_pk_bf16_f32 v31, v254, v255
    v_pk_fma_f32 v[250:251], v[24:25], v[232:233], v[250:251] op_sel_hi:[1,0,1]
    v_pk_mul_f32 v[252:253], v[232:233], v[242:243] op_sel:[1,0] op_sel_hi:[1,1]
    v_cvt_pk_bf16_f32 v24, v250, v251
    v_pk_fma_f32 v[252:253], v[26:27], v[232:233], v[252:253] op_sel_hi:[1,0,1]
    v_pk_mul_f32 v[254:255], v[232:233], v[244:245] op_sel:[1,0] op_sel_hi:[1,1]
    v_cvt_pk_bf16_f32 v25, v252, v253
    v_pk_fma_f32 v[254:255], v[40:41], v[232:233], v[254:255] op_sel_hi:[1,0,1]
    v_pk_mul_f32 v[250:251], v[232:233], v[246:247] op_sel:[1,0] op_sel_hi:[1,1]
    v_cvt_pk_bf16_f32 v26, v254, v255
    v_pk_fma_f32 v[250:251], v[42:43], v[232:233], v[250:251] op_sel_hi:[1,0,1]
    v_cvt_pk_bf16_f32 v27, v250, v251
    s_barrier
    ds_read_b128 v[180:183], v4
    ds_read_b64 v[160:161], v4 offset:1024
    ds_read_b64 v[170:171], v4 offset:1032
    v_mfma_f32_16x16x32_bf16 v[184:187], v[60:63], v[28:31], v[216:219]
    v_mfma_f32_16x16x32_bf16 v[188:191], v[56:59], v[28:31], v[220:223]
    v_mfma_f32_16x16x32_bf16 v[192:195], v[56:59], v[24:27], v[216:219]
    s_cmp_eq_u32 s23, 0
    s_cbranch_scc1 Lwt_105
    buffer_store_dwordx4 v[76:79], v0, s[88:91], s27 offen offset:1024
    buffer_store_dwordx4 v[92:95], v0, s[88:91], s27 offen offset:0
Lwt_106:
    s_waitcnt lgkmcnt(0)
    v_mfma_f32_16x16x32_bf16 v[196:199], v[180:183], v[24:27], v[228:231]
    v_xor_b32 v232, 0, v2
    v_xor_b32 v233, 32, v2
    v_xor_b32 v234, 64, v2
    v_xor_b32 v235, 96, v2
    v_add_u32 v236, 65536, v232
    v_max3_f32 v84, v184, v185, v188
    v_add_u32 v237, 65536, v233
    v_add_u32 v238, 65536, v234
    v_max3_f32 v100, v192, v193, v196
    v_max3_f32 v85, v186, v187, v190
    v_max3_f32 v101, v194, v195, v198
    v_max_f32 v84, v84, v189
    v_max_f32 v100, v100, v197
    v_max_f32 v85, v85, v191
    v_max_f32 v101, v101, v199
    v_max_f32 v86, v84, v85
    v_max_f32 v102, v100, v101
    v_add_u32 v239, 65536, v235
    v_add_u32 v240, 131072, v232
    v_permlane16_swap_b32 v86, v102
    v_add_u32 v241, 131072, v233
    v_max_f32 v86, v86, v102
    v_add_u32 v242, 131072, v234
    v_mov_b32 v102, v86
    v_add_u32 v243, 131072, v235
    v_add_u32 v248, s1, v0
    v_permlane32_swap_b32 v86, v102
    s_lshl_b32 s28, s3, 12
    v_max_f32 v86, v86, v102
    s_add_u32 s28, s28, 32768
    v_mov_b32 v102, v86
    v_add_u32 v249, s28, v0
    s_lshl_b32 s44, s21, 12
    v_permlane16_swap_b32 v86, v102
    s_xor_b32 s45, s44, 32768
    v_sub_f32 v84, v84, v86
    v_sub_f32 v100, v100, v102
    v_sub_f32 v85, v85, v86
    v_sub_f32 v101, v101, v102
    v_exp_f32 v84, v84
    v_exp_f32 v100, v100
    v_exp_f32 v85, v85
    v_exp_f32 v101, v101
    v_cvt_pk_bf16_f32 v84, v84, v84
    v_cvt_pk_bf16_f32 v100, v100, v100
    v_cvt_pk_bf16_f32 v85, v85, v85
    v_cvt_pk_bf16_f32 v101, v101, v101
    v_and_b32 v48, v84, v224
    v_and_b32 v52, v100, v224
    v_and_b32 v49, v85, v225
    v_and_b32 v53, v101, v225
    v_and_b32 v50, v84, v226
    v_and_b32 v54, v100, v226
    v_and_b32 v51, v85, v227
    v_and_b32 v55, v101, v227
    s_xor_b32 s46, s44, 4096
    v_mfma_f32_16x16x32_bf16 v[108:111], v[212:215], v[48:51], 0
    v_mfma_f32_16x16x32_bf16 v[76:79], v[162:165], v[48:51], 0
    v_mfma_f32_16x16x32_bf16 v[80:83], v[172:175], v[48:51], 0
    v_mfma_f32_16x16x32_bf16 v[112:115], v[212:215], v[52:55], 0
    v_mfma_f32_16x16x32_bf16 v[92:95], v[160:163], v[52:55], 0
    v_mfma_f32_16x16x32_bf16 v[96:99], v[170:173], v[52:55], 0
    s_xor_b32 s47, s44, 36864
    s_nop 1
    v_rcp_f32 v84, v108
    s_nop 1
    v_rcp_f32 v100, v112
    v_pk_mul_f32 v[76:77], v[76:77], v[84:85] op_sel_hi:[1,0]
    v_pk_mul_f32 v[92:93], v[92:93], v[100:101] op_sel_hi:[1,0]
    v_pk_mul_f32 v[78:79], v[78:79], v[84:85] op_sel_hi:[1,0]
    v_pk_mul_f32 v[94:95], v[94:95], v[100:101] op_sel_hi:[1,0]
    v_pk_mul_f32 v[80:81], v[80:81], v[84:85] op_sel_hi:[1,0]
    v_pk_mul_f32 v[96:97], v[96:97], v[100:101] op_sel_hi:[1,0]
    v_pk_mul_f32 v[82:83], v[82:83], v[84:85] op_sel_hi:[1,0]
    v_pk_mul_f32 v[98:99], v[98:99], v[100:101] op_sel_hi:[1,0]
    v_add_u32 v76, 0x8000, v76
    v_add_u32 v92, 0x8000, v92
    v_cvt_pk_bf16_f32 v76, v76, v77
    v_cvt_pk_bf16_f32 v92, v92, v93
    v_cvt_pk_bf16_f32 v77, v78, v79
    v_cvt_pk_bf16_f32 v93, v94, v95
    v_cvt_pk_bf16_f32 v78, v80, v81
    v_cvt_pk_bf16_f32 v94, v96, v97
    v_cvt_pk_bf16_f32 v79, v82, v83
    v_cvt_pk_bf16_f32 v95, v98, v99
    v_and_b32 v76, -2, v76
    v_and_b32 v92, -2, v92
    s_cmp_eq_u32 s23, 0
    s_cbranch_scc1 Lwt_107
    buffer_store_dwordx4 v[76:79], v0, s[88:91], s62 offen offset:1024
    buffer_store_dwordx4 v[92:95], v0, s[88:91], s62 offen offset:0
Lwt_108:
    s_branch L_g2
L_attA:
    s_waitcnt lgkmcnt(0)
    s_barrier
    s_cmp_ge_u32 s3, 4
    s_cbranch_scc0 Lif_109
    ds_read_b128 v[24:27], v130 offset:0
    ds_read_b128 v[28:31], v130 offset:1024
Lif_109:
    ds_read_b128 v[80:83], v128 offset:32768
    ds_read_b128 v[84:87], v128 offset:33792
    v_mov_b32 v66, 0
    v_mov_b32 v67, 0
    s_waitcnt lgkmcnt(0)
    v_mfma_f32_16x16x32_bf16 v[32:35], v[80:83], v[24:27], v[216:219]
    v_mfma_f32_16x16x32_bf16 v[40:43], v[80:83], v[28:31], 0
    v_mfma_f32_16x16x32_bf16 v[44:47], v[84:87], v[28:31], v[216:219]
    ds_read_b128 v[80:83], v128 offset:24576
    ds_read_b128 v[84:87], v128 offset:25600
    s_lshl_b32 m0, s3, 12
    s_add_u32 m0, m0, 32768
    s_nop 0
    buffer_load_dwordx4 v0, s[12:15], s55 offen offset:0 sc1 lds
    buffer_load_dwordx4 v0, s[12:15], s55 offen offset:1024 sc1 lds
    v_exp_f32 v32, v32
    buffer_load_dwordx4 v0, s[12:15], s55 offen offset:2048 sc1 lds
    v_exp_f32 v33, v33
    v_exp_f32 v34, v34
    v_exp_f32 v35, v35
    v_cvt_pk_bf16_f32 v64, v32, v33
    v_exp_f32 v40, v40
    buffer_load_dwordx4 v0, s[12:15], s55 offen offset:3072 sc1 lds
    v_exp_f32 v41, v41
    v_cvt_pk_bf16_f32 v65, v34, v35
    v_exp_f32 v42, v42
    ds_read_b128 v[88:91], v128 offset:34816
    ds_read_b128 v[92:95], v128 offset:35840
    s_cmp_eq_u32 s98, 1
    s_cbranch_scc1 Lbi_110
Lbj_111:
    s_waitcnt lgkmcnt(3)
    v_mfma_f32_16x16x32_bf16 v[48:51], v[80:83], v[24:27], v[224:227]
    v_exp_f32 v43, v43
    v_cvt_pk_bf16_f32 v68, v40, v41
    s_waitcnt lgkmcnt(2)
    v_mfma_f32_16x16x32_bf16 v[52:55], v[84:87], v[24:27], v[224:227]
    v_exp_f32 v44, v44
    v_mfma_f32_16x16x32_bf16 v[56:59], v[80:83], v[28:31], v[224:227]
    v_exp_f32 v45, v45
    v_cvt_pk_bf16_f32 v69, v42, v43
    v_mfma_f32_16x16x32_bf16 v[60:63], v[84:87], v[28:31], v[224:227]
    v_exp_f32 v46, v46
    v_exp_f32 v47, v47
    v_cvt_pk_bf16_f32 v70, v44, v45
    v_cvt_pk_bf16_f32 v71, v46, v47
    ds_read_b128 v[80:83], v128 offset:16384
    ds_read_b128 v[84:87], v128 offset:17408
    v_exp_f32 v48, v48
    s_waitcnt lgkmcnt(3)
    v_mfma_f32_16x16x32_bf16 v[104:107], v[88:91], v[64:67], 0
    v_exp_f32 v49, v49
    s_lshl_b32 m0, s3, 12
    s_add_u32 m0, m0, 0
    s_xor_b32 s36, s76, 0
    buffer_load_dwordx4 v3, s[8:11], s36 offen offset:0 lds
    v_exp_f32 v50, v50
    s_waitcnt lgkmcnt(2)
    v_mfma_f32_16x16x32_bf16 v[108:111], v[92:95], v[64:67], 0
    v_exp_f32 v51, v51
    v_cvt_pk_bf16_f32 v72, v48, v49
    v_mfma_f32_16x16x32_bf16 v[120:123], v[212:215], v[64:67], 0
    v_exp_f32 v52, v52
    v_exp_f32 v53, v53
    v_mfma_f32_16x16x32_bf16 v[112:115], v[88:91], v[68:71], 0
    v_cvt_pk_bf16_f32 v73, v50, v51
    buffer_load_dwordx4 v4, s[8:11], s36 offen offset:1024 lds
    v_exp_f32 v54, v54
    v_mfma_f32_16x16x32_bf16 v[116:119], v[92:95], v[68:71], 0
    v_exp_f32 v55, v55
    v_cvt_pk_bf16_f32 v74, v52, v53
    v_mfma_f32_16x16x32_bf16 v[124:127], v[212:215], v[68:71], 0
    v_exp_f32 v56, v56
    ds_read_b128 v[88:91], v128 offset:26624
    ds_read_b128 v[92:95], v128 offset:27648
    s_cmp_eq_u32 s98, 2
    s_cbranch_scc1 Lbi_112
Lbj_113:
    v_exp_f32 v57, v57
    s_waitcnt lgkmcnt(2)
    v_mfma_f32_16x16x32_bf16 v[32:35], v[80:83], v[24:27], v[224:227]
    v_cvt_pk_bf16_f32 v75, v54, v55
    buffer_load_dwordx4 v5, s[8:11], s36 offen offset:2048 lds
    v_exp_f32 v58, v58
    v_mfma_f32_16x16x32_bf16 v[36:39], v[84:87], v[24:27], v[224:227]
    v_exp_f32 v59, v59
    v_cvt_pk_bf16_f32 v76, v56, v57
    v_mfma_f32_16x16x32_bf16 v[40:43], v[80:83], v[28:31], v[224:227]
    v_exp_f32 v60, v60
    v_exp_f32 v61, v61
    v_mfma_f32_16x16x32_bf16 v[44:47], v[84:87], v[28:31], v[224:227]
    v_cvt_pk_bf16_f32 v77, v58, v59
    buffer_load_dwordx4 v211, s[8:11], s36 offen offset:3072 lds
    v_exp_f32 v62, v62
    v_exp_f32 v63, v63
    v_cvt_pk_bf16_f32 v78, v60, v61
    v_cvt_pk_bf16_f32 v79, v62, v63
    ds_read_b128 v[80:83], v128 offset:8192
    ds_read_b128 v[84:87], v128 offset:9216
    v_exp_f32 v32, v32
    s_waitcnt lgkmcnt(2)
    v_mfma_f32_16x16x32_bf16 v[104:107], v[88:91], v[72:75], v[104:107]
    v_exp_f32 v33, v33
    s_lshl_b32 m0, s3, 12
    s_add_u32 m0, m0, 65536
    s_xor_b32 s36, s76, 262144
    buffer_load_dwordx4 v3, s[8:11], s36 offen offset:0 lds
    v_exp_f32 v34, v34
    v_mfma_f32_16x16x32_bf16 v[108:111], v[92:95], v[72:75], v[108:111]
    v_exp_f32 v35, v35
    v_cvt_pk_bf16_f32 v64, v32, v33
    v_mfma_f32_16x16x32_bf16 v[120:123], v[212:215], v[72:75], v[120:123]
    v_exp_f32 v36, v36
    v_exp_f32 v37, v37
    v_mfma_f32_16x16x32_bf16 v[112:115], v[88:91], v[76:79], v[112:115]
    v_cvt_pk_bf16_f32 v65, v34, v35
    buffer_load_dwordx4 v4, s[8:11], s36 offen offset:1024 lds
    v_exp_f32 v38, v38
    v_mfma_f32_16x16x32_bf16 v[116:119], v[92:95], v[76:79], v[116:119]
    v_exp_f32 v39, v39
    v_cvt_pk_bf16_f32 v66, v36, v37
    v_mfma_f32_16x16x32_bf16 v[124:127], v[212:215], v[76:79], v[124:127]
    v_exp_f32 v40, v40
    ds_read_b128 v[88:91], v128 offset:18432
    ds_read_b128 v[92:95], v128 offset:19456
    s_cmp_eq_u32 s98, 3
    s_cbranch_scc1 Lbi_114
Lbj_115:
    v_exp_f32 v41, v41
    s_waitcnt lgkmcnt(2)
    v_mfma_f32_16x16x32_bf16 v[48:51], v[80:83], v[24:27], v[224:227]
    v_cvt_pk_bf16_f32 v67, v38, v39
    buffer_load_dwordx4 v5, s[8:11], s36 offen offset:2048 lds
    v_exp_f32 v42, v42
    v_mfma_f32_16x16x32_bf16 v[52:55], v[84:87], v[24:27], v[224:227]
    v_exp_f32 v43, v43
    v_cvt_pk_bf16_f32 v68, v40, v41
    v_mfma_f32_16x16x32_bf16 v[56:59], v[80:83], v[28:31], v[224:227]
    v_exp_f32 v44, v44
    v_exp_f32 v45, v45
    v_mfma_f32_16x16x32_bf16 v[60:63], v[84:87], v[28:31], v[224:227]
    v_cvt_pk_bf16_f32 v69, v42, v43
    buffer_load_dwordx4 v211, s[8:11], s36 offen offset:3072 lds
    v_exp_f32 v46, v46
    v_exp_f32 v47, v47
    v_cvt_pk_bf16_f32 v70, v44, v45
    v_cvt_pk_bf16_f32 v71, v46, v47
    ds_read_b128 v[80:83], v128 offset:0
    ds_read_b128 v[84:87], v128 offset:1024
    v_exp_f32 v48, v48
    s_waitcnt lgkmcnt(2)
    v_mfma_f32_16x16x32_bf16 v[104:107], v[88:91], v[64:67], v[104:107]
    v_exp_f32 v49, v49
    v_exp_f32 v50, v50
    v_mfma_f32_16x16x32_bf16 v[108:111], v[92:95], v[64:67], v[108:111]
    v_exp_f32 v51, v51
    s_cmp_eq_u32 s22, 0
    s_cbranch_scc0 Lif_116
    s_lshl_b32 s27, s2, 3
    s_add_u32 s27, s27, s3
    v_lshlrev_b32 v132, 7, v1
    s_mov_b32 s40, s58
    s_mov_b32 s41, s59
    s_mov_b32 s42, 2097152
    s_mov_b32 s43, 0x00020000
    s_lshl_b32 s28, s27, 10
    s_mul_i32 s27, s27, 3072
    s_mov_b64 exec, 0xffffff
    buffer_load_dword v255, v132, s[92:95], s27 offen
    s_mov_b64 exec, 0xff
    buffer_load_dword v255, v132, s[40:43], s28 offen
    s_mov_b64 exec, -1
Lif_116:
    v_cvt_pk_bf16_f32 v72, v48, v49
    v_mfma_f32_16x16x32_bf16 v[120:123], v[212:215], v[64:67], v[120:123]
    v_exp_f32 v52, v52
    v_exp_f32 v53, v53
    v_mfma_f32_16x16x32_bf16 v[112:115], v[88:91], v[68:71], v[112:115]
    v_cvt_pk_bf16_f32 v73, v50, v51
    v_exp_f32 v54, v54
    v_mfma_f32_16x16x32_bf16 v[116:119], v[92:95], v[68:71], v[116:119]
    v_exp_f32 v55, v55
    v_cvt_pk_bf16_f32 v74, v52, v53
    v_mfma_f32_16x16x32_bf16 v[124:127], v[212:215], v[68:71], v[124:127]
    v_exp_f32 v56, v56
    ds_read_b128 v[88:91], v128 offset:10240
    ds_read_b128 v[92:95], v128 offset:11264
    ds_read_b128 v[96:99], v128 offset:2048
    ds_read_b128 v[100:103], v128 offset:3072
    s_cmp_eq_u32 s98, 4
    s_cbranch_scc1 Lbi_117
Lbj_118:
    v_exp_f32 v57, v57
    s_waitcnt lgkmcnt(4)
    v_mfma_f32_16x16x32_bf16 v[32:35], v[80:83], v[24:27], v[220:223]
    v_cvt_pk_bf16_f32 v75, v54, v55
    v_exp_f32 v58, v58
    v_mfma_f32_16x16x32_bf16 v[36:39], v[84:87], v[24:27], v[224:227]
    v_exp_f32 v59, v59
    v_cvt_pk_bf16_f32 v76, v56, v57
    v_mfma_f32_16x16x32_bf16 v[44:47], v[84:87], v[28:31], v[220:223]
    v_exp_f32 v60, v60
    v_exp_f32 v61, v61
    v_cvt_pk_bf16_f32 v77, v58, v59
    v_exp_f32 v62, v62
    v_exp_f32 v63, v63
    v_cvt_pk_bf16_f32 v78, v60, v61
    v_cvt_pk_bf16_f32 v79, v62, v63
    s_waitcnt vmcnt(6) lgkmcnt(0)
    s_cmp_lg_u32 s22, 0
    s_cbranch_scc0 Lif_119
    s_waitcnt vmcnt(4)
Lif_119:
    s_barrier
    ds_read_b128 v[80:83], v129 offset:0
    ds_read_b128 v[84:87], v129 offset:1024
    v_mfma_f32_16x16x32_bf16 v[104:107], v[88:91], v[72:75], v[104:107]
    v_exp_f32 v32, v32
    s_lshl_b32 m0, s3, 12
    s_add_u32 m0, m0, 98304
    s_xor_b32 s36, s76, 524288
    buffer_load_dwordx4 v3, s[8:11], s36 offen offset:0 lds
    v_exp_f32 v33, v33
    v_mfma_f32_16x16x32_bf16 v[108:111], v[92:95], v[72:75], v[108:111]
    v_exp_f32 v34, v34
    v_exp_f32 v35, v35
    v_mfma_f32_16x16x32_bf16 v[120:123], v[212:215], v[72:75], v[120:123]
    v_cvt_pk_bf16_f32 v64, v32, v33
    v_mfma_f32_16x16x32_bf16 v[112:115], v[88:91], v[76:79], v[112:115]
    v_exp_f32 v36, v36
    v_exp_f32 v37, v37
    v_mfma_f32_16x16x32_bf16 v[116:119], v[92:95], v[76:79], v[116:119]
    v_cvt_pk_bf16_f32 v65, v34, v35
    v_exp_f32 v38, v38
    v_mfma_f32_16x16x32_bf16 v[124:127], v[212:215], v[76:79], v[124:127]
    v_exp_f32 v39, v39
    s_cmp_eq_u32 s20, 1
    s_cbranch_scc1 Lbi_120
Lbj_121:
    s_waitcnt lgkmcnt(0)
    v_mfma_f32_16x16x32_bf16 v[48:51], v[80:83], v[24:27], v[224:227]
    v_cvt_pk_bf16_f32 v66, v36, v37
    buffer_load_dwordx4 v4, s[8:11], s36 offen offset:1024 lds
    v_exp_f32 v44, v44
    v_mfma_f32_16x16x32_bf16 v[52:55], v[84:87], v[24:27], v[224:227]
    v_exp_f32 v45, v45
    v_cvt_pk_bf16_f32 v67, v38, v39
    v_mfma_f32_16x16x32_bf16 v[56:59], v[80:83], v[28:31], v[224:227]
    v_exp_f32 v46, v46
    v_mfma_f32_16x16x32_bf16 v[60:63], v[84:87], v[28:31], v[224:227]
    v_exp_f32 v47, v47
    v_cvt_pk_bf16_f32 v70, v44, v45
    v_mov_b32 v68, 0
    v_mov_b32 v69, 0
    v_cvt_pk_bf16_f32 v71, v46, v47
    ds_read_b128 v[80:83], v129 offset:8192
    ds_read_b128 v[84:87], v129 offset:9216
    v_exp_f32 v48, v48
    v_mfma_f32_16x16x32_bf16 v[104:107], v[96:99], v[64:67], v[104:107]
    v_exp_f32 v49, v49
    buffer_load_dwordx4 v5, s[8:11], s36 offen offset:2048 lds
    v_exp_f32 v50, v50
    v_mfma_f32_16x16x32_bf16 v[108:111], v[100:103], v[64:67], v[108:111]
    v_exp_f32 v51, v51
    v_cvt_pk_bf16_f32 v72, v48, v49
    v_mfma_f32_16x16x32_bf16 v[120:123], v[212:215], v[64:67], v[120:123]
    v_exp_f32 v52, v52
    v_exp_f32 v53, v53
    v_mfma_f32_16x16x32_bf16 v[112:115], v[96:99], v[68:71], v[112:115]
    v_cvt_pk_bf16_f32 v73, v50, v51
    v_exp_f32 v54, v54
    v_mfma_f32_16x16x32_bf16 v[116:119], v[100:103], v[68:71], v[116:119]
    v_exp_f32 v55, v55
    v_cvt_pk_bf16_f32 v74, v52, v53
    v_mfma_f32_16x16x32_bf16 v[124:127], v[212:215], v[68:71], v[124:127]
    v_exp_f32 v56, v56
    ds_read_b128 v[88:91], v129 offset:2048
    ds_read_b128 v[92:95], v129 offset:3072
    v_exp_f32 v57, v57
    s_waitcnt lgkmcnt(2)
    v_mfma_f32_16x16x32_bf16 v[32:35], v[80:83], v[24:27], v[224:227]
    v_cvt_pk_bf16_f32 v75, v54, v55
    buffer_load_dwordx4 v211, s[8:11], s36 offen offset:3072 lds
    v_exp_f32 v58, v58
    v_mfma_f32_16x16x32_bf16 v[36:39], v[84:87], v[24:27], v[224:227]
    v_exp_f32 v59, v59
    v_cvt_pk_bf16_f32 v76, v56, v57
    v_mfma_f32_16x16x32_bf16 v[40:43], v[80:83], v[28:31], v[224:227]
    v_exp_f32 v60, v60
    v_exp_f32 v61, v61
    v_mfma_f32_16x16x32_bf16 v[44:47], v[84:87], v[28:31], v[224:227]
    v_cvt_pk_bf16_f32 v77, v58, v59
    v_exp_f32 v62, v62
    v_exp_f32 v63, v63
    v_cvt_pk_bf16_f32 v78, v60, v61
    v_cvt_pk_bf16_f32 v79, v62, v63
    ds_read_b128 v[80:83], v129 offset:16384
    ds_read_b128 v[84:87], v129 offset:17408
    v_exp_f32 v32, v32
    s_waitcnt lgkmcnt(2)
    v_mfma_f32_16x16x32_bf16 v[104:107], v[88:91], v[72:75], v[104:107]
    v_exp_f32 v33, v33
    s_lshl_b32 m0, s3, 12
    s_add_u32 m0, m0, 131072
    s_xor_b32 s36, s76, 786432
    buffer_load_dwordx4 v3, s[8:11], s36 offen offset:0 lds
    v_exp_f32 v34, v34
    v_mfma_f32_16x16x32_bf16 v[108:111], v[92:95], v[72:75], v[108:111]
    v_exp_f32 v35, v35
    v_cvt_pk_bf16_f32 v64, v32, v33
    v_mfma_f32_16x16x32_bf16 v[120:123], v[212:215], v[72:75], v[120:123]
    v_exp_f32 v36, v36
    v_exp_f32 v37, v37
    v_mfma_f32_16x16x32_bf16 v[112:115], v[88:91], v[76:79], v[112:115]
    v_cvt_pk_bf16_f32 v65, v34, v35
    v_exp_f32 v38, v38
    v_mfma_f32_16x16x32_bf16 v[116:119], v[92:95], v[76:79], v[116:119]
    v_exp_f32 v39, v39
    v_cvt_pk_bf16_f32 v66, v36, v37
    v_mfma_f32_16x16x32_bf16 v[124:127], v[212:215], v[76:79], v[124:127]
    v_exp_f32 v40, v40
    ds_read_b128 v[88:91], v129 offset:10240
    ds_read_b128 v[92:95], v129 offset:11264
    v_exp_f32 v41, v41
    s_waitcnt lgkmcnt(2)
    v_mfma_f32_16x16x32_bf16 v[48:51], v[80:83], v[24:27], v[224:227]
    v_cvt_pk_bf16_f32 v67, v38, v39
    buffer_load_dwordx4 v4, s[8:11], s36 offen offset:1024 lds
    v_exp_f32 v42, v42
    v_mfma_f32_16x16x32_bf16 v[52:55], v[84:87], v[24:27], v[224:227]
    v_exp_f32 v43, v43
    v_cvt_pk_bf16_f32 v68, v40, v41
    v_mfma_f32_16x16x32_bf16 v[56:59], v[80:83], v[28:31], v[224:227]
    v_exp_f32 v44, v44
    v_exp_f32 v45, v45
    v_mfma_f32_16x16x32_bf16 v[60:63], v[84:87], v[28:31], v[224:227]
    v_cvt_pk_bf16_f32 v69, v42, v43
    v_exp_f32 v46, v46
    v_exp_f32 v47, v47
    v_cvt_pk_bf16_f32 v70, v44, v45
    v_cvt_pk_bf16_f32 v71, v46, v47
    ds_read_b128 v[80:83], v129 offset:24576
    ds_read_b128 v[84:87], v129 offset:25600
    v_exp_f32 v48, v48
    s_waitcnt lgkmcnt(2)
    v_mfma_f32_16x16x32_bf16 v[104:107], v[88:91], v[64:67], v[104:107]
    v_exp_f32 v49, v49
    buffer_load_dwordx4 v5, s[8:11], s36 offen offset:2048 lds
    v_exp_f32 v50, v50
    v_mfma_f32_16x16x32_bf16 v[108:111], v[92:95], v[64:67], v[108:111]
    v_exp_f32 v51, v51
    v_cvt_pk_bf16_f32 v72, v48, v49
    v_mfma_f32_16x16x32_bf16 v[120:123], v[212:215], v[64:67], v[120:123]
    v_exp_f32 v52, v52
    v_exp_f32 v53, v53
    v_mfma_f32_16x16x32_bf16 v[112:115], v[88:91], v[68:71], v[112:115]
    v_cvt_pk_bf16_f32 v73, v50, v51
    v_exp_f32 v54, v54
    v_mfma_f32_16x16x32_bf16 v[116:119], v[92:95], v[68:71], v[116:119]
    v_exp_f32 v55, v55
    v_cvt_pk_bf16_f32 v74, v52, v53
    v_mfma_f32_16x16x32_bf16 v[124:127], v[212:215], v[68:71], v[124:127]
    v_exp_f32 v56, v56
    ds_read_b128 v[88:91], v129 offset:18432
    ds_read_b128 v[92:95], v129 offset:19456
    v_exp_f32 v57, v57
    s_waitcnt lgkmcnt(2)
    v_mfma_f32_16x16x32_bf16 v[32:35], v[80:83], v[24:27], v[224:227]
    v_cvt_pk_bf16_f32 v75, v54, v55
    buffer_load_dwordx4 v211, s[8:11], s36 offen offset:3072 lds
    v_exp_f32 v58, v58
    v_mfma_f32_16x16x32_bf16 v[36:39], v[84:87], v[24:27], v[224:227]
    v_exp_f32 v59, v59
    v_cvt_pk_bf16_f32 v76, v56, v57
    v_mfma_f32_16x16x32_bf16 v[40:43], v[80:83], v[28:31], v[224:227]
    v_exp_f32 v60, v60
    v_exp_f32 v61, v61
    v_mfma_f32_16x16x32_bf16 v[44:47], v[84:87], v[28:31], v[224:227]
    v_cvt_pk_bf16_f32 v77, v58, v59
    v_exp_f32 v62, v62
    v_exp_f32 v63, v63
    v_cvt_pk_bf16_f32 v78, v60, v61
    v_cvt_pk_bf16_f32 v79, v62, v63
    v_exp_f32 v32, v32
    s_waitcnt lgkmcnt(1)
    v_mfma_f32_16x16x32_bf16 v[104:107], v[88:91], v[72:75], v[104:107]
    v_exp_f32 v33, v33
    v_exp_f32 v34, v34
    s_waitcnt lgkmcnt(0)
    v_mfma_f32_16x16x32_bf16 v[108:111], v[92:95], v[72:75], v[108:111]
    v_exp_f32 v35, v35
    v_cvt_pk_bf16_f32 v64, v32, v33
    v_mfma_f32_16x16x32_bf16 v[120:123], v[212:215], v[72:75], v[120:123]
    v_exp_f32 v36, v36
    v_exp_f32 v37, v37
    v_mfma_f32_16x16x32_bf16 v[112:115], v[88:91], v[76:79], v[112:115]
    v_cvt_pk_bf16_f32 v65, v34, v35
    v_exp_f32 v38, v38
    v_mfma_f32_16x16x32_bf16 v[116:119], v[92:95], v[76:79], v[116:119]
    v_exp_f32 v39, v39
    v_cvt_pk_bf16_f32 v66, v36, v37
    v_mfma_f32_16x16x32_bf16 v[124:127], v[212:215], v[76:79], v[124:127]
    v_exp_f32 v40, v40
    ds_read_b128 v[88:91], v129 offset:26624
    ds_read_b128 v[92:95], v129 offset:27648
    v_exp_f32 v41, v41
    v_cvt_pk_bf16_f32 v67, v38, v39
    v_exp_f32 v42, v42
    v_exp_f32 v43, v43
    v_cvt_pk_bf16_f32 v68, v40, v41
    v_exp_f32 v44, v44
    v_exp_f32 v45, v45
    v_cvt_pk_bf16_f32 v69, v42, v43
    v_exp_f32 v46, v46
    v_exp_f32 v47, v47
    v_cvt_pk_bf16_f32 v70, v44, v45
    v_cvt_pk_bf16_f32 v71, v46, v47
    s_waitcnt lgkmcnt(1)
    v_mfma_f32_16x16x32_bf16 v[104:107], v[88:91], v[64:67], v[104:107]
    s_waitcnt lgkmcnt(0)
    v_mfma_f32_16x16x32_bf16 v[108:111], v[92:95], v[64:67], v[108:111]
    v_mfma_f32_16x16x32_bf16 v[120:123], v[212:215], v[64:67], v[120:123]
    v_mfma_f32_16x16x32_bf16 v[112:115], v[88:91], v[68:71], v[112:115]
    v_mfma_f32_16x16x32_bf16 v[116:119], v[92:95], v[68:71], v[116:119]
    v_mfma_f32_16x16x32_bf16 v[124:127], v[212:215], v[68:71], v[124:127]
    v_mov_b32 v132, 0
    v_mov_b32 v133, 0
    v_maximum3_f32 v132, |v104|, |v105|, v132
    v_maximum3_f32 v133, |v106|, |v107|, v133
    v_maximum3_f32 v132, |v108|, |v109|, v132
    v_maximum3_f32 v133, |v110|, |v111|, v133
    v_maximum3_f32 v132, |v112|, |v113|, v132
    v_maximum3_f32 v133, |v114|, |v115|, v133
    v_maximum3_f32 v132, |v116|, |v117|, v132
    v_maximum3_f32 v133, |v118|, |v119|, v133
    v_min_f32 v134, v120, v124
    v_maximum3_f32 v132, v132, v133, 0
    v_cmp_nle_f32 vcc, 0x21800000, v134
    v_mul_f32 v132, 0x21800000, v132
    s_mov_b64 s[28:29], vcc
    v_maximum3_f32 v132, v132, v120, v124
    v_cmp_nge_f32 vcc, 0x5d800000, v132
    s_nop 0
    s_or_b64 vcc, vcc, s[28:29]
    s_cbranch_vccnz L_exact
L_aok:
    v_rcp_f32 v132, v120
    v_rcp_f32 v134, v124
    v_pk_mul_f32 v[104:105], v[104:105], v[132:133] op_sel_hi:[1,0]
    v_pk_mul_f32 v[112:113], v[112:113], v[134:135] op_sel_hi:[1,0]
    v_pk_mul_f32 v[106:107], v[106:107], v[132:133] op_sel_hi:[1,0]
    v_pk_mul_f32 v[114:115], v[114:115], v[134:135] op_sel_hi:[1,0]
    v_pk_mul_f32 v[108:109], v[108:109], v[132:133] op_sel_hi:[1,0]
    v_pk_mul_f32 v[116:117], v[116:117], v[134:135] op_sel_hi:[1,0]
    v_pk_mul_f32 v[110:111], v[110:111], v[132:133] op_sel_hi:[1,0]
    v_pk_mul_f32 v[118:119], v[118:119], v[134:135] op_sel_hi:[1,0]
    v_add_u32 v104, 0x8000, v104
    v_add_u32 v112, 0x8000, v112
    v_cvt_pk_bf16_f32 v104, v104, v105
    v_cvt_pk_bf16_f32 v112, v112, v113
    v_cvt_pk_bf16_f32 v105, v106, v107
    v_cvt_pk_bf16_f32 v113, v114, v115
    v_cvt_pk_bf16_f32 v106, v108, v109
    v_cvt_pk_bf16_f32 v114, v116, v117
    v_cvt_pk_bf16_f32 v107, v110, v111
    v_cvt_pk_bf16_f32 v115, v118, v119
    v_and_b32 v104, -2, v104
    v_and_b32 v112, -2, v112
    s_cmp_eq_u32 s23, 0
    s_cbranch_scc1 Lwt_122
    buffer_store_dwordx4 v[104:107], v0, s[88:91], s62 offen offset:0
    buffer_store_dwordx4 v[112:115], v0, s[88:91], s62 offen offset:1024
Lwt_123:
    s_cmp_ge_u32 s3, 4
    s_cbranch_scc1 L_lnext
    v_xor_b32 v232, 0, v2
    v_xor_b32 v233, 32, v2
    v_xor_b32 v234, 64, v2
    v_xor_b32 v235, 96, v2
    v_add_u32 v236, 65536, v232
    v_add_u32 v237, 65536, v233
    v_add_u32 v238, 65536, v234
    v_add_u32 v239, 65536, v235
    v_add_u32 v240, 131072, v232
    v_add_u32 v241, 131072, v233
    v_add_u32 v242, 131072, v234
    v_add_u32 v243, 131072, v235
    v_add_u32 v248, s1, v0
    s_lshl_b32 s28, s3, 12
    s_add_u32 s28, s28, 32768
    v_add_u32 v249, s28, v0
    s_lshl_b32 s44, s21, 12
    s_xor_b32 s45, s44, 32768
    s_xor_b32 s46, s44, 4096
    s_xor_b32 s47, s44, 36864
L_g2:
    buffer_load_dwordx4 v[56:59], v248, s[88:91], s44 offen offset:0 sc1
    buffer_load_dwordx4 v[60:63], v248, s[88:91], s44 offen offset:1024 sc1
    buffer_load_dwordx4 v[64:67], v248, s[88:91], s44 offen offset:2048 sc1
    buffer_load_dwordx4 v[68:71], v248, s[88:91], s44 offen offset:3072 sc1
    buffer_load_dwordx4 v[72:75], v248, s[88:91], s45 offen offset:0 sc1
    buffer_load_dwordx4 v[76:79], v248, s[88:91], s45 offen offset:1024 sc1
    buffer_load_dwordx4 v[80:83], v248, s[88:91], s45 offen offset:2048 sc1
    buffer_load_dwordx4 v[84:87], v248, s[88:91], s45 offen offset:3072 sc1
    buffer_load_dwordx4 v[88:91], v248, s[88:91], s46 offen offset:0 sc1
    buffer_load_dwordx4 v[92:95], v248, s[88:91], s46 offen offset:1024 sc1
    ds_read_b64_tr_b16 v[120:121], v232 offset:0
    ds_read_b64_tr_b16 v[122:123], v232 offset:2048
    ds_read_b64_tr_b16 v[124:125], v233 offset:0
    ds_read_b64_tr_b16 v[126:127], v233 offset:2048
    ds_read_b64_tr_b16 v[128:129], v234 offset:0
    ds_read_b64_tr_b16 v[130:131], v234 offset:2048
    ds_read_b64_tr_b16 v[132:133], v235 offset:0
    ds_read_b64_tr_b16 v[134:135], v235 offset:2048
    ds_read_b64_tr_b16 v[136:137], v232 offset:4096
    ds_read_b64_tr_b16 v[138:139], v232 offset:6144
    ds_read_b64_tr_b16 v[140:141], v233 offset:4096
    ds_read_b64_tr_b16 v[142:143], v233 offset:6144
    ds_read_b64_tr_b16 v[144:145], v234 offset:4096
    ds_read_b64_tr_b16 v[146:147], v234 offset:6144
    ds_read_b64_tr_b16 v[148:149], v235 offset:4096
    ds_read_b64_tr_b16 v[150:151], v235 offset:6144
    v_mov_b32 v96, 0
    v_mov_b32 v100, 0
    v_mov_b32 v104, 0
    v_mov_b32 v108, 0
    v_mov_b32 v112, 0
    v_mov_b32 v116, 0
    v_lshlrev_b32 v24, 16, v8
    v_and_b32 v25, 0xffff0000, v8
    v_lshlrev_b32 v26, 16, v9
    v_and_b32 v27, 0xffff0000, v9
    v_lshlrev_b32 v28, 16, v10
    v_and_b32 v29, 0xffff0000, v10
    v_lshlrev_b32 v30, 16, v11
    v_and_b32 v31, 0xffff0000, v11
    v_lshlrev_b32 v32, 16, v12
    v_and_b32 v33, 0xffff0000, v12
    v_lshlrev_b32 v34, 16, v13
    v_and_b32 v35, 0xffff0000, v13
    v_lshlrev_b32 v36, 16, v14
    v_and_b32 v37, 0xffff0000, v14
    v_lshlrev_b32 v38, 16, v15
    v_and_b32 v39, 0xffff0000, v15
    v_lshlrev_b32 v40, 16, v16
    v_and_b32 v41, 0xffff0000, v16
    v_lshlrev_b32 v42, 16, v17
    v_and_b32 v43, 0xffff0000, v17
    v_lshlrev_b32 v44, 16, v18
    v_and_b32 v45, 0xffff0000, v18
    v_lshlrev_b32 v46, 16, v19
    v_and_b32 v47, 0xffff0000, v19
    v_lshlrev_b32 v48, 16, v20
    v_and_b32 v49, 0xffff0000, v20
    v_lshlrev_b32 v50, 16, v21
    v_and_b32 v51, 0xffff0000, v21
    v_lshlrev_b32 v52, 16, v22
    v_and_b32 v53, 0xffff0000, v22
    v_lshlrev_b32 v54, 16, v23
    v_and_b32 v55, 0xffff0000, v23
    s_add_u32 s22, s22, 1
    s_mov_b32 s96, 0
    s_lshr_b32 s27, s3, 1
    s_lshl_b32 s27, s27, 13
    v_add_u32 v200, s27, v0
    v_add_u32 v201, 1024, v200
    v_and_b32 v206, 2147483647, v206
    s_bitcmp1_b32 s22, 0
    s_cselect_b32 s8, s58, s52
    s_cselect_b32 s9, s59, s53
    s_cbranch_scc1 Lmb_124
    v_and_b32 v224, 15, v1
    v_lshrrev_b32 v225, 4, v1
    v_lshlrev_b32 v225, 2, v225
    v_sub_u32 v224, v224, v225
    s_cmp_lt_u32 s20, 2
    s_cselect_b32 s27, 0, -1
    v_subrev_u32 v216, 0, v224
    v_subrev_u32 v217, 1, v224
    v_subrev_u32 v218, 2, v224
    v_subrev_u32 v219, 3, v224
    v_ashrrev_i32 v216, 31, v216
    v_ashrrev_i32 v217, 31, v217
    v_ashrrev_i32 v218, 31, v218
    v_ashrrev_i32 v219, 31, v219
    v_and_b32 v216, 4048155338, v216
    v_and_b32 v217, 4048155338, v217
    v_and_b32 v218, 4048155338, v218
    v_and_b32 v219, 4048155338, v219
    v_and_b32 v220, s27, v216
    v_and_b32 v221, s27, v217
    v_and_b32 v222, s27, v218
    v_and_b32 v223, s27, v219
    v_xor_b32 v220, 4048155338, v220
    v_xor_b32 v221, 4048155338, v221
    v_xor_b32 v222, 4048155338, v222
    v_xor_b32 v223, 4048155338, v223
    v_mov_b32 v224, 0
    v_mov_b32 v225, 0
    v_mov_b32 v226, 0
    v_mov_b32 v227, 0
    s_branch Lmc_125
Lmb_124:
    v_and_b32 v228, 15, v1
    v_lshrrev_b32 v229, 4, v1
    v_lshlrev_b32 v229, 2, v229
    v_sub_u32 v228, v228, v229
    v_subrev_u32 v224, 0, v228
    v_subrev_u32 v225, 1, v228
    v_subrev_u32 v226, 2, v228
    v_subrev_u32 v227, 3, v228
    v_lshlrev_b32 v220, 31, v224
    v_lshlrev_b32 v221, 31, v225
    v_lshlrev_b32 v222, 31, v226
    v_lshlrev_b32 v223, 31, v227
    v_or_b32 v216, v220, v224
    v_not_b32 v224, v224
    v_or_b32 v217, v221, v225
    v_not_b32 v225, v225
    v_or_b32 v218, v222, v226
    v_not_b32 v226, v226
    v_or_b32 v219, v223, v227
    v_not_b32 v227, v227
    v_or_b32 v220, v220, v224
    v_or_b32 v221, v221, v225
    v_or_b32 v222, v222, v226
    v_or_b32 v223, v223, v227
    v_ashrrev_i32 v216, 31, v216
    v_ashrrev_i32 v217, 31, v217
    v_ashrrev_i32 v218, 31, v218
    v_ashrrev_i32 v219, 31, v219
    v_ashrrev_i32 v220, 31, v220
    v_ashrrev_i32 v221, 31, v221
    v_ashrrev_i32 v222, 31, v222
    v_ashrrev_i32 v223, 31, v223
    s_mov_b32 s27, 0xffff
    v_bfi_b32 v224, s27, v220, v221
    v_bfi_b32 v225, s27, v222, v223
    v_bfi_b32 v226, s27, v216, v217
    v_bfi_b32 v227, s27, v218, v219
    v_not_b32 v224, v224
    v_not_b32 v225, v225
    v_not_b32 v226, v226
    v_not_b32 v227, v227
    v_and_b32 v216, 4048155338, v216
    v_and_b32 v217, 4048155338, v217
    v_and_b32 v218, 4048155338, v218
    v_and_b32 v219, 4048155338, v219
    v_and_b32 v220, 4048155338, v220
    v_and_b32 v221, 4048155338, v221
    v_and_b32 v222, 4048155338, v222
    v_and_b32 v223, 4048155338, v223
    s_lshr_b32 s27, s3, 1
    s_or_b32 s27, s27, s20
    s_cmp_eq_u32 s27, 0
    s_cselect_b32 s27, 4048155338, 0
    v_or_b32 v228, s27, v220
    v_or_b32 v229, s27, v221
    v_or_b32 v230, s27, v222
    v_or_b32 v231, s27, v223
Lmc_125:
    s_waitcnt vmcnt(8)
    v_bitop3_b32 v250, v56, v60, 1 bitop3:0xa8
    v_cmp_ne_u32 vcc, 0, v250
    s_nop 0
    s_cbranch_vccnz Lot_127
Look_128:
    s_waitcnt lgkmcnt(8)
    v_mfma_f32_16x16x32_bf16 v[24:27], v[120:123], v[56:59], v[24:27]
    ds_read_b64_tr_b16 v[152:153], v232 offset:8192
    v_mfma_f32_16x16x32_bf16 v[40:43], v[120:123], v[60:63], v[40:43]
    ds_read_b64_tr_b16 v[154:155], v232 offset:10240
    buffer_load_dwordx4 v[96:99], v248, s[88:91], s46 offen offset:2048 sc1
    v_mfma_f32_16x16x32_bf16 v[44:47], v[124:127], v[60:63], v[44:47]
    ds_read_b64_tr_b16 v[156:157], v233 offset:8192
    v_mfma_f32_16x16x32_bf16 v[28:31], v[124:127], v[56:59], v[28:31]
    ds_read_b64_tr_b16 v[158:159], v233 offset:10240
    buffer_load_dwordx4 v[100:103], v248, s[88:91], s46 offen offset:3072 sc1
    v_mfma_f32_16x16x32_bf16 v[32:35], v[128:131], v[56:59], v[32:35]
    ds_read_b64_tr_b16 v[160:161], v234 offset:8192
    s_waitcnt vmcnt(8)
    v_bitop3_b32 v250, v64, v68, 1 bitop3:0xa8
    v_mfma_f32_16x16x32_bf16 v[48:51], v[128:131], v[60:63], v[48:51]
    ds_read_b64_tr_b16 v[162:163], v234 offset:10240
    v_cmp_ne_u32 vcc, 0, v250
    v_mfma_f32_16x16x32_bf16 v[52:55], v[132:135], v[60:63], v[52:55]
    ds_read_b64_tr_b16 v[164:165], v235 offset:8192
    s_cbranch_vccnz Lot_130
Look_131:
    v_mfma_f32_16x16x32_bf16 v[36:39], v[132:135], v[56:59], v[36:39]
    ds_read_b64_tr_b16 v[166:167], v235 offset:10240
    s_waitcnt lgkmcnt(8)
    v_mfma_f32_16x16x32_bf16 v[24:27], v[136:139], v[64:67], v[24:27]
    ds_read_b64_tr_b16 v[120:121], v232 offset:12288
    v_mfma_f32_16x16x32_bf16 v[40:43], v[136:139], v[68:71], v[40:43]
    ds_read_b64_tr_b16 v[122:123], v232 offset:14336
    buffer_load_dwordx4 v[104:107], v248, s[88:91], s47 offen offset:0 sc1
    v_mfma_f32_16x16x32_bf16 v[44:47], v[140:143], v[68:71], v[44:47]
    ds_read_b64_tr_b16 v[124:125], v233 offset:12288
    v_mfma_f32_16x16x32_bf16 v[28:31], v[140:143], v[64:67], v[28:31]
    ds_read_b64_tr_b16 v[126:127], v233 offset:14336
    buffer_load_dwordx4 v[108:111], v248, s[88:91], s47 offen offset:1024 sc1
    v_mfma_f32_16x16x32_bf16 v[32:35], v[144:147], v[64:67], v[32:35]
    ds_read_b64_tr_b16 v[128:129], v234 offset:12288
    s_waitcnt vmcnt(8)
    v_bitop3_b32 v250, v72, v76, 1 bitop3:0xa8
    v_mfma_f32_16x16x32_bf16 v[48:51], v[144:147], v[68:71], v[48:51]
    ds_read_b64_tr_b16 v[130:131], v234 offset:14336
    v_cmp_ne_u32 vcc, 0, v250
    v_mfma_f32_16x16x32_bf16 v[52:55], v[148:151], v[68:71], v[52:55]
    ds_read_b64_tr_b16 v[132:133], v235 offset:12288
    s_cbranch_vccnz Lot_133
Look_134:
    v_mfma_f32_16x16x32_bf16 v[36:39], v[148:151], v[64:67], v[36:39]
    ds_read_b64_tr_b16 v[134:135], v235 offset:14336
    s_waitcnt lgkmcnt(8)
    v_mfma_f32_16x16x32_bf16 v[24:27], v[152:155], v[72:75], v[24:27]
    ds_read_b64_tr_b16 v[136:137], v232 offset:16384
    v_mfma_f32_16x16x32_bf16 v[40:43], v[152:155], v[76:79], v[40:43]
    ds_read_b64_tr_b16 v[138:139], v232 offset:18432
    buffer_load_dwordx4 v[112:115], v248, s[88:91], s47 offen offset:2048 sc1
    v_mfma_f32_16x16x32_bf16 v[44:47], v[156:159], v[76:79], v[44:47]
    ds_read_b64_tr_b16 v[140:141], v233 offset:16384
    v_mfma_f32_16x16x32_bf16 v[28:31], v[156:159], v[72:75], v[28:31]
    ds_read_b64_tr_b16 v[142:143], v233 offset:18432
    buffer_load_dwordx4 v[116:119], v248, s[88:91], s47 offen offset:3072 sc1
    v_mfma_f32_16x16x32_bf16 v[32:35], v[160:163], v[72:75], v[32:35]
    ds_read_b64_tr_b16 v[144:145], v234 offset:16384
    s_waitcnt vmcnt(8)
    v_bitop3_b32 v250, v80, v84, 1 bitop3:0xa8
    v_mfma_f32_16x16x32_bf16 v[48:51], v[160:163], v[76:79], v[48:51]
    ds_read_b64_tr_b16 v[146:147], v234 offset:18432
    v_cmp_ne_u32 vcc, 0, v250
    v_mfma_f32_16x16x32_bf16 v[52:55], v[164:167], v[76:79], v[52:55]
    ds_read_b64_tr_b16 v[148:149], v235 offset:16384
    s_cbranch_vccnz Lot_136
Look_137:
    v_mfma_f32_16x16x32_bf16 v[36:39], v[164:167], v[72:75], v[36:39]
    ds_read_b64_tr_b16 v[150:151], v235 offset:18432
    s_waitcnt lgkmcnt(8)
    v_mfma_f32_16x16x32_bf16 v[24:27], v[120:123], v[80:83], v[24:27]
    ds_read_b64_tr_b16 v[152:153], v232 offset:20480
    s_xor_b32 s44, s44, 8192
    v_mfma_f32_16x16x32_bf16 v[40:43], v[120:123], v[84:87], v[40:43]
    ds_read_b64_tr_b16 v[154:155], v232 offset:22528
    buffer_load_dwordx4 v[56:59], v248, s[88:91], s44 offen offset:0 sc1
    v_mfma_f32_16x16x32_bf16 v[44:47], v[124:127], v[84:87], v[44:47]
    ds_read_b64_tr_b16 v[156:157], v233 offset:20480
    v_mfma_f32_16x16x32_bf16 v[28:31], v[124:127], v[80:83], v[28:31]
    ds_read_b64_tr_b16 v[158:159], v233 offset:22528
    buffer_load_dwordx4 v[60:63], v248, s[88:91], s44 offen offset:1024 sc1
    v_mfma_f32_16x16x32_bf16 v[32:35], v[128:131], v[80:83], v[32:35]
    ds_read_b64_tr_b16 v[160:161], v234 offset:20480
    s_waitcnt vmcnt(8)
    v_bitop3_b32 v250, v88, v92, 1 bitop3:0xa8
    v_mfma_f32_16x16x32_bf16 v[48:51], v[128:131], v[84:87], v[48:51]
    ds_read_b64_tr_b16 v[162:163], v234 offset:22528
    v_cmp_ne_u32 vcc, 0, v250
    v_mfma_f32_16x16x32_bf16 v[52:55], v[132:135], v[84:87], v[52:55]
    ds_read_b64_tr_b16 v[164:165], v235 offset:20480
    s_cbranch_vccnz Lot_139
Look_140:
    v_mfma_f32_16x16x32_bf16 v[36:39], v[132:135], v[80:83], v[36:39]
    ds_read_b64_tr_b16 v[166:167], v235 offset:22528
    s_waitcnt lgkmcnt(8)
    v_mfma_f32_16x16x32_bf16 v[24:27], v[136:139], v[88:91], v[24:27]
    ds_read_b64_tr_b16 v[120:121], v232 offset:24576
    v_mfma_f32_16x16x32_bf16 v[40:43], v[136:139], v[92:95], v[40:43]
    ds_read_b64_tr_b16 v[122:123], v232 offset:26624
    buffer_load_dwordx4 v[64:67], v248, s[88:91], s44 offen offset:2048 sc1
    v_mfma_f32_16x16x32_bf16 v[44:47], v[140:143], v[92:95], v[44:47]
    ds_read_b64_tr_b16 v[124:125], v233 offset:24576
    v_mfma_f32_16x16x32_bf16 v[28:31], v[140:143], v[88:91], v[28:31]
    ds_read_b64_tr_b16 v[126:127], v233 offset:26624
    buffer_load_dwordx4 v[68:71], v248, s[88:91], s44 offen offset:3072 sc1
    v_mfma_f32_16x16x32_bf16 v[32:35], v[144:147], v[88:91], v[32:35]
    ds_read_b64_tr_b16 v[128:129], v234 offset:24576
    s_waitcnt vmcnt(8)
    v_bitop3_b32 v250, v96, v100, 1 bitop3:0xa8
    v_mfma_f32_16x16x32_bf16 v[48:51], v[144:147], v[92:95], v[48:51]
    ds_read_b64_tr_b16 v[130:131], v234 offset:26624
    v_cmp_ne_u32 vcc, 0, v250
    v_mfma_f32_16x16x32_bf16 v[52:55], v[148:151], v[92:95], v[52:55]
    ds_read_b64_tr_b16 v[132:133], v235 offset:24576
    s_cbranch_vccnz Lot_142
Look_143:
    v_mfma_f32_16x16x32_bf16 v[36:39], v[148:151], v[88:91], v[36:39]
    ds_read_b64_tr_b16 v[134:135], v235 offset:26624
    s_waitcnt lgkmcnt(8)
    v_mfma_f32_16x16x32_bf16 v[24:27], v[152:155], v[96:99], v[24:27]
    ds_read_b64_tr_b16 v[136:137], v232 offset:28672
    s_xor_b32 s45, s45, 8192
    v_mfma_f32_16x16x32_bf16 v[40:43], v[152:155], v[100:103], v[40:43]
    ds_read_b64_tr_b16 v[138:139], v232 offset:30720
    buffer_load_dwordx4 v[72:75], v248, s[88:91], s45 offen offset:0 sc1
    v_mfma_f32_16x16x32_bf16 v[44:47], v[156:159], v[100:103], v[44:47]
    ds_read_b64_tr_b16 v[140:141], v233 offset:28672
    v_mfma_f32_16x16x32_bf16 v[28:31], v[156:159], v[96:99], v[28:31]
    ds_read_b64_tr_b16 v[142:143], v233 offset:30720
    buffer_load_dwordx4 v[76:79], v248, s[88:91], s45 offen offset:1024 sc1
    v_mfma_f32_16x16x32_bf16 v[32:35], v[160:163], v[96:99], v[32:35]
    ds_read_b64_tr_b16 v[144:145], v234 offset:28672
    s_waitcnt vmcnt(8)
    v_bitop3_b32 v250, v104, v108, 1 bitop3:0xa8
    v_mfma_f32_16x16x32_bf16 v[48:51], v[160:163], v[100:103], v[48:51]
    ds_read_b64_tr_b16 v[146:147], v234 offset:30720
    v_cmp_ne_u32 vcc, 0, v250
    v_mfma_f32_16x16x32_bf16 v[52:55], v[164:167], v[100:103], v[52:55]
    ds_read_b64_tr_b16 v[148:149], v235 offset:28672
    s_cbranch_vccnz Lot_145
Look_146:
    v_mfma_f32_16x16x32_bf16 v[36:39], v[164:167], v[96:99], v[36:39]
    ds_read_b64_tr_b16 v[150:151], v235 offset:30720
    s_barrier
    s_waitcnt lgkmcnt(8)
    v_mfma_f32_16x16x32_bf16 v[24:27], v[120:123], v[104:107], v[24:27]
    ds_read_b64_tr_b16 v[152:153], v236 offset:0
    v_mfma_f32_16x16x32_bf16 v[40:43], v[120:123], v[108:111], v[40:43]
    ds_read_b64_tr_b16 v[154:155], v236 offset:2048
    buffer_load_dwordx4 v[80:83], v248, s[88:91], s45 offen offset:2048 sc1
    v_mfma_f32_16x16x32_bf16 v[44:47], v[124:127], v[108:111], v[44:47]
    ds_read_b64_tr_b16 v[156:157], v237 offset:0
    v_mfma_f32_16x16x32_bf16 v[28:31], v[124:127], v[104:107], v[28:31]
    ds_read_b64_tr_b16 v[158:159], v237 offset:2048
    buffer_load_dwordx4 v[84:87], v248, s[88:91], s45 offen offset:3072 sc1
    v_mfma_f32_16x16x32_bf16 v[32:35], v[128:131], v[104:107], v[32:35]
    ds_read_b64_tr_b16 v[160:161], v238 offset:0
    s_waitcnt vmcnt(8)
    v_bitop3_b32 v250, v112, v116, 1 bitop3:0xa8
    v_mfma_f32_16x16x32_bf16 v[48:51], v[128:131], v[108:111], v[48:51]
    ds_read_b64_tr_b16 v[162:163], v238 offset:2048
    v_cmp_ne_u32 vcc, 0, v250
    v_mfma_f32_16x16x32_bf16 v[52:55], v[132:135], v[108:111], v[52:55]
    ds_read_b64_tr_b16 v[164:165], v239 offset:0
    s_cbranch_vccnz Lot_148
Look_149:
    v_mfma_f32_16x16x32_bf16 v[36:39], v[132:135], v[104:107], v[36:39]
    ds_read_b64_tr_b16 v[166:167], v239 offset:2048
    s_waitcnt lgkmcnt(8)
    v_mfma_f32_16x16x32_bf16 v[24:27], v[136:139], v[112:115], v[24:27]
    ds_read_b64_tr_b16 v[120:121], v236 offset:4096
    s_xor_b32 s46, s46, 8192
    v_mfma_f32_16x16x32_bf16 v[40:43], v[136:139], v[116:119], v[40:43]
    ds_read_b64_tr_b16 v[122:123], v236 offset:6144
    buffer_load_dwordx4 v[88:91], v248, s[88:91], s46 offen offset:0 sc1
    v_mfma_f32_16x16x32_bf16 v[44:47], v[140:143], v[116:119], v[44:47]
    ds_read_b64_tr_b16 v[124:125], v237 offset:4096
    v_mfma_f32_16x16x32_bf16 v[28:31], v[140:143], v[112:115], v[28:31]
    ds_read_b64_tr_b16 v[126:127], v237 offset:6144
    buffer_load_dwordx4 v[92:95], v248, s[88:91], s46 offen offset:1024 sc1
    v_mfma_f32_16x16x32_bf16 v[32:35], v[144:147], v[112:115], v[32:35]
    ds_read_b64_tr_b16 v[128:129], v238 offset:4096
    s_waitcnt vmcnt(8)
    v_bitop3_b32 v250, v56, v60, 1 bitop3:0xa8
    v_mfma_f32_16x16x32_bf16 v[48:51], v[144:147], v[116:119], v[48:51]
    ds_read_b64_tr_b16 v[130:131], v238 offset:6144
    v_cmp_ne_u32 vcc, 0, v250
    v_mfma_f32_16x16x32_bf16 v[52:55], v[148:151], v[116:119], v[52:55]
    ds_read_b64_tr_b16 v[132:133], v239 offset:4096
    s_cbranch_vccnz Lot_151
Look_152:
    v_mfma_f32_16x16x32_bf16 v[36:39], v[148:151], v[112:115], v[36:39]
    ds_read_b64_tr_b16 v[134:135], v239 offset:6144
    s_waitcnt lgkmcnt(8)
    v_mfma_f32_16x16x32_bf16 v[24:27], v[152:155], v[56:59], v[24:27]
    ds_read_b64_tr_b16 v[136:137], v236 offset:8192
    v_mfma_f32_16x16x32_bf16 v[40:43], v[152:155], v[60:63], v[40:43]
    ds_read_b64_tr_b16 v[138:139], v236 offset:10240
    buffer_load_dwordx4 v[96:99], v248, s[88:91], s46 offen offset:2048 sc1
    v_mfma_f32_16x16x32_bf16 v[44:47], v[156:159], v[60:63], v[44:47]
    ds_read_b64_tr_b16 v[140:141], v237 offset:8192
    v_mfma_f32_16x16x32_bf16 v[28:31], v[156:159], v[56:59], v[28:31]
    ds_read_b64_tr_b16 v[142:143], v237 offset:10240
    buffer_load_dwordx4 v[100:103], v248, s[88:91], s46 offen offset:3072 sc1
    v_mfma_f32_16x16x32_bf16 v[32:35], v[160:163], v[56:59], v[32:35]
    ds_read_b64_tr_b16 v[144:145], v238 offset:8192
    s_waitcnt vmcnt(8)
    v_bitop3_b32 v250, v64, v68, 1 bitop3:0xa8
    v_mfma_f32_16x16x32_bf16 v[48:51], v[160:163], v[60:63], v[48:51]
    ds_read_b64_tr_b16 v[146:147], v238 offset:10240
    v_cmp_ne_u32 vcc, 0, v250
    v_mfma_f32_16x16x32_bf16 v[52:55], v[164:167], v[60:63], v[52:55]
    ds_read_b64_tr_b16 v[148:149], v239 offset:8192
    s_cbranch_vccnz Lot_154
Look_155:
    v_mfma_f32_16x16x32_bf16 v[36:39], v[164:167], v[56:59], v[36:39]
    ds_read_b64_tr_b16 v[150:151], v239 offset:10240
    s_waitcnt lgkmcnt(8)
    v_mfma_f32_16x16x32_bf16 v[24:27], v[120:123], v[64:67], v[24:27]
    ds_read_b64_tr_b16 v[152:153], v236 offset:12288
    s_xor_b32 s47, s47, 8192
    v_mfma_f32_16x16x32_bf16 v[40:43], v[120:123], v[68:71], v[40:43]
    ds_read_b64_tr_b16 v[154:155], v236 offset:14336
    buffer_load_dwordx4 v[104:107], v248, s[88:91], s47 offen offset:0 sc1
    v_mfma_f32_16x16x32_bf16 v[44:47], v[124:127], v[68:71], v[44:47]
    ds_read_b64_tr_b16 v[156:157], v237 offset:12288
    v_mfma_f32_16x16x32_bf16 v[28:31], v[124:127], v[64:67], v[28:31]
    ds_read_b64_tr_b16 v[158:159], v237 offset:14336
    buffer_load_dwordx4 v[108:111], v248, s[88:91], s47 offen offset:1024 sc1
    v_mfma_f32_16x16x32_bf16 v[32:35], v[128:131], v[64:67], v[32:35]
    ds_read_b64_tr_b16 v[160:161], v238 offset:12288
    s_waitcnt vmcnt(8)
    v_bitop3_b32 v250, v72, v76, 1 bitop3:0xa8
    v_mfma_f32_16x16x32_bf16 v[48:51], v[128:131], v[68:71], v[48:51]
    ds_read_b64_tr_b16 v[162:163], v238 offset:14336
    v_cmp_ne_u32 vcc, 0, v250
    v_mfma_f32_16x16x32_bf16 v[52:55], v[132:135], v[68:71], v[52:55]
    ds_read_b64_tr_b16 v[164:165], v239 offset:12288
    s_cbranch_vccnz Lot_157
Look_158:
    v_mfma_f32_16x16x32_bf16 v[36:39], v[132:135], v[64:67], v[36:39]
    ds_read_b64_tr_b16 v[166:167], v239 offset:14336
    s_waitcnt lgkmcnt(8)
    v_mfma_f32_16x16x32_bf16 v[24:27], v[136:139], v[72:75], v[24:27]
    ds_read_b64_tr_b16 v[120:121], v236 offset:16384
    v_mfma_f32_16x16x32_bf16 v[40:43], v[136:139], v[76:79], v[40:43]
    ds_read_b64_tr_b16 v[122:123], v236 offset:18432
    buffer_load_dwordx4 v[112:115], v248, s[88:91], s47 offen offset:2048 sc1
    v_mfma_f32_16x16x32_bf16 v[44:47], v[140:143], v[76:79], v[44:47]
    ds_read_b64_tr_b16 v[124:125], v237 offset:16384
    v_mfma_f32_16x16x32_bf16 v[28:31], v[140:143], v[72:75], v[28:31]
    ds_read_b64_tr_b16 v[126:127], v237 offset:18432
    buffer_load_dwordx4 v[116:119], v248, s[88:91], s47 offen offset:3072 sc1
    v_mfma_f32_16x16x32_bf16 v[32:35], v[144:147], v[72:75], v[32:35]
    ds_read_b64_tr_b16 v[128:129], v238 offset:16384
    s_waitcnt vmcnt(8)
    v_bitop3_b32 v250, v80, v84, 1 bitop3:0xa8
    v_mfma_f32_16x16x32_bf16 v[48:51], v[144:147], v[76:79], v[48:51]
    ds_read_b64_tr_b16 v[130:131], v238 offset:18432
    v_cmp_ne_u32 vcc, 0, v250
    v_mfma_f32_16x16x32_bf16 v[52:55], v[148:151], v[76:79], v[52:55]
    ds_read_b64_tr_b16 v[132:133], v239 offset:16384
    s_cbranch_vccnz Lot_160
Look_161:
    v_mfma_f32_16x16x32_bf16 v[36:39], v[148:151], v[72:75], v[36:39]
    ds_read_b64_tr_b16 v[134:135], v239 offset:18432
    s_waitcnt lgkmcnt(8)
    v_mfma_f32_16x16x32_bf16 v[24:27], v[152:155], v[80:83], v[24:27]
    ds_read_b64_tr_b16 v[136:137], v236 offset:20480
    s_xor_b32 s44, s44, 24576
    v_mfma_f32_16x16x32_bf16 v[40:43], v[152:155], v[84:87], v[40:43]
    ds_read_b64_tr_b16 v[138:139], v236 offset:22528
    buffer_load_dwordx4 v[56:59], v248, s[88:91], s44 offen offset:0 sc1
    v_mfma_f32_16x16x32_bf16 v[44:47], v[156:159], v[84:87], v[44:47]
    ds_read_b64_tr_b16 v[140:141], v237 offset:20480
    v_mfma_f32_16x16x32_bf16 v[28:31], v[156:159], v[80:83], v[28:31]
    ds_read_b64_tr_b16 v[142:143], v237 offset:22528
    buffer_load_dwordx4 v[60:63], v248, s[88:91], s44 offen offset:1024 sc1
    v_mfma_f32_16x16x32_bf16 v[32:35], v[160:163], v[80:83], v[32:35]
    ds_read_b64_tr_b16 v[144:145], v238 offset:20480
    s_waitcnt vmcnt(8)
    v_bitop3_b32 v250, v88, v92, 1 bitop3:0xa8
    v_mfma_f32_16x16x32_bf16 v[48:51], v[160:163], v[84:87], v[48:51]
    ds_read_b64_tr_b16 v[146:147], v238 offset:22528
    v_cmp_ne_u32 vcc, 0, v250
    v_mfma_f32_16x16x32_bf16 v[52:55], v[164:167], v[84:87], v[52:55]
    ds_read_b64_tr_b16 v[148:149], v239 offset:20480
    s_cbranch_vccnz Lot_163
Look_164:
    v_mfma_f32_16x16x32_bf16 v[36:39], v[164:167], v[80:83], v[36:39]
    ds_read_b64_tr_b16 v[150:151], v239 offset:22528
    s_waitcnt lgkmcnt(8)
    v_mfma_f32_16x16x32_bf16 v[24:27], v[120:123], v[88:91], v[24:27]
    ds_read_b64_tr_b16 v[152:153], v236 offset:24576
    v_mfma_f32_16x16x32_bf16 v[40:43], v[120:123], v[92:95], v[40:43]
    ds_read_b64_tr_b16 v[154:155], v236 offset:26624
    buffer_load_dwordx4 v[64:67], v248, s[88:91], s44 offen offset:2048 sc1
    v_mfma_f32_16x16x32_bf16 v[44:47], v[124:127], v[92:95], v[44:47]
    ds_read_b64_tr_b16 v[156:157], v237 offset:24576
    v_mfma_f32_16x16x32_bf16 v[28:31], v[124:127], v[88:91], v[28:31]
    ds_read_b64_tr_b16 v[158:159], v237 offset:26624
    buffer_load_dwordx4 v[68:71], v248, s[88:91], s44 offen offset:3072 sc1
    v_mfma_f32_16x16x32_bf16 v[32:35], v[128:131], v[88:91], v[32:35]
    ds_read_b64_tr_b16 v[160:161], v238 offset:24576
    s_waitcnt vmcnt(8)
    v_bitop3_b32 v250, v96, v100, 1 bitop3:0xa8
    v_mfma_f32_16x16x32_bf16 v[48:51], v[128:131], v[92:95], v[48:51]
    ds_read_b64_tr_b16 v[162:163], v238 offset:26624
    v_cmp_ne_u32 vcc, 0, v250
    v_mfma_f32_16x16x32_bf16 v[52:55], v[132:135], v[92:95], v[52:55]
    ds_read_b64_tr_b16 v[164:165], v239 offset:24576
    s_cbranch_vccnz Lot_166
Look_167:
    v_mfma_f32_16x16x32_bf16 v[36:39], v[132:135], v[88:91], v[36:39]
    ds_read_b64_tr_b16 v[166:167], v239 offset:26624
    s_waitcnt lgkmcnt(8)
    v_mfma_f32_16x16x32_bf16 v[24:27], v[136:139], v[96:99], v[24:27]
    ds_read_b64_tr_b16 v[120:121], v236 offset:28672
    s_xor_b32 s45, s45, 24576
    v_mfma_f32_16x16x32_bf16 v[40:43], v[136:139], v[100:103], v[40:43]
    ds_read_b64_tr_b16 v[122:123], v236 offset:30720
    buffer_load_dwordx4 v[72:75], v248, s[88:91], s45 offen offset:0 sc1
    v_mfma_f32_16x16x32_bf16 v[44:47], v[140:143], v[100:103], v[44:47]
    ds_read_b64_tr_b16 v[124:125], v237 offset:28672
    v_mfma_f32_16x16x32_bf16 v[28:31], v[140:143], v[96:99], v[28:31]
    ds_read_b64_tr_b16 v[126:127], v237 offset:30720
    buffer_load_dwordx4 v[76:79], v248, s[88:91], s45 offen offset:1024 sc1
    v_mfma_f32_16x16x32_bf16 v[32:35], v[144:147], v[96:99], v[32:35]
    ds_read_b64_tr_b16 v[128:129], v238 offset:28672
    s_waitcnt vmcnt(8)
    v_bitop3_b32 v250, v104, v108, 1 bitop3:0xa8
    v_mfma_f32_16x16x32_bf16 v[48:51], v[144:147], v[100:103], v[48:51]
    ds_read_b64_tr_b16 v[130:131], v238 offset:30720
    v_cmp_ne_u32 vcc, 0, v250
    v_mfma_f32_16x16x32_bf16 v[52:55], v[148:151], v[100:103], v[52:55]
    ds_read_b64_tr_b16 v[132:133], v239 offset:28672
    s_cbranch_vccnz Lot_169
Look_170:
    v_mfma_f32_16x16x32_bf16 v[36:39], v[148:151], v[96:99], v[36:39]
    ds_read_b64_tr_b16 v[134:135], v239 offset:30720
    s_waitcnt lgkmcnt(8)
    v_mfma_f32_16x16x32_bf16 v[24:27], v[152:155], v[104:107], v[24:27]
    ds_read_b64_tr_b16 v[136:137], v236 offset:32768
    v_mfma_f32_16x16x32_bf16 v[40:43], v[152:155], v[108:111], v[40:43]
    ds_read_b64_tr_b16 v[138:139], v236 offset:34816
    buffer_load_dwordx4 v[80:83], v248, s[88:91], s45 offen offset:2048 sc1
    v_mfma_f32_16x16x32_bf16 v[44:47], v[156:159], v[108:111], v[44:47]
    ds_read_b64_tr_b16 v[140:141], v237 offset:32768
    v_mfma_f32_16x16x32_bf16 v[28:31], v[156:159], v[104:107], v[28:31]
    ds_read_b64_tr_b16 v[142:143], v237 offset:34816
    buffer_load_dwordx4 v[84:87], v248, s[88:91], s45 offen offset:3072 sc1
    v_mfma_f32_16x16x32_bf16 v[32:35], v[160:163], v[104:107], v[32:35]
    ds_read_b64_tr_b16 v[144:145], v238 offset:32768
    s_waitcnt vmcnt(8)
    v_bitop3_b32 v250, v112, v116, 1 bitop3:0xa8
    v_mfma_f32_16x16x32_bf16 v[48:51], v[160:163], v[108:111], v[48:51]
    ds_read_b64_tr_b16 v[146:147], v238 offset:34816
    v_cmp_ne_u32 vcc, 0, v250
    v_mfma_f32_16x16x32_bf16 v[52:55], v[164:167], v[108:111], v[52:55]
    ds_read_b64_tr_b16 v[148:149], v239 offset:32768
    s_cbranch_vccnz Lot_172
Look_173:
    v_mfma_f32_16x16x32_bf16 v[36:39], v[164:167], v[104:107], v[36:39]
    ds_read_b64_tr_b16 v[150:151], v239 offset:34816
    s_waitcnt lgkmcnt(8)
    v_mfma_f32_16x16x32_bf16 v[24:27], v[120:123], v[112:115], v[24:27]
    ds_read_b64_tr_b16 v[152:153], v236 offset:36864
    s_xor_b32 s46, s46, 24576
    v_mfma_f32_16x16x32_bf16 v[40:43], v[120:123], v[116:119], v[40:43]
    ds_read_b64_tr_b16 v[154:155], v236 offset:38912
    buffer_load_dwordx4 v[88:91], v248, s[88:91], s46 offen offset:0 sc1
    v_mfma_f32_16x16x32_bf16 v[44:47], v[124:127], v[116:119], v[44:47]
    ds_read_b64_tr_b16 v[156:157], v237 offset:36864
    v_mfma_f32_16x16x32_bf16 v[28:31], v[124:127], v[112:115], v[28:31]
    ds_read_b64_tr_b16 v[158:159], v237 offset:38912
    buffer_load_dwordx4 v[92:95], v248, s[88:91], s46 offen offset:1024 sc1
    v_mfma_f32_16x16x32_bf16 v[32:35], v[128:131], v[112:115], v[32:35]
    ds_read_b64_tr_b16 v[160:161], v238 offset:36864
    s_waitcnt vmcnt(8)
    v_bitop3_b32 v250, v56, v60, 1 bitop3:0xa8
    v_mfma_f32_16x16x32_bf16 v[48:51], v[128:131], v[116:119], v[48:51]
    ds_read_b64_tr_b16 v[162:163], v238 offset:38912
    v_cmp_ne_u32 vcc, 0, v250
    v_mfma_f32_16x16x32_bf16 v[52:55], v[132:135], v[116:119], v[52:55]
    ds_read_b64_tr_b16 v[164:165], v239 offset:36864
    s_cbranch_vccnz Lot_175
Look_176:
    v_mfma_f32_16x16x32_bf16 v[36:39], v[132:135], v[112:115], v[36:39]
    ds_read_b64_tr_b16 v[166:167], v239 offset:38912
    s_waitcnt lgkmcnt(8)
    v_mfma_f32_16x16x32_bf16 v[24:27], v[136:139], v[56:59], v[24:27]
    ds_read_b64_tr_b16 v[120:121], v236 offset:40960
    v_mfma_f32_16x16x32_bf16 v[40:43], v[136:139], v[60:63], v[40:43]
    ds_read_b64_tr_b16 v[122:123], v236 offset:43008
    buffer_load_dwordx4 v[96:99], v248, s[88:91], s46 offen offset:2048 sc1
    v_mfma_f32_16x16x32_bf16 v[44:47], v[140:143], v[60:63], v[44:47]
    ds_read_b64_tr_b16 v[124:125], v237 offset:40960
    v_mfma_f32_16x16x32_bf16 v[28:31], v[140:143], v[56:59], v[28:31]
    ds_read_b64_tr_b16 v[126:127], v237 offset:43008
    buffer_load_dwordx4 v[100:103], v248, s[88:91], s46 offen offset:3072 sc1
    v_mfma_f32_16x16x32_bf16 v[32:35], v[144:147], v[56:59], v[32:35]
    ds_read_b64_tr_b16 v[128:129], v238 offset:40960
    s_waitcnt vmcnt(8)
    v_bitop3_b32 v250, v64, v68, 1 bitop3:0xa8
    v_mfma_f32_16x16x32_bf16 v[48:51], v[144:147], v[60:63], v[48:51]
    ds_read_b64_tr_b16 v[130:131], v238 offset:43008
    v_cmp_ne_u32 vcc, 0, v250
    v_mfma_f32_16x16x32_bf16 v[52:55], v[148:151], v[60:63], v[52:55]
    ds_read_b64_tr_b16 v[132:133], v239 offset:40960
    s_cbranch_vccnz Lot_178
Look_179:
    v_mfma_f32_16x16x32_bf16 v[36:39], v[148:151], v[56:59], v[36:39]
    ds_read_b64_tr_b16 v[134:135], v239 offset:43008
    s_waitcnt lgkmcnt(8)
    v_mfma_f32_16x16x32_bf16 v[24:27], v[152:155], v[64:67], v[24:27]
    ds_read_b64_tr_b16 v[136:137], v236 offset:45056
    s_xor_b32 s47, s47, 24576
    v_mfma_f32_16x16x32_bf16 v[40:43], v[152:155], v[68:71], v[40:43]
    ds_read_b64_tr_b16 v[138:139], v236 offset:47104
    buffer_load_dwordx4 v[104:107], v248, s[88:91], s47 offen offset:0 sc1
    v_mfma_f32_16x16x32_bf16 v[44:47], v[156:159], v[68:71], v[44:47]
    ds_read_b64_tr_b16 v[140:141], v237 offset:45056
    v_mfma_f32_16x16x32_bf16 v[28:31], v[156:159], v[64:67], v[28:31]
    ds_read_b64_tr_b16 v[142:143], v237 offset:47104
    buffer_load_dwordx4 v[108:111], v248, s[88:91], s47 offen offset:1024 sc1
    v_mfma_f32_16x16x32_bf16 v[32:35], v[160:163], v[64:67], v[32:35]
    ds_read_b64_tr_b16 v[144:145], v238 offset:45056
    s_waitcnt vmcnt(8)
    v_bitop3_b32 v250, v72, v76, 1 bitop3:0xa8
    v_mfma_f32_16x16x32_bf16 v[48:51], v[160:163], v[68:71], v[48:51]
    ds_read_b64_tr_b16 v[146:147], v238 offset:47104
    v_cmp_ne_u32 vcc, 0, v250
    v_mfma_f32_16x16x32_bf16 v[52:55], v[164:167], v[68:71], v[52:55]
    ds_read_b64_tr_b16 v[148:149], v239 offset:45056
    s_cbranch_vccnz Lot_181
Look_182:
    v_mfma_f32_16x16x32_bf16 v[36:39], v[164:167], v[64:67], v[36:39]
    ds_read_b64_tr_b16 v[150:151], v239 offset:47104
    s_waitcnt lgkmcnt(8)
    v_mfma_f32_16x16x32_bf16 v[24:27], v[120:123], v[72:75], v[24:27]
    ds_read_b64_tr_b16 v[152:153], v236 offset:49152
    v_mfma_f32_16x16x32_bf16 v[40:43], v[120:123], v[76:79], v[40:43]
    ds_read_b64_tr_b16 v[154:155], v236 offset:51200
    buffer_load_dwordx4 v[112:115], v248, s[88:91], s47 offen offset:2048 sc1
    v_mfma_f32_16x16x32_bf16 v[44:47], v[124:127], v[76:79], v[44:47]
    ds_read_b64_tr_b16 v[156:157], v237 offset:49152
    v_mfma_f32_16x16x32_bf16 v[28:31], v[124:127], v[72:75], v[28:31]
    ds_read_b64_tr_b16 v[158:159], v237 offset:51200
    buffer_load_dwordx4 v[116:119], v248, s[88:91], s47 offen offset:3072 sc1
    v_mfma_f32_16x16x32_bf16 v[32:35], v[128:131], v[72:75], v[32:35]
    ds_read_b64_tr_b16 v[160:161], v238 offset:49152
    s_waitcnt vmcnt(8)
    v_bitop3_b32 v250, v80, v84, 1 bitop3:0xa8
    v_mfma_f32_16x16x32_bf16 v[48:51], v[128:131], v[76:79], v[48:51]
    ds_read_b64_tr_b16 v[162:163], v238 offset:51200
    v_cmp_ne_u32 vcc, 0, v250
    v_mfma_f32_16x16x32_bf16 v[52:55], v[132:135], v[76:79], v[52:55]
    ds_read_b64_tr_b16 v[164:165], v239 offset:49152
    s_cbranch_vccnz Lot_184
Look_185:
    v_mfma_f32_16x16x32_bf16 v[36:39], v[132:135], v[72:75], v[36:39]
    ds_read_b64_tr_b16 v[166:167], v239 offset:51200
    s_waitcnt lgkmcnt(8)
    v_mfma_f32_16x16x32_bf16 v[24:27], v[136:139], v[80:83], v[24:27]
    ds_read_b64_tr_b16 v[120:121], v236 offset:53248
    s_xor_b32 s44, s44, 8192
    v_mfma_f32_16x16x32_bf16 v[40:43], v[136:139], v[84:87], v[40:43]
    ds_read_b64_tr_b16 v[122:123], v236 offset:55296
    buffer_load_dwordx4 v[56:59], v248, s[88:91], s44 offen offset:0 sc1
    v_mfma_f32_16x16x32_bf16 v[44:47], v[140:143], v[84:87], v[44:47]
    ds_read_b64_tr_b16 v[124:125], v237 offset:53248
    v_mfma_f32_16x16x32_bf16 v[28:31], v[140:143], v[80:83], v[28:31]
    ds_read_b64_tr_b16 v[126:127], v237 offset:55296
    buffer_load_dwordx4 v[60:63], v248, s[88:91], s44 offen offset:1024 sc1
    v_mfma_f32_16x16x32_bf16 v[32:35], v[144:147], v[80:83], v[32:35]
    ds_read_b64_tr_b16 v[128:129], v238 offset:53248
    s_waitcnt vmcnt(8)
    v_bitop3_b32 v250, v88, v92, 1 bitop3:0xa8
    v_mfma_f32_16x16x32_bf16 v[48:51], v[144:147], v[84:87], v[48:51]
    ds_read_b64_tr_b16 v[130:131], v238 offset:55296
    v_cmp_ne_u32 vcc, 0, v250
    v_mfma_f32_16x16x32_bf16 v[52:55], v[148:151], v[84:87], v[52:55]
    ds_read_b64_tr_b16 v[132:133], v239 offset:53248
    s_cbranch_vccnz Lot_187
Look_188:
    v_mfma_f32_16x16x32_bf16 v[36:39], v[148:151], v[80:83], v[36:39]
    ds_read_b64_tr_b16 v[134:135], v239 offset:55296
    s_waitcnt lgkmcnt(8)
    v_mfma_f32_16x16x32_bf16 v[24:27], v[152:155], v[88:91], v[24:27]
    ds_read_b64_tr_b16 v[136:137], v236 offset:57344
    v_mfma_f32_16x16x32_bf16 v[40:43], v[152:155], v[92:95], v[40:43]
    ds_read_b64_tr_b16 v[138:139], v236 offset:59392
    buffer_load_dwordx4 v[64:67], v248, s[88:91], s44 offen offset:2048 sc1
    v_mfma_f32_16x16x32_bf16 v[44:47], v[156:159], v[92:95], v[44:47]
    ds_read_b64_tr_b16 v[140:141], v237 offset:57344
    v_mfma_f32_16x16x32_bf16 v[28:31], v[156:159], v[88:91], v[28:31]
    ds_read_b64_tr_b16 v[142:143], v237 offset:59392
    buffer_load_dwordx4 v[68:71], v248, s[88:91], s44 offen offset:3072 sc1
    v_mfma_f32_16x16x32_bf16 v[32:35], v[160:163], v[88:91], v[32:35]
    ds_read_b64_tr_b16 v[144:145], v238 offset:57344
    s_waitcnt vmcnt(8)
    v_bitop3_b32 v250, v96, v100, 1 bitop3:0xa8
    v_mfma_f32_16x16x32_bf16 v[48:51], v[160:163], v[92:95], v[48:51]
    ds_read_b64_tr_b16 v[146:147], v238 offset:59392
    v_cmp_ne_u32 vcc, 0, v250
    v_mfma_f32_16x16x32_bf16 v[52:55], v[164:167], v[92:95], v[52:55]
    ds_read_b64_tr_b16 v[148:149], v239 offset:57344
    s_cbranch_vccnz Lot_190
Look_191:
    v_mfma_f32_16x16x32_bf16 v[36:39], v[164:167], v[88:91], v[36:39]
    ds_read_b64_tr_b16 v[150:151], v239 offset:59392
    s_waitcnt lgkmcnt(8)
    v_mfma_f32_16x16x32_bf16 v[24:27], v[120:123], v[96:99], v[24:27]
    ds_read_b64_tr_b16 v[152:153], v236 offset:61440
    s_xor_b32 s45, s45, 8192
    v_mfma_f32_16x16x32_bf16 v[40:43], v[120:123], v[100:103], v[40:43]
    ds_read_b64_tr_b16 v[154:155], v236 offset:63488
    buffer_load_dwordx4 v[72:75], v248, s[88:91], s45 offen offset:0 sc1
    v_mfma_f32_16x16x32_bf16 v[44:47], v[124:127], v[100:103], v[44:47]
    ds_read_b64_tr_b16 v[156:157], v237 offset:61440
    v_mfma_f32_16x16x32_bf16 v[28:31], v[124:127], v[96:99], v[28:31]
    ds_read_b64_tr_b16 v[158:159], v237 offset:63488
    buffer_load_dwordx4 v[76:79], v248, s[88:91], s45 offen offset:1024 sc1
    v_mfma_f32_16x16x32_bf16 v[32:35], v[128:131], v[96:99], v[32:35]
    ds_read_b64_tr_b16 v[160:161], v238 offset:61440
    s_waitcnt vmcnt(8)
    v_bitop3_b32 v250, v104, v108, 1 bitop3:0xa8
    v_mfma_f32_16x16x32_bf16 v[48:51], v[128:131], v[100:103], v[48:51]
    ds_read_b64_tr_b16 v[162:163], v238 offset:63488
    v_cmp_ne_u32 vcc, 0, v250
    v_mfma_f32_16x16x32_bf16 v[52:55], v[132:135], v[100:103], v[52:55]
    ds_read_b64_tr_b16 v[164:165], v239 offset:61440
    s_cbranch_vccnz Lot_193
Look_194:
    v_mfma_f32_16x16x32_bf16 v[36:39], v[132:135], v[96:99], v[36:39]
    ds_read_b64_tr_b16 v[166:167], v239 offset:63488
    s_waitcnt lgkmcnt(8)
    v_mfma_f32_16x16x32_bf16 v[24:27], v[136:139], v[104:107], v[24:27]
    ds_read_b64_tr_b16 v[120:121], v240 offset:0
    v_mfma_f32_16x16x32_bf16 v[40:43], v[136:139], v[108:111], v[40:43]
    ds_read_b64_tr_b16 v[122:123], v240 offset:2048
    buffer_load_dwordx4 v[80:83], v248, s[88:91], s45 offen offset:2048 sc1
    v_mfma_f32_16x16x32_bf16 v[44:47], v[140:143], v[108:111], v[44:47]
    ds_read_b64_tr_b16 v[124:125], v241 offset:0
    v_mfma_f32_16x16x32_bf16 v[28:31], v[140:143], v[104:107], v[28:31]
    ds_read_b64_tr_b16 v[126:127], v241 offset:2048
    buffer_load_dwordx4 v[84:87], v248, s[88:91], s45 offen offset:3072 sc1
    v_mfma_f32_16x16x32_bf16 v[32:35], v[144:147], v[104:107], v[32:35]
    ds_read_b64_tr_b16 v[128:129], v242 offset:0
    s_waitcnt vmcnt(8)
    v_bitop3_b32 v250, v112, v116, 1 bitop3:0xa8
    v_mfma_f32_16x16x32_bf16 v[48:51], v[144:147], v[108:111], v[48:51]
    ds_read_b64_tr_b16 v[130:131], v242 offset:2048
    v_cmp_ne_u32 vcc, 0, v250
    v_mfma_f32_16x16x32_bf16 v[52:55], v[148:151], v[108:111], v[52:55]
    ds_read_b64_tr_b16 v[132:133], v243 offset:0
    s_cbranch_vccnz Lot_196
Look_197:
    v_mfma_f32_16x16x32_bf16 v[36:39], v[148:151], v[104:107], v[36:39]
    ds_read_b64_tr_b16 v[134:135], v243 offset:2048
    s_waitcnt lgkmcnt(8)
    v_mfma_f32_16x16x32_bf16 v[24:27], v[152:155], v[112:115], v[24:27]
    ds_read_b64_tr_b16 v[136:137], v240 offset:4096
    s_xor_b32 s46, s46, 8192
    v_mfma_f32_16x16x32_bf16 v[40:43], v[152:155], v[116:119], v[40:43]
    ds_read_b64_tr_b16 v[138:139], v240 offset:6144
    buffer_load_dwordx4 v[88:91], v248, s[88:91], s46 offen offset:0 sc1
    v_mfma_f32_16x16x32_bf16 v[44:47], v[156:159], v[116:119], v[44:47]
    ds_read_b64_tr_b16 v[140:141], v241 offset:4096
    v_mfma_f32_16x16x32_bf16 v[28:31], v[156:159], v[112:115], v[28:31]
    ds_read_b64_tr_b16 v[142:143], v241 offset:6144
    buffer_load_dwordx4 v[92:95], v248, s[88:91], s46 offen offset:1024 sc1
    v_mfma_f32_16x16x32_bf16 v[32:35], v[160:163], v[112:115], v[32:35]
    ds_read_b64_tr_b16 v[144:145], v242 offset:4096
    s_waitcnt vmcnt(8)
    v_bitop3_b32 v250, v56, v60, 1 bitop3:0xa8
    v_mfma_f32_16x16x32_bf16 v[48:51], v[160:163], v[116:119], v[48:51]
    ds_read_b64_tr_b16 v[146:147], v242 offset:6144
    v_cmp_ne_u32 vcc, 0, v250
    v_mfma_f32_16x16x32_bf16 v[52:55], v[164:167], v[116:119], v[52:55]
    ds_read_b64_tr_b16 v[148:149], v243 offset:4096
    s_cbranch_vccnz Lot_199
Look_200:
    v_mfma_f32_16x16x32_bf16 v[36:39], v[164:167], v[112:115], v[36:39]
    ds_read_b64_tr_b16 v[150:151], v243 offset:6144
    s_waitcnt lgkmcnt(8)
    v_mfma_f32_16x16x32_bf16 v[24:27], v[120:123], v[56:59], v[24:27]
    ds_read_b64_tr_b16 v[152:153], v240 offset:8192
    v_mfma_f32_16x16x32_bf16 v[40:43], v[120:123], v[60:63], v[40:43]
    ds_read_b64_tr_b16 v[154:155], v240 offset:10240
    buffer_load_dwordx4 v[96:99], v248, s[88:91], s46 offen offset:2048 sc1
    v_mfma_f32_16x16x32_bf16 v[44:47], v[124:127], v[60:63], v[44:47]
    ds_read_b64_tr_b16 v[156:157], v241 offset:8192
    v_mfma_f32_16x16x32_bf16 v[28:31], v[124:127], v[56:59], v[28:31]
    ds_read_b64_tr_b16 v[158:159], v241 offset:10240
    buffer_load_dwordx4 v[100:103], v248, s[88:91], s46 offen offset:3072 sc1
    v_mfma_f32_16x16x32_bf16 v[32:35], v[128:131], v[56:59], v[32:35]
    ds_read_b64_tr_b16 v[160:161], v242 offset:8192
    s_waitcnt vmcnt(8)
    v_bitop3_b32 v250, v64, v68, 1 bitop3:0xa8
    v_mfma_f32_16x16x32_bf16 v[48:51], v[128:131], v[60:63], v[48:51]
    ds_read_b64_tr_b16 v[162:163], v242 offset:10240
    v_cmp_ne_u32 vcc, 0, v250
    v_mfma_f32_16x16x32_bf16 v[52:55], v[132:135], v[60:63], v[52:55]
    ds_read_b64_tr_b16 v[164:165], v243 offset:8192
    s_cbranch_vccnz Lot_202
Look_203:
    v_mfma_f32_16x16x32_bf16 v[36:39], v[132:135], v[56:59], v[36:39]
    ds_read_b64_tr_b16 v[166:167], v243 offset:10240
    s_waitcnt lgkmcnt(8)
    v_mfma_f32_16x16x32_bf16 v[24:27], v[136:139], v[64:67], v[24:27]
    ds_read_b64_tr_b16 v[120:121], v240 offset:12288
    s_xor_b32 s47, s47, 8192
    v_mfma_f32_16x16x32_bf16 v[40:43], v[136:139], v[68:71], v[40:43]
    ds_read_b64_tr_b16 v[122:123], v240 offset:14336
    buffer_load_dwordx4 v[104:107], v248, s[88:91], s47 offen offset:0 sc1
    v_mfma_f32_16x16x32_bf16 v[44:47], v[140:143], v[68:71], v[44:47]
    ds_read_b64_tr_b16 v[124:125], v241 offset:12288
    s_barrier
    v_mfma_f32_16x16x32_bf16 v[28:31], v[140:143], v[64:67], v[28:31]
    ds_read_b64_tr_b16 v[126:127], v241 offset:14336
    buffer_load_dwordx4 v[108:111], v248, s[88:91], s47 offen offset:1024 sc1
    v_mfma_f32_16x16x32_bf16 v[32:35], v[144:147], v[64:67], v[32:35]
    ds_read_b64_tr_b16 v[128:129], v242 offset:12288
    s_waitcnt vmcnt(8)
    v_bitop3_b32 v250, v72, v76, 1 bitop3:0xa8
    v_mfma_f32_16x16x32_bf16 v[48:51], v[144:147], v[68:71], v[48:51]
    ds_read_b64_tr_b16 v[130:131], v242 offset:14336
    v_cmp_ne_u32 vcc, 0, v250
    v_mfma_f32_16x16x32_bf16 v[52:55], v[148:151], v[68:71], v[52:55]
    ds_read_b64_tr_b16 v[132:133], v243 offset:12288
    s_cbranch_vccnz Lot_205
Look_206:
    v_mfma_f32_16x16x32_bf16 v[36:39], v[148:151], v[64:67], v[36:39]
    ds_read_b64_tr_b16 v[134:135], v243 offset:14336
    s_waitcnt lgkmcnt(8)
    v_mfma_f32_16x16x32_bf16 v[24:27], v[152:155], v[72:75], v[24:27]
    ds_read_b64_tr_b16 v[136:137], v240 offset:16384
    v_mfma_f32_16x16x32_bf16 v[40:43], v[152:155], v[76:79], v[40:43]
    ds_read_b64_tr_b16 v[138:139], v240 offset:18432
    buffer_load_dwordx4 v[112:115], v248, s[88:91], s47 offen offset:2048 sc1
    v_mfma_f32_16x16x32_bf16 v[44:47], v[156:159], v[76:79], v[44:47]
    ds_read_b64_tr_b16 v[140:141], v241 offset:16384
    v_mfma_f32_16x16x32_bf16 v[28:31], v[156:159], v[72:75], v[28:31]
    ds_read_b64_tr_b16 v[142:143], v241 offset:18432
    buffer_load_dwordx4 v[116:119], v248, s[88:91], s47 offen offset:3072 sc1
    v_mfma_f32_16x16x32_bf16 v[32:35], v[160:163], v[72:75], v[32:35]
    ds_read_b64_tr_b16 v[144:145], v242 offset:16384
    s_waitcnt vmcnt(8)
    v_bitop3_b32 v250, v80, v84, 1 bitop3:0xa8
    v_mfma_f32_16x16x32_bf16 v[48:51], v[160:163], v[76:79], v[48:51]
    ds_read_b64_tr_b16 v[146:147], v242 offset:18432
    v_cmp_ne_u32 vcc, 0, v250
    v_mfma_f32_16x16x32_bf16 v[52:55], v[164:167], v[76:79], v[52:55]
    ds_read_b64_tr_b16 v[148:149], v243 offset:16384
    s_cbranch_vccnz Lot_208
Look_209:
    v_mfma_f32_16x16x32_bf16 v[36:39], v[164:167], v[72:75], v[36:39]
    ds_read_b64_tr_b16 v[150:151], v243 offset:18432
    s_waitcnt lgkmcnt(8)
    v_mfma_f32_16x16x32_bf16 v[24:27], v[120:123], v[80:83], v[24:27]
    ds_read_b64_tr_b16 v[152:153], v240 offset:20480
    v_mfma_f32_16x16x32_bf16 v[40:43], v[120:123], v[84:87], v[40:43]
    ds_read_b64_tr_b16 v[154:155], v240 offset:22528
    v_mfma_f32_16x16x32_bf16 v[44:47], v[124:127], v[84:87], v[44:47]
    ds_read_b64_tr_b16 v[156:157], v241 offset:20480
    v_mfma_f32_16x16x32_bf16 v[28:31], v[124:127], v[80:83], v[28:31]
    ds_read_b64_tr_b16 v[158:159], v241 offset:22528
    v_mfma_f32_16x16x32_bf16 v[32:35], v[128:131], v[80:83], v[32:35]
    ds_read_b64_tr_b16 v[160:161], v242 offset:20480
    s_waitcnt vmcnt(6)
    v_bitop3_b32 v250, v88, v92, 1 bitop3:0xa8
    v_mfma_f32_16x16x32_bf16 v[48:51], v[128:131], v[84:87], v[48:51]
    ds_read_b64_tr_b16 v[162:163], v242 offset:22528
    v_cmp_ne_u32 vcc, 0, v250
    v_mfma_f32_16x16x32_bf16 v[52:55], v[132:135], v[84:87], v[52:55]
    ds_read_b64_tr_b16 v[164:165], v243 offset:20480
    s_cbranch_vccnz Lot_211
Look_212:
    v_mfma_f32_16x16x32_bf16 v[36:39], v[132:135], v[80:83], v[36:39]
    ds_read_b64_tr_b16 v[166:167], v243 offset:22528
    s_waitcnt lgkmcnt(8)
    v_mfma_f32_16x16x32_bf16 v[24:27], v[136:139], v[88:91], v[24:27]
    ds_read_b64_tr_b16 v[120:121], v240 offset:24576
    v_mfma_f32_16x16x32_bf16 v[40:43], v[136:139], v[92:95], v[40:43]
    ds_read_b64_tr_b16 v[122:123], v240 offset:26624
    v_mfma_f32_16x16x32_bf16 v[44:47], v[140:143], v[92:95], v[44:47]
    ds_read_b64_tr_b16 v[124:125], v241 offset:24576
    v_mfma_f32_16x16x32_bf16 v[28:31], v[140:143], v[88:91], v[28:31]
    ds_read_b64_tr_b16 v[126:127], v241 offset:26624
    v_mfma_f32_16x16x32_bf16 v[32:35], v[144:147], v[88:91], v[32:35]
    ds_read_b64_tr_b16 v[128:129], v242 offset:24576
    s_waitcnt vmcnt(4)
    v_bitop3_b32 v250, v96, v100, 1 bitop3:0xa8
    v_mfma_f32_16x16x32_bf16 v[48:51], v[144:147], v[92:95], v[48:51]
    ds_read_b64_tr_b16 v[130:131], v242 offset:26624
    v_cmp_ne_u32 vcc, 0, v250
    v_mfma_f32_16x16x32_bf16 v[52:55], v[148:151], v[92:95], v[52:55]
    ds_read_b64_tr_b16 v[132:133], v243 offset:24576
    s_cbranch_vccnz Lot_214
Look_215:
    v_mfma_f32_16x16x32_bf16 v[36:39], v[148:151], v[88:91], v[36:39]
    ds_read_b64_tr_b16 v[134:135], v243 offset:26624
    s_waitcnt lgkmcnt(8)
    v_mfma_f32_16x16x32_bf16 v[24:27], v[152:155], v[96:99], v[24:27]
    ds_read_b64_tr_b16 v[136:137], v240 offset:28672
    v_mfma_f32_16x16x32_bf16 v[40:43], v[152:155], v[100:103], v[40:43]
    ds_read_b64_tr_b16 v[138:139], v240 offset:30720
    v_mfma_f32_16x16x32_bf16 v[44:47], v[156:159], v[100:103], v[44:47]
    ds_read_b64_tr_b16 v[140:141], v241 offset:28672
    v_mfma_f32_16x16x32_bf16 v[28:31], v[156:159], v[96:99], v[28:31]
    ds_read_b64_tr_b16 v[142:143], v241 offset:30720
    v_mfma_f32_16x16x32_bf16 v[32:35], v[160:163], v[96:99], v[32:35]
    ds_read_b64_tr_b16 v[144:145], v242 offset:28672
    s_waitcnt vmcnt(2)
    v_bitop3_b32 v250, v104, v108, 1 bitop3:0xa8
    v_mfma_f32_16x16x32_bf16 v[48:51], v[160:163], v[100:103], v[48:51]
    ds_read_b64_tr_b16 v[146:147], v242 offset:30720
    v_cmp_ne_u32 vcc, 0, v250
    v_mfma_f32_16x16x32_bf16 v[52:55], v[164:167], v[100:103], v[52:55]
    ds_read_b64_tr_b16 v[148:149], v243 offset:28672
    s_cbranch_vccnz Lot_217
Look_218:
    v_mfma_f32_16x16x32_bf16 v[36:39], v[164:167], v[96:99], v[36:39]
    ds_read_b64_tr_b16 v[150:151], v243 offset:30720
    s_waitcnt lgkmcnt(8)
    v_mfma_f32_16x16x32_bf16 v[24:27], v[120:123], v[104:107], v[24:27]
    v_mfma_f32_16x16x32_bf16 v[40:43], v[120:123], v[108:111], v[40:43]
    v_mfma_f32_16x16x32_bf16 v[44:47], v[124:127], v[108:111], v[44:47]
    v_mfma_f32_16x16x32_bf16 v[28:31], v[124:127], v[104:107], v[28:31]
    v_mfma_f32_16x16x32_bf16 v[32:35], v[128:131], v[104:107], v[32:35]
    s_waitcnt vmcnt(0)
    v_bitop3_b32 v250, v112, v116, 1 bitop3:0xa8
    v_mfma_f32_16x16x32_bf16 v[48:51], v[128:131], v[108:111], v[48:51]
    v_cmp_ne_u32 vcc, 0, v250
    v_mfma_f32_16x16x32_bf16 v[52:55], v[132:135], v[108:111], v[52:55]
    s_cbranch_vccnz Lot_220
Look_221:
    v_mfma_f32_16x16x32_bf16 v[36:39], v[132:135], v[104:107], v[36:39]
    s_waitcnt lgkmcnt(0)
    v_mfma_f32_16x16x32_bf16 v[24:27], v[136:139], v[112:115], v[24:27]
    v_mfma_f32_16x16x32_bf16 v[28:31], v[140:143], v[112:115], v[28:31]
    v_mfma_f32_16x16x32_bf16 v[32:35], v[144:147], v[112:115], v[32:35]
    v_mfma_f32_16x16x32_bf16 v[36:39], v[148:151], v[112:115], v[36:39]
    v_mfma_f32_16x16x32_bf16 v[40:43], v[136:139], v[116:119], v[40:43]
    v_mfma_f32_16x16x32_bf16 v[44:47], v[140:143], v[116:119], v[44:47]
    v_mfma_f32_16x16x32_bf16 v[48:51], v[144:147], v[116:119], v[48:51]
    v_mfma_f32_16x16x32_bf16 v[52:55], v[148:151], v[116:119], v[52:55]
    s_cmp_eq_u32 s22, 4
    s_cbranch_scc1 L_final
    s_cmp_eq_u32 s23, 0
    s_cbranch_scc1 Lwt_222
    v_and_b32 v24, 0xffff0000, v24
    v_cvt_pk_bf16_f32 v9, v26, v27
    v_cvt_pk_bf16_f32 v8, v24, v25
    v_cvt_pk_bf16_f32 v10, v28, v29
    v_cvt_pk_bf16_f32 v11, v30, v31
    v_or_b32 v8, 1, v8
    buffer_store_dwordx4 v[8:11], v0, s[16:19], s0 offen offset:0
    ds_write_b128 v249, v[8:11] offset:0
    v_and_b32 v32, 0xffff0000, v32
    v_cvt_pk_bf16_f32 v13, v34, v35
    v_cvt_pk_bf16_f32 v12, v32, v33
    v_cvt_pk_bf16_f32 v14, v36, v37
    v_cvt_pk_bf16_f32 v15, v38, v39
    v_or_b32 v12, 1, v12
    buffer_store_dwordx4 v[12:15], v0, s[16:19], s0 offen offset:1024
    ds_write_b128 v249, v[12:15] offset:1024
    v_and_b32 v40, 0xffff0000, v40
    v_cvt_pk_bf16_f32 v17, v42, v43
    v_cvt_pk_bf16_f32 v16, v40, v41
    v_cvt_pk_bf16_f32 v18, v44, v45
    v_cvt_pk_bf16_f32 v19, v46, v47
    v_or_b32 v16, 1, v16
    buffer_store_dwordx4 v[16:19], v0, s[16:19], s0 offen offset:2048
    ds_write_b128 v249, v[16:19] offset:2048
    v_and_b32 v48, 0xffff0000, v48
    v_cvt_pk_bf16_f32 v21, v50, v51
    v_cvt_pk_bf16_f32 v20, v48, v49
    v_cvt_pk_bf16_f32 v22, v52, v53
    v_cvt_pk_bf16_f32 v23, v54, v55
    v_or_b32 v20, 1, v20
    buffer_store_dwordx4 v[20:23], v0, s[16:19], s0 offen offset:3072
    ds_write_b128 v249, v[20:23] offset:3072
Lwt_223:
    s_branch L_centry
L_ofix:
    s_waitcnt vmcnt(0)
    v_bitop3_b32 v250, v56, v60, 1 bitop3:0xa8
    v_cmp_ne_u32 vcc, 0, v250
    s_nop 0
    s_cbranch_vccz Lfx_224
    buffer_load_dwordx4 v[56:59], v248, s[88:91], s44 offen offset:0 sc1
    buffer_load_dwordx4 v[60:63], v248, s[88:91], s44 offen offset:1024 sc1
Lfx_224:
    v_bitop3_b32 v250, v64, v68, 1 bitop3:0xa8
    v_cmp_ne_u32 vcc, 0, v250
    s_nop 0
    s_cbranch_vccz Lfx_225
    buffer_load_dwordx4 v[64:67], v248, s[88:91], s44 offen offset:2048 sc1
    buffer_load_dwordx4 v[68:71], v248, s[88:91], s44 offen offset:3072 sc1
Lfx_225:
    v_bitop3_b32 v250, v72, v76, 1 bitop3:0xa8
    v_cmp_ne_u32 vcc, 0, v250
    s_nop 0
    s_cbranch_vccz Lfx_226
    buffer_load_dwordx4 v[72:75], v248, s[88:91], s45 offen offset:0 sc1
    buffer_load_dwordx4 v[76:79], v248, s[88:91], s45 offen offset:1024 sc1
Lfx_226:
    v_bitop3_b32 v250, v80, v84, 1 bitop3:0xa8
    v_cmp_ne_u32 vcc, 0, v250
    s_nop 0
    s_cbranch_vccz Lfx_227
    buffer_load_dwordx4 v[80:83], v248, s[88:91], s45 offen offset:2048 sc1
    buffer_load_dwordx4 v[84:87], v248, s[88:91], s45 offen offset:3072 sc1
Lfx_227:
    v_bitop3_b32 v250, v88, v92, 1 bitop3:0xa8
    v_cmp_ne_u32 vcc, 0, v250
    s_nop 0
    s_cbranch_vccz Lfx_228
    buffer_load_dwordx4 v[88:91], v248, s[88:91], s46 offen offset:0 sc1
    buffer_load_dwordx4 v[92:95], v248, s[88:91], s46 offen offset:1024 sc1
Lfx_228:
    v_bitop3_b32 v250, v96, v100, 1 bitop3:0xa8
    v_cmp_ne_u32 vcc, 0, v250
    s_nop 0
    s_cbranch_vccz Lfx_229
    buffer_load_dwordx4 v[96:99], v248, s[88:91], s46 offen offset:2048 sc1
    buffer_load_dwordx4 v[100:103], v248, s[88:91], s46 offen offset:3072 sc1
Lfx_229:
    v_bitop3_b32 v250, v104, v108, 1 bitop3:0xa8
    v_cmp_ne_u32 vcc, 0, v250
    s_nop 0
    s_cbranch_vccz Lfx_230
    buffer_load_dwordx4 v[104:107], v248, s[88:91], s47 offen offset:0 sc1
    buffer_load_dwordx4 v[108:111], v248, s[88:91], s47 offen offset:1024 sc1
Lfx_230:
    v_bitop3_b32 v250, v112, v116, 1 bitop3:0xa8
    v_cmp_ne_u32 vcc, 0, v250
    s_nop 0
    s_cbranch_vccz Lfx_231
    buffer_load_dwordx4 v[112:115], v248, s[88:91], s47 offen offset:2048 sc1
    buffer_load_dwordx4 v[116:119], v248, s[88:91], s47 offen offset:3072 sc1
Lfx_231:
    s_waitcnt vmcnt(0)
    s_add_u32 s96, s96, 1
    s_cmp_lt_u32 s96, 262144
    s_setpc_b64 s[72:73]
L_exact:
    s_lshl_b32 s29, s20, 2
    s_add_u32 s29, s29, s71
    s_lshl_b32 s27, s21, 15
    s_and_b32 s28, s54, 4096
    s_add_u32 s27, s27, s28
    s_add_u32 s27, s27, 2621440
    v_add_u32 v128, s27, v0
    v_and_b32 v134, 15, v1
    v_lshrrev_b32 v135, 4, v1
    v_lshlrev_b32 v135, 2, v135
    v_sub_u32 v134, v134, v135
    v_mov_b32 v129, 4048155338
    s_min_u32 s31, s29, 8
    v_mov_b32 v132, 4048155338
    v_mov_b32 v133, 4048155338
    v_mov_b32 v104, 0
    v_mov_b32 v105, 0
    v_mov_b32 v106, 0
    v_mov_b32 v107, 0
    v_mov_b32 v108, 0
    v_mov_b32 v109, 0
    v_mov_b32 v110, 0
    v_mov_b32 v111, 0
    v_mov_b32 v112, 0
    v_mov_b32 v113, 0
    v_mov_b32 v114, 0
    v_mov_b32 v115, 0
    v_mov_b32 v116, 0
    v_mov_b32 v117, 0
    v_mov_b32 v118, 0
    v_mov_b32 v119, 0
    v_mov_b32 v120, 0
    v_mov_b32 v121, 0
    v_mov_b32 v122, 0
    v_mov_b32 v123, 0
    v_mov_b32 v124, 0
    v_mov_b32 v125, 0
    v_mov_b32 v126, 0
    v_mov_b32 v127, 0
    s_mov_b32 s30, 0
L_ex0:
    s_sub_u32 s27, s29, s30
    s_lshr_b32 s28, s27, 2
    s_lshl_b32 s28, s28, 20
    s_and_b32 s27, s27, 3
    s_lshl_b32 s27, s27, 13
    s_add_u32 s27, s27, s28
    buffer_load_dwordx4 v[80:83], v128, s[12:15], s27 offen offset:0 sc1
    buffer_load_dwordx4 v[84:87], v128, s[12:15], s27 offen offset:1024 sc1
    s_lshl_b32 s28, s30, 5
    v_add_u32 v135, s28, v134
    v_add_u32 v48, 0, v135
    v_cmp_gt_u32 vcc, 0x100, v48
    s_nop 1
    v_cndmask_b32 v48, v129, 0, vcc
    v_add_u32 v49, 4294967295, v135
    v_cmp_gt_u32 vcc, 0x100, v49
    s_nop 1
    v_cndmask_b32 v49, v129, 0, vcc
    v_add_u32 v50, 4294967294, v135
    v_cmp_gt_u32 vcc, 0x100, v50
    s_nop 1
    v_cndmask_b32 v50, v129, 0, vcc
    v_add_u32 v51, 4294967293, v135
    v_cmp_gt_u32 vcc, 0x100, v51
    s_nop 1
    v_cndmask_b32 v51, v129, 0, vcc
    v_add_u32 v52, 4294967280, v135
    v_cmp_gt_u32 vcc, 0x100, v52
    s_nop 1
    v_cndmask_b32 v52, v129, 0, vcc
    v_add_u32 v53, 4294967279, v135
    v_cmp_gt_u32 vcc, 0x100, v53
    s_nop 1
    v_cndmask_b32 v53, v129, 0, vcc
    v_add_u32 v54, 4294967278, v135
    v_cmp_gt_u32 vcc, 0x100, v54
    s_nop 1
    v_cndmask_b32 v54, v129, 0, vcc
    v_add_u32 v55, 4294967277, v135
    v_cmp_gt_u32 vcc, 0x100, v55
    s_nop 1
    v_cndmask_b32 v55, v129, 0, vcc
    v_add_u32 v56, 16, v135
    v_cmp_gt_u32 vcc, 0x100, v56
    s_nop 1
    v_cndmask_b32 v56, v129, 0, vcc
    v_add_u32 v57, 15, v135
    v_cmp_gt_u32 vcc, 0x100, v57
    s_nop 1
    v_cndmask_b32 v57, v129, 0, vcc
    v_add_u32 v58, 14, v135
    v_cmp_gt_u32 vcc, 0x100, v58
    s_nop 1
    v_cndmask_b32 v58, v129, 0, vcc
    v_add_u32 v59, 13, v135
    v_cmp_gt_u32 vcc, 0x100, v59
    s_nop 1
    v_cndmask_b32 v59, v129, 0, vcc
    v_add_u32 v60, 0, v135
    v_cmp_gt_u32 vcc, 0x100, v60
    s_nop 1
    v_cndmask_b32 v60, v129, 0, vcc
    v_add_u32 v61, 4294967295, v135
    v_cmp_gt_u32 vcc, 0x100, v61
    s_nop 1
    v_cndmask_b32 v61, v129, 0, vcc
    v_add_u32 v62, 4294967294, v135
    v_cmp_gt_u32 vcc, 0x100, v62
    s_nop 1
    v_cndmask_b32 v62, v129, 0, vcc
    v_add_u32 v63, 4294967293, v135
    v_cmp_gt_u32 vcc, 0x100, v63
    s_nop 1
    v_cndmask_b32 v63, v129, 0, vcc
    s_waitcnt vmcnt(0)
    v_mfma_f32_16x16x32_bf16 v[32:35], v[80:83], v[24:27], v[48:51]
    v_mfma_f32_16x16x32_bf16 v[36:39], v[84:87], v[24:27], v[52:55]
    v_mfma_f32_16x16x32_bf16 v[40:43], v[80:83], v[28:31], v[56:59]
    v_mfma_f32_16x16x32_bf16 v[44:47], v[84:87], v[28:31], v[60:63]
    s_nop 4
    v_max3_f32 v132, v132, v32, v33
    v_max3_f32 v132, v132, v34, v35
    v_max3_f32 v132, v132, v36, v37
    v_max3_f32 v132, v132, v38, v39
    v_max3_f32 v133, v133, v40, v41
    v_max3_f32 v133, v133, v42, v43
    v_max3_f32 v133, v133, v44, v45
    s_nop 0
    v_max3_f32 v133, v133, v46, v47
    s_add_u32 s30, s30, 1
    s_cmp_le_u32 s30, s31
    s_cbranch_scc1 L_ex0
    v_mov_b32 v130, v132
    s_nop 1
    v_permlane16_swap_b32 v132, v130
    v_max_f32 v132, v132, v130
    v_mov_b32 v130, v132
    s_nop 1
    v_permlane32_swap_b32 v132, v130
    v_max_f32 v132, v132, v130
    v_mov_b32 v130, v133
    s_nop 1
    v_permlane16_swap_b32 v133, v130
    v_max_f32 v133, v133, v130
    v_mov_b32 v130, v133
    s_nop 1
    v_permlane32_swap_b32 v133, v130
    v_max_f32 v133, v133, v130
    s_mov_b32 s30, 0
L_ex1:
    s_sub_u32 s27, s29, s30
    s_lshr_b32 s28, s27, 2
    s_lshl_b32 s28, s28, 20
    s_and_b32 s27, s27, 3
    s_lshl_b32 s27, s27, 13
    s_add_u32 s27, s27, s28
    buffer_load_dwordx4 v[80:83], v128, s[12:15], s27 offen offset:0 sc1
    buffer_load_dwordx4 v[84:87], v128, s[12:15], s27 offen offset:1024 sc1
    buffer_load_dwordx4 v[88:91], v128, s[12:15], s27 offen offset:2048 sc1
    buffer_load_dwordx4 v[92:95], v128, s[12:15], s27 offen offset:3072 sc1
    s_lshl_b32 s28, s30, 5
    v_add_u32 v135, s28, v134
    v_add_u32 v48, 0, v135
    v_cmp_gt_u32 vcc, 0x100, v48
    s_nop 1
    v_cndmask_b32 v48, v129, 0, vcc
    v_add_u32 v49, 4294967295, v135
    v_cmp_gt_u32 vcc, 0x100, v49
    s_nop 1
    v_cndmask_b32 v49, v129, 0, vcc
    v_add_u32 v50, 4294967294, v135
    v_cmp_gt_u32 vcc, 0x100, v50
    s_nop 1
    v_cndmask_b32 v50, v129, 0, vcc
    v_add_u32 v51, 4294967293, v135
    v_cmp_gt_u32 vcc, 0x100, v51
    s_nop 1
    v_cndmask_b32 v51, v129, 0, vcc
    v_add_u32 v52, 4294967280, v135
    v_cmp_gt_u32 vcc, 0x100, v52
    s_nop 1
    v_cndmask_b32 v52, v129, 0, vcc
    v_add_u32 v53, 4294967279, v135
    v_cmp_gt_u32 vcc, 0x100, v53
    s_nop 1
    v_cndmask_b32 v53, v129, 0, vcc
    v_add_u32 v54, 4294967278, v135
    v_cmp_gt_u32 vcc, 0x100, v54
    s_nop 1
    v_cndmask_b32 v54, v129, 0, vcc
    v_add_u32 v55, 4294967277, v135
    v_cmp_gt_u32 vcc, 0x100, v55
    s_nop 1
    v_cndmask_b32 v55, v129, 0, vcc
    v_add_u32 v56, 16, v135
    v_cmp_gt_u32 vcc, 0x100, v56
    s_nop 1
    v_cndmask_b32 v56, v129, 0, vcc
    v_add_u32 v57, 15, v135
    v_cmp_gt_u32 vcc, 0x100, v57
    s_nop 1
    v_cndmask_b32 v57, v129, 0, vcc
    v_add_u32 v58, 14, v135
    v_cmp_gt_u32 vcc, 0x100, v58
    s_nop 1
    v_cndmask_b32 v58, v129, 0, vcc
    v_add_u32 v59, 13, v135
    v_cmp_gt_u32 vcc, 0x100, v59
    s_nop 1
    v_cndmask_b32 v59, v129, 0, vcc
    v_add_u32 v60, 0, v135
    v_cmp_gt_u32 vcc, 0x100, v60
    s_nop 1
    v_cndmask_b32 v60, v129, 0, vcc
    v_add_u32 v61, 4294967295, v135
    v_cmp_gt_u32 vcc, 0x100, v61
    s_nop 1
    v_cndmask_b32 v61, v129, 0, vcc
    v_add_u32 v62, 4294967294, v135
    v_cmp_gt_u32 vcc, 0x100, v62
    s_nop 1
    v_cndmask_b32 v62, v129, 0, vcc
    v_add_u32 v63, 4294967293, v135
    v_cmp_gt_u32 vcc, 0x100, v63
    s_nop 1
    v_cndmask_b32 v63, v129, 0, vcc
    s_waitcnt vmcnt(0)
    v_mfma_f32_16x16x32_bf16 v[32:35], v[80:83], v[24:27], v[48:51]
    v_mfma_f32_16x16x32_bf16 v[36:39], v[84:87], v[24:27], v[52:55]
    v_mfma_f32_16x16x32_bf16 v[40:43], v[80:83], v[28:31], v[56:59]
    v_mfma_f32_16x16x32_bf16 v[44:47], v[84:87], v[28:31], v[60:63]
    s_nop 4
    v_sub_f32 v32, v32, v132
    v_sub_f32 v33, v33, v132
    v_sub_f32 v34, v34, v132
    v_sub_f32 v35, v35, v132
    v_sub_f32 v36, v36, v132
    v_sub_f32 v37, v37, v132
    v_sub_f32 v38, v38, v132
    v_sub_f32 v39, v39, v132
    v_sub_f32 v40, v40, v133
    v_sub_f32 v41, v41, v133
    v_sub_f32 v42, v42, v133
    v_sub_f32 v43, v43, v133
    v_sub_f32 v44, v44, v133
    v_sub_f32 v45, v45, v133
    v_sub_f32 v46, v46, v133
    v_sub_f32 v47, v47, v133
    v_exp_f32 v32, v32
    v_exp_f32 v33, v33
    v_exp_f32 v34, v34
    v_exp_f32 v35, v35
    v_exp_f32 v36, v36
    v_exp_f32 v37, v37
    v_exp_f32 v38, v38
    v_exp_f32 v39, v39
    v_exp_f32 v40, v40
    v_exp_f32 v41, v41
    v_exp_f32 v42, v42
    v_exp_f32 v43, v43
    v_exp_f32 v44, v44
    v_exp_f32 v45, v45
    v_exp_f32 v46, v46
    v_exp_f32 v47, v47
    v_cvt_pk_bf16_f32 v64, v32, v33
    v_cvt_pk_bf16_f32 v65, v34, v35
    v_cvt_pk_bf16_f32 v66, v36, v37
    v_cvt_pk_bf16_f32 v67, v38, v39
    v_cvt_pk_bf16_f32 v68, v40, v41
    v_cvt_pk_bf16_f32 v69, v42, v43
    v_cvt_pk_bf16_f32 v70, v44, v45
    v_cvt_pk_bf16_f32 v71, v46, v47
    v_mfma_f32_16x16x32_bf16 v[104:107], v[88:91], v[64:67], v[104:107]
    v_mfma_f32_16x16x32_bf16 v[108:111], v[92:95], v[64:67], v[108:111]
    v_mfma_f32_16x16x32_bf16 v[120:123], v[212:215], v[64:67], v[120:123]
    v_mfma_f32_16x16x32_bf16 v[112:115], v[88:91], v[68:71], v[112:115]
    v_mfma_f32_16x16x32_bf16 v[116:119], v[92:95], v[68:71], v[116:119]
    v_mfma_f32_16x16x32_bf16 v[124:127], v[212:215], v[68:71], v[124:127]
    s_add_u32 s30, s30, 1
    s_cmp_le_u32 s30, s31
    s_cbranch_scc1 L_ex1
    s_nop 7
    s_branch L_aok
L_final:
    s_lshl_b32 s27, s20, 2
    s_add_u32 s27, s27, s3
    s_lshl_b32 s27, s27, 16
    s_lshl_b32 s28, s21, 7
    s_add_u32 s27, s27, s28
    v_and_b32 v160, 15, v1
    v_lshlrev_b32 v160, 11, v160
    v_bfe_u32 v161, v1, 4, 1
    v_lshl_add_u32 v160, v161, 5, v160
    v_lshrrev_b32 v161, 5, v1
    v_lshlrev_b32 v161, 4, v161
    v_add3_u32 v160, v160, v161, s27
    v_add_u32 v161, 32768, v160
    v_cvt_pk_bf16_f32 v8, v24, v25
    v_cvt_pk_bf16_f32 v9, v26, v27
    v_cvt_pk_bf16_f32 v10, v28, v29
    v_cvt_pk_bf16_f32 v11, v30, v31
    v_cvt_pk_bf16_f32 v12, v32, v33
    v_cvt_pk_bf16_f32 v13, v34, v35
    v_cvt_pk_bf16_f32 v14, v36, v37
    v_cvt_pk_bf16_f32 v15, v38, v39
    v_permlane16_swap_b32 v8, v10
    v_permlane16_swap_b32 v9, v11
    v_cvt_pk_bf16_f32 v16, v40, v41
    v_cvt_pk_bf16_f32 v17, v42, v43
    v_cvt_pk_bf16_f32 v18, v44, v45
    v_cvt_pk_bf16_f32 v19, v46, v47
    v_permlane16_swap_b32 v12, v14
    v_permlane16_swap_b32 v13, v15
    v_cvt_pk_bf16_f32 v20, v48, v49
    v_cvt_pk_bf16_f32 v21, v50, v51
    v_cvt_pk_bf16_f32 v22, v52, v53
    v_cvt_pk_bf16_f32 v23, v54, v55
    v_permlane16_swap_b32 v16, v18
    v_permlane16_swap_b32 v17, v19
    v_permlane16_swap_b32 v20, v22
    v_permlane16_swap_b32 v21, v23
    buffer_store_dwordx4 v[8:11], v160, s[16:19], 0 offen offset:0
    buffer_store_dwordx4 v[12:15], v160, s[16:19], 0 offen offset:64
    buffer_store_dwordx4 v[16:19], v161, s[16:19], 0 offen offset:0
    buffer_store_dwordx4 v[20:23], v161, s[16:19], 0 offen offset:64
L_out:
L_end:
    s_endpgm
Lrt_3:
    s_mov_b32 s26, 0
Lrt_3b:
    s_bfe_u32 s27, s74, 262148
    s_lshl_b32 s27, s27, 12
    s_add_u32 m0, s78, 0
    s_nop 0
    buffer_load_dwordx4 v8, s[88:91], s27 offen offset:0 sc1 lds
    buffer_load_dwordx4 v9, s[88:91], s27 offen offset:1024 sc1 lds
    buffer_load_dwordx4 v10, s[88:91], s27 offen offset:2048 sc1 lds
    buffer_load_dwordx4 v11, s[88:91], s27 offen offset:3072 sc1 lds
    s_waitcnt vmcnt(0)
    ds_read_b128 v[24:27], v195 offset:0
    ds_read_b128 v[28:31], v195 offset:1024
    ds_read_b128 v[32:35], v195 offset:2048
    ds_read_b128 v[36:39], v195 offset:3072
    s_waitcnt lgkmcnt(0)
    v_bitop3_b32 v25, v24, v28, v32 bitop3:0x80
    v_bitop3_b32 v25, v25, v36, 1 bitop3:0x80
    v_cmp_eq_u32 vcc, 0, v25
    s_nop 0
    s_cbranch_vccz Lok_4
    s_add_u32 s26, s26, 1
    s_cmp_lt_u32 s26, 262144
    s_cbranch_scc1 Lrt_3b
    s_branch Lok_4
Lwt_461006:
    buffer_store_dwordx2 v[240:241], v190, s[12:15], 0 offen sc1
    s_branch Lwt_461007
Lrt_11:
    s_mov_b32 s26, 0
Lrt_11b:
    s_bfe_u32 s27, s74, 262152
    s_lshl_b32 s27, s27, 12
    s_add_u32 m0, s78, 16384
    s_nop 0
    buffer_load_dwordx4 v8, s[88:91], s27 offen offset:0 sc1 lds
    buffer_load_dwordx4 v9, s[88:91], s27 offen offset:1024 sc1 lds
    buffer_load_dwordx4 v10, s[88:91], s27 offen offset:2048 sc1 lds
    buffer_load_dwordx4 v11, s[88:91], s27 offen offset:3072 sc1 lds
    s_waitcnt vmcnt(0)
    ds_read_b128 v[24:27], v195 offset:16384
    ds_read_b128 v[28:31], v195 offset:17408
    ds_read_b128 v[32:35], v195 offset:18432
    ds_read_b128 v[36:39], v195 offset:19456
    s_waitcnt lgkmcnt(0)
    v_bitop3_b32 v25, v24, v28, v32 bitop3:0x80
    v_bitop3_b32 v25, v25, v36, 1 bitop3:0x80
    v_cmp_eq_u32 vcc, 0, v25
    s_nop 0
    s_cbranch_vccz Lok_12
    s_add_u32 s26, s26, 1
    s_cmp_lt_u32 s26, 262144
    s_cbranch_scc1 Lrt_11b
    s_branch Lok_12
Lrt_17:
    s_mov_b32 s26, 0
Lrt_17b:
    s_bfe_u32 s27, s74, 262156
    s_lshl_b32 s27, s27, 12
    s_add_u32 m0, s78, 32768
    s_nop 0
    buffer_load_dwordx4 v8, s[88:91], s27 offen offset:0 sc1 lds
    buffer_load_dwordx4 v9, s[88:91], s27 offen offset:1024 sc1 lds
    buffer_load_dwordx4 v10, s[88:91], s27 offen offset:2048 sc1 lds
    buffer_load_dwordx4 v11, s[88:91], s27 offen offset:3072 sc1 lds
    s_waitcnt vmcnt(0)
    ds_read_b128 v[24:27], v195 offset:32768
    ds_read_b128 v[28:31], v195 offset:33792
    ds_read_b128 v[32:35], v195 offset:34816
    ds_read_b128 v[36:39], v195 offset:35840
    s_waitcnt lgkmcnt(0)
    v_bitop3_b32 v25, v24, v28, v32 bitop3:0x80
    v_bitop3_b32 v25, v25, v36, 1 bitop3:0x80
    v_cmp_eq_u32 vcc, 0, v25
    s_nop 0
    s_cbranch_vccz Lok_18
    s_add_u32 s26, s26, 1
    s_cmp_lt_u32 s26, 262144
    s_cbranch_scc1 Lrt_17b
    s_branch Lok_18
Lpoll_21:
    s_mov_b32 s26, 0
Lpoll_21b:
    buffer_load_dwordx2 v[244:245], v188, s[12:15], 0 offen sc1
    s_waitcnt vmcnt(0)
    v_xor_b32 v246, s24, v244
    v_xor_b32 v247, s25, v245
    v_lshrrev_b32 v247, 4, v247
    v_or_b32 v246, v246, v247
    v_cmp_ne_u32 vcc, 0, v246
    s_nop 0
    s_cbranch_vccz Lok_22
    s_add_u32 s26, s26, 1
    s_cmp_lt_u32 s26, 262144
    s_cbranch_scc1 Lpoll_21b
    s_branch Lok_22
Lrt_28:
    s_mov_b32 s26, 0
Lrt_28b:
    s_bfe_u32 s27, s74, 262160
    s_lshl_b32 s27, s27, 12
    s_add_u32 m0, s78, 0
    s_nop 0
    buffer_load_dwordx4 v8, s[88:91], s27 offen offset:0 sc1 lds
    buffer_load_dwordx4 v9, s[88:91], s27 offen offset:1024 sc1 lds
    buffer_load_dwordx4 v10, s[88:91], s27 offen offset:2048 sc1 lds
    buffer_load_dwordx4 v11, s[88:91], s27 offen offset:3072 sc1 lds
    s_waitcnt vmcnt(0)
    ds_read_b128 v[24:27], v195 offset:0
    ds_read_b128 v[28:31], v195 offset:1024
    ds_read_b128 v[32:35], v195 offset:2048
    ds_read_b128 v[36:39], v195 offset:3072
    s_waitcnt lgkmcnt(0)
    v_bitop3_b32 v25, v24, v28, v32 bitop3:0x80
    v_bitop3_b32 v25, v25, v36, 1 bitop3:0x80
    v_cmp_eq_u32 vcc, 0, v25
    s_nop 0
    s_cbranch_vccz Lok_29
    s_add_u32 s26, s26, 1
    s_cmp_lt_u32 s26, 262144
    s_cbranch_scc1 Lrt_28b
    s_branch Lok_29
Lwt_32:
    buffer_store_dwordx4 v[124:127], v0, s[40:43], s47 offen offset:0 sc1
    s_branch Lwt_33
Lwt_38:
    buffer_store_dwordx4 v[124:127], v0, s[40:43], s47 offen offset:1024 sc1
    s_branch Lwt_39
Lwt_42:
    buffer_store_dwordx4 v[124:127], v0, s[40:43], s47 offen offset:2048 sc1
    s_branch Lwt_43
Lwt_738045:
    buffer_store_dwordx4 v[76:79], v202, s[12:15], 0 offen sc1
    s_branch Lwt_738046
Lwt_47:
    buffer_store_dwordx4 v[124:127], v0, s[40:43], s47 offen offset:3072 sc1
    s_branch Lwt_48
Lwt_51:
    buffer_store_dwordx4 v[128:131], v0, s[16:19], s47 offen offset:0 sc1
    s_branch Lwt_52
Lwt_57:
    buffer_store_dwordx4 v[128:131], v0, s[16:19], s47 offen offset:1024 sc1
    s_branch Lwt_58
Lwt_61:
    buffer_store_dwordx4 v[128:131], v0, s[16:19], s47 offen offset:2048 sc1
    s_branch Lwt_62
Lwt_66:
    buffer_store_dwordx4 v[128:131], v0, s[16:19], s47 offen offset:3072 sc1
    s_branch Lwt_67
Lpoll_71:
    s_mov_b32 s26, 0
Lpoll_71b:
    buffer_load_dwordx2 v[244:245], v200, s[12:15], 0 offen sc1
    s_waitcnt vmcnt(0)
    v_xor_b32 v246, s24, v244
    v_xor_b32 v247, s25, v245
    v_lshrrev_b32 v247, 4, v247
    v_or_b32 v246, v246, v247
    v_cmp_ne_u32 vcc, 0, v246
    s_nop 0
    s_cbranch_vccz Lok_72
    s_add_u32 s26, s26, 1
    s_cmp_lt_u32 s26, 262144
    s_cbranch_scc1 Lpoll_71b
    s_branch Lok_72
Lrt_73:
    s_mov_b32 s26, 0
Lrt_73b:
    buffer_load_dwordx4 v[72:75], v189, s[12:15], 0 offen sc1
    s_waitcnt vmcnt(0)
    v_xor_b32 v76, s24, v74
    v_xor_b32 v77, s25, v75
    v_lshrrev_b32 v77, 4, v77
    v_or_b32 v76, v76, v77
    v_cmp_ne_u32 vcc, 0, v76
    s_nop 0
    s_cbranch_vccz Lok_74
    s_add_u32 s26, s26, 1
    s_cmp_lt_u32 s26, 262144
    s_cbranch_scc1 Lrt_73b
    s_branch Lok_74
Lwt_82:
    buffer_store_dwordx2 v[240:241], v190, s[12:15], 0 offen sc1
    s_branch Lwt_83
Lpoll_84:
    s_mov_b32 s26, 0
Lpoll_84b:
    buffer_load_dwordx2 v[74:75], v73, s[12:15], 0 offen sc1
    s_waitcnt vmcnt(0)
    v_xor_b32 v76, s24, v74
    v_xor_b32 v77, s25, v75
    v_lshrrev_b32 v77, 4, v77
    v_or_b32 v76, v76, v77
    v_cmp_ne_u32 vcc, 0, v76
    s_nop 0
    s_cbranch_vccz Lok_85
    s_add_u32 s26, s26, 1
    s_cmp_lt_u32 s26, 262144
    s_cbranch_scc1 Lpoll_84b
    s_branch Lok_85
Lwt_90:
    buffer_store_dwordx2 v[240:241], v190, s[12:15], 0 offen sc1
    s_branch Lwt_91
Lrt_93:
    s_mov_b32 s26, 0
Lrt_93b:
    buffer_load_dwordx4 v[32:35], v0, s[12:15], s27 offen sc1
    s_waitcnt vmcnt(0)
    v_cmp_eq_u32 vcc, -1, v32
    s_nop 0
    s_cbranch_vccz Lok_94
    s_add_u32 s26, s26, 1
    s_cmp_lt_u32 s26, 262144
    s_cbranch_scc1 Lrt_93b
    s_branch Lok_94
Lpoll_95:
    s_mov_b32 s26, 0
Lpoll_95b:
    buffer_load_dwordx2 v[244:245], v188, s[12:15], 0 offen sc1
    s_waitcnt vmcnt(0)
    v_xor_b32 v246, s24, v244
    v_xor_b32 v247, s25, v245
    v_lshrrev_b32 v247, 4, v247
    v_or_b32 v246, v246, v247
    v_cmp_ne_u32 vcc, 0, v246
    s_nop 0
    s_cbranch_vccz Lok_96
    s_add_u32 s26, s26, 1
    s_cmp_lt_u32 s26, 262144
    s_cbranch_scc1 Lpoll_95b
    s_branch Lok_96
Lwt_101:
    buffer_store_dwordx2 v[236:237], v206, s[12:15], 0 offen offset:0 sc1
    buffer_store_dwordx2 v[244:245], v206, s[12:15], 0 offen offset:2048 sc1
    s_branch Lwt_102
Lwt_103:
    buffer_store_dwordx2 v[236:237], v206, s[12:15], 0 offen offset:0 sc1
    buffer_store_dwordx2 v[244:245], v206, s[12:15], 0 offen offset:2048 sc1
    s_branch Lwt_104
Lwt_105:
    buffer_store_dwordx4 v[76:79], v0, s[88:91], s27 offen offset:1024 sc1
    buffer_store_dwordx4 v[92:95], v0, s[88:91], s27 offen offset:0 sc1
    s_branch Lwt_106
Lwt_107:
    buffer_store_dwordx4 v[76:79], v0, s[88:91], s62 offen offset:1024 sc1
    buffer_store_dwordx4 v[92:95], v0, s[88:91], s62 offen offset:0 sc1
    s_branch Lwt_108
Lbi_110:
    v_mov_b32 v224, 4048155338
    v_mov_b32 v225, 4048155338
    v_mov_b32 v226, 4048155338
    v_mov_b32 v227, 4048155338
    s_branch Lbj_111
Lbi_112:
    v_mov_b32 v224, 4048155338
    v_mov_b32 v225, 4048155338
    v_mov_b32 v226, 4048155338
    v_mov_b32 v227, 4048155338
    s_branch Lbj_113
Lbi_114:
    v_mov_b32 v224, 4048155338
    v_mov_b32 v225, 4048155338
    v_mov_b32 v226, 4048155338
    v_mov_b32 v227, 4048155338
    s_branch Lbj_115
Lbi_117:
    v_mov_b32 v224, 4048155338
    v_mov_b32 v225, 4048155338
    v_mov_b32 v226, 4048155338
    v_mov_b32 v227, 4048155338
    s_branch Lbj_118
Lbi_120:
    v_mov_b32 v224, 0
    v_mov_b32 v225, 0
    v_mov_b32 v226, 0
    v_mov_b32 v227, 0
    s_branch Lbj_121
Lwt_122:
    buffer_store_dwordx4 v[104:107], v0, s[88:91], s62 offen offset:0 sc1
    buffer_store_dwordx4 v[112:115], v0, s[88:91], s62 offen offset:1024 sc1
    s_branch Lwt_123
Lot_127:
    s_call_b64 s[72:73], L_ofix
    s_cbranch_scc0 Look_128
    v_bitop3_b32 v250, v56, v60, 1 bitop3:0xa8
    v_cmp_ne_u32 vcc, 0, v250
    s_nop 0
    s_cbranch_vccnz Lot_127
    s_branch Look_128
Lot_130:
    s_call_b64 s[72:73], L_ofix
    s_cbranch_scc0 Look_131
    v_bitop3_b32 v250, v64, v68, 1 bitop3:0xa8
    v_cmp_ne_u32 vcc, 0, v250
    s_nop 0
    s_cbranch_vccnz Lot_130
    s_branch Look_131
Lot_133:
    s_call_b64 s[72:73], L_ofix
    s_cbranch_scc0 Look_134
    v_bitop3_b32 v250, v72, v76, 1 bitop3:0xa8
    v_cmp_ne_u32 vcc, 0, v250
    s_nop 0
    s_cbranch_vccnz Lot_133
    s_branch Look_134
Lot_136:
    s_call_b64 s[72:73], L_ofix
    s_cbranch_scc0 Look_137
    v_bitop3_b32 v250, v80, v84, 1 bitop3:0xa8
    v_cmp_ne_u32 vcc, 0, v250
    s_nop 0
    s_cbranch_vccnz Lot_136
    s_branch Look_137
Lot_139:
    s_call_b64 s[72:73], L_ofix
    s_cbranch_scc0 Look_140
    v_bitop3_b32 v250, v88, v92, 1 bitop3:0xa8
    v_cmp_ne_u32 vcc, 0, v250
    s_nop 0
    s_cbranch_vccnz Lot_139
    s_branch Look_140
Lot_142:
    s_call_b64 s[72:73], L_ofix
    s_cbranch_scc0 Look_143
    v_bitop3_b32 v250, v96, v100, 1 bitop3:0xa8
    v_cmp_ne_u32 vcc, 0, v250
    s_nop 0
    s_cbranch_vccnz Lot_142
    s_branch Look_143
Lot_145:
    s_call_b64 s[72:73], L_ofix
    s_cbranch_scc0 Look_146
    v_bitop3_b32 v250, v104, v108, 1 bitop3:0xa8
    v_cmp_ne_u32 vcc, 0, v250
    s_nop 0
    s_cbranch_vccnz Lot_145
    s_branch Look_146
Lot_148:
    s_call_b64 s[72:73], L_ofix
    s_cbranch_scc0 Look_149
    v_bitop3_b32 v250, v112, v116, 1 bitop3:0xa8
    v_cmp_ne_u32 vcc, 0, v250
    s_nop 0
    s_cbranch_vccnz Lot_148
    s_branch Look_149
Lot_151:
    s_call_b64 s[72:73], L_ofix
    s_cbranch_scc0 Look_152
    v_bitop3_b32 v250, v56, v60, 1 bitop3:0xa8
    v_cmp_ne_u32 vcc, 0, v250
    s_nop 0
    s_cbranch_vccnz Lot_151
    s_branch Look_152
Lot_154:
    s_call_b64 s[72:73], L_ofix
    s_cbranch_scc0 Look_155
    v_bitop3_b32 v250, v64, v68, 1 bitop3:0xa8
    v_cmp_ne_u32 vcc, 0, v250
    s_nop 0
    s_cbranch_vccnz Lot_154
    s_branch Look_155
Lot_157:
    s_call_b64 s[72:73], L_ofix
    s_cbranch_scc0 Look_158
    v_bitop3_b32 v250, v72, v76, 1 bitop3:0xa8
    v_cmp_ne_u32 vcc, 0, v250
    s_nop 0
    s_cbranch_vccnz Lot_157
    s_branch Look_158
Lot_160:
    s_call_b64 s[72:73], L_ofix
    s_cbranch_scc0 Look_161
    v_bitop3_b32 v250, v80, v84, 1 bitop3:0xa8
    v_cmp_ne_u32 vcc, 0, v250
    s_nop 0
    s_cbranch_vccnz Lot_160
    s_branch Look_161
Lot_163:
    s_call_b64 s[72:73], L_ofix
    s_cbranch_scc0 Look_164
    v_bitop3_b32 v250, v88, v92, 1 bitop3:0xa8
    v_cmp_ne_u32 vcc, 0, v250
    s_nop 0
    s_cbranch_vccnz Lot_163
    s_branch Look_164
Lot_166:
    s_call_b64 s[72:73], L_ofix
    s_cbranch_scc0 Look_167
    v_bitop3_b32 v250, v96, v100, 1 bitop3:0xa8
    v_cmp_ne_u32 vcc, 0, v250
    s_nop 0
    s_cbranch_vccnz Lot_166
    s_branch Look_167
Lot_169:
    s_call_b64 s[72:73], L_ofix
    s_cbranch_scc0 Look_170
    v_bitop3_b32 v250, v104, v108, 1 bitop3:0xa8
    v_cmp_ne_u32 vcc, 0, v250
    s_nop 0
    s_cbranch_vccnz Lot_169
    s_branch Look_170
Lot_172:
    s_call_b64 s[72:73], L_ofix
    s_cbranch_scc0 Look_173
    v_bitop3_b32 v250, v112, v116, 1 bitop3:0xa8
    v_cmp_ne_u32 vcc, 0, v250
    s_nop 0
    s_cbranch_vccnz Lot_172
    s_branch Look_173
Lot_175:
    s_call_b64 s[72:73], L_ofix
    s_cbranch_scc0 Look_176
    v_bitop3_b32 v250, v56, v60, 1 bitop3:0xa8
    v_cmp_ne_u32 vcc, 0, v250
    s_nop 0
    s_cbranch_vccnz Lot_175
    s_branch Look_176
Lot_178:
    s_call_b64 s[72:73], L_ofix
    s_cbranch_scc0 Look_179
    v_bitop3_b32 v250, v64, v68, 1 bitop3:0xa8
    v_cmp_ne_u32 vcc, 0, v250
    s_nop 0
    s_cbranch_vccnz Lot_178
    s_branch Look_179
Lot_181:
    s_call_b64 s[72:73], L_ofix
    s_cbranch_scc0 Look_182
    v_bitop3_b32 v250, v72, v76, 1 bitop3:0xa8
    v_cmp_ne_u32 vcc, 0, v250
    s_nop 0
    s_cbranch_vccnz Lot_181
    s_branch Look_182
Lot_184:
    s_call_b64 s[72:73], L_ofix
    s_cbranch_scc0 Look_185
    v_bitop3_b32 v250, v80, v84, 1 bitop3:0xa8
    v_cmp_ne_u32 vcc, 0, v250
    s_nop 0
    s_cbranch_vccnz Lot_184
    s_branch Look_185
Lot_187:
    s_call_b64 s[72:73], L_ofix
    s_cbranch_scc0 Look_188
    v_bitop3_b32 v250, v88, v92, 1 bitop3:0xa8
    v_cmp_ne_u32 vcc, 0, v250
    s_nop 0
    s_cbranch_vccnz Lot_187
    s_branch Look_188
Lot_190:
    s_call_b64 s[72:73], L_ofix
    s_cbranch_scc0 Look_191
    v_bitop3_b32 v250, v96, v100, 1 bitop3:0xa8
    v_cmp_ne_u32 vcc, 0, v250
    s_nop 0
    s_cbranch_vccnz Lot_190
    s_branch Look_191
Lot_193:
    s_call_b64 s[72:73], L_ofix
    s_cbranch_scc0 Look_194
    v_bitop3_b32 v250, v104, v108, 1 bitop3:0xa8
    v_cmp_ne_u32 vcc, 0, v250
    s_nop 0
    s_cbranch_vccnz Lot_193
    s_branch Look_194
Lot_196:
    s_call_b64 s[72:73], L_ofix
    s_cbranch_scc0 Look_197
    v_bitop3_b32 v250, v112, v116, 1 bitop3:0xa8
    v_cmp_ne_u32 vcc, 0, v250
    s_nop 0
    s_cbranch_vccnz Lot_196
    s_branch Look_197
Lot_199:
    s_call_b64 s[72:73], L_ofix
    s_cbranch_scc0 Look_200
    v_bitop3_b32 v250, v56, v60, 1 bitop3:0xa8
    v_cmp_ne_u32 vcc, 0, v250
    s_nop 0
    s_cbranch_vccnz Lot_199
    s_branch Look_200
Lot_202:
    s_call_b64 s[72:73], L_ofix
    s_cbranch_scc0 Look_203
    v_bitop3_b32 v250, v64, v68, 1 bitop3:0xa8
    v_cmp_ne_u32 vcc, 0, v250
    s_nop 0
    s_cbranch_vccnz Lot_202
    s_branch Look_203
Lot_205:
    s_call_b64 s[72:73], L_ofix
    s_cbranch_scc0 Look_206
    v_bitop3_b32 v250, v72, v76, 1 bitop3:0xa8
    v_cmp_ne_u32 vcc, 0, v250
    s_nop 0
    s_cbranch_vccnz Lot_205
    s_branch Look_206
Lot_208:
    s_call_b64 s[72:73], L_ofix
    s_cbranch_scc0 Look_209
    v_bitop3_b32 v250, v80, v84, 1 bitop3:0xa8
    v_cmp_ne_u32 vcc, 0, v250
    s_nop 0
    s_cbranch_vccnz Lot_208
    s_branch Look_209
Lot_211:
    s_call_b64 s[72:73], L_ofix
    s_cbranch_scc0 Look_212
    v_bitop3_b32 v250, v88, v92, 1 bitop3:0xa8
    v_cmp_ne_u32 vcc, 0, v250
    s_nop 0
    s_cbranch_vccnz Lot_211
    s_branch Look_212
Lot_214:
    s_call_b64 s[72:73], L_ofix
    s_cbranch_scc0 Look_215
    v_bitop3_b32 v250, v96, v100, 1 bitop3:0xa8
    v_cmp_ne_u32 vcc, 0, v250
    s_nop 0
    s_cbranch_vccnz Lot_214
    s_branch Look_215
Lot_217:
    s_call_b64 s[72:73], L_ofix
    s_cbranch_scc0 Look_218
    v_bitop3_b32 v250, v104, v108, 1 bitop3:0xa8
    v_cmp_ne_u32 vcc, 0, v250
    s_nop 0
    s_cbranch_vccnz Lot_217
    s_branch Look_218
Lot_220:
    s_call_b64 s[72:73], L_ofix
    s_cbranch_scc0 Look_221
    v_bitop3_b32 v250, v112, v116, 1 bitop3:0xa8
    v_cmp_ne_u32 vcc, 0, v250
    s_nop 0
    s_cbranch_vccnz Lot_220
    s_branch Look_221
Lwt_222:
    v_and_b32 v24, 0xffff0000, v24
    v_cvt_pk_bf16_f32 v9, v26, v27
    v_cvt_pk_bf16_f32 v8, v24, v25
    v_cvt_pk_bf16_f32 v10, v28, v29
    v_cvt_pk_bf16_f32 v11, v30, v31
    v_or_b32 v8, 1, v8
    buffer_store_dwordx4 v[8:11], v0, s[16:19], s0 offen offset:0 sc1
    ds_write_b128 v249, v[8:11] offset:0
    v_and_b32 v32, 0xffff0000, v32
    v_cvt_pk_bf16_f32 v13, v34, v35
    v_cvt_pk_bf16_f32 v12, v32, v33
    v_cvt_pk_bf16_f32 v14, v36, v37
    v_cvt_pk_bf16_f32 v15, v38, v39
    v_or_b32 v12, 1, v12
    buffer_store_dwordx4 v[12:15], v0, s[16:19], s0 offen offset:1024 sc1
    ds_write_b128 v249, v[12:15] offset:1024
    v_and_b32 v40, 0xffff0000, v40
    v_cvt_pk_bf16_f32 v17, v42, v43
    v_cvt_pk_bf16_f32 v16, v40, v41
    v_cvt_pk_bf16_f32 v18, v44, v45
    v_cvt_pk_bf16_f32 v19, v46, v47
    v_or_b32 v16, 1, v16
    buffer_store_dwordx4 v[16:19], v0, s[16:19], s0 offen offset:2048 sc1
    ds_write_b128 v249, v[16:19] offset:2048
    v_and_b32 v48, 0xffff0000, v48
    v_cvt_pk_bf16_f32 v21, v50, v51
    v_cvt_pk_bf16_f32 v20, v48, v49
    v_cvt_pk_bf16_f32 v22, v52, v53
    v_cvt_pk_bf16_f32 v23, v54, v55
    v_or_b32 v20, 1, v20
    buffer_store_dwordx4 v[20:23], v0, s[16:19], s0 offen offset:3072 sc1
    ds_write_b128 v249, v[20:23] offset:3072
    s_branch Lwt_223
L_last:
    s_endpgm

.section .rodata,"a"
.p2align 6
.amdhsa_kernel interleave_layers__sliding_block__sliding_local_dilated__prompt_kernel
  .amdhsa_next_free_vgpr 256
  .amdhsa_next_free_sgpr 102
  .amdhsa_accum_offset 256
  .amdhsa_group_segment_fixed_size 0
  .amdhsa_kernarg_size 72
  .amdhsa_user_sgpr_count 2
  .amdhsa_user_sgpr_kernarg_segment_ptr 1
  .amdhsa_system_sgpr_workgroup_id_x 1
.end_amdhsa_kernel
```

```asm
; @launch grid=(256,1,1) block=(512,1,1) lds=163840
.amdgcn_target "amdgcn-amd-amdhsa--gfx950"
.text
.globl interleave_layers__sliding_block__sliding_local_dilated__prompt_kernel
.p2align 8
.type interleave_layers__sliding_block__sliding_local_dilated__prompt_kernel,@function
interleave_layers__sliding_block__sliding_local_dilated__prompt_kernel:
    s_cmp_ge_u32 s2, 256
    s_cbranch_scc1 L_end
    s_load_dwordx16 s[48:63], s[0:1], 0
    s_load_dwordx2 s[64:65], s[0:1], 64
    v_lshrrev_b32 v1, 6, v0
    s_nop 0
    v_readfirstlane_b32 s3, v1
    v_and_b32 v1, 63, v0
    v_lshlrev_b32 v0, 4, v1
    s_and_b32 s27, s2, 7
    s_lshl_b32 s20, s27, 1
    s_bfe_u32 s27, s2, 0x10003
    s_add_u32 s20, s20, s27
    s_lshr_b32 s21, s2, 4
    s_mov_b32 s22, 0
    s_cmp_lt_u32 s3, 4
    s_cbranch_scc1 L_cstart
    s_sub_u32 s87, s3, 4
    s_lshl_b32 s78, s87, 12
    s_lshl_b32 s79, s87, 11
    s_lshr_b32 s27, s20, 1
    s_lshl_b32 s27, s27, 3
    s_mov_b32 s28, 3013775744
    s_mov_b32 s29, 4159100356
    s_lshr_b64 s[74:75], s[28:29], s27
    s_sub_u32 s27, 64, s27
    s_lshl_b64 s[28:29], s[28:29], s27
    s_or_b64 s[74:75], s[74:75], s[28:29]
    s_mov_b32 s77, 7
    v_lshrrev_b32 v14, 3, v1
    v_and_b32 v15, 6, v14
    v_and_b32 v16, 7, v1
    v_xor_b32 v15, v15, v16
    v_and_b32 v16, 4, v14
    v_add_u32 v14, v14, v16
    s_lshr_b32 s27, s87, 1
    s_lshl_b32 s27, s27, 5
    s_and_b32 s28, s87, 1
    s_lshl_b32 s28, s28, 2
    s_add_u32 s27, s27, s28
    s_mul_i32 s27, s27, 6144
    s_lshl_b32 s28, s21, 7
    s_add_u32 s27, s27, s28
    v_mul_u32_u24 v14, 6144, v14
    v_lshlrev_b32 v15, 4, v15
    v_add3_u32 v12, v14, v15, s27
    v_add_u32 v13, 97280, v12
    v_add_u32 v14, 2048, v12
    v_add_u32 v15, 99328, v12
    v_add_u32 v16, 4096, v12
    v_add_u32 v17, 101376, v12
    s_lshl_b32 s27, s20, 2
    s_add_u32 s27, s27, s87
    s_lshl_b32 s27, s27, 16
    v_lshrrev_b32 v9, 4, v1
    v_and_b32 v10, 7, v1
    v_xor_b32 v9, v9, v10
    v_lshlrev_b32 v9, 4, v9
    v_lshrrev_b32 v10, 3, v1
    v_lshlrev_b32 v10, 11, v10
    v_add3_u32 v8, v9, v10, s27
    v_xor_b32 v9, 64, v8
    v_add_u32 v10, 30720, v8
    v_add_u32 v11, 46080, v9
    v_add_u32 v9, 15360, v9
    s_bfe_u32 s27, s74, 262144
    s_lshl_b32 s84, s27, s77
    s_mul_i32 s85, s27, 393216
    s_waitcnt lgkmcnt(0)
    s_mov_b32 s4, s50
    s_mov_b32 s5, s51
    s_mov_b32 s6, 6291456
    s_mov_b32 s7, 0x00020000
    s_mov_b32 s88, s48
    s_mov_b32 s89, s49
    s_mov_b32 s90, 4194304
    s_mov_b32 s91, 0x00020000
    s_add_u32 m0, s79, 81920
    s_nop 0
    buffer_load_dwordx4 v12, s[4:7], s85 offen offset:0 lds
    buffer_load_dwordx4 v13, s[4:7], s85 offen offset:1024 lds
    s_add_u32 m0, s79, 49152
    s_nop 0
    buffer_load_dwordx4 v14, s[4:7], s85 offen offset:0 lds
    buffer_load_dwordx4 v15, s[4:7], s85 offen offset:1024 lds
    s_add_u32 m0, s79, 57344
    s_nop 0
    buffer_load_dwordx4 v16, s[4:7], s85 offen offset:0 lds
    buffer_load_dwordx4 v17, s[4:7], s85 offen offset:1024 lds
    s_add_u32 m0, s78, 32768
    s_nop 0
    buffer_load_dwordx4 v8, s[88:91], s84 offen offset:0 sc1 lds
    buffer_load_dwordx4 v9, s[88:91], s84 offen offset:1024 sc1 lds
    buffer_load_dwordx4 v10, s[88:91], s84 offen offset:2048 sc1 lds
    buffer_load_dwordx4 v11, s[88:91], s84 offen offset:3072 sc1 lds
    s_mov_b32 s12, s64
    s_mov_b32 s13, s65
    s_mov_b32 s14, 75497472
    s_mov_b32 s15, 0x00020000
    v_mov_b32 v28, 671744
    buffer_load_dwordx2 v[26:27], v28, s[12:15], 0 offen sc1
    s_lshr_b32 s27, s4, 7
    s_sub_u32 s27, 3, s27
    s_and_b32 s27, s27, 7
    s_and_b32 s28, s21, 8
    s_add_u32 s27, s27, s28
    s_bfe_u32 s28, s2, 0x40003
    s_lshl_b32 s28, s28, 2
    s_add_u32 s28, s28, s87
    s_mul_i32 s28, s28, 6144
    s_lshl_b32 s46, s27, 7
    s_add_u32 s46, s46, s28
    s_mov_b64 s[44:45], s[74:75]
    s_bfe_u32 s37, s44, 262148
    s_mul_i32 s37, s37, 393216
    s_add_u32 s37, s37, s46
    s_buffer_load_dwordx2 s[38:39], s[4:7], s37 offset:60
    s_buffer_load_dwordx2 s[38:39], s[4:7], s37 offset:2108
    s_buffer_load_dwordx2 s[38:39], s[4:7], s37 offset:4156
    s_bfe_u32 s37, s44, 262152
    s_mul_i32 s37, s37, 393216
    s_add_u32 s37, s37, s46
    s_buffer_load_dwordx2 s[38:39], s[4:7], s37 offset:60
    s_buffer_load_dwordx2 s[38:39], s[4:7], s37 offset:2108
    s_buffer_load_dwordx2 s[38:39], s[4:7], s37 offset:4156
    s_bfe_u32 s37, s44, 262156
    s_mul_i32 s37, s37, 393216
    s_add_u32 s37, s37, s46
    s_buffer_load_dwordx2 s[38:39], s[4:7], s37 offset:60
    s_buffer_load_dwordx2 s[38:39], s[4:7], s37 offset:2108
    s_buffer_load_dwordx2 s[38:39], s[4:7], s37 offset:4156
    s_bfe_u32 s27, s74, 262148
    s_lshl_b32 s84, s27, s77
    s_mul_i32 s85, s27, 393216
    s_add_u32 m0, s78, 0
    s_nop 0
    buffer_load_dwordx4 v8, s[88:91], s84 offen offset:0 sc1 lds
    buffer_load_dwordx4 v9, s[88:91], s84 offen offset:1024 sc1 lds
    buffer_load_dwordx4 v10, s[88:91], s84 offen offset:2048 sc1 lds
    buffer_load_dwordx4 v11, s[88:91], s84 offen offset:3072 sc1 lds
    s_add_u32 m0, s79, 65536
    s_nop 0
    buffer_load_dwordx4 v12, s[4:7], s85 offen offset:0 lds
    buffer_load_dwordx4 v13, s[4:7], s85 offen offset:1024 lds
    s_add_u32 m0, s79, 98304
    s_nop 0
    buffer_load_dwordx4 v14, s[4:7], s85 offen offset:0 lds
    buffer_load_dwordx4 v15, s[4:7], s85 offen offset:1024 lds
    s_add_u32 m0, s79, 106496
    s_nop 0
    buffer_load_dwordx4 v16, s[4:7], s85 offen offset:0 lds
    buffer_load_dwordx4 v17, s[4:7], s85 offen offset:1024 lds
    s_bfe_u32 s27, s74, 262152
    s_lshl_b32 s84, s27, s77
    s_mul_i32 s85, s27, 393216
    s_add_u32 m0, s78, 16384
    s_nop 0
    buffer_load_dwordx4 v8, s[88:91], s84 offen offset:0 sc1 lds
    buffer_load_dwordx4 v9, s[88:91], s84 offen offset:1024 sc1 lds
    buffer_load_dwordx4 v10, s[88:91], s84 offen offset:2048 sc1 lds
    buffer_load_dwordx4 v11, s[88:91], s84 offen offset:3072 sc1 lds
    s_add_u32 m0, s79, 73728
    s_nop 0
    buffer_load_dwordx4 v12, s[4:7], s85 offen offset:0 lds
    buffer_load_dwordx4 v13, s[4:7], s85 offen offset:1024 lds
    s_add_u32 m0, s79, 114688
    s_nop 0
    buffer_load_dwordx4 v14, s[4:7], s85 offen offset:0 lds
    buffer_load_dwordx4 v15, s[4:7], s85 offen offset:1024 lds
    s_add_u32 m0, s79, 122880
    s_nop 0
    buffer_load_dwordx4 v16, s[4:7], s85 offen offset:0 lds
    buffer_load_dwordx4 v17, s[4:7], s85 offen offset:1024 lds
    s_mov_b32 s12, s64
    s_mov_b32 s13, s65
    s_mov_b32 s14, 75497472
    s_mov_b32 s15, 0x00020000
    s_mov_b32 s8, s52
    s_mov_b32 s9, s53
    s_mov_b32 s10, 2097152
    s_mov_b32 s11, 0x00020000
    s_mov_b32 s40, s60
    s_mov_b32 s41, s61
    s_mov_b32 s42, 4194304
    s_mov_b32 s43, 0x00020000
    s_add_u32 s16, s64, 18874368
    s_addc_u32 s17, s65, 0
    s_mov_b32 s18, 4194304
    s_mov_b32 s19, 0x00020000
    s_mov_b32 s92, s56
    s_mov_b32 s93, s57
    s_mov_b32 s94, 6291456
    s_mov_b32 s95, 0x00020000
    s_mov_b32 s23, 0
    v_mov_b32 v6, 0
    v_mov_b32 v7, 0
    v_mov_b32 v206, 1073741824
    s_lshl_b32 s97, s20, 20
    s_add_u32 s97, s97, 2097152
    s_lshl_b32 s99, s21, 17
    v_bfe_u32 v28, v1, 2, 3
    v_bfe_u32 v29, v1, 1, 1
    v_and_b32 v30, 6, v28
    v_xor_b32 v29, v29, v30
    v_lshlrev_b32 v29, 4, v29
    v_lshlrev_b32 v28, 7, v28
    v_and_b32 v30, 1, v1
    v_lshlrev_b32 v30, 3, v30
    v_add3_u32 v28, v28, v29, v30
    v_lshrrev_b32 v29, 5, v1
    v_lshl_add_u32 v2, v29, 10, v28
    v_lshrrev_b32 v28, 3, v1
    v_and_b32 v29, 6, v28
    v_and_b32 v30, 7, v1
    v_xor_b32 v29, v29, v30
    v_lshlrev_b32 v29, 4, v29
    v_lshlrev_b32 v28, 11, v28
    s_lshl_b32 s27, s21, 7
    v_add3_u32 v3, v28, v29, s27
    v_and_b32 v212, 3, v1
    v_cmp_eq_u32 vcc, 0, v212
    v_mov_b32 v213, 0x3f803f80
    s_nop 0
    v_cndmask_b32 v212, 0, v213, vcc
    v_mov_b32 v213, v212
    v_mov_b32 v214, v212
    v_mov_b32 v215, v212
    s_lshl_b32 s27, s3, 2
    s_lshr_b32 s71, 0x11332200, s27
    s_and_b32 s71, s71, 3
    s_and_b32 s27, s3, 1
    s_lshl_b32 s28, s71, 1
    s_add_u32 s28, s28, s27
    s_and_b32 s98, s28, 3
    s_lshl_b32 s28, s28, 12
    s_add_u32 s54, s28, 98304
    s_lshl_b32 s28, s21, 1
    s_add_u32 s28, s28, s27
    s_lshl_b32 s28, s28, 11
    s_lshl_b32 s29, s71, 16
    s_add_u32 s28, s28, s29
    s_lshl_b32 s29, s20, 18
    s_add_u32 s62, s28, s29
    s_lshr_b32 s28, s71, 1
    s_add_u32 s28, s28, 1
    s_cmp_lt_u32 s20, s28
    s_cselect_b32 s28, 0, s28
    s_lshl_b32 s28, s28, 20
    s_sub_u32 s28, s97, s28
    s_lshl_b32 s29, s21, 3
    s_xor_b32 s27, s98, 2
    s_add_u32 s27, s27, s29
    s_lshl_b32 s27, s27, 12
    s_add_u32 s27, s27, s28
    s_add_u32 s55, s27, 524288
    s_lshl_b32 s28, s98, 3
    s_lshr_b32 s27, 302125056, s28
    s_and_b32 s27, s27, 31
    s_lshl_b32 s27, s27, 16
    s_xor_b32 s76, s99, s27
    s_lshr_b32 s27, s20, 1
    s_lshl_b32 s27, s27, 3
    s_mov_b32 s28, 1262102808
    s_mov_b32 s29, 259943772
    s_lshr_b64 s[100:101], s[28:29], s27
    s_sub_u32 s27, 60, s27
    s_lshl_b64 s[28:29], s[28:29], s27
    s_or_b64 s[100:101], s[100:101], s[28:29]
    s_lshl_b64 s[100:101], s[100:101], 4
    s_mul_i32 s27, s21, 0x11111111
    s_xor_b32 s100, s100, s27
    s_xor_b32 s101, s101, s27
    s_lshl_b32 s27, s87, 14
    v_add_u32 v20, s27, v3
    v_and_b32 v72, 15, v1
    v_lshrrev_b32 v73, 4, v1
    s_lshl_b32 s27, s22, 4
    s_add_u32 s27, s27, s20
    s_lshl_b32 s28, s27, 7
    s_add_u32 s28, s28, 655360
    v_lshl_add_u32 v188, v72, 3, s28
    s_lshl_b32 s29, s21, 3
    s_add_u32 s28, s28, s29
    v_mov_b32 v190, s28
    s_lshl_b32 s27, s27, 11
    s_add_u32 s27, s27, 917504
    s_lshl_b32 s28, s87, 5
    v_and_b32 v74, 31, v1
    v_add_u32 v74, s28, v74
    v_lshl_add_u32 v189, v74, 4, s27
    v_lshlrev_b32 v192, 2, v74
    s_lshl_b32 s28, s21, 7
    s_add_u32 s27, s27, s28
    v_and_b32 v74, 3, v1
    v_lshrrev_b32 v75, 5, v1
    v_lshl_add_u32 v74, v74, 1, v75
    v_lshl_add_u32 v202, v74, 4, s27
    v_and_b32 v74, 28, v1
    v_lshl_add_u32 v202, v74, 26, v202
    s_lshl_b32 s27, s20, 4
    s_add_u32 s27, s27, s21
    s_lshl_b32 s27, s27, 10
    v_add_u32 v191, s27, v0
    s_lshl_b32 s27, s22, 2
    s_add_u32 s27, s27, s87
    s_lshl_b32 s27, s27, 4
    s_add_u32 s27, s27, s21
    s_lshl_b32 s27, s27, 7
    s_add_u32 s27, s27, 688128
    v_lshl_add_u32 v200, v72, 3, s27
    s_lshl_b32 s28, s20, 3
    s_add_u32 s27, s27, s28
    v_mov_b32 v201, s27
    s_lshl_b32 s27, s22, 4
    s_add_u32 s27, s27, s21
    s_mul_i32 s27, s27, 12288
    s_mul_i32 s28, s87, 192
    s_add_u32 s27, s27, s28
    s_add_u32 s27, s27, 262144
    v_min_u32 v74, 11, v72
    v_lshlrev_b32 v74, 4, v74
    v_add_u32 v194, s28, v74
    v_mul_u32_u24 v75, 3072, v73
    v_add3_u32 v193, v74, v75, s27
    s_mul_i32 s28, s20, 768
    s_add_u32 s27, s27, s28
    v_lshl_add_u32 v199, v1, 2, s27
    v_cmp_gt_u32 vcc, 48, v1
    v_mov_b32 v74, 1073741824
    s_nop 0
    v_cndmask_b32 v199, v74, v199, vcc
    v_add_u32 v195, s78, v0
    s_and_b32 s86, s20, 1
    s_add_u32 s86, s86, 3
    s_add_u32 s27, s20, s22
    s_cmp_eq_u32 s27, 16
    s_cselect_b32 s86, 0, s86
    s_cmp_eq_u32 s86, 4
    s_mov_b32 s28, 81920
    s_cselect_b32 s28, 65536, s28
    s_mov_b32 s29, 40960
    s_cselect_b32 s29, 90112, s29
    s_mul_i32 s27, s87, 3
    s_add_u32 s27, s27, 0
    s_and_b32 s30, s27, 3
    s_lshl_b32 s30, s30, 5
    v_xor_b32 v196, s30, v2
    s_lshr_b32 s27, s27, 2
    s_lshl_b32 s30, s27, 13
    s_add_u32 s30, s30, s29
    s_cmp_eq_u32 s27, 0
    s_cselect_b32 s30, s28, s30
    v_add_u32 v196, s30, v196
    s_mul_i32 s27, s87, 3
    s_add_u32 s27, s27, 1
    s_and_b32 s30, s27, 3
    s_lshl_b32 s30, s30, 5
    v_xor_b32 v197, s30, v2
    s_lshr_b32 s27, s27, 2
    s_lshl_b32 s30, s27, 13
    s_add_u32 s30, s30, s29
    s_cmp_eq_u32 s27, 0
    s_cselect_b32 s30, s28, s30
    v_add_u32 v197, s30, v197
    s_mul_i32 s27, s87, 3
    s_add_u32 s27, s27, 2
    s_and_b32 s30, s27, 3
    s_lshl_b32 s30, s30, 5
    v_xor_b32 v198, s30, v2
    s_lshr_b32 s27, s27, 2
    s_lshl_b32 s30, s27, 13
    s_add_u32 s30, s30, s29
    s_cmp_eq_u32 s27, 0
    s_cselect_b32 s30, s28, s30
    v_add_u32 v198, s30, v198
    v_mov_b32 v124, -1
    v_mov_b32 v125, -1
    v_mov_b32 v126, -1
    v_mov_b32 v127, -1
    v_mov_b32 v128, 0
    v_mov_b32 v129, 0
    v_mov_b32 v130, 0
    v_mov_b32 v131, 0
    s_lshl_b32 s27, s20, 2
    s_add_u32 s27, s27, s87
    s_lshl_b32 s27, s27, 4
    s_add_u32 s27, s27, s21
    s_lshl_b32 s47, s27, 12
    s_bfe_u32 s37, s44, 262160
    s_mul_i32 s37, s37, 393216
    s_add_u32 s37, s37, s46
    s_buffer_load_dwordx2 s[38:39], s[4:7], s37 offset:60
    s_buffer_load_dwordx2 s[38:39], s[4:7], s37 offset:2108
    s_buffer_load_dwordx2 s[38:39], s[4:7], s37 offset:4156
    s_waitcnt vmcnt(20)
    v_readfirstlane_b32 s24, v26
    v_readfirstlane_b32 s25, v27
    s_add_u32 s24, s24, 1
    s_add_u32 s25, s25, 16
    s_and_b32 s25, s25, 0xfffffff0
    s_getreg_b32 s27, hwreg(HW_REG_XCC_ID, 0, 4)
    s_or_b32 s25, s25, s27
    s_barrier
    s_cmp_eq_u32 s87, 0
    s_cbranch_scc0 Lif_1
    v_mov_b32 v240, s24
    v_mov_b32 v241, s25
    s_mov_b64 exec, 1
    buffer_store_dwordx2 v[240:241], v190, s[12:15], 0 offen sc1
    s_mov_b64 exec, -1
Lif_1:
L_lbody:
    s_cmp_lg_u32 s22, 0
    s_cbranch_scc0 Lif_2
    s_bfe_u32 s27, s74, 262148
    s_lshl_b32 s84, s27, s77
    s_add_u32 m0, s78, 0
    s_nop 0
    buffer_load_dwordx4 v8, s[88:91], s84 offen offset:0 sc1 lds
    buffer_load_dwordx4 v9, s[88:91], s84 offen offset:1024 sc1 lds
    buffer_load_dwordx4 v10, s[88:91], s84 offen offset:2048 sc1 lds
    buffer_load_dwordx4 v11, s[88:91], s84 offen offset:3072 sc1 lds
    s_bfe_u32 s27, s74, 262152
    s_lshl_b32 s84, s27, s77
    s_mul_i32 s85, s27, 393216
    s_add_u32 m0, s78, 16384
    s_nop 0
    buffer_load_dwordx4 v8, s[88:91], s84 offen offset:0 sc1 lds
    buffer_load_dwordx4 v9, s[88:91], s84 offen offset:1024 sc1 lds
    buffer_load_dwordx4 v10, s[88:91], s84 offen offset:2048 sc1 lds
    buffer_load_dwordx4 v11, s[88:91], s84 offen offset:3072 sc1 lds
    s_waitcnt vmcnt(4)
    ds_read_b128 v[24:27], v195 offset:0
    ds_read_b128 v[28:31], v195 offset:1024
    ds_read_b128 v[32:35], v195 offset:2048
    ds_read_b128 v[36:39], v195 offset:3072
    s_add_u32 m0, s79, 73728
    s_nop 0
    buffer_load_dwordx4 v12, s[4:7], s85 offen offset:0 lds
    buffer_load_dwordx4 v13, s[4:7], s85 offen offset:1024 lds
    s_waitcnt lgkmcnt(0)
    v_bitop3_b32 v25, v24, v28, v32 bitop3:0x80
    v_bitop3_b32 v25, v25, v36, 1 bitop3:0x80
    v_cmp_eq_u32 vcc, 0, v25
    s_nop 0
    s_cbranch_vccnz Lrt_3
Lok_4:
    s_cmp_eq_u32 s86, 0
    s_cbranch_scc0 Lif_5
    s_call_b64 s[72:73], L_colsum
Lif_5:
Lif_2:
    s_waitcnt vmcnt(10)
    s_barrier
    s_cmp_lg_u32 s22, 0
    s_cbranch_scc0 Lon_7
    s_cmp_eq_u32 s87, 0
    s_cbranch_scc0 Lon_6
    v_mov_b32 v240, s24
    v_mov_b32 v241, s25
    s_mov_b64 exec, 1
    s_cmp_eq_u32 s23, 0
    s_cbranch_scc1 Lwt_436006
    buffer_store_dwordx2 v[240:241], v190, s[12:15], 0 offen
Lwt_436007:
    s_mov_b64 exec, -1
Lon_6:
    s_add_u32 m0, s79, 114688
    s_nop 0
    buffer_load_dwordx4 v14, s[4:7], s85 offen offset:0 lds
    buffer_load_dwordx4 v15, s[4:7], s85 offen offset:1024 lds
    s_add_u32 m0, s79, 122880
    s_nop 0
    buffer_load_dwordx4 v16, s[4:7], s85 offen offset:0 lds
    buffer_load_dwordx4 v17, s[4:7], s85 offen offset:1024 lds
Lon_7:
    s_bfe_u32 s27, s74, 262156
    s_lshl_b32 s84, s27, s77
    s_mul_i32 s85, s27, 393216
    s_add_u32 m0, s78, 32768
    s_nop 0
    buffer_load_dwordx4 v8, s[88:91], s84 offen offset:0 sc1 lds
    buffer_load_dwordx4 v9, s[88:91], s84 offen offset:1024 sc1 lds
    buffer_load_dwordx4 v10, s[88:91], s84 offen offset:2048 sc1 lds
    buffer_load_dwordx4 v11, s[88:91], s84 offen offset:3072 sc1 lds
    s_cmp_lg_u32 s22, 0
    s_cbranch_scc0 Lif_8
    s_waitcnt vmcnt(10)
    ds_read_b128 v[24:27], v195 offset:16384
    ds_read_b128 v[28:31], v195 offset:17408
    ds_read_b128 v[32:35], v195 offset:18432
    ds_read_b128 v[36:39], v195 offset:19456
Lif_8:
    s_add_u32 m0, s79, 81920
    s_nop 0
    buffer_load_dwordx4 v12, s[4:7], s85 offen offset:0 lds
    buffer_load_dwordx4 v13, s[4:7], s85 offen offset:1024 lds
    s_cmp_lg_u32 s22, 0
    s_cbranch_scc0 Lif_10
    s_waitcnt lgkmcnt(0)
    v_bitop3_b32 v25, v24, v28, v32 bitop3:0x80
    v_bitop3_b32 v25, v25, v36, 1 bitop3:0x80
    v_cmp_eq_u32 vcc, 0, v25
    s_nop 0
    s_cbranch_vccnz Lrt_11
Lok_12:
Lif_10:
    s_add_u32 m0, s79, 49152
    s_nop 0
    buffer_load_dwordx4 v14, s[4:7], s85 offen offset:0 lds
    buffer_load_dwordx4 v15, s[4:7], s85 offen offset:1024 lds
    s_add_u32 m0, s79, 57344
    s_nop 0
    buffer_load_dwordx4 v16, s[4:7], s85 offen offset:0 lds
    buffer_load_dwordx4 v17, s[4:7], s85 offen offset:1024 lds
    s_bfe_u32 s37, s44, 262164
    s_mul_i32 s37, s37, 393216
    s_add_u32 s37, s37, s46
    s_buffer_load_dwordx2 s[38:39], s[4:7], s37 offset:60
    s_buffer_load_dwordx2 s[38:39], s[4:7], s37 offset:2108
    s_buffer_load_dwordx2 s[38:39], s[4:7], s37 offset:4156
    s_waitcnt vmcnt(10)
    s_barrier
    buffer_load_dwordx2 v[244:245], v188, s[12:15], 0 offen sc1
    s_bfe_u32 s27, s74, 262160
    s_lshl_b32 s84, s27, s77
    s_mul_i32 s85, s27, 393216
    s_add_u32 m0, s78, 0
    s_nop 0
    buffer_load_dwordx4 v8, s[88:91], s84 offen offset:0 sc1 lds
    buffer_load_dwordx4 v9, s[88:91], s84 offen offset:1024 sc1 lds
    buffer_load_dwordx4 v10, s[88:91], s84 offen offset:2048 sc1 lds
    buffer_load_dwordx4 v11, s[88:91], s84 offen offset:3072 sc1 lds
    s_cmp_lg_u32 s22, 0
    s_cbranch_scc0 Lif_14
    s_waitcnt vmcnt(11)
    ds_read_b128 v[24:27], v195 offset:32768
    ds_read_b128 v[28:31], v195 offset:33792
    ds_read_b128 v[32:35], v195 offset:34816
    ds_read_b128 v[36:39], v195 offset:35840
Lif_14:
    s_add_u32 m0, s79, 65536
    s_nop 0
    buffer_load_dwordx4 v12, s[4:7], s85 offen offset:0 lds
    buffer_load_dwordx4 v13, s[4:7], s85 offen offset:1024 lds
    s_cmp_lg_u32 s22, 0
    s_cbranch_scc0 Lif_16
    s_waitcnt lgkmcnt(0)
    v_bitop3_b32 v25, v24, v28, v32 bitop3:0x80
    v_bitop3_b32 v25, v25, v36, 1 bitop3:0x80
    v_cmp_eq_u32 vcc, 0, v25
    s_nop 0
    s_cbranch_vccnz Lrt_17
Lok_18:
Lif_16:
    s_add_u32 m0, s79, 98304
    s_nop 0
    buffer_load_dwordx4 v14, s[4:7], s85 offen offset:0 lds
    buffer_load_dwordx4 v15, s[4:7], s85 offen offset:1024 lds
    s_add_u32 m0, s79, 106496
    s_nop 0
    buffer_load_dwordx4 v16, s[4:7], s85 offen offset:0 lds
    buffer_load_dwordx4 v17, s[4:7], s85 offen offset:1024 lds
    s_bfe_u32 s37, s44, 262168
    s_mul_i32 s37, s37, 393216
    s_add_u32 s37, s37, s46
    s_buffer_load_dwordx2 s[38:39], s[4:7], s37 offset:60
    s_buffer_load_dwordx2 s[38:39], s[4:7], s37 offset:2108
    s_buffer_load_dwordx2 s[38:39], s[4:7], s37 offset:4156
    s_waitcnt vmcnt(11)
    s_barrier
    s_bfe_u32 s27, s74, 262164
    s_lshl_b32 s84, s27, s77
    s_mul_i32 s85, s27, 393216
    s_add_u32 m0, s79, 73728
    s_nop 0
    buffer_load_dwordx4 v12, s[4:7], s85 offen offset:0 lds
    buffer_load_dwordx4 v13, s[4:7], s85 offen offset:1024 lds
    s_waitcnt vmcnt(12)
    v_xor_b32 v246, s24, v244
    v_xor_b32 v247, s25, v245
    v_lshrrev_b32 v247, 4, v247
    v_or_b32 v246, v246, v247
    v_cmp_ne_u32 vcc, 0, v246
    s_nop 0
    s_cbranch_vccnz Lpoll_21
Lok_22:
    s_cmp_eq_u32 s22, 0
    s_cbranch_scc0 Lif_23
    v_cmp_ne_u32 vcc, s25, v245
    s_nop 0
    s_cmp_eq_u64 vcc, 0
    s_cselect_b32 s23, 1, 0
Lif_23:
    s_cmp_eq_u32 s23, 0
    s_cbranch_scc0 Lif_24
    buffer_inv sc1
    s_waitcnt vmcnt(0)
Lif_24:
    s_add_u32 m0, s79, 114688
    s_nop 0
    buffer_load_dwordx4 v14, s[4:7], s85 offen offset:0 lds
    buffer_load_dwordx4 v15, s[4:7], s85 offen offset:1024 lds
    s_cmp_lg_u32 s22, 0
    s_cbranch_scc0 Lif_25
    s_waitcnt vmcnt(10)
    ds_read_b128 v[24:27], v195 offset:0
    ds_read_b128 v[28:31], v195 offset:1024
    ds_read_b128 v[32:35], v195 offset:2048
    ds_read_b128 v[36:39], v195 offset:3072
Lif_25:
    s_add_u32 m0, s79, 122880
    s_nop 0
    buffer_load_dwordx4 v16, s[4:7], s85 offen offset:0 lds
    buffer_load_dwordx4 v17, s[4:7], s85 offen offset:1024 lds
    s_cmp_lg_u32 s22, 0
    s_cbranch_scc0 Lif_27
    s_waitcnt lgkmcnt(0)
    v_bitop3_b32 v25, v24, v28, v32 bitop3:0x80
    v_bitop3_b32 v25, v25, v36, 1 bitop3:0x80
    v_cmp_eq_u32 vcc, 0, v25
    s_nop 0
    s_cbranch_vccnz Lrt_28
Lok_29:
Lif_27:
    s_add_u32 m0, s78, 16384
    s_nop 0
    buffer_load_dwordx4 v8, s[88:91], s84 offen offset:0 sc1 lds
    buffer_load_dwordx4 v9, s[88:91], s84 offen offset:1024 sc1 lds
    buffer_load_dwordx4 v10, s[88:91], s84 offen offset:2048 sc1 lds
    buffer_load_dwordx4 v11, s[88:91], s84 offen offset:3072 sc1 lds
    s_cmp_eq_u32 s22, 0
    s_cbranch_scc0 Lif_30
    s_cmp_eq_u32 s23, 0
    s_cbranch_scc1 Lwt_31
    buffer_store_dwordx4 v[124:127], v0, s[40:43], s47 offen offset:0
Lwt_32:
    s_lshl_b32 s32, s21, 2
    s_add_u32 s32, s32, s87
    s_lshl_b32 s32, s32, 10
    s_add_u32 s32, s32, s97
    s_add_u32 s32, s32, 0
    buffer_store_dwordx4 v[124:127], v0, s[12:15], s32 offen sc1
Lif_30:
    s_cmp_eq_u32 s86, 3
    s_cbranch_scc0 Lif_33
    s_call_b64 s[72:73], L_colsum
Lif_33:
    s_bfe_u32 s37, s44, 262172
    s_mul_i32 s37, s37, 393216
    s_add_u32 s37, s37, s46
    s_buffer_load_dwordx2 s[38:39], s[4:7], s37 offset:60
    s_buffer_load_dwordx2 s[38:39], s[4:7], s37 offset:2108
    s_buffer_load_dwordx2 s[38:39], s[4:7], s37 offset:4156
    s_waitcnt vmcnt(12)
    s_bitcmp1_b32 1, s22
    s_cbranch_scc1 Lvm_34
    s_waitcnt vmcnt(10)
Lvm_34:
    s_barrier
    s_cmp_eq_u32 s87, 3
    s_cbranch_scc0 Lon_35
    buffer_load_dwordx4 v[72:75], v191, s[12:15], 0 offen sc1
Lon_35:
    s_bfe_u32 s27, s74, 262168
    s_lshl_b32 s84, s27, s77
    s_mul_i32 s85, s27, 393216
    s_add_u32 m0, s78, 32768
    s_nop 0
    buffer_load_dwordx4 v8, s[88:91], s84 offen offset:0 sc1 lds
    buffer_load_dwordx4 v9, s[88:91], s84 offen offset:1024 sc1 lds
    buffer_load_dwordx4 v10, s[88:91], s84 offen offset:2048 sc1 lds
    buffer_load_dwordx4 v11, s[88:91], s84 offen offset:3072 sc1 lds
    s_add_u32 m0, s79, 81920
    s_nop 0
    buffer_load_dwordx4 v12, s[4:7], s85 offen offset:0 lds
    buffer_load_dwordx4 v13, s[4:7], s85 offen offset:1024 lds
    s_add_u32 m0, s79, 49152
    s_nop 0
    buffer_load_dwordx4 v14, s[4:7], s85 offen offset:0 lds
    buffer_load_dwordx4 v15, s[4:7], s85 offen offset:1024 lds
    s_add_u32 m0, s79, 57344
    s_nop 0
    buffer_load_dwordx4 v16, s[4:7], s85 offen offset:0 lds
    buffer_load_dwordx4 v17, s[4:7], s85 offen offset:1024 lds
    s_cmp_eq_u32 s22, 0
    s_cbranch_scc0 Lif_36
    s_cmp_eq_u32 s23, 0
    s_cbranch_scc1 Lwt_37
    buffer_store_dwordx4 v[124:127], v0, s[40:43], s47 offen offset:1024
Lwt_38:
    s_lshl_b32 s32, s21, 2
    s_add_u32 s32, s32, s87
    s_lshl_b32 s32, s32, 10
    s_add_u32 s32, s32, s97
    s_add_u32 s32, s32, 65536
    buffer_store_dwordx4 v[124:127], v0, s[12:15], s32 offen sc1
Lif_36:
    s_cmp_eq_u32 s86, 4
    s_cbranch_scc0 Lif_39
    s_call_b64 s[72:73], L_colsum
Lif_39:
    s_bfe_u32 s37, s45, 262144
    s_mul_i32 s37, s37, 393216
    s_add_u32 s37, s37, s46
    s_buffer_load_dwordx2 s[38:39], s[4:7], s37 offset:60
    s_buffer_load_dwordx2 s[38:39], s[4:7], s37 offset:2108
    s_buffer_load_dwordx2 s[38:39], s[4:7], s37 offset:4156
    s_waitcnt vmcnt(14)
    s_bitcmp1_b32 1, s22
    s_cbranch_scc1 Lvm_40
    s_waitcnt vmcnt(10)
Lvm_40:
    s_barrier
    s_bfe_u32 s27, s74, 262172
    s_lshl_b32 s84, s27, s77
    s_mul_i32 s85, s27, 393216
    s_add_u32 m0, s78, 0
    s_bfe_u32 s37, s45, 262148
    s_mul_i32 s37, s37, 393216
    buffer_load_dwordx4 v8, s[88:91], s84 offen offset:0 sc1 lds
    s_add_u32 s37, s37, s46
    s_buffer_load_dwordx2 s[38:39], s[4:7], s37 offset:60
    buffer_load_dwordx4 v9, s[88:91], s84 offen offset:1024 sc1 lds
    s_buffer_load_dwordx2 s[38:39], s[4:7], s37 offset:2108
    s_buffer_load_dwordx2 s[38:39], s[4:7], s37 offset:4156
    buffer_load_dwordx4 v10, s[88:91], s84 offen offset:2048 sc1 lds
    s_lshl_b32 s27, s22, 4
    s_add_u32 s27, s27, s20
    buffer_load_dwordx4 v11, s[88:91], s84 offen offset:3072 sc1 lds
    s_add_u32 m0, s79, 65536
    s_lshl_b32 s27, s27, 4
    s_add_u32 s27, s27, s21
    buffer_load_dwordx4 v12, s[4:7], s85 offen offset:0 lds
    s_lshl_b32 s27, s27, 7
    s_buffer_load_dwordx2 s[38:39], s[12:15], s27 offset:917564
    buffer_load_dwordx4 v13, s[4:7], s85 offen offset:1024 lds
    s_add_u32 m0, s79, 98304
    s_nop 0
    buffer_load_dwordx4 v14, s[4:7], s85 offen offset:0 lds
    buffer_load_dwordx4 v15, s[4:7], s85 offen offset:1024 lds
    s_add_u32 m0, s79, 106496
    s_nop 0
    buffer_load_dwordx4 v16, s[4:7], s85 offen offset:0 lds
    buffer_load_dwordx4 v17, s[4:7], s85 offen offset:1024 lds
    s_cmp_eq_u32 s22, 0
    s_cbranch_scc0 Lif_41
    s_cmp_eq_u32 s23, 0
    s_cbranch_scc1 Lwt_42
    buffer_store_dwordx4 v[124:127], v0, s[40:43], s47 offen offset:2048
Lwt_43:
Lif_41:
    s_waitcnt vmcnt(13)
    s_bitcmp1_b32 1, s22
    s_cbranch_scc1 Lvm_44
    s_waitcnt vmcnt(10)
Lvm_44:
    s_barrier
    s_bfe_u32 s27, s75, 262144
    s_lshl_b32 s84, s27, s77
    s_mul_i32 s85, s27, 393216
    s_add_u32 m0, s78, 16384
    s_bfe_u32 s37, s45, 262152
    buffer_load_dwordx4 v8, s[88:91], s84 offen offset:0 sc1 lds
    s_cmp_eq_u32 s87, 3
    s_cselect_b64 vcc, -1, 0
    s_mul_i32 s37, s37, 393216
    buffer_load_dwordx4 v9, s[88:91], s84 offen offset:1024 sc1 lds
    s_cbranch_vccz Lu_45
    v_add_f32_dpp v72, v72, v72 row_ror:4 row_mask:0xf bank_mask:0xf
Lu_45:
    s_add_u32 s37, s37, s46
    buffer_load_dwordx4 v10, s[88:91], s84 offen offset:2048 sc1 lds
    s_cbranch_vccz Lu_46
    v_add_f32_dpp v73, v73, v73 row_ror:4 row_mask:0xf bank_mask:0xf
Lu_46:
    s_buffer_load_dwordx2 s[38:39], s[4:7], s37 offset:60
    buffer_load_dwordx4 v11, s[88:91], s84 offen offset:3072 sc1 lds
    s_cbranch_vccz Lu_47
    v_add_f32_dpp v74, v74, v74 row_ror:4 row_mask:0xf bank_mask:0xf
Lu_47:
    s_add_u32 m0, s79, 73728
    s_buffer_load_dwordx2 s[38:39], s[4:7], s37 offset:2108
    buffer_load_dwordx4 v12, s[4:7], s85 offen offset:0 lds
    s_cbranch_vccz Lu_48
    v_add_f32_dpp v75, v75, v75 row_ror:4 row_mask:0xf bank_mask:0xf
Lu_48:
    s_buffer_load_dwordx2 s[38:39], s[4:7], s37 offset:4156
    buffer_load_dwordx4 v13, s[4:7], s85 offen offset:1024 lds
    s_cbranch_vccz Lu_49
    v_add_f32_dpp v72, v72, v72 row_ror:8 row_mask:0xf bank_mask:0xf
Lu_49:
    s_add_u32 m0, s79, 114688
    s_nop 0
    buffer_load_dwordx4 v14, s[4:7], s85 offen offset:0 lds
    s_cbranch_vccz Lu_50
    v_add_f32_dpp v73, v73, v73 row_ror:8 row_mask:0xf bank_mask:0xf
Lu_50:
    buffer_load_dwordx4 v15, s[4:7], s85 offen offset:1024 lds
    s_cbranch_vccz Lu_51
    v_add_f32_dpp v74, v74, v74 row_ror:8 row_mask:0xf bank_mask:0xf
Lu_51:
    s_add_u32 m0, s79, 122880
    s_nop 0
    buffer_load_dwordx4 v16, s[4:7], s85 offen offset:0 lds
    s_cbranch_vccz Lu_52
    v_add_f32_dpp v75, v75, v75 row_ror:8 row_mask:0xf bank_mask:0xf
Lu_52:
    buffer_load_dwordx4 v17, s[4:7], s85 offen offset:1024 lds
    s_cbranch_vccz Lu_53
    v_permlane32_swap_b32 v72, v74
Lu_53:
    s_cmp_eq_u32 s22, 0
    s_cbranch_scc0 Lif_71
    s_cmp_eq_u32 s23, 0
    s_cbranch_scc1 Lwt_72
    buffer_store_dwordx4 v[124:127], v0, s[40:43], s47 offen offset:3072
Lwt_73:
Lif_71:
    s_waitcnt vmcnt(12)
    s_bitcmp1_b32 1, s22
    s_cbranch_scc1 Lvm_74
    s_waitcnt vmcnt(10)
Lvm_74:
    s_barrier
    s_bfe_u32 s27, s75, 262148
    s_lshl_b32 s84, s27, s77
    s_mul_i32 s85, s27, 393216
    s_add_u32 m0, s78, 32768
    s_bfe_u32 s37, s45, 262156
    buffer_load_dwordx4 v8, s[88:91], s84 offen offset:0 sc1 lds
    s_cbranch_vccz Lu_54
    v_permlane32_swap_b32 v73, v75
Lu_54:
    s_mul_i32 s37, s37, 393216
    buffer_load_dwordx4 v9, s[88:91], s84 offen offset:1024 sc1 lds
    s_cbranch_vccz Lu_55
    v_pk_add_f32 v[72:73], v[72:73], v[74:75]
Lu_55:
    s_add_u32 s37, s37, s46
    buffer_load_dwordx4 v10, s[88:91], s84 offen offset:2048 sc1 lds
    s_cbranch_vccz Lu_56
    v_mov_b32 v74, v72
Lu_56:
    s_buffer_load_dwordx2 s[38:39], s[4:7], s37 offset:60
    buffer_load_dwordx4 v11, s[88:91], s84 offen offset:3072 sc1 lds
    s_cbranch_vccz Lu_57
    v_mov_b32 v75, v73
Lu_57:
    s_add_u32 m0, s79, 81920
    s_buffer_load_dwordx2 s[38:39], s[4:7], s37 offset:2108
    buffer_load_dwordx4 v12, s[4:7], s85 offen offset:0 lds
    s_cbranch_vccz Lu_58
    v_permlane16_swap_b32 v72, v74
Lu_58:
    s_buffer_load_dwordx2 s[38:39], s[4:7], s37 offset:4156
    buffer_load_dwordx4 v13, s[4:7], s85 offen offset:1024 lds
    s_cbranch_vccz Lu_59
    v_permlane16_swap_b32 v73, v75
Lu_59:
    s_add_u32 m0, s79, 49152
    s_nop 0
    buffer_load_dwordx4 v14, s[4:7], s85 offen offset:0 lds
    s_cbranch_vccz Lu_60
    v_pk_add_f32 v[72:73], v[72:73], v[74:75]
Lu_60:
    buffer_load_dwordx4 v15, s[4:7], s85 offen offset:1024 lds
    s_cbranch_vccz Lu_61
    v_mul_f32 v77, 0xba800000, v72
Lu_61:
    s_add_u32 m0, s79, 57344
    s_nop 0
    buffer_load_dwordx4 v16, s[4:7], s85 offen offset:0 lds
    s_cbranch_vccz Lu_62
    v_mul_f32 v73, 0x3a800000, v73
Lu_62:
    buffer_load_dwordx4 v17, s[4:7], s85 offen offset:1024 lds
    s_cbranch_vccz Lu_63
    v_fma_f32 v73, -v77, v77, v73
Lu_63:
    s_cmp_eq_u32 s22, 0
    s_cbranch_scc0 Lif_75
    s_cmp_eq_u32 s23, 0
    s_cbranch_scc1 Lwt_76
    buffer_store_dwordx4 v[128:131], v0, s[16:19], s47 offen offset:0
Lwt_77:
Lif_75:
    s_cmp_lt_u32 s22, 2
    s_cbranch_scc0 Lon_78
    v_mov_b32 v240, s24
    v_mov_b32 v241, s25
    s_mov_b64 exec, 1
    buffer_store_dwordx2 v[240:241], v201, s[12:15], 0 offen sc1
    s_mov_b64 exec, -1
Lon_78:
    s_cmp_eq_u32 s22, 1
    s_cbranch_scc0 Lif_79
    s_or_b32 s32, s2, s87
    s_cmp_lg_u32 s32, 0
    s_cbranch_scc1 Lif_79
    v_mov_b32 v242, 671744
    v_mov_b32 v240, s24
    v_mov_b32 v241, s25
    s_mov_b64 exec, 1
    buffer_store_dwordx2 v[240:241], v242, s[12:15], 0 offen sc1
    s_mov_b64 exec, -1
Lif_79:
    s_waitcnt vmcnt(13)
    s_bitcmp1_b32 1, s22
    s_cbranch_scc1 Lvm_80
    s_waitcnt vmcnt(11)
    s_bitcmp1_b32 2, s22
    s_cbranch_scc1 Lvm_80
    s_waitcnt vmcnt(10)
Lvm_80:
    s_barrier
    s_bfe_u32 s27, s75, 262152
    s_lshl_b32 s84, s27, s77
    s_mul_i32 s85, s27, 393216
    s_add_u32 m0, s78, 0
    s_bfe_u32 s37, s45, 262160
    buffer_load_dwordx4 v8, s[88:91], s84 offen offset:0 sc1 lds
    s_cbranch_vccz Lu_64
    v_max_f32 v73, 0, v73
Lu_64:
    s_mul_i32 s37, s37, 393216
    buffer_load_dwordx4 v9, s[88:91], s84 offen offset:1024 sc1 lds
    s_cbranch_vccz Lu_65
    v_add_f32 v73, 0x3727c5ac, v73
Lu_65:
    s_add_u32 s37, s37, s46
    buffer_load_dwordx4 v10, s[88:91], s84 offen offset:2048 sc1 lds
    s_cbranch_vccz Lu_66
    v_rsq_f32 v76, v73
Lu_66:
    s_buffer_load_dwordx2 s[38:39], s[4:7], s37 offset:60
    buffer_load_dwordx4 v11, s[88:91], s84 offen offset:3072 sc1 lds
    s_cbranch_vccz Lu_67
    v_mov_b32 v78, s24
Lu_67:
    s_add_u32 m0, s79, 65536
    s_buffer_load_dwordx2 s[38:39], s[4:7], s37 offset:2108
    buffer_load_dwordx4 v12, s[4:7], s85 offen offset:0 lds
    s_cbranch_vccz Lu_68
    v_mov_b32 v79, s25
Lu_68:
    s_buffer_load_dwordx2 s[38:39], s[4:7], s37 offset:4156
    buffer_load_dwordx4 v13, s[4:7], s85 offen offset:1024 lds
    s_cbranch_vccz Lu_69
    v_mul_f32 v77, v77, v76
Lu_69:
    s_add_u32 m0, s79, 98304
    s_lshl_b32 s27, s22, 4
    buffer_load_dwordx4 v14, s[4:7], s85 offen offset:0 lds
    s_cbranch_vccz Lu_70
    s_cmp_eq_u32 s23, 0
    s_cbranch_scc1 Lwt_715045
    buffer_store_dwordx4 v[76:79], v202, s[12:15], 0 offen
Lwt_715046:
Lu_70:
    s_add_u32 s27, s27, s20
    buffer_load_dwordx4 v15, s[4:7], s85 offen offset:1024 lds
    s_add_u32 m0, s79, 106496
    s_lshl_b32 s27, s27, 7
    buffer_load_dwordx4 v16, s[4:7], s85 offen offset:0 lds
    s_buffer_load_dwordx2 s[38:39], s[12:15], s27 offset:663612
    buffer_load_dwordx4 v17, s[4:7], s85 offen offset:1024 lds
    s_cmp_eq_u32 s22, 0
    s_cbranch_scc0 Lif_81
    s_cmp_eq_u32 s23, 0
    s_cbranch_scc1 Lwt_82
    buffer_store_dwordx4 v[128:131], v0, s[16:19], s47 offen offset:1024
Lwt_83:
Lif_81:
    s_waitcnt vmcnt(13)
    s_bitcmp1_b32 1, s22
    s_cbranch_scc1 Lvm_84
    s_waitcnt vmcnt(11)
    s_bitcmp1_b32 2, s22
    s_cbranch_scc1 Lvm_84
    s_waitcnt vmcnt(10)
Lvm_84:
    s_barrier
    s_bfe_u32 s27, s75, 262156
    s_lshl_b32 s84, s27, s77
    s_mul_i32 s85, s27, 393216
    s_add_u32 m0, s78, 16384
    s_lshr_b32 s28, s8, 7
    s_sub_u32 s28, 3, s28
    s_and_b32 s28, s28, 7
    buffer_load_dwordx4 v8, s[88:91], s84 offen offset:0 sc1 lds
    s_and_b32 s29, s21, 8
    s_add_u32 s28, s28, s29
    s_bfe_u32 s29, s2, 0x40003
    buffer_load_dwordx4 v9, s[88:91], s84 offen offset:1024 sc1 lds
    s_lshl_b32 s29, s29, 2
    s_add_u32 s29, s29, s87
    s_lshl_b32 s28, s28, 7
    buffer_load_dwordx4 v10, s[88:91], s84 offen offset:2048 sc1 lds
    s_lshl_b32 s29, s29, 15
    s_add_u32 s35, s28, s29
    s_buffer_load_dwordx2 s[38:39], s[8:11], s35 offset:60
    buffer_load_dwordx4 v11, s[88:91], s84 offen offset:3072 sc1 lds
    s_add_u32 m0, s79, 73728
    s_buffer_load_dwordx2 s[38:39], s[8:11], s35 offset:8252
    s_buffer_load_dwordx2 s[38:39], s[8:11], s35 offset:16444
    s_buffer_load_dwordx2 s[38:39], s[8:11], s35 offset:24636
    buffer_load_dwordx4 v12, s[4:7], s85 offen offset:0 lds
    s_bfe_u32 s37, s45, 262164
    s_mul_i32 s37, s37, 393216
    s_add_u32 s37, s37, s46
    buffer_load_dwordx4 v13, s[4:7], s85 offen offset:1024 lds
    s_add_u32 m0, s79, 114688
    s_buffer_load_dwordx2 s[38:39], s[4:7], s37 offset:60
    s_buffer_load_dwordx2 s[38:39], s[4:7], s37 offset:2108
    s_buffer_load_dwordx2 s[38:39], s[4:7], s37 offset:4156
    buffer_load_dwordx4 v14, s[4:7], s85 offen offset:0 lds
    buffer_load_dwordx4 v15, s[4:7], s85 offen offset:1024 lds
    s_add_u32 m0, s79, 122880
    s_nop 0
    buffer_load_dwordx4 v16, s[4:7], s85 offen offset:0 lds
    buffer_load_dwordx4 v17, s[4:7], s85 offen offset:1024 lds
    s_cmp_eq_u32 s22, 0
    s_cbranch_scc0 Lif_85
    s_cmp_eq_u32 s23, 0
    s_cbranch_scc1 Lwt_86
    buffer_store_dwordx4 v[128:131], v0, s[16:19], s47 offen offset:2048
Lwt_87:
Lif_85:
    s_waitcnt vmcnt(12)
    s_bitcmp1_b32 1, s22
    s_cbranch_scc1 Lvm_88
    s_waitcnt vmcnt(10)
Lvm_88:
    s_barrier
    s_cmp_lt_u32 s22, 2
    s_cbranch_scc0 Lon_89
    buffer_load_dwordx2 v[244:245], v200, s[12:15], 0 offen sc1
Lon_89:
    s_bfe_u32 s27, s75, 262160
    s_lshl_b32 s84, s27, s77
    s_mul_i32 s85, s27, 393216
    s_add_u32 m0, s78, 32768
    s_buffer_load_dwordx2 s[38:39], s[8:11], s35 offset:2108
    buffer_load_dwordx4 v8, s[88:91], s84 offen offset:0 sc1 lds
    s_buffer_load_dwordx2 s[38:39], s[8:11], s35 offset:10300
    buffer_load_dwordx4 v9, s[88:91], s84 offen offset:1024 sc1 lds
    s_buffer_load_dwordx2 s[38:39], s[8:11], s35 offset:18492
    buffer_load_dwordx4 v10, s[88:91], s84 offen offset:2048 sc1 lds
    s_buffer_load_dwordx2 s[38:39], s[8:11], s35 offset:26684
    buffer_load_dwordx4 v11, s[88:91], s84 offen offset:3072 sc1 lds
    s_add_u32 m0, s79, 81920
    s_bfe_u32 s37, s45, 262168
    buffer_load_dwordx4 v12, s[4:7], s85 offen offset:0 lds
    s_mul_i32 s37, s37, 393216
    buffer_load_dwordx4 v13, s[4:7], s85 offen offset:1024 lds
    s_add_u32 m0, s79, 49152
    s_add_u32 s37, s37, s46
    buffer_load_dwordx4 v14, s[4:7], s85 offen offset:0 lds
    s_buffer_load_dwordx2 s[38:39], s[4:7], s37 offset:60
    buffer_load_dwordx4 v15, s[4:7], s85 offen offset:1024 lds
    s_add_u32 m0, s79, 57344
    s_buffer_load_dwordx2 s[38:39], s[4:7], s37 offset:2108
    buffer_load_dwordx4 v16, s[4:7], s85 offen offset:0 lds
    s_buffer_load_dwordx2 s[38:39], s[4:7], s37 offset:4156
    buffer_load_dwordx4 v17, s[4:7], s85 offen offset:1024 lds
    s_cmp_eq_u32 s22, 0
    s_cbranch_scc0 Lif_90
    s_cmp_eq_u32 s23, 0
    s_cbranch_scc1 Lwt_91
    buffer_store_dwordx4 v[128:131], v0, s[16:19], s47 offen offset:3072
Lwt_92:
Lif_90:
    s_waitcnt vmcnt(13)
    s_bitcmp1_b32 1, s22
    s_cbranch_scc1 Lvm_93
    s_waitcnt vmcnt(11)
    s_bitcmp1_b32 2, s22
    s_cbranch_scc1 Lvm_93
    s_waitcnt vmcnt(10)
Lvm_93:
    s_barrier
    buffer_load_dwordx4 v[72:75], v189, s[12:15], 0 offen sc1
    s_bfe_u32 s27, s75, 262164
    s_lshl_b32 s84, s27, s77
    s_mul_i32 s85, s27, 393216
    s_add_u32 m0, s78, 0
    s_buffer_load_dwordx2 s[38:39], s[8:11], s35 offset:4156
    buffer_load_dwordx4 v8, s[88:91], s84 offen offset:0 sc1 lds
    s_cmp_lt_u32 s22, 2
    s_cbranch_scc0 Lif_94
    s_waitcnt vmcnt(13)
    s_bitcmp1_b32 1, s22
    s_cbranch_scc1 Lvm_95
    s_waitcnt vmcnt(12)
Lvm_95:
    v_xor_b32 v246, s24, v244
    v_xor_b32 v247, s25, v245
    v_lshrrev_b32 v247, 4, v247
    v_or_b32 v246, v246, v247
    v_cmp_ne_u32 vcc, 0, v246
    s_nop 0
    s_cbranch_vccnz Lpoll_96
Lok_97:
    buffer_load_dwordx4 v[88:91], v193, s[12:15], 0 offen offset:0 sc1
    buffer_load_dwordx4 v[92:95], v193, s[12:15], 0 offen offset:768 sc1
    buffer_load_dwordx4 v[96:99], v193, s[12:15], 0 offen offset:1536 sc1
    buffer_load_dwordx4 v[100:103], v193, s[12:15], 0 offen offset:2304 sc1
Lif_94:
    s_buffer_load_dwordx2 s[38:39], s[8:11], s35 offset:12348
    buffer_load_dwordx4 v9, s[88:91], s84 offen offset:1024 sc1 lds
    s_buffer_load_dwordx2 s[38:39], s[8:11], s35 offset:20540
    buffer_load_dwordx4 v10, s[88:91], s84 offen offset:2048 sc1 lds
    s_buffer_load_dwordx2 s[38:39], s[8:11], s35 offset:28732
    buffer_load_dwordx4 v11, s[88:91], s84 offen offset:3072 sc1 lds
    s_add_u32 m0, s79, 65536
    s_bfe_u32 s37, s45, 262172
    buffer_load_dwordx4 v12, s[4:7], s85 offen offset:0 lds
    s_mul_i32 s37, s37, 393216
    buffer_load_dwordx4 v13, s[4:7], s85 offen offset:1024 lds
    s_add_u32 m0, s79, 98304
    s_add_u32 s37, s37, s46
    buffer_load_dwordx4 v14, s[4:7], s85 offen offset:0 lds
    s_buffer_load_dwordx2 s[38:39], s[4:7], s37 offset:60
    buffer_load_dwordx4 v15, s[4:7], s85 offen offset:1024 lds
    s_add_u32 m0, s79, 106496
    s_buffer_load_dwordx2 s[38:39], s[4:7], s37 offset:2108
    buffer_load_dwordx4 v16, s[4:7], s85 offen offset:0 lds
    s_buffer_load_dwordx2 s[38:39], s[4:7], s37 offset:4156
    buffer_load_dwordx4 v17, s[4:7], s85 offen offset:1024 lds
    s_waitcnt vmcnt(16)
    s_bitcmp1_b32 1, s22
    s_cbranch_scc1 Lvm_98
    s_waitcnt vmcnt(15)
    s_bitcmp1_b32 2, s22
    s_cbranch_scc1 Lvm_98
    s_waitcnt vmcnt(11)
Lvm_98:
    s_barrier
    s_bfe_u32 s27, s75, 262168
    s_lshl_b32 s84, s27, s77
    s_mul_i32 s85, s27, 393216
    s_add_u32 m0, s78, 16384
    s_buffer_load_dwordx2 s[38:39], s[8:11], s35 offset:6204
    buffer_load_dwordx4 v8, s[88:91], s84 offen offset:0 sc1 lds
    s_waitcnt vmcnt(15)
    s_bitcmp1_b32 3, s22
    s_cbranch_scc1 Lvm_99
    s_waitcnt vmcnt(11)
Lvm_99:
    s_buffer_load_dwordx2 s[38:39], s[8:11], s35 offset:14396
    buffer_load_dwordx4 v9, s[88:91], s84 offen offset:1024 sc1 lds
    v_xor_b32 v76, s24, v74
    v_xor_b32 v77, s25, v75
    v_lshrrev_b32 v77, 4, v77
    v_or_b32 v76, v76, v77
    v_cmp_ne_u32 vcc, 0, v76
    s_nop 0
    s_cbranch_vccnz Lrt_100
Lok_101:
    s_buffer_load_dwordx2 s[38:39], s[8:11], s35 offset:22588
    buffer_load_dwordx4 v10, s[88:91], s84 offen offset:2048 sc1 lds
    v_add_u32 v76, 90112, v192
    v_add_u32 v77, v76, v192
    s_buffer_load_dwordx2 s[38:39], s[8:11], s35 offset:30780
    buffer_load_dwordx4 v11, s[88:91], s84 offen offset:3072 sc1 lds
    s_add_u32 m0, s79, 73728
    s_nop 0
    buffer_load_dwordx4 v12, s[4:7], s85 offen offset:0 lds
    buffer_load_dwordx4 v13, s[4:7], s85 offen offset:1024 lds
    s_add_u32 m0, s79, 114688
    s_nop 0
    buffer_load_dwordx4 v14, s[4:7], s85 offen offset:0 lds
    buffer_load_dwordx4 v15, s[4:7], s85 offen offset:1024 lds
    s_add_u32 m0, s79, 122880
    s_nop 0
    buffer_load_dwordx4 v16, s[4:7], s85 offen offset:0 lds
    buffer_load_dwordx4 v17, s[4:7], s85 offen offset:1024 lds
    s_waitcnt vmcnt(10)
    s_barrier
    s_bfe_u32 s27, s75, 262172
    s_lshl_b32 s84, s27, s77
    s_mul_i32 s85, s27, 393216
    s_add_u32 m0, s78, 32768
    s_nop 0
    buffer_load_dwordx4 v8, s[88:91], s84 offen offset:0 sc1 lds
    s_cmp_lt_u32 s22, 2
    s_cselect_b64 vcc, -1, 0
    buffer_load_dwordx4 v9, s[88:91], s84 offen offset:1024 sc1 lds
    s_cbranch_vccz Lu_103
    v_pk_add_f32 v[88:89], v[88:89], v[96:97]
    v_pk_add_f32 v[90:91], v[90:91], v[98:99]
Lu_103:
    buffer_load_dwordx4 v10, s[88:91], s84 offen offset:2048 sc1 lds
    s_cbranch_vccz Lu_104
    v_pk_add_f32 v[92:93], v[92:93], v[100:101]
    v_pk_add_f32 v[94:95], v[94:95], v[102:103]
Lu_104:
    buffer_load_dwordx4 v11, s[88:91], s84 offen offset:3072 sc1 lds
    s_cbranch_vccz Lu_105
    v_pk_add_f32 v[232:233], v[88:89], v[92:93]
    v_pk_add_f32 v[234:235], v[90:91], v[94:95]
Lu_105:
    s_add_u32 m0, s79, 81920
    s_nop 0
    buffer_load_dwordx4 v12, s[4:7], s85 offen offset:0 lds
    s_cbranch_vccz Lu_106
    v_mov_b32 v88, v232
    v_mov_b32 v89, v233
Lu_106:
    buffer_load_dwordx4 v13, s[4:7], s85 offen offset:1024 lds
    s_cbranch_vccz Lu_107
    v_mov_b32 v90, v234
    v_mov_b32 v91, v235
Lu_107:
    s_add_u32 m0, s79, 49152
    s_nop 0
    buffer_load_dwordx4 v14, s[4:7], s85 offen offset:0 lds
    s_cbranch_vccz Lu_108
    v_permlane16_swap_b32 v232, v88
    v_permlane16_swap_b32 v233, v89
Lu_108:
    buffer_load_dwordx4 v15, s[4:7], s85 offen offset:1024 lds
    s_cbranch_vccz Lu_109
    v_permlane16_swap_b32 v234, v90
    v_permlane16_swap_b32 v235, v91
Lu_109:
    s_add_u32 m0, s79, 57344
    s_nop 0
    buffer_load_dwordx4 v16, s[4:7], s85 offen offset:0 lds
    s_cbranch_vccz Lu_110
    v_pk_add_f32 v[232:233], v[232:233], v[88:89]
    v_pk_add_f32 v[234:235], v[234:235], v[90:91]
Lu_110:
    buffer_load_dwordx4 v17, s[4:7], s85 offen offset:1024 lds
    s_cbranch_vccz Lu_111
    v_mov_b32 v88, v232
    v_mov_b32 v89, v233
Lu_111:
    s_bitcmp1_b32 s22, 0
    s_cbranch_scc1 L_lB
    s_and_b32 s27, s20, 1
    s_lshl_b32 s27, s27, 2
    s_add_u32 s27, s27, s87
    s_lshl_b32 s27, s27, 13
    s_lshl_b32 s28, s21, 7
    s_add_u32 s27, s27, s28
    s_add_u32 s35, s27, s99
    s_waitcnt vmcnt(10)
    s_barrier
    v_lshrrev_b32 v120, 2, v1
    v_add_u32 v120, 0, v120
    v_and_b32 v121, 1, v120
    v_lshrrev_b32 v122, 2, v120
    v_lshl_add_u32 v121, v122, 1, v121
    v_bfe_u32 v120, v120, 1, 1
    v_lshl_add_u32 v120, v120, 4, v121
    v_lshlrev_b32 v120, 16, v120
    v_xor_b32 v120, s35, v120
    v_and_b32 v121, 3, v1
    v_lshl_add_u32 v120, v121, 11, v120
    s_mov_b32 exec_lo, 4294967295
    s_mov_b32 exec_hi, 0
    buffer_load_dword v255, v120, s[8:11], 0 offen
    s_mov_b64 exec, -1
    ds_write_b32 v76, v72
    ds_write_b32 v76, v73 offset:512
    ds_write_b64 v77, v[72:73] offset:1024
    s_cbranch_vccz Lu_112
    v_mov_b32 v90, v234
    v_mov_b32 v91, v235
Lu_112:
    s_cbranch_vccz Lu_113
    v_permlane32_swap_b32 v232, v88
    v_permlane32_swap_b32 v233, v89
Lu_113:
    s_cbranch_vccz Lu_114
    v_permlane32_swap_b32 v234, v90
    v_permlane32_swap_b32 v235, v91
Lu_114:
    s_cbranch_vccz Lu_115
    v_pk_add_f32 v[232:233], v[232:233], v[88:89]
    v_pk_add_f32 v[234:235], v[234:235], v[90:91]
Lu_115:
    v_add_u32 v78, 92160, v194
    v_mov_b32 v79, s23
    v_mov_b32 v80, 92928
    ds_write_b128 v78, v[232:235]
    ds_write_b32 v80, v79
    s_waitcnt lgkmcnt(0)
    s_cmp_eq_u32 s22, 0
    s_cbranch_scc0 Lif_117
    s_mov_b64 s[88:89], s[40:41]
    v_lshrrev_b32 v14, 3, v1
    v_and_b32 v15, 6, v14
    v_and_b32 v16, 7, v1
    v_xor_b32 v15, v15, v16
    s_lshl_b32 s27, s87, 4
    s_mul_i32 s27, s27, 6144
    s_lshl_b32 s28, s21, 7
    s_add_u32 s27, s27, s28
    v_mul_u32_u24 v14, 6144, v14
    v_lshlrev_b32 v15, 4, v15
    v_add3_u32 v12, v14, v15, s27
    v_add_u32 v13, 48128, v12
    v_add_u32 v14, 2048, v12
    v_add_u32 v15, 50176, v12
    v_add_u32 v16, 4096, v12
    v_add_u32 v17, 52224, v12
Lif_117:
    s_waitcnt vmcnt(1)
    s_barrier
    v_add_u32 v188, 8192, v188
    v_add_u32 v190, 8192, v190
    s_cmp_eq_u32 s87, 0
    s_cbranch_scc0 Lif_119
    v_mov_b32 v240, s24
    v_mov_b32 v241, s25
    s_mov_b64 exec, 1
    s_cmp_eq_u32 s23, 0
    s_cbranch_scc1 Lwt_120
    buffer_store_dwordx2 v[240:241], v190, s[12:15], 0 offen
Lwt_121:
    s_mov_b64 exec, -1
Lif_119:
    s_barrier
    v_swap_b32 v232, v236
    v_swap_b32 v233, v237
    v_swap_b32 v234, v238
    v_swap_b32 v235, v239
    v_and_b32 v224, 15, v1
    v_lshrrev_b32 v225, 4, v1
    v_lshlrev_b32 v225, 2, v225
    v_sub_u32 v224, v224, v225
    s_cmp_lt_u32 s20, 2
    s_cselect_b32 s27, 0, -1
    v_subrev_u32 v216, 0, v224
    v_subrev_u32 v217, 1, v224
    v_subrev_u32 v218, 2, v224
    v_subrev_u32 v219, 3, v224
    v_ashrrev_i32 v216, 31, v216
    v_ashrrev_i32 v217, 31, v217
    v_ashrrev_i32 v218, 31, v218
    v_ashrrev_i32 v219, 31, v219
    v_and_b32 v216, 4048155338, v216
    v_and_b32 v217, 4048155338, v217
    v_and_b32 v218, 4048155338, v218
    v_and_b32 v219, 4048155338, v219
    v_and_b32 v220, s27, v216
    v_and_b32 v221, s27, v217
    v_and_b32 v222, s27, v218
    v_and_b32 v223, s27, v219
    v_xor_b32 v220, 4048155338, v220
    v_xor_b32 v221, 4048155338, v221
    v_xor_b32 v222, 4048155338, v222
    v_xor_b32 v223, 4048155338, v223
    v_mov_b32 v224, 0
    v_mov_b32 v225, 0
    v_mov_b32 v226, 0
    v_mov_b32 v227, 0
    v_add_u32 v128, s54, v0
    s_lshl_b32 s28, s3, 11
    s_add_u32 s28, s28, 40960
    v_add_u32 v130, s28, v0
    v_subrev_u32 v129, 32768, v128
    v_add_u32 v4, 15360, v3
    v_add_u32 v5, 30720, v3
    v_add_u32 v211, 46080, v3
    s_setprio 1
    s_branch L_attA
L_lB:
    s_waitcnt vmcnt(10)
    s_barrier
    s_lshl_b32 m0, s87, 10
    s_add_u32 m0, m0, 0
    s_xor_b32 s36, s99, 0
    buffer_load_dwordx4 v20, s[8:11], s36 offen lds
    ds_write_b32 v76, v72
    s_lshl_b32 m0, s87, 10
    s_add_u32 m0, m0, 4096
    s_xor_b32 s36, s99, 65536
    buffer_load_dwordx4 v20, s[8:11], s36 offen lds
    ds_write_b32 v76, v73 offset:512
    s_lshl_b32 m0, s87, 10
    s_add_u32 m0, m0, 8192
    s_xor_b32 s36, s99, 1048576
    buffer_load_dwordx4 v20, s[8:11], s36 offen lds
    ds_write_b64 v77, v[72:73] offset:1024
    s_lshl_b32 m0, s87, 10
    s_add_u32 m0, m0, 12288
    s_xor_b32 s36, s99, 1114112
    buffer_load_dwordx4 v20, s[8:11], s36 offen lds
    s_cbranch_vccz Lv_112
    v_mov_b32 v90, v234
    v_mov_b32 v91, v235
Lv_112:
    s_lshl_b32 m0, s87, 10
    s_add_u32 m0, m0, 65536
    s_xor_b32 s36, s99, 262144
    buffer_load_dwordx4 v20, s[8:11], s36 offen lds
    s_cbranch_vccz Lv_113
    v_permlane32_swap_b32 v232, v88
    v_permlane32_swap_b32 v233, v89
Lv_113:
    s_lshl_b32 m0, s87, 10
    s_add_u32 m0, m0, 69632
    s_xor_b32 s36, s99, 327680
    buffer_load_dwordx4 v20, s[8:11], s36 offen lds
    s_cbranch_vccz Lv_114
    v_permlane32_swap_b32 v234, v90
    v_permlane32_swap_b32 v235, v91
Lv_114:
    s_lshl_b32 m0, s87, 10
    s_add_u32 m0, m0, 98304
    s_xor_b32 s36, s99, 524288
    buffer_load_dwordx4 v20, s[8:11], s36 offen lds
    s_cbranch_vccz Lv_115
    v_pk_add_f32 v[232:233], v[232:233], v[88:89]
    v_pk_add_f32 v[234:235], v[234:235], v[90:91]
Lv_115:
    s_lshl_b32 m0, s87, 10
    s_add_u32 m0, m0, 102400
    s_xor_b32 s36, s99, 589824
    buffer_load_dwordx4 v20, s[8:11], s36 offen lds
    v_add_u32 v78, 92160, v194
    v_mov_b32 v79, s23
    s_lshl_b32 m0, s87, 10
    s_add_u32 m0, m0, 106496
    s_xor_b32 s36, s99, 1572864
    buffer_load_dwordx4 v20, s[8:11], s36 offen lds
    v_mov_b32 v80, 92928
    s_lshl_b32 m0, s87, 10
    s_add_u32 m0, m0, 110592
    s_xor_b32 s36, s99, 1638400
    buffer_load_dwordx4 v20, s[8:11], s36 offen lds
    ds_write_b128 v78, v[232:235]
    ds_write_b32 v80, v79
    s_waitcnt lgkmcnt(0)
    s_waitcnt vmcnt(10)
    s_barrier
    v_add_u32 v188, 8192, v188
    v_add_u32 v190, 8192, v190
    s_cmp_eq_u32 s87, 0
    s_cbranch_scc0 Lif_124
    v_mov_b32 v240, s24
    v_mov_b32 v241, s25
    s_mov_b64 exec, 1
    s_cmp_eq_u32 s23, 0
    s_cbranch_scc1 Lwt_125
    buffer_store_dwordx2 v[240:241], v190, s[12:15], 0 offen
Lwt_126:
    s_mov_b64 exec, -1
Lif_124:
    s_lshl_b32 m0, s87, 10
    s_add_u32 m0, m0, 16384
    s_xor_b32 s36, s99, 131072
    buffer_load_dwordx4 v20, s[8:11], s36 offen lds
    s_lshl_b32 m0, s87, 10
    s_add_u32 m0, m0, 20480
    s_xor_b32 s36, s99, 196608
    buffer_load_dwordx4 v20, s[8:11], s36 offen lds
    s_lshl_b32 m0, s87, 10
    s_add_u32 m0, m0, 24576
    s_xor_b32 s36, s99, 1179648
    buffer_load_dwordx4 v20, s[8:11], s36 offen lds
    s_lshl_b32 m0, s87, 10
    s_add_u32 m0, m0, 28672
    s_xor_b32 s36, s99, 1245184
    buffer_load_dwordx4 v20, s[8:11], s36 offen lds
    s_lshl_b32 m0, s87, 10
    s_add_u32 m0, m0, 73728
    s_xor_b32 s36, s99, 1310720
    buffer_load_dwordx4 v20, s[8:11], s36 offen lds
    s_lshl_b32 m0, s87, 10
    s_add_u32 m0, m0, 77824
    s_xor_b32 s36, s99, 1376256
    buffer_load_dwordx4 v20, s[8:11], s36 offen lds
    s_lshl_b32 m0, s87, 10
    s_add_u32 m0, m0, 114688
    s_xor_b32 s36, s99, 655360
    buffer_load_dwordx4 v20, s[8:11], s36 offen lds
    s_lshl_b32 m0, s87, 10
    s_add_u32 m0, m0, 118784
    s_xor_b32 s36, s99, 720896
    buffer_load_dwordx4 v20, s[8:11], s36 offen lds
    s_lshl_b32 m0, s87, 10
    s_add_u32 m0, m0, 122880
    s_xor_b32 s36, s99, 1703936
    buffer_load_dwordx4 v20, s[8:11], s36 offen lds
    s_lshl_b32 m0, s87, 10
    s_add_u32 m0, m0, 126976
    s_xor_b32 s36, s99, 1769472
    buffer_load_dwordx4 v20, s[8:11], s36 offen lds
    s_barrier
    s_lshl_b32 m0, s87, 10
    s_add_u32 m0, m0, 81920
    s_xor_b32 s36, s99, 393216
    buffer_load_dwordx4 v20, s[8:11], s36 offen lds
    s_lshl_b32 m0, s87, 10
    s_add_u32 m0, m0, 86016
    s_xor_b32 s36, s99, 458752
    buffer_load_dwordx4 v20, s[8:11], s36 offen lds
    s_lshl_b32 m0, s87, 10
    s_add_u32 m0, m0, 131072
    s_xor_b32 s36, s99, 786432
    buffer_load_dwordx4 v20, s[8:11], s36 offen lds
    s_lshl_b32 m0, s87, 10
    s_add_u32 m0, m0, 135168
    s_xor_b32 s36, s99, 851968
    buffer_load_dwordx4 v20, s[8:11], s36 offen lds
    s_lshl_b32 m0, s87, 10
    s_add_u32 m0, m0, 139264
    s_xor_b32 s36, s99, 1835008
    buffer_load_dwordx4 v20, s[8:11], s36 offen lds
    s_lshl_b32 m0, s87, 10
    s_add_u32 m0, m0, 143360
    s_xor_b32 s36, s99, 1900544
    buffer_load_dwordx4 v20, s[8:11], s36 offen lds
    s_lshl_b32 m0, s87, 10
    s_add_u32 m0, m0, 147456
    s_xor_b32 s36, s99, 917504
    buffer_load_dwordx4 v20, s[8:11], s36 offen lds
    s_lshl_b32 m0, s87, 10
    s_add_u32 m0, m0, 151552
    s_xor_b32 s36, s99, 983040
    buffer_load_dwordx4 v20, s[8:11], s36 offen lds
    s_lshl_b32 m0, s87, 10
    s_add_u32 m0, m0, 155648
    s_xor_b32 s36, s99, 1966080
    buffer_load_dwordx4 v20, s[8:11], s36 offen lds
    s_lshl_b32 m0, s87, 10
    s_add_u32 m0, m0, 159744
    s_xor_b32 s36, s99, 2031616
    buffer_load_dwordx4 v20, s[8:11], s36 offen lds
    v_swap_b32 v232, v236
    v_swap_b32 v233, v237
    v_swap_b32 v234, v238
    v_swap_b32 v235, v239
    buffer_load_dwordx2 v[244:245], v188, s[12:15], 0 offen sc1
    s_lshl_b32 s27, s87, 10
    s_add_u32 s28, s27, 49152
    v_add_u32 v72, s28, v0
    v_mov_b32 v32, 0
    v_mov_b32 v33, 0
    v_mov_b32 v34, 0
    v_mov_b32 v35, 0
    s_cmp_lg_u32 s20, 0
    s_cbranch_scc0 Lif_127
    s_lshr_b32 s28, s22, 1
    s_lshl_b32 s28, s28, 4
    s_add_u32 s28, s28, s21
    s_lshl_b32 s28, s28, 12
    s_add_u32 s27, s27, s28
    s_add_u32 s27, s27, s97
    s_sub_u32 s27, s27, 1048576
    buffer_load_dwordx4 v[32:35], v0, s[12:15], s27 offen sc1
    s_waitcnt vmcnt(0)
    v_cmp_eq_u32 vcc, -1, v32
    s_nop 0
    s_cbranch_vccnz Lrt_128
Lok_129:
Lif_127:
    ds_write_b128 v72, v[32:35]
    s_waitcnt vmcnt(0)
    v_xor_b32 v246, s24, v244
    v_xor_b32 v247, s25, v245
    v_lshrrev_b32 v247, 4, v247
    v_or_b32 v246, v246, v247
    v_cmp_ne_u32 vcc, 0, v246
    s_nop 0
    s_cbranch_vccnz Lpoll_130
Lok_131:
    s_cmp_eq_u32 s23, 0
    s_cbranch_scc0 Lif_132
    buffer_inv sc1
    s_waitcnt vmcnt(0)
Lif_132:
    s_waitcnt lgkmcnt(0)
    s_barrier
    s_lshl_b32 m0, s87, 10
    s_add_u32 m0, m0, 90112
    s_xor_b32 s36, s99, 1441792
    buffer_load_dwordx4 v20, s[8:11], s36 offen lds
    s_lshl_b32 m0, s87, 10
    s_add_u32 m0, m0, 94208
    s_xor_b32 s36, s99, 1507328
    buffer_load_dwordx4 v20, s[8:11], s36 offen lds
    s_branch L_lnext
L_lnext:
    s_add_u32 s22, s22, 1
    s_setprio 0
    s_cmp_eq_u32 s22, 4
    s_cbranch_scc1 L_lfinal
    s_bitcmp1_b32 s22, 0
    s_cselect_b32 s8, s58, s52
    s_cselect_b32 s9, s59, s53
    s_cselect_b32 s4, s56, s50
    s_cselect_b32 s5, s57, s51
    s_cselect_b32 s92, s50, s56
    s_cselect_b32 s93, s51, s57
    s_xor_b64 s[88:89], s[88:89], s[16:17]
    s_xor_b64 s[16:17], s[88:89], s[16:17]
    s_xor_b64 s[88:89], s[88:89], s[16:17]
    s_waitcnt vmcnt(0)
    s_barrier
    v_add_u32 v188, 4294961152, v188
    v_add_u32 v190, 4294961152, v190
    v_add_u32 v189, 32768, v189
    v_add_u32 v202, 32768, v202
    s_mov_b32 s86, 99
    s_cmp_eq_u32 s22, 1
    s_cbranch_scc0 Lif_133
    v_add_u32 v200, 8192, v200
    v_add_u32 v201, 8192, v201
    v_add_u32 v193, 196608, v193
    v_add_u32 v199, 196608, v199
    s_and_b32 s86, s20, 1
    s_add_u32 s86, s86, 3
    s_add_u32 s27, s20, s22
    s_cmp_eq_u32 s27, 16
    s_cselect_b32 s86, 0, s86
    s_cmp_eq_u32 s86, 4
    s_mov_b32 s28, 81920
    s_cselect_b32 s28, 65536, s28
    s_mov_b32 s29, 40960
    s_cselect_b32 s29, 90112, s29
    s_mul_i32 s27, s87, 3
    s_add_u32 s27, s27, 0
    s_and_b32 s30, s27, 3
    s_lshl_b32 s30, s30, 5
    v_xor_b32 v196, s30, v2
    s_lshr_b32 s27, s27, 2
    s_lshl_b32 s30, s27, 13
    s_add_u32 s30, s30, s29
    s_cmp_eq_u32 s27, 0
    s_cselect_b32 s30, s28, s30
    v_add_u32 v196, s30, v196
    s_mul_i32 s27, s87, 3
    s_add_u32 s27, s27, 1
    s_and_b32 s30, s27, 3
    s_lshl_b32 s30, s30, 5
    v_xor_b32 v197, s30, v2
    s_lshr_b32 s27, s27, 2
    s_lshl_b32 s30, s27, 13
    s_add_u32 s30, s30, s29
    s_cmp_eq_u32 s27, 0
    s_cselect_b32 s30, s28, s30
    v_add_u32 v197, s30, v197
    s_mul_i32 s27, s87, 3
    s_add_u32 s27, s27, 2
    s_and_b32 s30, s27, 3
    s_lshl_b32 s30, s30, 5
    v_xor_b32 v198, s30, v2
    s_lshr_b32 s27, s27, 2
    s_lshl_b32 s30, s27, 13
    s_add_u32 s30, s30, s29
    s_cmp_eq_u32 s27, 0
    s_cselect_b32 s30, s28, s30
    v_add_u32 v198, s30, v198
    s_lshl_b32 s27, s20, 2
    s_add_u32 s27, s27, s87
    s_lshl_b32 s27, s27, 16
    v_add_u32 v8, s27, v0
    v_add_u32 v9, s27, v0
    v_add_u32 v10, s27, v0
    v_add_u32 v11, s27, v0
    s_mov_b64 s[74:75], s[100:101]
    s_mov_b32 s77, 12
Lif_133:
    s_lshr_b32 s27, s4, 7
    s_sub_u32 s27, 3, s27
    s_and_b32 s27, s27, 7
    s_and_b32 s28, s21, 8
    s_add_u32 s27, s27, s28
    s_bfe_u32 s28, s2, 0x40003
    s_lshl_b32 s28, s28, 2
    s_add_u32 s28, s28, s87
    s_mul_i32 s28, s28, 6144
    s_lshl_b32 s46, s27, 7
    s_add_u32 s46, s46, s28
    s_xor_b32 s27, s27, s21
    s_mul_i32 s27, s27, 0x11111111
    s_xor_b32 s44, s74, s27
    s_xor_b32 s45, s75, s27
    s_bfe_u32 s37, s44, 262144
    s_mul_i32 s37, s37, 393216
    s_add_u32 s37, s37, s46
    s_buffer_load_dwordx2 s[38:39], s[4:7], s37 offset:60
    s_buffer_load_dwordx2 s[38:39], s[4:7], s37 offset:2108
    s_buffer_load_dwordx2 s[38:39], s[4:7], s37 offset:4156
    s_bfe_u32 s37, s44, 262148
    s_mul_i32 s37, s37, 393216
    s_add_u32 s37, s37, s46
    s_buffer_load_dwordx2 s[38:39], s[4:7], s37 offset:60
    s_buffer_load_dwordx2 s[38:39], s[4:7], s37 offset:2108
    s_buffer_load_dwordx2 s[38:39], s[4:7], s37 offset:4156
    s_bfe_u32 s37, s44, 262152
    s_mul_i32 s37, s37, 393216
    s_add_u32 s37, s37, s46
    s_buffer_load_dwordx2 s[38:39], s[4:7], s37 offset:60
    s_buffer_load_dwordx2 s[38:39], s[4:7], s37 offset:2108
    s_buffer_load_dwordx2 s[38:39], s[4:7], s37 offset:4156
    s_bfe_u32 s37, s44, 262156
    s_mul_i32 s37, s37, 393216
    s_add_u32 s37, s37, s46
    s_buffer_load_dwordx2 s[38:39], s[4:7], s37 offset:60
    s_buffer_load_dwordx2 s[38:39], s[4:7], s37 offset:2108
    s_buffer_load_dwordx2 s[38:39], s[4:7], s37 offset:4156
    s_bfe_u32 s37, s44, 262160
    s_mul_i32 s37, s37, 393216
    s_add_u32 s37, s37, s46
    s_buffer_load_dwordx2 s[38:39], s[4:7], s37 offset:60
    s_buffer_load_dwordx2 s[38:39], s[4:7], s37 offset:2108
    s_buffer_load_dwordx2 s[38:39], s[4:7], s37 offset:4156
    v_add_u32 v72, s79, v0
    v_add_u32 v73, 65536, v72
    s_barrier
    s_bfe_u32 s27, s74, 262144
    s_mul_i32 s85, s27, 393216
    s_add_u32 m0, s79, 81920
    s_nop 0
    buffer_load_dwordx4 v12, s[4:7], s85 offen offset:0 lds
    buffer_load_dwordx4 v13, s[4:7], s85 offen offset:1024 lds
    s_add_u32 m0, s79, 49152
    s_nop 0
    buffer_load_dwordx4 v14, s[4:7], s85 offen offset:0 lds
    buffer_load_dwordx4 v15, s[4:7], s85 offen offset:1024 lds
    s_add_u32 m0, s79, 57344
    s_nop 0
    buffer_load_dwordx4 v16, s[4:7], s85 offen offset:0 lds
    buffer_load_dwordx4 v17, s[4:7], s85 offen offset:1024 lds
    s_bfe_u32 s27, s74, 262148
    s_mul_i32 s85, s27, 393216
    s_add_u32 m0, s79, 65536
    s_nop 0
    buffer_load_dwordx4 v12, s[4:7], s85 offen offset:0 lds
    buffer_load_dwordx4 v13, s[4:7], s85 offen offset:1024 lds
    s_add_u32 m0, s79, 98304
    s_nop 0
    buffer_load_dwordx4 v14, s[4:7], s85 offen offset:0 lds
    buffer_load_dwordx4 v15, s[4:7], s85 offen offset:1024 lds
    s_add_u32 m0, s79, 106496
    s_nop 0
    buffer_load_dwordx4 v16, s[4:7], s85 offen offset:0 lds
    buffer_load_dwordx4 v17, s[4:7], s85 offen offset:1024 lds
    s_waitcnt vmcnt(6)
    s_barrier
    s_branch L_lbody
L_lfinal:
    s_waitcnt vmcnt(0)
    s_barrier
    s_lshr_b32 s27, s2, 3
    s_add_u32 s27, s27, s87
    s_cmp_eq_u32 s27, 0
    s_cbranch_scc0 Lif_134
    buffer_wbl2 sc1
Lif_134:
    s_barrier
    s_branch L_out
L_colsum:
    ds_read_b64_tr_b16 v[40:41], v196 offset:0
    ds_read_b64_tr_b16 v[42:43], v196 offset:2048
    ds_read_b64_tr_b16 v[44:45], v196 offset:4096
    ds_read_b64_tr_b16 v[46:47], v196 offset:6144
    ds_read_b64_tr_b16 v[48:49], v197 offset:0
    ds_read_b64_tr_b16 v[50:51], v197 offset:2048
    ds_read_b64_tr_b16 v[52:53], v197 offset:4096
    ds_read_b64_tr_b16 v[54:55], v197 offset:6144
    ds_read_b64_tr_b16 v[56:57], v198 offset:0
    ds_read_b64_tr_b16 v[58:59], v198 offset:2048
    ds_read_b64_tr_b16 v[60:61], v198 offset:4096
    ds_read_b64_tr_b16 v[62:63], v198 offset:6144
    v_and_b32 v88, 15, v1
    v_cmp_eq_u32 vcc, 0, v88
    v_mov_b32 v89, 0x3f803f80
    s_nop 0
    v_cndmask_b32 v88, 0, v89, vcc
    v_mov_b32 v89, v88
    v_mov_b32 v90, v88
    v_mov_b32 v91, v88
    v_and_b32 v92, 15, v1
    v_cmp_eq_u32 vcc, 4, v92
    v_mov_b32 v93, 0x3f803f80
    s_nop 0
    v_cndmask_b32 v92, 0, v93, vcc
    v_mov_b32 v93, v92
    v_mov_b32 v94, v92
    v_mov_b32 v95, v92
    v_and_b32 v96, 15, v1
    v_cmp_eq_u32 vcc, 8, v96
    v_mov_b32 v97, 0x3f803f80
    s_nop 0
    v_cndmask_b32 v96, 0, v97, vcc
    v_mov_b32 v97, v96
    v_mov_b32 v98, v96
    v_mov_b32 v99, v96
    s_waitcnt lgkmcnt(0)
    v_mfma_f32_16x16x32_bf16 v[100:103], v[88:91], v[40:43], 0
    v_mfma_f32_16x16x32_bf16 v[100:103], v[88:91], v[44:47], v[100:103]
    v_mfma_f32_16x16x32_bf16 v[100:103], v[92:95], v[48:51], v[100:103]
    v_mfma_f32_16x16x32_bf16 v[100:103], v[92:95], v[52:55], v[100:103]
    v_mfma_f32_16x16x32_bf16 v[100:103], v[96:99], v[56:59], v[100:103]
    v_mfma_f32_16x16x32_bf16 v[100:103], v[96:99], v[60:63], v[100:103]
    s_nop 7
    buffer_store_dword v100, v199, s[12:15], 0 offen sc1
    s_setpc_b64 s[72:73]
L_cstart:
    s_cmp_eq_u32 s3, 3
    s_cbranch_scc0 Lif_135
    s_getpc_b64 s[40:41]
L_pc:
    s_sub_u32 s40, s40, L_pc - interleave_layers__sliding_block__sliding_local_dilated__prompt_kernel
    s_subb_u32 s41, s41, 0
    s_lshr_b32 s27, s2, 3
    s_mul_i32 s27, s27, 1664
    v_lshlrev_b32 v28, 7, v1
    v_add_u32 v28, s27, v28
    s_mov_b32 s27, L_last - interleave_layers__sliding_block__sliding_local_dilated__prompt_kernel
    v_min_u32 v28, s27, v28
    v_mov_b32 v29, s41
    v_add_co_u32 v28, vcc, s40, v28
    s_nop 1
    v_addc_co_u32 v29, vcc, 0, v29, vcc
    s_mov_b64 exec, 8191
    global_load_dword v255, v[28:29], off
    s_mov_b64 exec, -1
Lif_135:
    s_lshl_b32 s27, s20, 2
    s_add_u32 s27, s27, s3
    s_lshl_b32 s27, s27, 16
    s_lshl_b32 s28, s21, 7
    s_add_u32 s27, s27, s28
    v_and_b32 v24, 15, v1
    v_lshlrev_b32 v24, 11, v24
    v_bfe_u32 v25, v1, 4, 1
    v_lshl_add_u32 v24, v25, 5, v24
    v_lshrrev_b32 v25, 5, v1
    v_lshlrev_b32 v25, 4, v25
    v_add3_u32 v24, v24, v25, s27
    v_add_u32 v25, 32768, v24
    s_waitcnt lgkmcnt(0)
    s_mov_b32 s88, s48
    s_mov_b32 s89, s49
    s_mov_b32 s90, 4194304
    s_mov_b32 s91, 0x00020000
    buffer_load_dwordx4 v[8:11], v24, s[88:91], 0 offen offset:0
    buffer_load_dwordx4 v[12:15], v24, s[88:91], 0 offen offset:64
    buffer_load_dwordx4 v[16:19], v25, s[88:91], 0 offen offset:0
    buffer_load_dwordx4 v[20:23], v25, s[88:91], 0 offen offset:64
    s_mov_b32 s12, s64
    s_mov_b32 s13, s65
    s_mov_b32 s14, 75497472
    s_mov_b32 s15, 0x00020000
    v_mov_b32 v28, 671744
    buffer_load_dwordx2 v[26:27], v28, s[12:15], 0 offen sc1
    s_mov_b32 s12, s64
    s_mov_b32 s13, s65
    s_mov_b32 s14, 75497472
    s_mov_b32 s15, 0x00020000
    s_mov_b32 s8, s52
    s_mov_b32 s9, s53
    s_mov_b32 s10, 2097152
    s_mov_b32 s11, 0x00020000
    s_mov_b32 s40, s60
    s_mov_b32 s41, s61
    s_mov_b32 s42, 4194304
    s_mov_b32 s43, 0x00020000
    s_add_u32 s16, s64, 18874368
    s_addc_u32 s17, s65, 0
    s_mov_b32 s18, 4194304
    s_mov_b32 s19, 0x00020000
    s_mov_b32 s92, s56
    s_mov_b32 s93, s57
    s_mov_b32 s94, 6291456
    s_mov_b32 s95, 0x00020000
    s_mov_b32 s23, 0
    v_mov_b32 v6, 0
    v_mov_b32 v7, 0
    v_mov_b32 v206, 1073741824
    s_lshl_b32 s97, s20, 20
    s_add_u32 s97, s97, 2097152
    s_lshl_b32 s99, s21, 17
    v_bfe_u32 v28, v1, 2, 3
    v_bfe_u32 v29, v1, 1, 1
    v_and_b32 v30, 6, v28
    v_xor_b32 v29, v29, v30
    v_lshlrev_b32 v29, 4, v29
    v_lshlrev_b32 v28, 7, v28
    v_and_b32 v30, 1, v1
    v_lshlrev_b32 v30, 3, v30
    v_add3_u32 v28, v28, v29, v30
    v_lshrrev_b32 v29, 5, v1
    v_lshl_add_u32 v2, v29, 10, v28
    v_lshrrev_b32 v28, 3, v1
    v_and_b32 v29, 6, v28
    v_and_b32 v30, 7, v1
    v_xor_b32 v29, v29, v30
    v_lshlrev_b32 v29, 4, v29
    v_lshlrev_b32 v28, 11, v28
    s_lshl_b32 s27, s21, 7
    v_add3_u32 v3, v28, v29, s27
    v_and_b32 v212, 3, v1
    v_cmp_eq_u32 vcc, 0, v212
    v_mov_b32 v213, 0x3f803f80
    s_nop 0
    v_cndmask_b32 v212, 0, v213, vcc
    v_mov_b32 v213, v212
    v_mov_b32 v214, v212
    v_mov_b32 v215, v212
    s_lshl_b32 s27, s3, 2
    s_lshr_b32 s71, 0x11332200, s27
    s_and_b32 s71, s71, 3
    s_and_b32 s27, s3, 1
    s_lshl_b32 s28, s71, 1
    s_add_u32 s28, s28, s27
    s_and_b32 s98, s28, 3
    s_lshl_b32 s28, s28, 12
    s_add_u32 s54, s28, 98304
    s_lshl_b32 s28, s21, 1
    s_add_u32 s28, s28, s27
    s_lshl_b32 s28, s28, 11
    s_lshl_b32 s29, s71, 16
    s_add_u32 s28, s28, s29
    s_lshl_b32 s29, s20, 18
    s_add_u32 s62, s28, s29
    s_lshr_b32 s28, s71, 1
    s_add_u32 s28, s28, 1
    s_cmp_lt_u32 s20, s28
    s_cselect_b32 s28, 0, s28
    s_lshl_b32 s28, s28, 20
    s_sub_u32 s28, s97, s28
    s_lshl_b32 s29, s21, 3
    s_xor_b32 s27, s98, 2
    s_add_u32 s27, s27, s29
    s_lshl_b32 s27, s27, 12
    s_add_u32 s27, s27, s28
    s_add_u32 s55, s27, 524288
    s_lshl_b32 s28, s98, 3
    s_lshr_b32 s27, 302125056, s28
    s_and_b32 s27, s27, 31
    s_lshl_b32 s27, s27, 16
    s_xor_b32 s76, s99, s27
    s_mov_b32 s4, s50
    s_mov_b32 s5, s51
    s_mov_b32 s6, 6291456
    s_mov_b32 s7, 0x00020000
    s_lshr_b32 s27, s3, 1
    s_lshl_b32 s27, s27, 13
    v_and_b32 v200, 15, v1
    v_bfe_u32 v201, v1, 1, 3
    v_lshrrev_b32 v202, 4, v1
    v_xor_b32 v201, v201, v202
    v_lshlrev_b32 v200, 7, v200
    v_lshlrev_b32 v201, 4, v201
    v_add3_u32 v200, v200, v201, s27
    v_xor_b32 v201, 64, v200
    s_and_b32 s27, s3, 1
    s_lshl_b32 s28, s27, 6
    v_xor_b32 v202, s28, v2
    v_xor_b32 v203, 32, v202
    v_add_u32 v204, 98304, v202
    v_add_u32 v205, 98304, v203
    v_add_u32 v202, 49152, v202
    v_add_u32 v203, 49152, v203
    v_and_b32 v24, 15, v1
    v_lshrrev_b32 v25, 4, v1
    s_lshl_b32 s27, s27, 7
    s_add_u32 s27, s27, 92160
    v_lshl_add_u32 v209, v25, 4, s27
    v_lshl_add_u32 v210, v24, 2, s27
    s_lshr_b32 s27, s3, 1
    s_lshl_b32 s27, s27, 8
    s_add_u32 s28, s27, 90112
    v_lshl_add_u32 v208, v25, 4, s28
    s_add_u32 s28, s28, s27
    v_lshl_add_u32 v207, v24, 3, s28
    s_lshl_b32 s27, s20, 2
    s_add_u32 s27, s27, s3
    s_lshl_b32 s27, s27, 4
    s_add_u32 s27, s27, s21
    s_lshl_b32 s0, s27, 12
    s_lshr_b32 s27, s27, 4
    s_lshl_b32 s1, s27, 16
    s_lshl_b32 s27, s27, 12
    s_lshl_b32 s28, s21, 6
    s_add_u32 s27, s27, s28
    v_and_b32 v28, 7, v24
    v_lshl_add_u32 v206, v28, 3, s27
    v_lshrrev_b32 v28, 3, v24
    v_lshl_add_u32 v206, v28, 10, v206
    v_lshrrev_b32 v24, 2, v24
    v_cmp_eq_u32 vcc, v24, v25
    v_mov_b32 v24, 1073741824
    s_nop 0
    v_cndmask_b32 v206, v24, v206, vcc
    s_mov_b32 s84, 0xaaaaaaaa
    s_mov_b32 s86, 0xcccccccc
    s_mov_b32 s85, 0xaaaaaaaa
    s_mov_b32 s87, 0xcccccccc
    s_sub_u32 s27, s54, 98304
    s_add_u32 s48, s27, 131072
    s_lshl_b32 s28, s21, 15
    s_add_u32 s27, s27, s28
    s_add_u32 s27, s27, s97
    s_add_u32 s63, s27, 524288
    s_lshl_b32 s27, s21, 1
    s_add_u32 s27, s27, s3
    s_sub_u32 s27, s27, 2
    s_lshl_b32 s27, s27, 11
    s_add_u32 s27, s27, s97
    s_cmp_ge_u32 s3, 2
    s_cselect_b32 s49, s27, 1073741824
    v_and_b32 v224, 15, v1
    v_lshrrev_b32 v225, 4, v1
    v_lshlrev_b32 v225, 2, v225
    v_sub_u32 v224, v224, v225
    s_cmp_lt_u32 s20, 2
    s_cselect_b32 s27, 0, -1
    v_subrev_u32 v216, 0, v224
    v_subrev_u32 v217, 1, v224
    v_subrev_u32 v218, 2, v224
    v_subrev_u32 v219, 3, v224
    v_ashrrev_i32 v216, 31, v216
    v_ashrrev_i32 v217, 31, v217
    v_ashrrev_i32 v218, 31, v218
    v_ashrrev_i32 v219, 31, v219
    v_and_b32 v216, 4048155338, v216
    v_and_b32 v217, 4048155338, v217
    v_and_b32 v218, 4048155338, v218
    v_and_b32 v219, 4048155338, v219
    v_and_b32 v220, s27, v216
    v_and_b32 v221, s27, v217
    v_and_b32 v222, s27, v218
    v_and_b32 v223, s27, v219
    v_xor_b32 v220, 4048155338, v220
    v_xor_b32 v221, 4048155338, v221
    v_xor_b32 v222, 4048155338, v222
    v_xor_b32 v223, 4048155338, v223
    v_mov_b32 v224, 0
    v_mov_b32 v225, 0
    v_mov_b32 v226, 0
    v_mov_b32 v227, 0
    s_mov_b64 s[88:89], s[16:17]
    s_mov_b64 s[16:17], s[40:41]
    s_waitcnt vmcnt(0)
    v_readfirstlane_b32 s24, v26
    v_readfirstlane_b32 s25, v27
    s_add_u32 s24, s24, 1
    s_add_u32 s25, s25, 16
    s_and_b32 s25, s25, 0xfffffff0
    s_getreg_b32 s27, hwreg(HW_REG_XCC_ID, 0, 4)
    s_or_b32 s25, s25, s27
    v_permlane16_swap_b32 v8, v10
    v_permlane16_swap_b32 v9, v11
    v_permlane16_swap_b32 v12, v14
    v_permlane16_swap_b32 v13, v15
    v_permlane16_swap_b32 v16, v18
    v_permlane16_swap_b32 v17, v19
    v_permlane16_swap_b32 v20, v22
    v_permlane16_swap_b32 v21, v23
    v_mfma_f32_16x16x32_bf16 v[232:235], v[8:11], v[8:11], 0
    v_mfma_f32_16x16x32_bf16 v[236:239], v[212:215], v[8:11], 0
    v_mfma_f32_16x16x32_bf16 v[240:243], v[16:19], v[16:19], 0
    v_mfma_f32_16x16x32_bf16 v[244:247], v[212:215], v[16:19], 0
    v_mfma_f32_16x16x32_bf16 v[232:235], v[12:15], v[12:15], v[232:235]
    v_mfma_f32_16x16x32_bf16 v[236:239], v[212:215], v[12:15], v[236:239]
    v_mfma_f32_16x16x32_bf16 v[240:243], v[20:23], v[20:23], v[240:243]
    v_mfma_f32_16x16x32_bf16 v[244:247], v[212:215], v[20:23], v[244:247]
    s_nop 4
    v_cndmask_b32 v232, v232, v233, s[84:85]
    v_cndmask_b32 v234, v234, v235, s[84:85]
    v_cndmask_b32 v240, v240, v241, s[84:85]
    v_cndmask_b32 v242, v242, v243, s[84:85]
    v_cndmask_b32 v237, v232, v234, s[86:87]
    v_cndmask_b32 v245, v240, v242, s[86:87]
    s_cmp_eq_u32 s23, 0
    s_cbranch_scc1 Lwt_136
    buffer_store_dwordx2 v[236:237], v206, s[12:15], 0 offen offset:0
    buffer_store_dwordx2 v[244:245], v206, s[12:15], 0 offen offset:2048
Lwt_137:
    v_or_b32 v206, 2147483648, v206
    s_waitcnt vmcnt(0)
    s_branch L_cfirst
L_centry:
    v_mfma_f32_16x16x32_bf16 v[232:235], v[8:11], v[8:11], 0
    v_mfma_f32_16x16x32_bf16 v[236:239], v[212:215], v[8:11], 0
    v_mfma_f32_16x16x32_bf16 v[240:243], v[16:19], v[16:19], 0
    v_mfma_f32_16x16x32_bf16 v[244:247], v[212:215], v[16:19], 0
    v_mfma_f32_16x16x32_bf16 v[232:235], v[12:15], v[12:15], v[232:235]
    v_mfma_f32_16x16x32_bf16 v[236:239], v[212:215], v[12:15], v[236:239]
    v_mfma_f32_16x16x32_bf16 v[240:243], v[20:23], v[20:23], v[240:243]
    v_mfma_f32_16x16x32_bf16 v[244:247], v[212:215], v[20:23], v[244:247]
    s_waitcnt lgkmcnt(0)
L_cfirst:
    s_barrier
    ds_read_b128 v[120:123], v200 offset:32768
    ds_read_b64_tr_b16 v[136:137], v202 offset:32768
    ds_read_b64_tr_b16 v[138:139], v202 offset:34816
    ds_read_b128 v[124:127], v200 offset:34816
    ds_read_b128 v[128:131], v200 offset:36864
    ds_read_b128 v[132:135], v200 offset:38912
    ds_read_b64_tr_b16 v[140:141], v203 offset:32768
    ds_read_b64_tr_b16 v[142:143], v203 offset:34816
    ds_read_b64_tr_b16 v[144:145], v202 offset:0
    ds_read_b64_tr_b16 v[146:147], v202 offset:2048
    ds_read_b64_tr_b16 v[148:149], v203 offset:0
    ds_read_b64_tr_b16 v[150:151], v203 offset:2048
    ds_read_b64_tr_b16 v[152:153], v202 offset:8192
    ds_read_b64_tr_b16 v[154:155], v202 offset:10240
    ds_read_b64_tr_b16 v[156:157], v203 offset:8192
    ds_read_b64_tr_b16 v[158:159], v203 offset:10240
    v_cndmask_b32 v232, v232, v233, s[84:85]
    v_cndmask_b32 v234, v234, v235, s[84:85]
    v_cndmask_b32 v240, v240, v241, s[84:85]
    v_cndmask_b32 v242, v242, v243, s[84:85]
    v_cndmask_b32 v237, v232, v234, s[86:87]
    v_cndmask_b32 v245, v240, v242, s[86:87]
    s_cmp_eq_u32 s23, 0
    s_cbranch_scc1 Lwt_138
    buffer_store_dwordx2 v[236:237], v206, s[12:15], 0 offen offset:0
    buffer_store_dwordx2 v[244:245], v206, s[12:15], 0 offen offset:2048
Lwt_139:
    s_waitcnt lgkmcnt(13)
    v_mfma_f32_16x16x32_bf16 v[24:27], v[136:139], v[120:123], 0
    ds_read_b128 v[160:163], v201 offset:32768
    s_waitcnt lgkmcnt(13)
    v_mfma_f32_16x16x32_bf16 v[28:31], v[136:139], v[124:127], 0
    ds_read_b64_tr_b16 v[176:177], v202 offset:36864
    s_waitcnt lgkmcnt(13)
    v_mfma_f32_16x16x32_bf16 v[32:35], v[136:139], v[128:131], 0
    ds_read_b64_tr_b16 v[178:179], v202 offset:38912
    s_waitcnt lgkmcnt(13)
    v_mfma_f32_16x16x32_bf16 v[36:39], v[136:139], v[132:135], 0
    ds_read_b128 v[164:167], v201 offset:34816
    s_waitcnt lgkmcnt(12)
    v_mfma_f32_16x16x32_bf16 v[52:55], v[140:143], v[132:135], 0
    ds_read_b128 v[168:171], v201 offset:36864
    v_mfma_f32_16x16x32_bf16 v[48:51], v[140:143], v[128:131], 0
    ds_read_b128 v[172:175], v201 offset:38912
    v_mfma_f32_16x16x32_bf16 v[44:47], v[140:143], v[124:127], 0
    ds_read_b64_tr_b16 v[180:181], v203 offset:36864
    v_mfma_f32_16x16x32_bf16 v[40:43], v[140:143], v[120:123], 0
    ds_read_b64_tr_b16 v[182:183], v203 offset:38912
    s_waitcnt lgkmcnt(5)
    v_mfma_f32_16x16x32_bf16 v[56:59], v[144:147], v[120:123], 0
    ds_read_b64_tr_b16 v[184:185], v202 offset:4096
    v_mfma_f32_16x16x32_bf16 v[60:63], v[144:147], v[124:127], 0
    ds_read_b64_tr_b16 v[186:187], v202 offset:6144
    v_mfma_f32_16x16x32_bf16 v[64:67], v[144:147], v[128:131], 0
    ds_read_b64_tr_b16 v[188:189], v203 offset:4096
    v_mfma_f32_16x16x32_bf16 v[68:71], v[144:147], v[132:135], 0
    ds_read_b64_tr_b16 v[190:191], v203 offset:6144
    v_mfma_f32_16x16x32_bf16 v[84:87], v[148:151], v[132:135], 0
    ds_read_b64_tr_b16 v[192:193], v202 offset:12288
    v_mfma_f32_16x16x32_bf16 v[80:83], v[148:151], v[128:131], 0
    ds_read_b64_tr_b16 v[194:195], v202 offset:14336
    v_mfma_f32_16x16x32_bf16 v[76:79], v[148:151], v[124:127], 0
    ds_read_b64_tr_b16 v[196:197], v203 offset:12288
    v_mfma_f32_16x16x32_bf16 v[72:75], v[148:151], v[120:123], 0
    ds_read_b64_tr_b16 v[198:199], v203 offset:14336
    v_mfma_f32_16x16x32_bf16 v[88:91], v[120:123], v[152:155], 0
    s_mov_b32 s96, 0
    v_mfma_f32_16x16x32_bf16 v[92:95], v[124:127], v[152:155], 0
    s_xor_b64 s[88:89], s[88:89], s[16:17]
    v_mfma_f32_16x16x32_bf16 v[96:99], v[128:131], v[152:155], 0
    s_xor_b64 s[16:17], s[88:89], s[16:17]
    v_mfma_f32_16x16x32_bf16 v[100:103], v[132:135], v[152:155], 0
    s_xor_b64 s[88:89], s[88:89], s[16:17]
    v_mfma_f32_16x16x32_bf16 v[116:119], v[132:135], v[156:159], 0
    v_mfma_f32_16x16x32_bf16 v[112:115], v[128:131], v[156:159], 0
    v_mfma_f32_16x16x32_bf16 v[108:111], v[124:127], v[156:159], 0
    v_mfma_f32_16x16x32_bf16 v[104:107], v[120:123], v[156:159], 0
    v_mfma_f32_16x16x32_bf16 v[24:27], v[176:179], v[160:163], v[24:27]
    s_waitcnt lgkmcnt(0)
    v_mfma_f32_16x16x32_bf16 v[28:31], v[176:179], v[164:167], v[28:31]
    v_mfma_f32_16x16x32_bf16 v[32:35], v[176:179], v[168:171], v[32:35]
    v_mfma_f32_16x16x32_bf16 v[36:39], v[176:179], v[172:175], v[36:39]
    v_mfma_f32_16x16x32_bf16 v[52:55], v[180:183], v[172:175], v[52:55]
    v_mfma_f32_16x16x32_bf16 v[48:51], v[180:183], v[168:171], v[48:51]
    v_mfma_f32_16x16x32_bf16 v[44:47], v[180:183], v[164:167], v[44:47]
    v_mfma_f32_16x16x32_bf16 v[40:43], v[180:183], v[160:163], v[40:43]
    s_waitcnt vmcnt(0)
    s_barrier
    v_mfma_f32_16x16x32_bf16 v[56:59], v[184:187], v[160:163], v[56:59]
    ds_read_b128 v[120:123], v200 offset:0
    ds_read_b64_tr_b16 v[136:137], v202 offset:16384
    v_mfma_f32_16x16x32_bf16 v[60:63], v[184:187], v[164:167], v[60:63]
    ds_read_b64_tr_b16 v[138:139], v202 offset:18432
    v_mfma_f32_16x16x32_bf16 v[64:67], v[184:187], v[168:171], v[64:67]
    ds_read_b128 v[124:127], v200 offset:2048
    v_mfma_f32_16x16x32_bf16 v[68:71], v[184:187], v[172:175], v[68:71]
    ds_read_b128 v[128:131], v200 offset:4096
    ds_read_b128 v[132:135], v200 offset:6144
    v_mfma_f32_16x16x32_bf16 v[84:87], v[188:191], v[172:175], v[84:87]
    ds_read_b64_tr_b16 v[140:141], v203 offset:16384
    v_mfma_f32_16x16x32_bf16 v[80:83], v[188:191], v[168:171], v[80:83]
    ds_read_b64_tr_b16 v[142:143], v203 offset:18432
    v_mfma_f32_16x16x32_bf16 v[76:79], v[188:191], v[164:167], v[76:79]
    ds_read_b64_tr_b16 v[144:145], v204 offset:0
    ds_read_b64_tr_b16 v[146:147], v204 offset:2048
    v_mfma_f32_16x16x32_bf16 v[72:75], v[188:191], v[160:163], v[72:75]
    ds_read_b64_tr_b16 v[148:149], v205 offset:0
    v_mfma_f32_16x16x32_bf16 v[88:91], v[160:163], v[192:195], v[88:91]
    ds_read_b64_tr_b16 v[150:151], v205 offset:2048
    v_mfma_f32_16x16x32_bf16 v[92:95], v[164:167], v[192:195], v[92:95]
    ds_read_b64_tr_b16 v[152:153], v204 offset:8192
    ds_read_b64_tr_b16 v[154:155], v204 offset:10240
    v_mfma_f32_16x16x32_bf16 v[96:99], v[168:171], v[192:195], v[96:99]
    ds_read_b64_tr_b16 v[156:157], v205 offset:8192
    v_mfma_f32_16x16x32_bf16 v[100:103], v[172:175], v[192:195], v[100:103]
    ds_read_b64_tr_b16 v[158:159], v205 offset:10240
    v_mfma_f32_16x16x32_bf16 v[116:119], v[172:175], v[196:199], v[116:119]
    v_mfma_f32_16x16x32_bf16 v[112:115], v[168:171], v[196:199], v[112:115]
    v_mfma_f32_16x16x32_bf16 v[108:111], v[164:167], v[196:199], v[108:111]
    v_mfma_f32_16x16x32_bf16 v[104:107], v[160:163], v[196:199], v[104:107]
L_cloop:
    s_waitcnt lgkmcnt(0)
    v_mfma_f32_16x16x32_bf16 v[24:27], v[136:139], v[120:123], v[24:27]
    ds_read_b128 v[160:163], v201 offset:0
    v_mfma_f32_16x16x32_bf16 v[28:31], v[136:139], v[124:127], v[28:31]
    ds_read_b64_tr_b16 v[176:177], v202 offset:20480
    v_mfma_f32_16x16x32_bf16 v[32:35], v[136:139], v[128:131], v[32:35]
    ds_read_b64_tr_b16 v[178:179], v202 offset:22528
    v_mfma_f32_16x16x32_bf16 v[36:39], v[136:139], v[132:135], v[36:39]
    ds_read_b128 v[164:167], v201 offset:2048
    v_mfma_f32_16x16x32_bf16 v[52:55], v[140:143], v[132:135], v[52:55]
    ds_read_b128 v[168:171], v201 offset:4096
    v_mfma_f32_16x16x32_bf16 v[48:51], v[140:143], v[128:131], v[48:51]
    ds_read_b128 v[172:175], v201 offset:6144
    v_mfma_f32_16x16x32_bf16 v[44:47], v[140:143], v[124:127], v[44:47]
    ds_read_b64_tr_b16 v[180:181], v203 offset:20480
    v_mfma_f32_16x16x32_bf16 v[40:43], v[140:143], v[120:123], v[40:43]
    ds_read_b64_tr_b16 v[182:183], v203 offset:22528
    v_mfma_f32_16x16x32_bf16 v[56:59], v[144:147], v[120:123], v[56:59]
    ds_read_b64_tr_b16 v[184:185], v204 offset:4096
    v_mfma_f32_16x16x32_bf16 v[60:63], v[144:147], v[124:127], v[60:63]
    ds_read_b64_tr_b16 v[186:187], v204 offset:6144
    v_mfma_f32_16x16x32_bf16 v[64:67], v[144:147], v[128:131], v[64:67]
    ds_read_b64_tr_b16 v[188:189], v205 offset:4096
    v_mfma_f32_16x16x32_bf16 v[68:71], v[144:147], v[132:135], v[68:71]
    ds_read_b64_tr_b16 v[190:191], v205 offset:6144
    v_mfma_f32_16x16x32_bf16 v[84:87], v[148:151], v[132:135], v[84:87]
    ds_read_b64_tr_b16 v[192:193], v204 offset:12288
    v_mfma_f32_16x16x32_bf16 v[80:83], v[148:151], v[128:131], v[80:83]
    ds_read_b64_tr_b16 v[194:195], v204 offset:14336
    v_mfma_f32_16x16x32_bf16 v[76:79], v[148:151], v[124:127], v[76:79]
    ds_read_b64_tr_b16 v[196:197], v205 offset:12288
    v_mfma_f32_16x16x32_bf16 v[72:75], v[148:151], v[120:123], v[72:75]
    ds_read_b64_tr_b16 v[198:199], v205 offset:14336
    v_mfma_f32_16x16x32_bf16 v[88:91], v[120:123], v[152:155], v[88:91]
    v_mfma_f32_16x16x32_bf16 v[92:95], v[124:127], v[152:155], v[92:95]
    v_mfma_f32_16x16x32_bf16 v[96:99], v[128:131], v[152:155], v[96:99]
    v_mfma_f32_16x16x32_bf16 v[100:103], v[132:135], v[152:155], v[100:103]
    v_mfma_f32_16x16x32_bf16 v[116:119], v[132:135], v[156:159], v[116:119]
    v_mfma_f32_16x16x32_bf16 v[112:115], v[128:131], v[156:159], v[112:115]
    v_mfma_f32_16x16x32_bf16 v[108:111], v[124:127], v[156:159], v[108:111]
    v_mfma_f32_16x16x32_bf16 v[104:107], v[120:123], v[156:159], v[104:107]
    s_waitcnt lgkmcnt(0)
    v_mfma_f32_16x16x32_bf16 v[24:27], v[176:179], v[160:163], v[24:27]
    v_mfma_f32_16x16x32_bf16 v[28:31], v[176:179], v[164:167], v[28:31]
    s_barrier
    v_mfma_f32_16x16x32_bf16 v[32:35], v[176:179], v[168:171], v[32:35]
    ds_read_b128 v[120:123], v200 offset:16384
    v_mfma_f32_16x16x32_bf16 v[36:39], v[176:179], v[172:175], v[36:39]
    ds_read_b64_tr_b16 v[136:137], v202 offset:24576
    v_mfma_f32_16x16x32_bf16 v[52:55], v[180:183], v[172:175], v[52:55]
    ds_read_b64_tr_b16 v[138:139], v202 offset:26624
    v_mfma_f32_16x16x32_bf16 v[48:51], v[180:183], v[168:171], v[48:51]
    ds_read_b128 v[124:127], v200 offset:18432
    v_mfma_f32_16x16x32_bf16 v[44:47], v[180:183], v[164:167], v[44:47]
    ds_read_b128 v[128:131], v200 offset:20480
    v_mfma_f32_16x16x32_bf16 v[40:43], v[180:183], v[160:163], v[40:43]
    ds_read_b128 v[132:135], v200 offset:22528
    v_mfma_f32_16x16x32_bf16 v[56:59], v[184:187], v[160:163], v[56:59]
    ds_read_b64_tr_b16 v[140:141], v203 offset:24576
    v_mfma_f32_16x16x32_bf16 v[60:63], v[184:187], v[164:167], v[60:63]
    ds_read_b64_tr_b16 v[142:143], v203 offset:26624
    v_mfma_f32_16x16x32_bf16 v[64:67], v[184:187], v[168:171], v[64:67]
    ds_read_b64_tr_b16 v[144:145], v204 offset:16384
    v_mfma_f32_16x16x32_bf16 v[68:71], v[184:187], v[172:175], v[68:71]
    ds_read_b64_tr_b16 v[146:147], v204 offset:18432
    v_mfma_f32_16x16x32_bf16 v[84:87], v[188:191], v[172:175], v[84:87]
    ds_read_b64_tr_b16 v[148:149], v205 offset:16384
    v_mfma_f32_16x16x32_bf16 v[80:83], v[188:191], v[168:171], v[80:83]
    ds_read_b64_tr_b16 v[150:151], v205 offset:18432
    v_mfma_f32_16x16x32_bf16 v[76:79], v[188:191], v[164:167], v[76:79]
    ds_read_b64_tr_b16 v[152:153], v204 offset:24576
    v_mfma_f32_16x16x32_bf16 v[72:75], v[188:191], v[160:163], v[72:75]
    ds_read_b64_tr_b16 v[154:155], v204 offset:26624
    v_mfma_f32_16x16x32_bf16 v[88:91], v[160:163], v[192:195], v[88:91]
    ds_read_b64_tr_b16 v[156:157], v205 offset:24576
    v_mfma_f32_16x16x32_bf16 v[92:95], v[164:167], v[192:195], v[92:95]
    ds_read_b64_tr_b16 v[158:159], v205 offset:26624
    v_mfma_f32_16x16x32_bf16 v[96:99], v[168:171], v[192:195], v[96:99]
    v_mfma_f32_16x16x32_bf16 v[100:103], v[172:175], v[192:195], v[100:103]
    v_mfma_f32_16x16x32_bf16 v[116:119], v[172:175], v[196:199], v[116:119]
    v_mfma_f32_16x16x32_bf16 v[112:115], v[168:171], v[196:199], v[112:115]
    v_mfma_f32_16x16x32_bf16 v[108:111], v[164:167], v[196:199], v[108:111]
    v_mfma_f32_16x16x32_bf16 v[104:107], v[160:163], v[196:199], v[104:107]
    s_waitcnt lgkmcnt(0)
    v_mfma_f32_16x16x32_bf16 v[24:27], v[136:139], v[120:123], v[24:27]
    ds_read_b128 v[160:163], v201 offset:16384
    v_mfma_f32_16x16x32_bf16 v[28:31], v[136:139], v[124:127], v[28:31]
    ds_read_b64_tr_b16 v[176:177], v202 offset:28672
    v_mfma_f32_16x16x32_bf16 v[32:35], v[136:139], v[128:131], v[32:35]
    ds_read_b64_tr_b16 v[178:179], v202 offset:30720
    v_mfma_f32_16x16x32_bf16 v[36:39], v[136:139], v[132:135], v[36:39]
    ds_read_b128 v[164:167], v201 offset:18432
    v_mfma_f32_16x16x32_bf16 v[52:55], v[140:143], v[132:135], v[52:55]
    ds_read_b128 v[168:171], v201 offset:20480
    v_mfma_f32_16x16x32_bf16 v[48:51], v[140:143], v[128:131], v[48:51]
    ds_read_b128 v[172:175], v201 offset:22528
    v_mfma_f32_16x16x32_bf16 v[44:47], v[140:143], v[124:127], v[44:47]
    ds_read_b64_tr_b16 v[180:181], v203 offset:28672
    v_mfma_f32_16x16x32_bf16 v[40:43], v[140:143], v[120:123], v[40:43]
    ds_read_b64_tr_b16 v[182:183], v203 offset:30720
    v_mfma_f32_16x16x32_bf16 v[56:59], v[144:147], v[120:123], v[56:59]
    ds_read_b64_tr_b16 v[184:185], v204 offset:20480
    v_mfma_f32_16x16x32_bf16 v[60:63], v[144:147], v[124:127], v[60:63]
    ds_read_b64_tr_b16 v[186:187], v204 offset:22528
    v_mfma_f32_16x16x32_bf16 v[64:67], v[144:147], v[128:131], v[64:67]
    ds_read_b64_tr_b16 v[188:189], v205 offset:20480
    v_mfma_f32_16x16x32_bf16 v[68:71], v[144:147], v[132:135], v[68:71]
    ds_read_b64_tr_b16 v[190:191], v205 offset:22528
    v_mfma_f32_16x16x32_bf16 v[84:87], v[148:151], v[132:135], v[84:87]
    ds_read_b64_tr_b16 v[192:193], v204 offset:28672
    v_mfma_f32_16x16x32_bf16 v[80:83], v[148:151], v[128:131], v[80:83]
    ds_read_b64_tr_b16 v[194:195], v204 offset:30720
    v_mfma_f32_16x16x32_bf16 v[76:79], v[148:151], v[124:127], v[76:79]
    ds_read_b64_tr_b16 v[196:197], v205 offset:28672
    v_mfma_f32_16x16x32_bf16 v[72:75], v[148:151], v[120:123], v[72:75]
    ds_read_b64_tr_b16 v[198:199], v205 offset:30720
    v_mfma_f32_16x16x32_bf16 v[88:91], v[120:123], v[152:155], v[88:91]
    v_mfma_f32_16x16x32_bf16 v[92:95], v[124:127], v[152:155], v[92:95]
    v_mfma_f32_16x16x32_bf16 v[96:99], v[128:131], v[152:155], v[96:99]
    v_mfma_f32_16x16x32_bf16 v[100:103], v[132:135], v[152:155], v[100:103]
    v_mfma_f32_16x16x32_bf16 v[116:119], v[132:135], v[156:159], v[116:119]
    v_mfma_f32_16x16x32_bf16 v[112:115], v[128:131], v[156:159], v[112:115]
    v_mfma_f32_16x16x32_bf16 v[108:111], v[124:127], v[156:159], v[108:111]
    v_mfma_f32_16x16x32_bf16 v[104:107], v[120:123], v[156:159], v[104:107]
    s_waitcnt lgkmcnt(0)
    v_mfma_f32_16x16x32_bf16 v[24:27], v[176:179], v[160:163], v[24:27]
    v_mfma_f32_16x16x32_bf16 v[28:31], v[176:179], v[164:167], v[28:31]
    s_waitcnt vmcnt(0)
    s_barrier
    v_mfma_f32_16x16x32_bf16 v[32:35], v[176:179], v[168:171], v[32:35]
    ds_read_b128 v[120:123], v200 offset:32768
    v_mfma_f32_16x16x32_bf16 v[36:39], v[176:179], v[172:175], v[36:39]
    ds_read_b64_tr_b16 v[136:137], v202 offset:32768
    v_mfma_f32_16x16x32_bf16 v[52:55], v[180:183], v[172:175], v[52:55]
    ds_read_b64_tr_b16 v[138:139], v202 offset:34816
    v_mfma_f32_16x16x32_bf16 v[48:51], v[180:183], v[168:171], v[48:51]
    ds_read_b128 v[124:127], v200 offset:34816
    v_mfma_f32_16x16x32_bf16 v[44:47], v[180:183], v[164:167], v[44:47]
    ds_read_b128 v[128:131], v200 offset:36864
    v_mfma_f32_16x16x32_bf16 v[40:43], v[180:183], v[160:163], v[40:43]
    ds_read_b128 v[132:135], v200 offset:38912
    v_mfma_f32_16x16x32_bf16 v[56:59], v[184:187], v[160:163], v[56:59]
    ds_read_b64_tr_b16 v[140:141], v203 offset:32768
    v_mfma_f32_16x16x32_bf16 v[60:63], v[184:187], v[164:167], v[60:63]
    ds_read_b64_tr_b16 v[142:143], v203 offset:34816
    v_mfma_f32_16x16x32_bf16 v[64:67], v[184:187], v[168:171], v[64:67]
    ds_read_b64_tr_b16 v[144:145], v202 offset:0
    v_mfma_f32_16x16x32_bf16 v[68:71], v[184:187], v[172:175], v[68:71]
    ds_read_b64_tr_b16 v[146:147], v202 offset:2048
    v_mfma_f32_16x16x32_bf16 v[84:87], v[188:191], v[172:175], v[84:87]
    ds_read_b64_tr_b16 v[148:149], v203 offset:0
    v_mfma_f32_16x16x32_bf16 v[80:83], v[188:191], v[168:171], v[80:83]
    ds_read_b64_tr_b16 v[150:151], v203 offset:2048
    v_mfma_f32_16x16x32_bf16 v[76:79], v[188:191], v[164:167], v[76:79]
    ds_read_b64_tr_b16 v[152:153], v202 offset:8192
    v_mfma_f32_16x16x32_bf16 v[72:75], v[188:191], v[160:163], v[72:75]
    ds_read_b64_tr_b16 v[154:155], v202 offset:10240
    v_mfma_f32_16x16x32_bf16 v[88:91], v[160:163], v[192:195], v[88:91]
    ds_read_b64_tr_b16 v[156:157], v203 offset:8192
    v_mfma_f32_16x16x32_bf16 v[92:95], v[164:167], v[192:195], v[92:95]
    ds_read_b64_tr_b16 v[158:159], v203 offset:10240
    v_mfma_f32_16x16x32_bf16 v[96:99], v[168:171], v[192:195], v[96:99]
    v_mfma_f32_16x16x32_bf16 v[100:103], v[172:175], v[192:195], v[100:103]
    v_mfma_f32_16x16x32_bf16 v[116:119], v[172:175], v[196:199], v[116:119]
    v_mfma_f32_16x16x32_bf16 v[112:115], v[168:171], v[196:199], v[112:115]
    v_mfma_f32_16x16x32_bf16 v[108:111], v[164:167], v[196:199], v[108:111]
    v_mfma_f32_16x16x32_bf16 v[104:107], v[160:163], v[196:199], v[104:107]
    s_waitcnt lgkmcnt(0)
    v_mfma_f32_16x16x32_bf16 v[24:27], v[136:139], v[120:123], v[24:27]
    ds_read_b128 v[160:163], v201 offset:32768
    v_mfma_f32_16x16x32_bf16 v[28:31], v[136:139], v[124:127], v[28:31]
    ds_read_b64_tr_b16 v[176:177], v202 offset:36864
    v_mfma_f32_16x16x32_bf16 v[32:35], v[136:139], v[128:131], v[32:35]
    ds_read_b64_tr_b16 v[178:179], v202 offset:38912
    v_mfma_f32_16x16x32_bf16 v[36:39], v[136:139], v[132:135], v[36:39]
    ds_read_b128 v[164:167], v201 offset:34816
    v_mfma_f32_16x16x32_bf16 v[52:55], v[140:143], v[132:135], v[52:55]
    ds_read_b128 v[168:171], v201 offset:36864
    v_mfma_f32_16x16x32_bf16 v[48:51], v[140:143], v[128:131], v[48:51]
    ds_read_b128 v[172:175], v201 offset:38912
    v_mfma_f32_16x16x32_bf16 v[44:47], v[140:143], v[124:127], v[44:47]
    ds_read_b64_tr_b16 v[180:181], v203 offset:36864
    v_mfma_f32_16x16x32_bf16 v[40:43], v[140:143], v[120:123], v[40:43]
    ds_read_b64_tr_b16 v[182:183], v203 offset:38912
    v_mfma_f32_16x16x32_bf16 v[56:59], v[144:147], v[120:123], v[56:59]
    ds_read_b64_tr_b16 v[184:185], v202 offset:4096
    v_mfma_f32_16x16x32_bf16 v[60:63], v[144:147], v[124:127], v[60:63]
    ds_read_b64_tr_b16 v[186:187], v202 offset:6144
    v_mfma_f32_16x16x32_bf16 v[64:67], v[144:147], v[128:131], v[64:67]
    ds_read_b64_tr_b16 v[188:189], v203 offset:4096
    v_mfma_f32_16x16x32_bf16 v[68:71], v[144:147], v[132:135], v[68:71]
    ds_read_b64_tr_b16 v[190:191], v203 offset:6144
    v_mfma_f32_16x16x32_bf16 v[84:87], v[148:151], v[132:135], v[84:87]
    ds_read_b64_tr_b16 v[192:193], v202 offset:12288
    v_mfma_f32_16x16x32_bf16 v[80:83], v[148:151], v[128:131], v[80:83]
    ds_read_b64_tr_b16 v[194:195], v202 offset:14336
    v_mfma_f32_16x16x32_bf16 v[76:79], v[148:151], v[124:127], v[76:79]
    ds_read_b64_tr_b16 v[196:197], v203 offset:12288
    v_mfma_f32_16x16x32_bf16 v[72:75], v[148:151], v[120:123], v[72:75]
    ds_read_b64_tr_b16 v[198:199], v203 offset:14336
    v_mfma_f32_16x16x32_bf16 v[88:91], v[120:123], v[152:155], v[88:91]
    v_mfma_f32_16x16x32_bf16 v[92:95], v[124:127], v[152:155], v[92:95]
    v_mfma_f32_16x16x32_bf16 v[96:99], v[128:131], v[152:155], v[96:99]
    v_mfma_f32_16x16x32_bf16 v[100:103], v[132:135], v[152:155], v[100:103]
    v_mfma_f32_16x16x32_bf16 v[116:119], v[132:135], v[156:159], v[116:119]
    v_mfma_f32_16x16x32_bf16 v[112:115], v[128:131], v[156:159], v[112:115]
    v_mfma_f32_16x16x32_bf16 v[108:111], v[124:127], v[156:159], v[108:111]
    v_mfma_f32_16x16x32_bf16 v[104:107], v[120:123], v[156:159], v[104:107]
    s_waitcnt lgkmcnt(0)
    v_mfma_f32_16x16x32_bf16 v[24:27], v[176:179], v[160:163], v[24:27]
    v_mfma_f32_16x16x32_bf16 v[28:31], v[176:179], v[164:167], v[28:31]
    s_barrier
    v_mfma_f32_16x16x32_bf16 v[32:35], v[176:179], v[168:171], v[32:35]
    ds_read_b128 v[120:123], v200 offset:0
    v_mfma_f32_16x16x32_bf16 v[36:39], v[176:179], v[172:175], v[36:39]
    ds_read_b64_tr_b16 v[136:137], v202 offset:16384
    v_mfma_f32_16x16x32_bf16 v[52:55], v[180:183], v[172:175], v[52:55]
    ds_read_b64_tr_b16 v[138:139], v202 offset:18432
    v_mfma_f32_16x16x32_bf16 v[48:51], v[180:183], v[168:171], v[48:51]
    ds_read_b128 v[124:127], v200 offset:2048
    v_mfma_f32_16x16x32_bf16 v[44:47], v[180:183], v[164:167], v[44:47]
    ds_read_b128 v[128:131], v200 offset:4096
    v_mfma_f32_16x16x32_bf16 v[40:43], v[180:183], v[160:163], v[40:43]
    ds_read_b128 v[132:135], v200 offset:6144
    v_mfma_f32_16x16x32_bf16 v[56:59], v[184:187], v[160:163], v[56:59]
    ds_read_b64_tr_b16 v[140:141], v203 offset:16384
    v_mfma_f32_16x16x32_bf16 v[60:63], v[184:187], v[164:167], v[60:63]
    ds_read_b64_tr_b16 v[142:143], v203 offset:18432
    v_mfma_f32_16x16x32_bf16 v[64:67], v[184:187], v[168:171], v[64:67]
    ds_read_b64_tr_b16 v[144:145], v204 offset:0
    v_mfma_f32_16x16x32_bf16 v[68:71], v[184:187], v[172:175], v[68:71]
    ds_read_b64_tr_b16 v[146:147], v204 offset:2048
    v_mfma_f32_16x16x32_bf16 v[84:87], v[188:191], v[172:175], v[84:87]
    ds_read_b64_tr_b16 v[148:149], v205 offset:0
    v_mfma_f32_16x16x32_bf16 v[80:83], v[188:191], v[168:171], v[80:83]
    ds_read_b64_tr_b16 v[150:151], v205 offset:2048
    v_mfma_f32_16x16x32_bf16 v[76:79], v[188:191], v[164:167], v[76:79]
    ds_read_b64_tr_b16 v[152:153], v204 offset:8192
    v_mfma_f32_16x16x32_bf16 v[72:75], v[188:191], v[160:163], v[72:75]
    ds_read_b64_tr_b16 v[154:155], v204 offset:10240
    v_mfma_f32_16x16x32_bf16 v[88:91], v[160:163], v[192:195], v[88:91]
    ds_read_b64_tr_b16 v[156:157], v205 offset:8192
    v_mfma_f32_16x16x32_bf16 v[92:95], v[164:167], v[192:195], v[92:95]
    ds_read_b64_tr_b16 v[158:159], v205 offset:10240
    v_mfma_f32_16x16x32_bf16 v[96:99], v[168:171], v[192:195], v[96:99]
    s_add_u32 s96, s96, 3
    v_mfma_f32_16x16x32_bf16 v[100:103], v[172:175], v[192:195], v[100:103]
    s_cmp_lt_u32 s96, 12
    v_mfma_f32_16x16x32_bf16 v[116:119], v[172:175], v[196:199], v[116:119]
    v_mfma_f32_16x16x32_bf16 v[112:115], v[168:171], v[196:199], v[112:115]
    v_mfma_f32_16x16x32_bf16 v[108:111], v[164:167], v[196:199], v[108:111]
    v_mfma_f32_16x16x32_bf16 v[104:107], v[160:163], v[196:199], v[104:107]
    s_cbranch_scc1 L_cloop
    s_bitcmp1_b32 s22, 0
    s_cbranch_scc1 L_ctailB
    s_waitcnt lgkmcnt(0)
    v_mfma_f32_16x16x32_bf16 v[24:27], v[136:139], v[120:123], v[24:27]
    ds_read_b128 v[160:163], v201 offset:0
    v_mfma_f32_16x16x32_bf16 v[28:31], v[136:139], v[124:127], v[28:31]
    ds_read_b64_tr_b16 v[184:185], v204 offset:4096
    v_mfma_f32_16x16x32_bf16 v[32:35], v[136:139], v[128:131], v[32:35]
    ds_read_b64_tr_b16 v[186:187], v204 offset:6144
    v_mfma_f32_16x16x32_bf16 v[36:39], v[136:139], v[132:135], v[36:39]
    ds_read_b128 v[164:167], v201 offset:2048
    v_mfma_f32_16x16x32_bf16 v[52:55], v[140:143], v[132:135], v[52:55]
    ds_read_b128 v[168:171], v201 offset:4096
    v_mfma_f32_16x16x32_bf16 v[48:51], v[140:143], v[128:131], v[48:51]
    ds_read_b128 v[172:175], v201 offset:6144
    v_mfma_f32_16x16x32_bf16 v[44:47], v[140:143], v[124:127], v[44:47]
    ds_read_b64_tr_b16 v[188:189], v205 offset:4096
    v_mfma_f32_16x16x32_bf16 v[40:43], v[140:143], v[120:123], v[40:43]
    ds_read_b64_tr_b16 v[190:191], v205 offset:6144
    v_mfma_f32_16x16x32_bf16 v[56:59], v[144:147], v[120:123], v[56:59]
    ds_read_b64_tr_b16 v[192:193], v204 offset:12288
    v_mfma_f32_16x16x32_bf16 v[60:63], v[144:147], v[124:127], v[60:63]
    ds_read_b64_tr_b16 v[194:195], v204 offset:14336
    v_mfma_f32_16x16x32_bf16 v[64:67], v[144:147], v[128:131], v[64:67]
    ds_read_b64_tr_b16 v[196:197], v205 offset:12288
    v_mfma_f32_16x16x32_bf16 v[68:71], v[144:147], v[132:135], v[68:71]
    ds_read_b64_tr_b16 v[198:199], v205 offset:14336
    v_mfma_f32_16x16x32_bf16 v[84:87], v[148:151], v[132:135], v[84:87]
    v_mfma_f32_16x16x32_bf16 v[80:83], v[148:151], v[128:131], v[80:83]
    v_mfma_f32_16x16x32_bf16 v[76:79], v[148:151], v[124:127], v[76:79]
    v_mfma_f32_16x16x32_bf16 v[72:75], v[148:151], v[120:123], v[72:75]
    v_mfma_f32_16x16x32_bf16 v[88:91], v[120:123], v[152:155], v[88:91]
    v_mfma_f32_16x16x32_bf16 v[92:95], v[124:127], v[152:155], v[92:95]
    v_mfma_f32_16x16x32_bf16 v[96:99], v[128:131], v[152:155], v[96:99]
    v_mfma_f32_16x16x32_bf16 v[100:103], v[132:135], v[152:155], v[100:103]
    v_mfma_f32_16x16x32_bf16 v[116:119], v[132:135], v[156:159], v[116:119]
    v_mfma_f32_16x16x32_bf16 v[112:115], v[128:131], v[156:159], v[112:115]
    v_mfma_f32_16x16x32_bf16 v[108:111], v[124:127], v[156:159], v[108:111]
    v_mfma_f32_16x16x32_bf16 v[104:107], v[120:123], v[156:159], v[104:107]
    s_waitcnt lgkmcnt(0)
    s_barrier
    v_mfma_f32_16x16x32_bf16 v[56:59], v[184:187], v[160:163], v[56:59]
    ds_read_b128 v[120:123], v200 offset:16384
    v_mfma_f32_16x16x32_bf16 v[60:63], v[184:187], v[164:167], v[60:63]
    ds_read_b64_tr_b16 v[144:145], v204 offset:16384
    v_mfma_f32_16x16x32_bf16 v[64:67], v[184:187], v[168:171], v[64:67]
    ds_read_b64_tr_b16 v[146:147], v204 offset:18432
    v_mfma_f32_16x16x32_bf16 v[68:71], v[184:187], v[172:175], v[68:71]
    ds_read_b128 v[124:127], v200 offset:18432
    v_mfma_f32_16x16x32_bf16 v[84:87], v[188:191], v[172:175], v[84:87]
    ds_read_b128 v[128:131], v200 offset:20480
    v_mfma_f32_16x16x32_bf16 v[80:83], v[188:191], v[168:171], v[80:83]
    ds_read_b128 v[132:135], v200 offset:22528
    v_mfma_f32_16x16x32_bf16 v[76:79], v[188:191], v[164:167], v[76:79]
    ds_read_b64_tr_b16 v[148:149], v205 offset:16384
    v_mfma_f32_16x16x32_bf16 v[72:75], v[188:191], v[160:163], v[72:75]
    ds_read_b64_tr_b16 v[150:151], v205 offset:18432
    v_mfma_f32_16x16x32_bf16 v[88:91], v[160:163], v[192:195], v[88:91]
    ds_read_b64_tr_b16 v[152:153], v204 offset:24576
    v_mfma_f32_16x16x32_bf16 v[92:95], v[164:167], v[192:195], v[92:95]
    ds_read_b64_tr_b16 v[154:155], v204 offset:26624
    v_mfma_f32_16x16x32_bf16 v[96:99], v[168:171], v[192:195], v[96:99]
    ds_read_b64_tr_b16 v[156:157], v205 offset:24576
    v_mfma_f32_16x16x32_bf16 v[100:103], v[172:175], v[192:195], v[100:103]
    ds_read_b64_tr_b16 v[158:159], v205 offset:26624
    v_mfma_f32_16x16x32_bf16 v[116:119], v[172:175], v[196:199], v[116:119]
    v_mfma_f32_16x16x32_bf16 v[112:115], v[168:171], v[196:199], v[112:115]
    v_mfma_f32_16x16x32_bf16 v[108:111], v[164:167], v[196:199], v[108:111]
    v_mfma_f32_16x16x32_bf16 v[104:107], v[160:163], v[196:199], v[104:107]
    s_waitcnt lgkmcnt(1)
    v_mfma_f32_16x16x32_bf16 v[56:59], v[144:147], v[120:123], v[56:59]
    ds_read_b128 v[160:163], v201 offset:16384
    v_mfma_f32_16x16x32_bf16 v[60:63], v[144:147], v[124:127], v[60:63]
    ds_read_b64_tr_b16 v[184:185], v204 offset:20480
    v_mfma_f32_16x16x32_bf16 v[64:67], v[144:147], v[128:131], v[64:67]
    ds_read_b64_tr_b16 v[186:187], v204 offset:22528
    v_mfma_f32_16x16x32_bf16 v[68:71], v[144:147], v[132:135], v[68:71]
    ds_read_b128 v[164:167], v201 offset:18432
    v_mfma_f32_16x16x32_bf16 v[84:87], v[148:151], v[132:135], v[84:87]
    ds_read_b128 v[168:171], v201 offset:20480
    v_mfma_f32_16x16x32_bf16 v[80:83], v[148:151], v[128:131], v[80:83]
    ds_read_b128 v[172:175], v201 offset:22528
    v_mfma_f32_16x16x32_bf16 v[76:79], v[148:151], v[124:127], v[76:79]
    ds_read_b64_tr_b16 v[188:189], v205 offset:20480
    v_mfma_f32_16x16x32_bf16 v[72:75], v[148:151], v[120:123], v[72:75]
    ds_read_b64_tr_b16 v[190:191], v205 offset:22528
    v_mfma_f32_16x16x32_bf16 v[88:91], v[120:123], v[152:155], v[88:91]
    ds_read_b64_tr_b16 v[192:193], v204 offset:28672
    v_mfma_f32_16x16x32_bf16 v[92:95], v[124:127], v[152:155], v[92:95]
    ds_read_b64_tr_b16 v[194:195], v204 offset:30720
    v_mfma_f32_16x16x32_bf16 v[96:99], v[128:131], v[152:155], v[96:99]
    ds_read_b64_tr_b16 v[196:197], v205 offset:28672
    v_mfma_f32_16x16x32_bf16 v[100:103], v[132:135], v[152:155], v[100:103]
    ds_read_b64_tr_b16 v[198:199], v205 offset:30720
    s_waitcnt lgkmcnt(5)
    v_mfma_f32_16x16x32_bf16 v[116:119], v[132:135], v[156:159], v[116:119]
    v_mfma_f32_16x16x32_bf16 v[112:115], v[128:131], v[156:159], v[112:115]
    v_mfma_f32_16x16x32_bf16 v[108:111], v[124:127], v[156:159], v[108:111]
    v_mfma_f32_16x16x32_bf16 v[104:107], v[120:123], v[156:159], v[104:107]
    s_waitcnt lgkmcnt(0)
    s_barrier
    v_mfma_f32_16x16x32_bf16 v[56:59], v[184:187], v[160:163], v[56:59]
    ds_read_b128 v[120:123], v200 offset:32768
    v_mfma_f32_16x16x32_bf16 v[60:63], v[184:187], v[164:167], v[60:63]
    ds_read_b64_tr_b16 v[144:145], v202 offset:0
    v_mfma_f32_16x16x32_bf16 v[64:67], v[184:187], v[168:171], v[64:67]
    ds_read_b64_tr_b16 v[146:147], v202 offset:2048
    v_mfma_f32_16x16x32_bf16 v[68:71], v[184:187], v[172:175], v[68:71]
    ds_read_b128 v[124:127], v200 offset:34816
    v_mfma_f32_16x16x32_bf16 v[84:87], v[188:191], v[172:175], v[84:87]
    ds_read_b128 v[128:131], v200 offset:36864
    v_mfma_f32_16x16x32_bf16 v[80:83], v[188:191], v[168:171], v[80:83]
    ds_read_b128 v[132:135], v200 offset:38912
    v_mfma_f32_16x16x32_bf16 v[76:79], v[188:191], v[164:167], v[76:79]
    ds_read_b64_tr_b16 v[148:149], v203 offset:0
    v_mfma_f32_16x16x32_bf16 v[72:75], v[188:191], v[160:163], v[72:75]
    ds_read_b64_tr_b16 v[150:151], v203 offset:2048
    v_mfma_f32_16x16x32_bf16 v[88:91], v[160:163], v[192:195], v[88:91]
    ds_read_b64_tr_b16 v[152:153], v202 offset:8192
    v_mfma_f32_16x16x32_bf16 v[92:95], v[164:167], v[192:195], v[92:95]
    ds_read_b64_tr_b16 v[154:155], v202 offset:10240
    v_mfma_f32_16x16x32_bf16 v[96:99], v[168:171], v[192:195], v[96:99]
    ds_read_b64_tr_b16 v[156:157], v203 offset:8192
    v_mfma_f32_16x16x32_bf16 v[100:103], v[172:175], v[192:195], v[100:103]
    ds_read_b64_tr_b16 v[158:159], v203 offset:10240
    v_mfma_f32_16x16x32_bf16 v[116:119], v[172:175], v[196:199], v[116:119]
    v_mfma_f32_16x16x32_bf16 v[112:115], v[168:171], v[196:199], v[112:115]
    v_mfma_f32_16x16x32_bf16 v[108:111], v[164:167], v[196:199], v[108:111]
    v_mfma_f32_16x16x32_bf16 v[104:107], v[160:163], v[196:199], v[104:107]
    s_waitcnt lgkmcnt(1)
    v_mfma_f32_16x16x32_bf16 v[56:59], v[144:147], v[120:123], v[56:59]
    ds_read_b128 v[160:163], v201 offset:32768
    v_mfma_f32_16x16x32_bf16 v[60:63], v[144:147], v[124:127], v[60:63]
    ds_read_b64_tr_b16 v[184:185], v202 offset:4096
    v_mfma_f32_16x16x32_bf16 v[64:67], v[144:147], v[128:131], v[64:67]
    ds_read_b64_tr_b16 v[186:187], v202 offset:6144
    v_mfma_f32_16x16x32_bf16 v[68:71], v[144:147], v[132:135], v[68:71]
    ds_read_b128 v[164:167], v201 offset:34816
    v_mfma_f32_16x16x32_bf16 v[84:87], v[148:151], v[132:135], v[84:87]
    ds_read_b128 v[168:171], v201 offset:36864
    v_mfma_f32_16x16x32_bf16 v[80:83], v[148:151], v[128:131], v[80:83]
    ds_read_b128 v[172:175], v201 offset:38912
    v_mfma_f32_16x16x32_bf16 v[76:79], v[148:151], v[124:127], v[76:79]
    ds_read_b64_tr_b16 v[188:189], v203 offset:4096
    v_mfma_f32_16x16x32_bf16 v[72:75], v[148:151], v[120:123], v[72:75]
    ds_read_b64_tr_b16 v[190:191], v203 offset:6144
    v_mfma_f32_16x16x32_bf16 v[88:91], v[120:123], v[152:155], v[88:91]
    ds_read_b64_tr_b16 v[192:193], v202 offset:12288
    v_mfma_f32_16x16x32_bf16 v[92:95], v[124:127], v[152:155], v[92:95]
    ds_read_b64_tr_b16 v[194:195], v202 offset:14336
    v_mfma_f32_16x16x32_bf16 v[96:99], v[128:131], v[152:155], v[96:99]
    ds_read_b64_tr_b16 v[196:197], v203 offset:12288
    v_mfma_f32_16x16x32_bf16 v[100:103], v[132:135], v[152:155], v[100:103]
    ds_read_b64_tr_b16 v[198:199], v203 offset:14336
    s_waitcnt lgkmcnt(5)
    v_mfma_f32_16x16x32_bf16 v[116:119], v[132:135], v[156:159], v[116:119]
    v_add_u32 v176, s48, v0
    v_mfma_f32_16x16x32_bf16 v[112:115], v[128:131], v[156:159], v[112:115]
    s_add_u32 s27, s63, 8192
    v_mfma_f32_16x16x32_bf16 v[108:111], v[124:127], v[156:159], v[108:111]
    v_mov_b32 v255, 92928
    v_mfma_f32_16x16x32_bf16 v[104:107], v[120:123], v[156:159], v[104:107]
    s_waitcnt lgkmcnt(0)
    s_barrier
    v_mfma_f32_16x16x32_bf16 v[56:59], v[184:187], v[160:163], v[56:59]
    ds_read_b32 v255, v255
    ds_read_b128 v[152:155], v209 offset:256
    v_mfma_f32_16x16x32_bf16 v[60:63], v[184:187], v[164:167], v[60:63]
    ds_read_b128 v[156:159], v209 offset:320
    ds_read_b64 v[236:237], v207 offset:1280
    v_mfma_f32_16x16x32_bf16 v[64:67], v[184:187], v[168:171], v[64:67]
    ds_read_b64 v[238:239], v207 offset:1408
    v_mfma_f32_16x16x32_bf16 v[68:71], v[184:187], v[172:175], v[68:71]
    ds_read_b64 v[232:233], v207 offset:1024
    ds_read_b64 v[234:235], v207 offset:1152
    v_mfma_f32_16x16x32_bf16 v[84:87], v[188:191], v[172:175], v[84:87]
    ds_read_b32 v248, v210 offset:512
    v_mfma_f32_16x16x32_bf16 v[80:83], v[188:191], v[168:171], v[80:83]
    ds_read_b32 v249, v210 offset:576
    ds_read_b128 v[128:131], v208 offset:128
    v_mfma_f32_16x16x32_bf16 v[76:79], v[188:191], v[164:167], v[76:79]
    ds_read_b128 v[144:147], v208 offset:640
    ds_read_b128 v[132:135], v208 offset:192
    v_mfma_f32_16x16x32_bf16 v[72:75], v[188:191], v[160:163], v[72:75]
    ds_read_b128 v[148:151], v208 offset:704
    v_mfma_f32_16x16x32_bf16 v[88:91], v[160:163], v[192:195], v[88:91]
    ds_read_b128 v[120:123], v208 offset:0
    ds_read_b128 v[136:139], v208 offset:512
    v_mfma_f32_16x16x32_bf16 v[92:95], v[164:167], v[192:195], v[92:95]
    ds_read_b128 v[124:127], v208 offset:64
    v_mfma_f32_16x16x32_bf16 v[96:99], v[168:171], v[192:195], v[96:99]
    ds_read_b128 v[140:143], v208 offset:576
    ds_read_b128 v[240:243], v209 offset:0
    v_mfma_f32_16x16x32_bf16 v[100:103], v[172:175], v[192:195], v[100:103]
    ds_read_b128 v[244:247], v209 offset:64
    v_mfma_f32_16x16x32_bf16 v[116:119], v[172:175], v[196:199], v[116:119]
    v_mfma_f32_16x16x32_bf16 v[112:115], v[168:171], v[196:199], v[112:115]
    v_mfma_f32_16x16x32_bf16 v[108:111], v[164:167], v[196:199], v[108:111]
    v_mfma_f32_16x16x32_bf16 v[104:107], v[160:163], v[196:199], v[104:107]
    v_mov_b32 v199, v176
    s_waitcnt lgkmcnt(1)
    v_readfirstlane_b32 s23, v255
    v_pk_mul_f32 v[250:251], v[236:237], v[152:153] op_sel:[1,0] op_sel_hi:[1,1]
    v_pk_fma_f32 v[250:251], v[64:65], v[236:237], v[250:251] op_sel_hi:[1,0,1]
    v_pk_mul_f32 v[252:253], v[236:237], v[154:155] op_sel:[1,0] op_sel_hi:[1,1]
    v_cvt_pk_bf16_f32 v64, v250, v251
    v_pk_fma_f32 v[252:253], v[66:67], v[236:237], v[252:253] op_sel_hi:[1,0,1]
    v_pk_mul_f32 v[254:255], v[236:237], v[156:157] op_sel:[1,0] op_sel_hi:[1,1]
    v_cvt_pk_bf16_f32 v65, v252, v253
    v_pk_fma_f32 v[254:255], v[80:81], v[236:237], v[254:255] op_sel_hi:[1,0,1]
    v_pk_mul_f32 v[250:251], v[236:237], v[158:159] op_sel:[1,0] op_sel_hi:[1,1]
    v_cvt_pk_bf16_f32 v66, v254, v255
    v_pk_fma_f32 v[250:251], v[82:83], v[236:237], v[250:251] op_sel_hi:[1,0,1]
    v_pk_mul_f32 v[252:253], v[238:239], v[152:153] op_sel:[1,0] op_sel_hi:[1,1]
    v_cvt_pk_bf16_f32 v67, v250, v251
    v_pk_fma_f32 v[252:253], v[68:69], v[238:239], v[252:253] op_sel_hi:[1,0,1]
    v_pk_mul_f32 v[254:255], v[238:239], v[154:155] op_sel:[1,0] op_sel_hi:[1,1]
    buffer_store_dwordx4 v[64:67], v0, s[12:15], s27 offen offset:0 sc1
    ds_write_b128 v199, v[64:67] offset:8192
    v_cvt_pk_bf16_f32 v68, v252, v253
    v_pk_fma_f32 v[254:255], v[70:71], v[238:239], v[254:255] op_sel_hi:[1,0,1]
    v_pk_mul_f32 v[250:251], v[238:239], v[156:157] op_sel:[1,0] op_sel_hi:[1,1]
    v_cvt_pk_bf16_f32 v69, v254, v255
    v_pk_fma_f32 v[250:251], v[84:85], v[238:239], v[250:251] op_sel_hi:[1,0,1]
    v_pk_mul_f32 v[252:253], v[238:239], v[158:159] op_sel:[1,0] op_sel_hi:[1,1]
    v_cvt_pk_bf16_f32 v70, v250, v251
    v_pk_fma_f32 v[252:253], v[86:87], v[238:239], v[252:253] op_sel_hi:[1,0,1]
    v_pk_mul_f32 v[254:255], v[144:145], v[248:249] op_sel_hi:[1,0]
    v_cvt_pk_bf16_f32 v71, v252, v253
    v_pk_fma_f32 v[254:255], v[96:97], v[128:129], v[254:255]
    v_pk_mul_f32 v[250:251], v[146:147], v[248:249] op_sel_hi:[1,0]
    buffer_store_dwordx4 v[68:71], v0, s[12:15], s27 offen offset:1024 sc1
    ds_write_b128 v199, v[68:71] offset:9216
    v_cvt_pk_bf16_f32 v96, v254, v255
    v_pk_fma_f32 v[250:251], v[98:99], v[130:131], v[250:251]
    v_pk_mul_f32 v[252:253], v[148:149], v[248:249] op_sel_hi:[1,0]
    v_cvt_pk_bf16_f32 v97, v250, v251
    v_pk_fma_f32 v[252:253], v[100:101], v[132:133], v[252:253]
    v_pk_mul_f32 v[254:255], v[150:151], v[248:249] op_sel_hi:[1,0]
    v_cvt_pk_bf16_f32 v98, v252, v253
    v_pk_fma_f32 v[254:255], v[102:103], v[134:135], v[254:255]
    v_pk_mul_f32 v[250:251], v[248:249], v[144:145] op_sel:[1,0] op_sel_hi:[1,1]
    v_cvt_pk_bf16_f32 v99, v254, v255
    v_pk_fma_f32 v[250:251], v[112:113], v[128:129], v[250:251]
    v_pk_mul_f32 v[252:253], v[248:249], v[146:147] op_sel:[1,0] op_sel_hi:[1,1]
    buffer_store_dwordx4 v[96:99], v0, s[12:15], s27 offen offset:2048 sc1
    ds_write_b128 v199, v[96:99] offset:10240
    v_cvt_pk_bf16_f32 v112, v250, v251
    v_pk_fma_f32 v[252:253], v[114:115], v[130:131], v[252:253]
    v_pk_mul_f32 v[254:255], v[248:249], v[148:149] op_sel:[1,0] op_sel_hi:[1,1]
    v_cvt_pk_bf16_f32 v113, v252, v253
    v_pk_fma_f32 v[254:255], v[116:117], v[132:133], v[254:255]
    v_pk_mul_f32 v[250:251], v[248:249], v[150:151] op_sel:[1,0] op_sel_hi:[1,1]
    v_cvt_pk_bf16_f32 v114, v254, v255
    v_pk_fma_f32 v[250:251], v[118:119], v[134:135], v[250:251]
    v_pk_mul_f32 v[252:253], v[232:233], v[152:153] op_sel:[1,0] op_sel_hi:[1,1]
    v_cvt_pk_bf16_f32 v115, v250, v251
    v_pk_fma_f32 v[252:253], v[56:57], v[232:233], v[252:253] op_sel_hi:[1,0,1]
    v_pk_mul_f32 v[254:255], v[232:233], v[154:155] op_sel:[1,0] op_sel_hi:[1,1]
    buffer_store_dwordx4 v[112:115], v0, s[12:15], s27 offen offset:3072 sc1
    ds_write_b128 v199, v[112:115] offset:11264
    v_cvt_pk_bf16_f32 v56, v252, v253
    v_pk_fma_f32 v[254:255], v[58:59], v[232:233], v[254:255] op_sel_hi:[1,0,1]
    v_pk_mul_f32 v[250:251], v[232:233], v[156:157] op_sel:[1,0] op_sel_hi:[1,1]
    v_cvt_pk_bf16_f32 v57, v254, v255
    v_pk_fma_f32 v[250:251], v[72:73], v[232:233], v[250:251] op_sel_hi:[1,0,1]
    v_pk_mul_f32 v[252:253], v[232:233], v[158:159] op_sel:[1,0] op_sel_hi:[1,1]
    v_cvt_pk_bf16_f32 v58, v250, v251
    v_pk_fma_f32 v[252:253], v[74:75], v[232:233], v[252:253] op_sel_hi:[1,0,1]
    v_pk_mul_f32 v[254:255], v[234:235], v[152:153] op_sel:[1,0] op_sel_hi:[1,1]
    v_cvt_pk_bf16_f32 v59, v252, v253
    v_pk_fma_f32 v[254:255], v[60:61], v[234:235], v[254:255] op_sel_hi:[1,0,1]
    v_pk_mul_f32 v[250:251], v[234:235], v[154:155] op_sel:[1,0] op_sel_hi:[1,1]
    buffer_store_dwordx4 v[56:59], v0, s[12:15], s63 offen offset:0 sc1
    ds_write_b128 v199, v[56:59] offset:0
    v_cvt_pk_bf16_f32 v60, v254, v255
    v_pk_fma_f32 v[250:251], v[62:63], v[234:235], v[250:251] op_sel_hi:[1,0,1]
    v_pk_mul_f32 v[252:253], v[234:235], v[156:157] op_sel:[1,0] op_sel_hi:[1,1]
    v_cvt_pk_bf16_f32 v61, v250, v251
    v_pk_fma_f32 v[252:253], v[76:77], v[234:235], v[252:253] op_sel_hi:[1,0,1]
    v_pk_mul_f32 v[254:255], v[234:235], v[158:159] op_sel:[1,0] op_sel_hi:[1,1]
    v_cvt_pk_bf16_f32 v62, v252, v253
    v_pk_fma_f32 v[254:255], v[78:79], v[234:235], v[254:255] op_sel_hi:[1,0,1]
    v_pk_mul_f32 v[250:251], v[136:137], v[248:249] op_sel_hi:[1,0]
    v_cvt_pk_bf16_f32 v63, v254, v255
    v_pk_fma_f32 v[250:251], v[88:89], v[120:121], v[250:251]
    v_pk_mul_f32 v[252:253], v[138:139], v[248:249] op_sel_hi:[1,0]
    buffer_store_dwordx4 v[60:63], v0, s[12:15], s63 offen offset:1024 sc1
    ds_write_b128 v199, v[60:63] offset:1024
    ds_read_b128 v[160:163], v201 offset:0
    ds_read_b64_tr_b16 v[176:177], v202 offset:20480
    ds_read_b64_tr_b16 v[178:179], v202 offset:22528
    ds_read_b128 v[164:167], v201 offset:2048
    ds_read_b128 v[168:171], v201 offset:4096
    ds_read_b128 v[172:175], v201 offset:6144
    ds_read_b64_tr_b16 v[180:181], v203 offset:20480
    ds_read_b64_tr_b16 v[182:183], v203 offset:22528
    v_cvt_pk_bf16_f32 v88, v250, v251
    v_pk_fma_f32 v[252:253], v[90:91], v[122:123], v[252:253]
    v_pk_mul_f32 v[254:255], v[140:141], v[248:249] op_sel_hi:[1,0]
    v_cvt_pk_bf16_f32 v89, v252, v253
    v_pk_fma_f32 v[254:255], v[92:93], v[124:125], v[254:255]
    v_pk_mul_f32 v[250:251], v[142:143], v[248:249] op_sel_hi:[1,0]
    v_cvt_pk_bf16_f32 v90, v254, v255
    v_pk_fma_f32 v[250:251], v[94:95], v[126:127], v[250:251]
    v_pk_mul_f32 v[252:253], v[248:249], v[136:137] op_sel:[1,0] op_sel_hi:[1,1]
    v_cvt_pk_bf16_f32 v91, v250, v251
    v_pk_fma_f32 v[252:253], v[104:105], v[120:121], v[252:253]
    v_pk_mul_f32 v[254:255], v[248:249], v[138:139] op_sel:[1,0] op_sel_hi:[1,1]
    buffer_store_dwordx4 v[88:91], v0, s[12:15], s63 offen offset:2048 sc1
    ds_write_b128 v199, v[88:91] offset:2048
    v_cvt_pk_bf16_f32 v104, v252, v253
    v_pk_fma_f32 v[254:255], v[106:107], v[122:123], v[254:255]
    v_pk_mul_f32 v[250:251], v[248:249], v[140:141] op_sel:[1,0] op_sel_hi:[1,1]
    v_cvt_pk_bf16_f32 v105, v254, v255
    v_pk_fma_f32 v[250:251], v[108:109], v[124:125], v[250:251]
    v_pk_mul_f32 v[252:253], v[248:249], v[142:143] op_sel:[1,0] op_sel_hi:[1,1]
    v_cvt_pk_bf16_f32 v106, v250, v251
    v_pk_fma_f32 v[252:253], v[110:111], v[126:127], v[252:253]
    v_cvt_pk_bf16_f32 v107, v252, v253
    buffer_store_dwordx4 v[104:107], v0, s[12:15], s63 offen offset:3072 sc1
    ds_write_b128 v199, v[104:107] offset:3072
    s_waitcnt lgkmcnt(2)
    v_mfma_f32_16x16x32_bf16 v[24:27], v[176:179], v[160:163], v[24:27]
    ds_read_b128 v[120:123], v200 offset:16384
    v_mfma_f32_16x16x32_bf16 v[28:31], v[176:179], v[164:167], v[28:31]
    ds_read_b64_tr_b16 v[136:137], v202 offset:24576
    v_mfma_f32_16x16x32_bf16 v[32:35], v[176:179], v[168:171], v[32:35]
    ds_read_b64_tr_b16 v[138:139], v202 offset:26624
    v_mfma_f32_16x16x32_bf16 v[36:39], v[176:179], v[172:175], v[36:39]
    ds_read_b128 v[124:127], v200 offset:18432
    v_mfma_f32_16x16x32_bf16 v[52:55], v[180:183], v[172:175], v[52:55]
    ds_read_b128 v[128:131], v200 offset:20480
    v_mfma_f32_16x16x32_bf16 v[48:51], v[180:183], v[168:171], v[48:51]
    ds_read_b128 v[132:135], v200 offset:22528
    v_mfma_f32_16x16x32_bf16 v[44:47], v[180:183], v[164:167], v[44:47]
    ds_read_b64_tr_b16 v[140:141], v203 offset:24576
    v_mfma_f32_16x16x32_bf16 v[40:43], v[180:183], v[160:163], v[40:43]
    ds_read_b64_tr_b16 v[142:143], v203 offset:26624
    s_waitcnt lgkmcnt(5)
    v_mfma_f32_16x16x32_bf16 v[24:27], v[136:139], v[120:123], v[24:27]
    ds_read_b128 v[160:163], v201 offset:16384
    s_waitcnt lgkmcnt(5)
    v_mfma_f32_16x16x32_bf16 v[28:31], v[136:139], v[124:127], v[28:31]
    ds_read_b64_tr_b16 v[176:177], v202 offset:28672
    s_waitcnt lgkmcnt(5)
    v_mfma_f32_16x16x32_bf16 v[32:35], v[136:139], v[128:131], v[32:35]
    ds_read_b64_tr_b16 v[178:179], v202 offset:30720
    s_waitcnt lgkmcnt(5)
    v_mfma_f32_16x16x32_bf16 v[36:39], v[136:139], v[132:135], v[36:39]
    ds_read_b128 v[164:167], v201 offset:18432
    s_waitcnt lgkmcnt(4)
    v_mfma_f32_16x16x32_bf16 v[52:55], v[140:143], v[132:135], v[52:55]
    ds_read_b128 v[168:171], v201 offset:20480
    v_mfma_f32_16x16x32_bf16 v[48:51], v[140:143], v[128:131], v[48:51]
    ds_read_b128 v[172:175], v201 offset:22528
    v_mfma_f32_16x16x32_bf16 v[44:47], v[140:143], v[124:127], v[44:47]
    ds_read_b64_tr_b16 v[180:181], v203 offset:28672
    v_mfma_f32_16x16x32_bf16 v[40:43], v[140:143], v[120:123], v[40:43]
    ds_read_b64_tr_b16 v[182:183], v203 offset:30720
    s_waitcnt lgkmcnt(5)
    v_mfma_f32_16x16x32_bf16 v[24:27], v[176:179], v[160:163], v[24:27]
    ds_read_b128 v[120:123], v200 offset:32768
    s_waitcnt lgkmcnt(5)
    v_mfma_f32_16x16x32_bf16 v[28:31], v[176:179], v[164:167], v[28:31]
    ds_read_b64_tr_b16 v[136:137], v202 offset:32768
    s_waitcnt lgkmcnt(5)
    v_mfma_f32_16x16x32_bf16 v[32:35], v[176:179], v[168:171], v[32:35]
    ds_read_b64_tr_b16 v[138:139], v202 offset:34816
    s_waitcnt lgkmcnt(5)
    v_mfma_f32_16x16x32_bf16 v[36:39], v[176:179], v[172:175], v[36:39]
    ds_read_b128 v[124:127], v200 offset:34816
    s_waitcnt lgkmcnt(4)
    v_mfma_f32_16x16x32_bf16 v[52:55], v[180:183], v[172:175], v[52:55]
    ds_read_b128 v[128:131], v200 offset:36864
    v_mfma_f32_16x16x32_bf16 v[48:51], v[180:183], v[168:171], v[48:51]
    ds_read_b128 v[132:135], v200 offset:38912
    v_mfma_f32_16x16x32_bf16 v[44:47], v[180:183], v[164:167], v[44:47]
    ds_read_b64_tr_b16 v[140:141], v203 offset:32768
    v_mfma_f32_16x16x32_bf16 v[40:43], v[180:183], v[160:163], v[40:43]
    ds_read_b64_tr_b16 v[142:143], v203 offset:34816
    s_waitcnt lgkmcnt(5)
    v_mfma_f32_16x16x32_bf16 v[24:27], v[136:139], v[120:123], v[24:27]
    ds_read_b128 v[160:163], v201 offset:32768
    s_waitcnt lgkmcnt(5)
    v_mfma_f32_16x16x32_bf16 v[28:31], v[136:139], v[124:127], v[28:31]
    ds_read_b64_tr_b16 v[176:177], v202 offset:36864
    s_waitcnt lgkmcnt(5)
    v_mfma_f32_16x16x32_bf16 v[32:35], v[136:139], v[128:131], v[32:35]
    ds_read_b64_tr_b16 v[178:179], v202 offset:38912
    s_waitcnt lgkmcnt(5)
    v_mfma_f32_16x16x32_bf16 v[36:39], v[136:139], v[132:135], v[36:39]
    ds_read_b128 v[164:167], v201 offset:34816
    s_waitcnt lgkmcnt(4)
    v_mfma_f32_16x16x32_bf16 v[52:55], v[140:143], v[132:135], v[52:55]
    ds_read_b128 v[168:171], v201 offset:36864
    v_mfma_f32_16x16x32_bf16 v[48:51], v[140:143], v[128:131], v[48:51]
    ds_read_b128 v[172:175], v201 offset:38912
    v_mfma_f32_16x16x32_bf16 v[44:47], v[140:143], v[124:127], v[44:47]
    ds_read_b64_tr_b16 v[180:181], v203 offset:36864
    v_mfma_f32_16x16x32_bf16 v[40:43], v[140:143], v[120:123], v[40:43]
    ds_read_b64_tr_b16 v[182:183], v203 offset:38912
    s_waitcnt lgkmcnt(3)
    v_mfma_f32_16x16x32_bf16 v[32:35], v[176:179], v[168:171], v[32:35]
    v_mul_f32 v232, 1048744942, v232
    v_mul_f32 v233, 1048744942, v233
    s_waitcnt lgkmcnt(0)
    v_mfma_f32_16x16x32_bf16 v[48:51], v[180:183], v[168:171], v[48:51]
    v_mul_f32 v234, 1048744942, v234
    v_mul_f32 v235, 1048744942, v235
    v_mfma_f32_16x16x32_bf16 v[52:55], v[180:183], v[172:175], v[52:55]
    v_mul_f32 v236, 1048744942, v236
    v_mul_f32 v237, 1048744942, v237
    v_mfma_f32_16x16x32_bf16 v[36:39], v[176:179], v[172:175], v[36:39]
    v_mul_f32 v238, 1048744942, v238
    v_mul_f32 v239, 1048744942, v239
    v_mfma_f32_16x16x32_bf16 v[24:27], v[176:179], v[160:163], v[24:27]
    s_xor_b32 s27, s3, 2
    s_lshl_b32 s27, s27, 11
    v_mfma_f32_16x16x32_bf16 v[40:43], v[180:183], v[160:163], v[40:43]
    s_add_u32 s27, s27, 49152
    v_add_u32 v199, s27, v0
    v_mfma_f32_16x16x32_bf16 v[44:47], v[180:183], v[164:167], v[44:47]
    v_mfma_f32_16x16x32_bf16 v[28:31], v[176:179], v[164:167], v[28:31]
    v_add_u32 v128, s54, v0
    s_lshl_b32 s28, s3, 11
    s_add_u32 s28, s28, 40960
    v_add_u32 v130, s28, v0
    v_subrev_u32 v129, 32768, v128
    v_add_u32 v4, 15360, v3
    v_add_u32 v5, 30720, v3
    v_add_u32 v211, 46080, v3
    v_pk_mul_f32 v[250:251], v[236:237], v[240:241] op_sel:[1,0] op_sel_hi:[1,1]
    v_pk_fma_f32 v[250:251], v[32:33], v[236:237], v[250:251] op_sel_hi:[1,0,1]
    v_pk_mul_f32 v[252:253], v[236:237], v[242:243] op_sel:[1,0] op_sel_hi:[1,1]
    v_cvt_pk_bf16_f32 v32, v250, v251
    v_pk_fma_f32 v[252:253], v[34:35], v[236:237], v[252:253] op_sel_hi:[1,0,1]
    v_pk_mul_f32 v[254:255], v[236:237], v[244:245] op_sel:[1,0] op_sel_hi:[1,1]
    v_cvt_pk_bf16_f32 v33, v252, v253
    v_pk_fma_f32 v[254:255], v[48:49], v[236:237], v[254:255] op_sel_hi:[1,0,1]
    v_pk_mul_f32 v[250:251], v[236:237], v[246:247] op_sel:[1,0] op_sel_hi:[1,1]
    v_cvt_pk_bf16_f32 v34, v254, v255
    v_pk_fma_f32 v[250:251], v[50:51], v[236:237], v[250:251] op_sel_hi:[1,0,1]
    v_pk_mul_f32 v[252:253], v[238:239], v[240:241] op_sel:[1,0] op_sel_hi:[1,1]
    v_cvt_pk_bf16_f32 v35, v250, v251
    v_pk_fma_f32 v[252:253], v[36:37], v[238:239], v[252:253] op_sel_hi:[1,0,1]
    v_pk_mul_f32 v[254:255], v[238:239], v[242:243] op_sel:[1,0] op_sel_hi:[1,1]
    ds_write_b128 v199, v[32:35]
    v_cvt_pk_bf16_f32 v36, v252, v253
    v_pk_fma_f32 v[254:255], v[38:39], v[238:239], v[254:255] op_sel_hi:[1,0,1]
    v_pk_mul_f32 v[250:251], v[238:239], v[244:245] op_sel:[1,0] op_sel_hi:[1,1]
    v_cvt_pk_bf16_f32 v37, v254, v255
    v_pk_fma_f32 v[250:251], v[52:53], v[238:239], v[250:251] op_sel_hi:[1,0,1]
    v_pk_mul_f32 v[252:253], v[238:239], v[246:247] op_sel:[1,0] op_sel_hi:[1,1]
    v_cvt_pk_bf16_f32 v38, v250, v251
    v_pk_fma_f32 v[252:253], v[54:55], v[238:239], v[252:253] op_sel_hi:[1,0,1]
    v_pk_mul_f32 v[254:255], v[232:233], v[240:241] op_sel:[1,0] op_sel_hi:[1,1]
    v_cvt_pk_bf16_f32 v39, v252, v253
    v_pk_fma_f32 v[254:255], v[24:25], v[232:233], v[254:255] op_sel_hi:[1,0,1]
    v_pk_mul_f32 v[250:251], v[232:233], v[242:243] op_sel:[1,0] op_sel_hi:[1,1]
    ds_write_b128 v199, v[36:39] offset:1024
    v_cvt_pk_bf16_f32 v24, v254, v255
    v_pk_fma_f32 v[250:251], v[26:27], v[232:233], v[250:251] op_sel_hi:[1,0,1]
    v_pk_mul_f32 v[252:253], v[232:233], v[244:245] op_sel:[1,0] op_sel_hi:[1,1]
    v_cvt_pk_bf16_f32 v25, v250, v251
    v_pk_fma_f32 v[252:253], v[40:41], v[232:233], v[252:253] op_sel_hi:[1,0,1]
    v_pk_mul_f32 v[254:255], v[232:233], v[246:247] op_sel:[1,0] op_sel_hi:[1,1]
    v_cvt_pk_bf16_f32 v26, v252, v253
    v_pk_fma_f32 v[254:255], v[42:43], v[232:233], v[254:255] op_sel_hi:[1,0,1]
    v_pk_mul_f32 v[250:251], v[234:235], v[240:241] op_sel:[1,0] op_sel_hi:[1,1]
    v_cvt_pk_bf16_f32 v27, v254, v255
    v_pk_fma_f32 v[250:251], v[28:29], v[234:235], v[250:251] op_sel_hi:[1,0,1]
    v_pk_mul_f32 v[252:253], v[234:235], v[242:243] op_sel:[1,0] op_sel_hi:[1,1]
    v_cvt_pk_bf16_f32 v28, v250, v251
    v_pk_fma_f32 v[252:253], v[30:31], v[234:235], v[252:253] op_sel_hi:[1,0,1]
    v_pk_mul_f32 v[254:255], v[234:235], v[244:245] op_sel:[1,0] op_sel_hi:[1,1]
    v_cvt_pk_bf16_f32 v29, v252, v253
    v_pk_fma_f32 v[254:255], v[44:45], v[234:235], v[254:255] op_sel_hi:[1,0,1]
    v_pk_mul_f32 v[250:251], v[234:235], v[246:247] op_sel:[1,0] op_sel_hi:[1,1]
    v_cvt_pk_bf16_f32 v30, v254, v255
    v_pk_fma_f32 v[250:251], v[46:47], v[234:235], v[250:251] op_sel_hi:[1,0,1]
    v_cvt_pk_bf16_f32 v31, v250, v251
    s_lshl_b32 s28, s22, 4
    s_add_u32 s28, s28, s21
    s_lshl_b32 s28, s28, 4
    s_add_u32 s28, s28, s20
    s_lshl_b32 s28, s28, 4
    s_add_u32 s28, s28, s3
    s_lshl_b32 s28, s28, 3
    s_add_u32 s28, s28, 786432
    v_mov_b32 v184, s28
    s_waitcnt vmcnt(0)
    v_mov_b32 v186, s24
    v_mov_b32 v187, s25
    s_mov_b64 exec, 1
    buffer_store_dwordx2 v[186:187], v184, s[12:15], 0 offen sc1
    s_mov_b64 exec, -1
    s_branch L_attA
L_ctailB:
    s_waitcnt lgkmcnt(0)
    v_mfma_f32_16x16x32_bf16 v[24:27], v[136:139], v[120:123], v[24:27]
    ds_read_b128 v[160:163], v201 offset:0
    v_mfma_f32_16x16x32_bf16 v[28:31], v[136:139], v[124:127], v[28:31]
    ds_read_b64_tr_b16 v[176:177], v202 offset:20480
    v_mfma_f32_16x16x32_bf16 v[32:35], v[136:139], v[128:131], v[32:35]
    ds_read_b64_tr_b16 v[178:179], v202 offset:22528
    v_mfma_f32_16x16x32_bf16 v[36:39], v[136:139], v[132:135], v[36:39]
    ds_read_b128 v[164:167], v201 offset:2048
    v_mfma_f32_16x16x32_bf16 v[52:55], v[140:143], v[132:135], v[52:55]
    ds_read_b128 v[168:171], v201 offset:4096
    v_mfma_f32_16x16x32_bf16 v[48:51], v[140:143], v[128:131], v[48:51]
    ds_read_b128 v[172:175], v201 offset:6144
    v_mfma_f32_16x16x32_bf16 v[44:47], v[140:143], v[124:127], v[44:47]
    ds_read_b64_tr_b16 v[180:181], v203 offset:20480
    v_mfma_f32_16x16x32_bf16 v[40:43], v[140:143], v[120:123], v[40:43]
    ds_read_b64_tr_b16 v[182:183], v203 offset:22528
    v_mfma_f32_16x16x32_bf16 v[56:59], v[144:147], v[120:123], v[56:59]
    ds_read_b64_tr_b16 v[184:185], v204 offset:4096
    v_mfma_f32_16x16x32_bf16 v[60:63], v[144:147], v[124:127], v[60:63]
    ds_read_b64_tr_b16 v[186:187], v204 offset:6144
    v_mfma_f32_16x16x32_bf16 v[64:67], v[144:147], v[128:131], v[64:67]
    ds_read_b64_tr_b16 v[188:189], v205 offset:4096
    v_mfma_f32_16x16x32_bf16 v[68:71], v[144:147], v[132:135], v[68:71]
    ds_read_b64_tr_b16 v[190:191], v205 offset:6144
    v_mfma_f32_16x16x32_bf16 v[84:87], v[148:151], v[132:135], v[84:87]
    ds_read_b64_tr_b16 v[192:193], v204 offset:12288
    v_mfma_f32_16x16x32_bf16 v[80:83], v[148:151], v[128:131], v[80:83]
    ds_read_b64_tr_b16 v[194:195], v204 offset:14336
    v_mfma_f32_16x16x32_bf16 v[76:79], v[148:151], v[124:127], v[76:79]
    ds_read_b64_tr_b16 v[196:197], v205 offset:12288
    v_mfma_f32_16x16x32_bf16 v[72:75], v[148:151], v[120:123], v[72:75]
    ds_read_b64_tr_b16 v[198:199], v205 offset:14336
    v_mfma_f32_16x16x32_bf16 v[88:91], v[120:123], v[152:155], v[88:91]
    v_mfma_f32_16x16x32_bf16 v[92:95], v[124:127], v[152:155], v[92:95]
    v_mfma_f32_16x16x32_bf16 v[96:99], v[128:131], v[152:155], v[96:99]
    v_mfma_f32_16x16x32_bf16 v[100:103], v[132:135], v[152:155], v[100:103]
    v_mfma_f32_16x16x32_bf16 v[116:119], v[132:135], v[156:159], v[116:119]
    v_mfma_f32_16x16x32_bf16 v[112:115], v[128:131], v[156:159], v[112:115]
    v_mfma_f32_16x16x32_bf16 v[108:111], v[124:127], v[156:159], v[108:111]
    v_mfma_f32_16x16x32_bf16 v[104:107], v[120:123], v[156:159], v[104:107]
    s_waitcnt lgkmcnt(0)
    v_mfma_f32_16x16x32_bf16 v[24:27], v[176:179], v[160:163], v[24:27]
    v_mfma_f32_16x16x32_bf16 v[28:31], v[176:179], v[164:167], v[28:31]
    s_barrier
    v_mfma_f32_16x16x32_bf16 v[32:35], v[176:179], v[168:171], v[32:35]
    ds_read_b128 v[120:123], v200 offset:16384
    v_mfma_f32_16x16x32_bf16 v[36:39], v[176:179], v[172:175], v[36:39]
    ds_read_b64_tr_b16 v[136:137], v202 offset:24576
    v_mfma_f32_16x16x32_bf16 v[52:55], v[180:183], v[172:175], v[52:55]
    ds_read_b64_tr_b16 v[138:139], v202 offset:26624
    v_mfma_f32_16x16x32_bf16 v[48:51], v[180:183], v[168:171], v[48:51]
    ds_read_b128 v[124:127], v200 offset:18432
    v_mfma_f32_16x16x32_bf16 v[44:47], v[180:183], v[164:167], v[44:47]
    ds_read_b128 v[128:131], v200 offset:20480
    v_mfma_f32_16x16x32_bf16 v[40:43], v[180:183], v[160:163], v[40:43]
    ds_read_b128 v[132:135], v200 offset:22528
    v_mfma_f32_16x16x32_bf16 v[56:59], v[184:187], v[160:163], v[56:59]
    ds_read_b64_tr_b16 v[140:141], v203 offset:24576
    v_mfma_f32_16x16x32_bf16 v[60:63], v[184:187], v[164:167], v[60:63]
    ds_read_b64_tr_b16 v[142:143], v203 offset:26624
    v_mfma_f32_16x16x32_bf16 v[64:67], v[184:187], v[168:171], v[64:67]
    ds_read_b64_tr_b16 v[144:145], v204 offset:16384
    v_mfma_f32_16x16x32_bf16 v[68:71], v[184:187], v[172:175], v[68:71]
    ds_read_b64_tr_b16 v[146:147], v204 offset:18432
    v_mfma_f32_16x16x32_bf16 v[84:87], v[188:191], v[172:175], v[84:87]
    ds_read_b64_tr_b16 v[148:149], v205 offset:16384
    v_mfma_f32_16x16x32_bf16 v[80:83], v[188:191], v[168:171], v[80:83]
    ds_read_b64_tr_b16 v[150:151], v205 offset:18432
    v_mfma_f32_16x16x32_bf16 v[76:79], v[188:191], v[164:167], v[76:79]
    ds_read_b64_tr_b16 v[152:153], v204 offset:24576
    v_mfma_f32_16x16x32_bf16 v[72:75], v[188:191], v[160:163], v[72:75]
    ds_read_b64_tr_b16 v[154:155], v204 offset:26624
    v_mfma_f32_16x16x32_bf16 v[88:91], v[160:163], v[192:195], v[88:91]
    ds_read_b64_tr_b16 v[156:157], v205 offset:24576
    v_mfma_f32_16x16x32_bf16 v[92:95], v[164:167], v[192:195], v[92:95]
    ds_read_b64_tr_b16 v[158:159], v205 offset:26624
    v_mfma_f32_16x16x32_bf16 v[96:99], v[168:171], v[192:195], v[96:99]
    v_mfma_f32_16x16x32_bf16 v[100:103], v[172:175], v[192:195], v[100:103]
    v_mfma_f32_16x16x32_bf16 v[116:119], v[172:175], v[196:199], v[116:119]
    v_mfma_f32_16x16x32_bf16 v[112:115], v[168:171], v[196:199], v[112:115]
    v_mfma_f32_16x16x32_bf16 v[108:111], v[164:167], v[196:199], v[108:111]
    v_mfma_f32_16x16x32_bf16 v[104:107], v[160:163], v[196:199], v[104:107]
    s_waitcnt lgkmcnt(0)
    v_mfma_f32_16x16x32_bf16 v[24:27], v[136:139], v[120:123], v[24:27]
    ds_read_b128 v[160:163], v201 offset:16384
    v_mfma_f32_16x16x32_bf16 v[28:31], v[136:139], v[124:127], v[28:31]
    ds_read_b64_tr_b16 v[176:177], v202 offset:28672
    v_mfma_f32_16x16x32_bf16 v[32:35], v[136:139], v[128:131], v[32:35]
    ds_read_b64_tr_b16 v[178:179], v202 offset:30720
    v_mfma_f32_16x16x32_bf16 v[36:39], v[136:139], v[132:135], v[36:39]
    ds_read_b128 v[164:167], v201 offset:18432
    v_mfma_f32_16x16x32_bf16 v[52:55], v[140:143], v[132:135], v[52:55]
    ds_read_b128 v[168:171], v201 offset:20480
    v_mfma_f32_16x16x32_bf16 v[48:51], v[140:143], v[128:131], v[48:51]
    ds_read_b128 v[172:175], v201 offset:22528
    v_mfma_f32_16x16x32_bf16 v[44:47], v[140:143], v[124:127], v[44:47]
    ds_read_b64_tr_b16 v[180:181], v203 offset:28672
    v_mfma_f32_16x16x32_bf16 v[40:43], v[140:143], v[120:123], v[40:43]
    ds_read_b64_tr_b16 v[182:183], v203 offset:30720
    v_mfma_f32_16x16x32_bf16 v[56:59], v[144:147], v[120:123], v[56:59]
    ds_read_b64_tr_b16 v[184:185], v204 offset:20480
    v_mfma_f32_16x16x32_bf16 v[60:63], v[144:147], v[124:127], v[60:63]
    ds_read_b64_tr_b16 v[186:187], v204 offset:22528
    v_mfma_f32_16x16x32_bf16 v[64:67], v[144:147], v[128:131], v[64:67]
    ds_read_b64_tr_b16 v[188:189], v205 offset:20480
    v_mfma_f32_16x16x32_bf16 v[68:71], v[144:147], v[132:135], v[68:71]
    ds_read_b64_tr_b16 v[190:191], v205 offset:22528
    v_mfma_f32_16x16x32_bf16 v[84:87], v[148:151], v[132:135], v[84:87]
    ds_read_b64_tr_b16 v[192:193], v204 offset:28672
    v_mfma_f32_16x16x32_bf16 v[80:83], v[148:151], v[128:131], v[80:83]
    ds_read_b64_tr_b16 v[194:195], v204 offset:30720
    v_mfma_f32_16x16x32_bf16 v[76:79], v[148:151], v[124:127], v[76:79]
    ds_read_b64_tr_b16 v[196:197], v205 offset:28672
    v_mfma_f32_16x16x32_bf16 v[72:75], v[148:151], v[120:123], v[72:75]
    ds_read_b64_tr_b16 v[198:199], v205 offset:30720
    v_mfma_f32_16x16x32_bf16 v[88:91], v[120:123], v[152:155], v[88:91]
    v_mfma_f32_16x16x32_bf16 v[92:95], v[124:127], v[152:155], v[92:95]
    v_mfma_f32_16x16x32_bf16 v[96:99], v[128:131], v[152:155], v[96:99]
    v_mfma_f32_16x16x32_bf16 v[100:103], v[132:135], v[152:155], v[100:103]
    v_mfma_f32_16x16x32_bf16 v[116:119], v[132:135], v[156:159], v[116:119]
    v_mfma_f32_16x16x32_bf16 v[112:115], v[128:131], v[156:159], v[112:115]
    v_mfma_f32_16x16x32_bf16 v[108:111], v[124:127], v[156:159], v[108:111]
    v_mfma_f32_16x16x32_bf16 v[104:107], v[120:123], v[156:159], v[104:107]
    s_waitcnt lgkmcnt(0)
    v_mfma_f32_16x16x32_bf16 v[24:27], v[176:179], v[160:163], v[24:27]
    v_mfma_f32_16x16x32_bf16 v[28:31], v[176:179], v[164:167], v[28:31]
    s_barrier
    v_mfma_f32_16x16x32_bf16 v[32:35], v[176:179], v[168:171], v[32:35]
    ds_read_b128 v[120:123], v200 offset:32768
    v_mfma_f32_16x16x32_bf16 v[36:39], v[176:179], v[172:175], v[36:39]
    ds_read_b64_tr_b16 v[136:137], v202 offset:32768
    v_mfma_f32_16x16x32_bf16 v[52:55], v[180:183], v[172:175], v[52:55]
    ds_read_b64_tr_b16 v[138:139], v202 offset:34816
    v_mfma_f32_16x16x32_bf16 v[48:51], v[180:183], v[168:171], v[48:51]
    ds_read_b128 v[124:127], v200 offset:34816
    v_mfma_f32_16x16x32_bf16 v[44:47], v[180:183], v[164:167], v[44:47]
    ds_read_b128 v[128:131], v200 offset:36864
    v_mfma_f32_16x16x32_bf16 v[40:43], v[180:183], v[160:163], v[40:43]
    ds_read_b128 v[132:135], v200 offset:38912
    v_mfma_f32_16x16x32_bf16 v[56:59], v[184:187], v[160:163], v[56:59]
    ds_read_b64_tr_b16 v[140:141], v203 offset:32768
    v_mfma_f32_16x16x32_bf16 v[60:63], v[184:187], v[164:167], v[60:63]
    ds_read_b64_tr_b16 v[142:143], v203 offset:34816
    v_mfma_f32_16x16x32_bf16 v[64:67], v[184:187], v[168:171], v[64:67]
    ds_read_b64_tr_b16 v[144:145], v202 offset:0
    v_mfma_f32_16x16x32_bf16 v[68:71], v[184:187], v[172:175], v[68:71]
    ds_read_b64_tr_b16 v[146:147], v202 offset:2048
    v_mfma_f32_16x16x32_bf16 v[84:87], v[188:191], v[172:175], v[84:87]
    ds_read_b64_tr_b16 v[148:149], v203 offset:0
    v_mfma_f32_16x16x32_bf16 v[80:83], v[188:191], v[168:171], v[80:83]
    ds_read_b64_tr_b16 v[150:151], v203 offset:2048
    v_mfma_f32_16x16x32_bf16 v[76:79], v[188:191], v[164:167], v[76:79]
    ds_read_b64_tr_b16 v[152:153], v202 offset:8192
    v_mfma_f32_16x16x32_bf16 v[72:75], v[188:191], v[160:163], v[72:75]
    ds_read_b64_tr_b16 v[154:155], v202 offset:10240
    v_mfma_f32_16x16x32_bf16 v[88:91], v[160:163], v[192:195], v[88:91]
    ds_read_b64_tr_b16 v[156:157], v203 offset:8192
    v_mfma_f32_16x16x32_bf16 v[92:95], v[164:167], v[192:195], v[92:95]
    ds_read_b64_tr_b16 v[158:159], v203 offset:10240
    v_mfma_f32_16x16x32_bf16 v[96:99], v[168:171], v[192:195], v[96:99]
    v_mfma_f32_16x16x32_bf16 v[100:103], v[172:175], v[192:195], v[100:103]
    v_mfma_f32_16x16x32_bf16 v[116:119], v[172:175], v[196:199], v[116:119]
    v_mfma_f32_16x16x32_bf16 v[112:115], v[168:171], v[196:199], v[112:115]
    v_mfma_f32_16x16x32_bf16 v[108:111], v[164:167], v[196:199], v[108:111]
    v_mfma_f32_16x16x32_bf16 v[104:107], v[160:163], v[196:199], v[104:107]
    s_waitcnt lgkmcnt(0)
    v_mfma_f32_16x16x32_bf16 v[24:27], v[136:139], v[120:123], v[24:27]
    ds_read_b128 v[160:163], v201 offset:32768
    v_mfma_f32_16x16x32_bf16 v[28:31], v[136:139], v[124:127], v[28:31]
    ds_read_b64_tr_b16 v[176:177], v202 offset:36864
    v_mfma_f32_16x16x32_bf16 v[32:35], v[136:139], v[128:131], v[32:35]
    ds_read_b64_tr_b16 v[178:179], v202 offset:38912
    v_mfma_f32_16x16x32_bf16 v[36:39], v[136:139], v[132:135], v[36:39]
    ds_read_b128 v[164:167], v201 offset:34816
    v_mfma_f32_16x16x32_bf16 v[52:55], v[140:143], v[132:135], v[52:55]
    ds_read_b128 v[168:171], v201 offset:36864
    v_mfma_f32_16x16x32_bf16 v[48:51], v[140:143], v[128:131], v[48:51]
    ds_read_b128 v[172:175], v201 offset:38912
    v_mfma_f32_16x16x32_bf16 v[44:47], v[140:143], v[124:127], v[44:47]
    ds_read_b64_tr_b16 v[180:181], v203 offset:36864
    v_mfma_f32_16x16x32_bf16 v[40:43], v[140:143], v[120:123], v[40:43]
    ds_read_b64_tr_b16 v[182:183], v203 offset:38912
    v_mfma_f32_16x16x32_bf16 v[56:59], v[144:147], v[120:123], v[56:59]
    ds_read_b64_tr_b16 v[184:185], v202 offset:4096
    v_mfma_f32_16x16x32_bf16 v[60:63], v[144:147], v[124:127], v[60:63]
    ds_read_b64_tr_b16 v[186:187], v202 offset:6144
    v_mfma_f32_16x16x32_bf16 v[64:67], v[144:147], v[128:131], v[64:67]
    ds_read_b64_tr_b16 v[188:189], v203 offset:4096
    v_mfma_f32_16x16x32_bf16 v[68:71], v[144:147], v[132:135], v[68:71]
    ds_read_b64_tr_b16 v[190:191], v203 offset:6144
    v_mfma_f32_16x16x32_bf16 v[84:87], v[148:151], v[132:135], v[84:87]
    ds_read_b64_tr_b16 v[192:193], v202 offset:12288
    v_mfma_f32_16x16x32_bf16 v[80:83], v[148:151], v[128:131], v[80:83]
    ds_read_b64_tr_b16 v[194:195], v202 offset:14336
    v_mfma_f32_16x16x32_bf16 v[76:79], v[148:151], v[124:127], v[76:79]
    ds_read_b64_tr_b16 v[196:197], v203 offset:12288
    v_mfma_f32_16x16x32_bf16 v[72:75], v[148:151], v[120:123], v[72:75]
    ds_read_b64_tr_b16 v[198:199], v203 offset:14336
    v_mfma_f32_16x16x32_bf16 v[88:91], v[120:123], v[152:155], v[88:91]
    v_mov_b32 v255, 92928
    v_mfma_f32_16x16x32_bf16 v[92:95], v[124:127], v[152:155], v[92:95]
    s_lshl_b32 s27, s3, 11
    v_mfma_f32_16x16x32_bf16 v[96:99], v[128:131], v[152:155], v[96:99]
    s_add_u32 s27, s27, 49152
    v_mfma_f32_16x16x32_bf16 v[100:103], v[132:135], v[152:155], v[100:103]
    v_add_u32 v4, s27, v0
    v_mfma_f32_16x16x32_bf16 v[116:119], v[132:135], v[156:159], v[116:119]
    v_add_u32 v5, s49, v0
    v_mfma_f32_16x16x32_bf16 v[112:115], v[128:131], v[156:159], v[112:115]
    s_add_u32 s49, s49, 65536
    v_mfma_f32_16x16x32_bf16 v[108:111], v[124:127], v[156:159], v[108:111]
    v_mfma_f32_16x16x32_bf16 v[104:107], v[120:123], v[156:159], v[104:107]
    s_waitcnt lgkmcnt(0)
    s_barrier
    v_mfma_f32_16x16x32_bf16 v[68:71], v[184:187], v[172:175], v[68:71]
    ds_read_b128 v[152:155], v209 offset:256
    v_mfma_f32_16x16x32_bf16 v[84:87], v[188:191], v[172:175], v[84:87]
    ds_read_b128 v[156:159], v209 offset:320
    v_mfma_f32_16x16x32_bf16 v[100:103], v[172:175], v[192:195], v[100:103]
    ds_read_b64 v[238:239], v207 offset:1408
    v_mfma_f32_16x16x32_bf16 v[116:119], v[172:175], v[196:199], v[116:119]
    ds_read_b32 v248, v210 offset:512
    v_mfma_f32_16x16x32_bf16 v[112:115], v[168:171], v[196:199], v[112:115]
    ds_read_b32 v249, v210 offset:576
    v_mfma_f32_16x16x32_bf16 v[108:111], v[164:167], v[196:199], v[108:111]
    ds_read_b128 v[132:135], v208 offset:192
    v_mfma_f32_16x16x32_bf16 v[104:107], v[160:163], v[196:199], v[104:107]
    ds_read_b128 v[148:151], v208 offset:704
    v_mfma_f32_16x16x32_bf16 v[88:91], v[160:163], v[192:195], v[88:91]
    ds_read_b32 v255, v255
    v_mfma_f32_16x16x32_bf16 v[92:95], v[164:167], v[192:195], v[92:95]
    ds_read_b64 v[236:237], v207 offset:1280
    v_mfma_f32_16x16x32_bf16 v[96:99], v[168:171], v[192:195], v[96:99]
    ds_read_b64 v[234:235], v207 offset:1152
    v_mfma_f32_16x16x32_bf16 v[80:83], v[188:191], v[168:171], v[80:83]
    ds_read_b128 v[128:131], v208 offset:128
    v_mfma_f32_16x16x32_bf16 v[76:79], v[188:191], v[164:167], v[76:79]
    ds_read_b128 v[144:147], v208 offset:640
    v_mfma_f32_16x16x32_bf16 v[72:75], v[188:191], v[160:163], v[72:75]
    ds_read_b128 v[124:127], v208 offset:64
    v_mfma_f32_16x16x32_bf16 v[56:59], v[184:187], v[160:163], v[56:59]
    ds_read_b128 v[140:143], v208 offset:576
    v_mfma_f32_16x16x32_bf16 v[60:63], v[184:187], v[164:167], v[60:63]
    ds_read_b128 v[240:243], v209 offset:0
    v_mfma_f32_16x16x32_bf16 v[64:67], v[184:187], v[168:171], v[64:67]
    ds_read_b128 v[244:247], v209 offset:64
    v_mfma_f32_16x16x32_bf16 v[24:27], v[176:179], v[160:163], v[24:27]
    ds_read_b64 v[232:233], v207 offset:1024
    v_mfma_f32_16x16x32_bf16 v[28:31], v[176:179], v[164:167], v[28:31]
    ds_read_b128 v[120:123], v208 offset:0
    v_mfma_f32_16x16x32_bf16 v[32:35], v[176:179], v[168:171], v[32:35]
    ds_read_b128 v[136:139], v208 offset:512
    v_mfma_f32_16x16x32_bf16 v[36:39], v[176:179], v[172:175], v[36:39]
    v_mfma_f32_16x16x32_bf16 v[52:55], v[180:183], v[172:175], v[52:55]
    v_mfma_f32_16x16x32_bf16 v[48:51], v[180:183], v[168:171], v[48:51]
    v_mfma_f32_16x16x32_bf16 v[44:47], v[180:183], v[164:167], v[44:47]
    v_mfma_f32_16x16x32_bf16 v[40:43], v[180:183], v[160:163], v[40:43]
    s_waitcnt lgkmcnt(0)
    v_readfirstlane_b32 s23, v255
    v_pk_mul_f32 v[250:251], v[238:239], v[152:153] op_sel:[1,0] op_sel_hi:[1,1]
    v_pk_fma_f32 v[250:251], v[68:69], v[238:239], v[250:251] op_sel_hi:[1,0,1]
    v_pk_mul_f32 v[252:253], v[238:239], v[154:155] op_sel:[1,0] op_sel_hi:[1,1]
    v_cvt_pk_bf16_f32 v68, v250, v251
    v_pk_fma_f32 v[252:253], v[70:71], v[238:239], v[252:253] op_sel_hi:[1,0,1]
    v_pk_mul_f32 v[254:255], v[238:239], v[156:157] op_sel:[1,0] op_sel_hi:[1,1]
    v_cvt_pk_bf16_f32 v69, v252, v253
    v_pk_fma_f32 v[254:255], v[84:85], v[238:239], v[254:255] op_sel_hi:[1,0,1]
    v_pk_mul_f32 v[250:251], v[238:239], v[158:159] op_sel:[1,0] op_sel_hi:[1,1]
    v_cvt_pk_bf16_f32 v70, v254, v255
    v_pk_fma_f32 v[250:251], v[86:87], v[238:239], v[250:251] op_sel_hi:[1,0,1]
    v_pk_mul_f32 v[252:253], v[148:149], v[248:249] op_sel_hi:[1,0]
    v_cvt_pk_bf16_f32 v71, v250, v251
    v_pk_fma_f32 v[252:253], v[100:101], v[132:133], v[252:253]
    v_pk_mul_f32 v[254:255], v[150:151], v[248:249] op_sel_hi:[1,0]
    v_min_u32 v68, -2, v68
    buffer_store_dwordx4 v[68:71], v5, s[12:15], 0 offen offset:0 sc1
    ds_write_b128 v4, v[68:71] offset:4096
    v_mul_f32 v238, 1048744942, v238
    v_mul_f32 v239, 1048744942, v239
    v_cvt_pk_bf16_f32 v100, v252, v253
    v_pk_fma_f32 v[254:255], v[102:103], v[134:135], v[254:255]
    v_pk_mul_f32 v[250:251], v[248:249], v[148:149] op_sel:[1,0] op_sel_hi:[1,1]
    v_cvt_pk_bf16_f32 v101, v254, v255
    v_pk_fma_f32 v[250:251], v[116:117], v[132:133], v[250:251]
    v_pk_mul_f32 v[252:253], v[248:249], v[150:151] op_sel:[1,0] op_sel_hi:[1,1]
    v_cvt_pk_bf16_f32 v102, v250, v251
    v_pk_fma_f32 v[252:253], v[118:119], v[134:135], v[252:253]
    v_pk_mul_f32 v[254:255], v[236:237], v[152:153] op_sel:[1,0] op_sel_hi:[1,1]
    v_cvt_pk_bf16_f32 v103, v252, v253
    v_pk_fma_f32 v[254:255], v[64:65], v[236:237], v[254:255] op_sel_hi:[1,0,1]
    v_pk_mul_f32 v[250:251], v[236:237], v[154:155] op_sel:[1,0] op_sel_hi:[1,1]
    v_min_u32 v100, -2, v100
    buffer_store_dwordx4 v[100:103], v5, s[12:15], 0 offen offset:1024 sc1
    ds_write_b128 v4, v[100:103] offset:5120
    v_mov_b32 v168, v100
    v_mov_b32 v169, v101
    v_mov_b32 v178, v102
    v_mov_b32 v179, v103
    v_cvt_pk_bf16_f32 v64, v254, v255
    v_pk_fma_f32 v[250:251], v[66:67], v[236:237], v[250:251] op_sel_hi:[1,0,1]
    v_pk_mul_f32 v[252:253], v[236:237], v[156:157] op_sel:[1,0] op_sel_hi:[1,1]
    v_cvt_pk_bf16_f32 v65, v250, v251
    v_pk_fma_f32 v[252:253], v[80:81], v[236:237], v[252:253] op_sel_hi:[1,0,1]
    v_pk_mul_f32 v[254:255], v[236:237], v[158:159] op_sel:[1,0] op_sel_hi:[1,1]
    v_cvt_pk_bf16_f32 v66, v252, v253
    v_pk_fma_f32 v[254:255], v[82:83], v[236:237], v[254:255] op_sel_hi:[1,0,1]
    v_pk_mul_f32 v[250:251], v[234:235], v[152:153] op_sel:[1,0] op_sel_hi:[1,1]
    v_cvt_pk_bf16_f32 v67, v254, v255
    v_pk_fma_f32 v[250:251], v[60:61], v[234:235], v[250:251] op_sel_hi:[1,0,1]
    v_pk_mul_f32 v[252:253], v[234:235], v[154:155] op_sel:[1,0] op_sel_hi:[1,1]
    v_mul_f32 v236, 1048744942, v236
    v_mul_f32 v237, 1048744942, v237
    v_cvt_pk_bf16_f32 v60, v250, v251
    v_pk_fma_f32 v[252:253], v[62:63], v[234:235], v[252:253] op_sel_hi:[1,0,1]
    v_pk_mul_f32 v[254:255], v[234:235], v[156:157] op_sel:[1,0] op_sel_hi:[1,1]
    v_cvt_pk_bf16_f32 v61, v252, v253
    v_pk_fma_f32 v[254:255], v[76:77], v[234:235], v[254:255] op_sel_hi:[1,0,1]
    v_pk_mul_f32 v[250:251], v[234:235], v[158:159] op_sel:[1,0] op_sel_hi:[1,1]
    v_cvt_pk_bf16_f32 v62, v254, v255
    v_pk_fma_f32 v[250:251], v[78:79], v[234:235], v[250:251] op_sel_hi:[1,0,1]
    v_pk_mul_f32 v[252:253], v[238:239], v[240:241] op_sel:[1,0] op_sel_hi:[1,1]
    v_cvt_pk_bf16_f32 v63, v250, v251
    v_pk_fma_f32 v[252:253], v[36:37], v[238:239], v[252:253] op_sel_hi:[1,0,1]
    v_pk_mul_f32 v[254:255], v[238:239], v[242:243] op_sel:[1,0] op_sel_hi:[1,1]
    v_mul_f32 v234, 1048744942, v234
    v_mul_f32 v235, 1048744942, v235
    v_cvt_pk_bf16_f32 v36, v252, v253
    v_pk_fma_f32 v[254:255], v[38:39], v[238:239], v[254:255] op_sel_hi:[1,0,1]
    v_pk_mul_f32 v[250:251], v[238:239], v[244:245] op_sel:[1,0] op_sel_hi:[1,1]
    v_cvt_pk_bf16_f32 v37, v254, v255
    v_pk_fma_f32 v[250:251], v[52:53], v[238:239], v[250:251] op_sel_hi:[1,0,1]
    v_pk_mul_f32 v[252:253], v[238:239], v[246:247] op_sel:[1,0] op_sel_hi:[1,1]
    v_cvt_pk_bf16_f32 v38, v250, v251
    v_pk_fma_f32 v[252:253], v[54:55], v[238:239], v[252:253] op_sel_hi:[1,0,1]
    v_pk_mul_f32 v[254:255], v[236:237], v[240:241] op_sel:[1,0] op_sel_hi:[1,1]
    v_cvt_pk_bf16_f32 v39, v252, v253
    v_pk_fma_f32 v[254:255], v[32:33], v[236:237], v[254:255] op_sel_hi:[1,0,1]
    v_pk_mul_f32 v[250:251], v[236:237], v[242:243] op_sel:[1,0] op_sel_hi:[1,1]
    v_cvt_pk_bf16_f32 v32, v254, v255
    v_pk_fma_f32 v[250:251], v[34:35], v[236:237], v[250:251] op_sel_hi:[1,0,1]
    v_pk_mul_f32 v[252:253], v[236:237], v[244:245] op_sel:[1,0] op_sel_hi:[1,1]
    v_cvt_pk_bf16_f32 v33, v250, v251
    v_pk_fma_f32 v[252:253], v[48:49], v[236:237], v[252:253] op_sel_hi:[1,0,1]
    v_pk_mul_f32 v[254:255], v[236:237], v[246:247] op_sel:[1,0] op_sel_hi:[1,1]
    v_cvt_pk_bf16_f32 v34, v252, v253
    v_pk_fma_f32 v[254:255], v[50:51], v[236:237], v[254:255] op_sel_hi:[1,0,1]
    v_pk_mul_f32 v[250:251], v[144:145], v[248:249] op_sel_hi:[1,0]
    v_cvt_pk_bf16_f32 v35, v254, v255
    v_pk_fma_f32 v[250:251], v[96:97], v[128:129], v[250:251]
    v_pk_mul_f32 v[252:253], v[146:147], v[248:249] op_sel_hi:[1,0]
    v_cvt_pk_bf16_f32 v166, v250, v251
    v_pk_fma_f32 v[252:253], v[98:99], v[130:131], v[252:253]
    v_pk_mul_f32 v[254:255], v[248:249], v[144:145] op_sel:[1,0] op_sel_hi:[1,1]
    v_cvt_pk_bf16_f32 v167, v252, v253
    v_pk_fma_f32 v[254:255], v[112:113], v[128:129], v[254:255]
    v_pk_mul_f32 v[250:251], v[248:249], v[146:147] op_sel:[1,0] op_sel_hi:[1,1]
    v_cvt_pk_bf16_f32 v176, v254, v255
    v_pk_fma_f32 v[250:251], v[114:115], v[130:131], v[250:251]
    v_pk_mul_f32 v[252:253], v[140:141], v[248:249] op_sel_hi:[1,0]
    v_cvt_pk_bf16_f32 v177, v250, v251
    v_pk_fma_f32 v[252:253], v[92:93], v[124:125], v[252:253]
    v_pk_mul_f32 v[254:255], v[142:143], v[248:249] op_sel_hi:[1,0]
    v_cvt_pk_bf16_f32 v164, v252, v253
    v_pk_fma_f32 v[254:255], v[94:95], v[126:127], v[254:255]
    v_pk_mul_f32 v[250:251], v[248:249], v[140:141] op_sel:[1,0] op_sel_hi:[1,1]
    v_cvt_pk_bf16_f32 v165, v254, v255
    v_pk_fma_f32 v[250:251], v[108:109], v[124:125], v[250:251]
    v_pk_mul_f32 v[252:253], v[248:249], v[142:143] op_sel:[1,0] op_sel_hi:[1,1]
    v_cvt_pk_bf16_f32 v174, v250, v251
    v_pk_fma_f32 v[252:253], v[110:111], v[126:127], v[252:253]
    v_cvt_pk_bf16_f32 v175, v252, v253
    s_waitcnt lgkmcnt(0)
    s_add_u32 s27, s62, 65536
    v_mfma_f32_16x16x32_bf16 v[184:187], v[68:71], v[36:39], v[216:219]
    v_mfma_f32_16x16x32_bf16 v[188:191], v[64:67], v[36:39], v[220:223]
    v_mfma_f32_16x16x32_bf16 v[192:195], v[64:67], v[32:35], v[216:219]
    v_mfma_f32_16x16x32_bf16 v[196:199], v[60:63], v[32:35], v[220:223]
    v_pk_mul_f32 v[250:251], v[232:233], v[152:153] op_sel:[1,0] op_sel_hi:[1,1]
    v_pk_fma_f32 v[250:251], v[56:57], v[232:233], v[250:251] op_sel_hi:[1,0,1]
    v_pk_mul_f32 v[252:253], v[232:233], v[154:155] op_sel:[1,0] op_sel_hi:[1,1]
    v_cvt_pk_bf16_f32 v56, v250, v251
    v_pk_fma_f32 v[252:253], v[58:59], v[232:233], v[252:253] op_sel_hi:[1,0,1]
    v_pk_mul_f32 v[254:255], v[232:233], v[156:157] op_sel:[1,0] op_sel_hi:[1,1]
    v_max3_f32 v84, v184, v185, v188
    v_cvt_pk_bf16_f32 v57, v252, v253
    v_max3_f32 v100, v192, v193, v196
    v_max3_f32 v85, v186, v187, v190
    v_max3_f32 v101, v194, v195, v198
    v_max_f32 v84, v84, v189
    v_max_f32 v100, v100, v197
    v_max_f32 v85, v85, v191
    v_max_f32 v101, v101, v199
    v_max_f32 v86, v84, v85
    v_max_f32 v102, v100, v101
    v_pk_fma_f32 v[254:255], v[72:73], v[232:233], v[254:255] op_sel_hi:[1,0,1]
    v_pk_mul_f32 v[250:251], v[232:233], v[158:159] op_sel:[1,0] op_sel_hi:[1,1]
    v_permlane16_swap_b32 v86, v102
    v_cvt_pk_bf16_f32 v58, v254, v255
    v_max_f32 v86, v86, v102
    v_pk_fma_f32 v[250:251], v[74:75], v[232:233], v[250:251] op_sel_hi:[1,0,1]
    v_mov_b32 v102, v86
    v_pk_mul_f32 v[252:253], v[136:137], v[248:249] op_sel_hi:[1,0]
    v_cvt_pk_bf16_f32 v59, v250, v251
    v_permlane32_swap_b32 v86, v102
    v_pk_fma_f32 v[252:253], v[88:89], v[120:121], v[252:253]
    v_max_f32 v86, v86, v102
    v_pk_mul_f32 v[254:255], v[138:139], v[248:249] op_sel_hi:[1,0]
    v_mov_b32 v102, v86
    v_mul_f32 v232, 1048744942, v232
    v_mul_f32 v233, 1048744942, v233
    v_permlane16_swap_b32 v86, v102
    v_cvt_pk_bf16_f32 v162, v252, v253
    v_sub_f32 v84, v84, v86
    v_sub_f32 v100, v100, v102
    v_sub_f32 v85, v85, v86
    v_sub_f32 v101, v101, v102
    v_exp_f32 v84, v84
    v_exp_f32 v100, v100
    v_exp_f32 v85, v85
    v_exp_f32 v101, v101
    v_cvt_pk_bf16_f32 v84, v84, v84
    v_cvt_pk_bf16_f32 v100, v100, v100
    v_cvt_pk_bf16_f32 v85, v85, v85
    v_cvt_pk_bf16_f32 v101, v101, v101
    v_and_b32 v48, v84, v224
    v_and_b32 v52, v100, v224
    v_and_b32 v49, v85, v225
    v_and_b32 v53, v101, v225
    v_and_b32 v50, v84, v226
    v_and_b32 v54, v100, v226
    v_and_b32 v51, v85, v227
    v_and_b32 v55, v101, v227
    v_pk_fma_f32 v[254:255], v[90:91], v[122:123], v[254:255]
    v_mfma_f32_16x16x32_bf16 v[108:111], v[212:215], v[48:51], 0
    v_mfma_f32_16x16x32_bf16 v[76:79], v[166:169], v[48:51], 0
    v_mfma_f32_16x16x32_bf16 v[80:83], v[176:179], v[48:51], 0
    v_mfma_f32_16x16x32_bf16 v[112:115], v[212:215], v[52:55], 0
    v_mfma_f32_16x16x32_bf16 v[92:95], v[164:167], v[52:55], 0
    v_mfma_f32_16x16x32_bf16 v[96:99], v[174:177], v[52:55], 0
    v_pk_mul_f32 v[250:251], v[248:249], v[136:137] op_sel:[1,0] op_sel_hi:[1,1]
    v_cvt_pk_bf16_f32 v163, v254, v255
    v_pk_fma_f32 v[250:251], v[104:105], v[120:121], v[250:251]
    v_rcp_f32 v84, v108
    v_pk_mul_f32 v[252:253], v[248:249], v[138:139] op_sel:[1,0] op_sel_hi:[1,1]
    v_cvt_pk_bf16_f32 v172, v250, v251
    v_rcp_f32 v100, v112
    v_pk_mul_f32 v[76:77], v[76:77], v[84:85] op_sel_hi:[1,0]
    v_pk_mul_f32 v[92:93], v[92:93], v[100:101] op_sel_hi:[1,0]
    v_pk_mul_f32 v[78:79], v[78:79], v[84:85] op_sel_hi:[1,0]
    v_pk_mul_f32 v[94:95], v[94:95], v[100:101] op_sel_hi:[1,0]
    v_pk_mul_f32 v[80:81], v[80:81], v[84:85] op_sel_hi:[1,0]
    v_pk_mul_f32 v[96:97], v[96:97], v[100:101] op_sel_hi:[1,0]
    v_pk_mul_f32 v[82:83], v[82:83], v[84:85] op_sel_hi:[1,0]
    v_pk_mul_f32 v[98:99], v[98:99], v[100:101] op_sel_hi:[1,0]
    v_add_u32 v76, 0x8000, v76
    v_add_u32 v92, 0x8000, v92
    v_cvt_pk_bf16_f32 v76, v76, v77
    v_cvt_pk_bf16_f32 v92, v92, v93
    v_cvt_pk_bf16_f32 v77, v78, v79
    v_cvt_pk_bf16_f32 v93, v94, v95
    v_cvt_pk_bf16_f32 v78, v80, v81
    v_cvt_pk_bf16_f32 v94, v96, v97
    v_cvt_pk_bf16_f32 v79, v82, v83
    v_cvt_pk_bf16_f32 v95, v98, v99
    v_and_b32 v76, -2, v76
    v_and_b32 v92, -2, v92
    v_pk_fma_f32 v[252:253], v[106:107], v[122:123], v[252:253]
    v_pk_mul_f32 v[254:255], v[234:235], v[240:241] op_sel:[1,0] op_sel_hi:[1,1]
    v_cvt_pk_bf16_f32 v173, v252, v253
    v_pk_fma_f32 v[254:255], v[28:29], v[234:235], v[254:255] op_sel_hi:[1,0,1]
    v_pk_mul_f32 v[250:251], v[234:235], v[242:243] op_sel:[1,0] op_sel_hi:[1,1]
    v_cvt_pk_bf16_f32 v28, v254, v255
    v_pk_fma_f32 v[250:251], v[30:31], v[234:235], v[250:251] op_sel_hi:[1,0,1]
    v_pk_mul_f32 v[252:253], v[234:235], v[244:245] op_sel:[1,0] op_sel_hi:[1,1]
    v_cvt_pk_bf16_f32 v29, v250, v251
    v_pk_fma_f32 v[252:253], v[44:45], v[234:235], v[252:253] op_sel_hi:[1,0,1]
    v_pk_mul_f32 v[254:255], v[234:235], v[246:247] op_sel:[1,0] op_sel_hi:[1,1]
    v_cvt_pk_bf16_f32 v30, v252, v253
    v_pk_fma_f32 v[254:255], v[46:47], v[234:235], v[254:255] op_sel_hi:[1,0,1]
    v_pk_mul_f32 v[250:251], v[232:233], v[240:241] op_sel:[1,0] op_sel_hi:[1,1]
    v_cvt_pk_bf16_f32 v31, v254, v255
    v_pk_fma_f32 v[250:251], v[24:25], v[232:233], v[250:251] op_sel_hi:[1,0,1]
    v_pk_mul_f32 v[252:253], v[232:233], v[242:243] op_sel:[1,0] op_sel_hi:[1,1]
    v_cvt_pk_bf16_f32 v24, v250, v251
    v_pk_fma_f32 v[252:253], v[26:27], v[232:233], v[252:253] op_sel_hi:[1,0,1]
    v_pk_mul_f32 v[254:255], v[232:233], v[244:245] op_sel:[1,0] op_sel_hi:[1,1]
    v_cvt_pk_bf16_f32 v25, v252, v253
    v_pk_fma_f32 v[254:255], v[40:41], v[232:233], v[254:255] op_sel_hi:[1,0,1]
    v_pk_mul_f32 v[250:251], v[232:233], v[246:247] op_sel:[1,0] op_sel_hi:[1,1]
    v_cvt_pk_bf16_f32 v26, v254, v255
    v_pk_fma_f32 v[250:251], v[42:43], v[232:233], v[250:251] op_sel_hi:[1,0,1]
    v_cvt_pk_bf16_f32 v27, v250, v251
    s_barrier
    ds_read_b128 v[180:183], v4
    ds_read_b64 v[160:161], v4 offset:1024
    ds_read_b64 v[170:171], v4 offset:1032
    v_mfma_f32_16x16x32_bf16 v[184:187], v[60:63], v[28:31], v[216:219]
    v_mfma_f32_16x16x32_bf16 v[188:191], v[56:59], v[28:31], v[220:223]
    v_mfma_f32_16x16x32_bf16 v[192:195], v[56:59], v[24:27], v[216:219]
    s_cmp_eq_u32 s23, 0
    s_cbranch_scc1 Lwt_140
    buffer_store_dwordx4 v[76:79], v0, s[88:91], s27 offen offset:1024
    buffer_store_dwordx4 v[92:95], v0, s[88:91], s27 offen offset:0
Lwt_141:
    s_waitcnt lgkmcnt(0)
    v_mfma_f32_16x16x32_bf16 v[196:199], v[180:183], v[24:27], v[228:231]
    v_xor_b32 v232, 0, v2
    v_xor_b32 v233, 32, v2
    v_xor_b32 v234, 64, v2
    v_xor_b32 v235, 96, v2
    v_add_u32 v236, 65536, v232
    v_max3_f32 v84, v184, v185, v188
    v_add_u32 v237, 65536, v233
    v_add_u32 v238, 65536, v234
    v_max3_f32 v100, v192, v193, v196
    v_max3_f32 v85, v186, v187, v190
    v_max3_f32 v101, v194, v195, v198
    v_max_f32 v84, v84, v189
    v_max_f32 v100, v100, v197
    v_max_f32 v85, v85, v191
    v_max_f32 v101, v101, v199
    v_max_f32 v86, v84, v85
    v_max_f32 v102, v100, v101
    v_add_u32 v239, 65536, v235
    v_add_u32 v240, 131072, v232
    v_permlane16_swap_b32 v86, v102
    v_add_u32 v241, 131072, v233
    v_max_f32 v86, v86, v102
    v_add_u32 v242, 131072, v234
    v_mov_b32 v102, v86
    v_add_u32 v243, 131072, v235
    v_add_u32 v248, s1, v0
    v_permlane32_swap_b32 v86, v102
    s_lshl_b32 s28, s3, 12
    v_max_f32 v86, v86, v102
    s_add_u32 s28, s28, 32768
    v_mov_b32 v102, v86
    v_add_u32 v249, s28, v0
    s_lshl_b32 s44, s21, 12
    v_permlane16_swap_b32 v86, v102
    s_xor_b32 s45, s44, 32768
    v_sub_f32 v84, v84, v86
    v_sub_f32 v100, v100, v102
    v_sub_f32 v85, v85, v86
    v_sub_f32 v101, v101, v102
    v_exp_f32 v84, v84
    v_exp_f32 v100, v100
    v_exp_f32 v85, v85
    v_exp_f32 v101, v101
    v_cvt_pk_bf16_f32 v84, v84, v84
    v_cvt_pk_bf16_f32 v100, v100, v100
    v_cvt_pk_bf16_f32 v85, v85, v85
    v_cvt_pk_bf16_f32 v101, v101, v101
    v_and_b32 v48, v84, v224
    v_and_b32 v52, v100, v224
    v_and_b32 v49, v85, v225
    v_and_b32 v53, v101, v225
    v_and_b32 v50, v84, v226
    v_and_b32 v54, v100, v226
    v_and_b32 v51, v85, v227
    v_and_b32 v55, v101, v227
    s_xor_b32 s46, s44, 4096
    v_mfma_f32_16x16x32_bf16 v[108:111], v[212:215], v[48:51], 0
    v_mfma_f32_16x16x32_bf16 v[76:79], v[162:165], v[48:51], 0
    v_mfma_f32_16x16x32_bf16 v[80:83], v[172:175], v[48:51], 0
    v_mfma_f32_16x16x32_bf16 v[112:115], v[212:215], v[52:55], 0
    v_mfma_f32_16x16x32_bf16 v[92:95], v[160:163], v[52:55], 0
    v_mfma_f32_16x16x32_bf16 v[96:99], v[170:173], v[52:55], 0
    s_xor_b32 s47, s44, 36864
    s_nop 1
    v_rcp_f32 v84, v108
    s_nop 1
    v_rcp_f32 v100, v112
    v_pk_mul_f32 v[76:77], v[76:77], v[84:85] op_sel_hi:[1,0]
    v_pk_mul_f32 v[92:93], v[92:93], v[100:101] op_sel_hi:[1,0]
    v_pk_mul_f32 v[78:79], v[78:79], v[84:85] op_sel_hi:[1,0]
    v_pk_mul_f32 v[94:95], v[94:95], v[100:101] op_sel_hi:[1,0]
    v_pk_mul_f32 v[80:81], v[80:81], v[84:85] op_sel_hi:[1,0]
    v_pk_mul_f32 v[96:97], v[96:97], v[100:101] op_sel_hi:[1,0]
    v_pk_mul_f32 v[82:83], v[82:83], v[84:85] op_sel_hi:[1,0]
    v_pk_mul_f32 v[98:99], v[98:99], v[100:101] op_sel_hi:[1,0]
    v_add_u32 v76, 0x8000, v76
    v_add_u32 v92, 0x8000, v92
    v_cvt_pk_bf16_f32 v76, v76, v77
    v_cvt_pk_bf16_f32 v92, v92, v93
    v_cvt_pk_bf16_f32 v77, v78, v79
    v_cvt_pk_bf16_f32 v93, v94, v95
    v_cvt_pk_bf16_f32 v78, v80, v81
    v_cvt_pk_bf16_f32 v94, v96, v97
    v_cvt_pk_bf16_f32 v79, v82, v83
    v_cvt_pk_bf16_f32 v95, v98, v99
    v_and_b32 v76, -2, v76
    v_and_b32 v92, -2, v92
    s_cmp_eq_u32 s23, 0
    s_cbranch_scc1 Lwt_142
    buffer_store_dwordx4 v[76:79], v0, s[88:91], s62 offen offset:1024
    buffer_store_dwordx4 v[92:95], v0, s[88:91], s62 offen offset:0
Lwt_143:
    s_branch L_g2
L_attA:
    s_waitcnt lgkmcnt(0)
    s_barrier
    s_cmp_ge_u32 s3, 4
    s_cbranch_scc0 Lif_144
    ds_read_b128 v[24:27], v130 offset:0
    ds_read_b128 v[28:31], v130 offset:1024
Lif_144:
    ds_read_b128 v[80:83], v128 offset:32768
    ds_read_b128 v[84:87], v128 offset:33792
    ds_read_b128 v[88:91], v128 offset:34816
    ds_read_b128 v[92:95], v128 offset:35840
    v_mov_b32 v66, 0
    v_mov_b32 v67, 0
    s_waitcnt lgkmcnt(3)
    v_mfma_f32_16x16x32_bf16 v[32:35], v[80:83], v[24:27], v[216:219]
    v_mfma_f32_16x16x32_bf16 v[40:43], v[80:83], v[28:31], 0
    s_waitcnt lgkmcnt(2)
    v_mfma_f32_16x16x32_bf16 v[44:47], v[84:87], v[28:31], v[216:219]
    s_cmp_eq_u32 s71, 0
    s_cbranch_scc1 Lht_146
Lhb_145:
    ds_read_b128 v[80:83], v128 offset:24576
    ds_read_b128 v[84:87], v128 offset:25600
    s_nop 0
    v_exp_f32 v32, v32
    v_exp_f32 v33, v33
    v_exp_f32 v34, v34
    v_exp_f32 v35, v35
    v_cvt_pk_bf16_f32 v64, v32, v33
    v_exp_f32 v40, v40
    v_exp_f32 v41, v41
    v_cvt_pk_bf16_f32 v65, v34, v35
    v_exp_f32 v42, v42
    ds_read_b128 v[96:99], v128 offset:26624
    ds_read_b128 v[100:103], v128 offset:27648
    s_waitcnt lgkmcnt(3)
    v_mfma_f32_16x16x32_bf16 v[48:51], v[80:83], v[24:27], v[224:227]
    v_exp_f32 v43, v43
    v_cvt_pk_bf16_f32 v68, v40, v41
    s_waitcnt lgkmcnt(2)
    v_mfma_f32_16x16x32_bf16 v[52:55], v[84:87], v[24:27], v[224:227]
    v_exp_f32 v44, v44
    v_mfma_f32_16x16x32_bf16 v[56:59], v[80:83], v[28:31], v[224:227]
    v_exp_f32 v45, v45
    v_cvt_pk_bf16_f32 v69, v42, v43
    v_mfma_f32_16x16x32_bf16 v[60:63], v[84:87], v[28:31], v[224:227]
    v_exp_f32 v46, v46
    v_exp_f32 v47, v47
    v_cvt_pk_bf16_f32 v70, v44, v45
    v_cvt_pk_bf16_f32 v71, v46, v47
    s_cmp_eq_u32 s71, 1
    s_cbranch_scc1 Lht_148
Lhb_147:
    ds_read_b128 v[80:83], v128 offset:16384
    ds_read_b128 v[84:87], v128 offset:17408
    v_exp_f32 v48, v48
    v_mfma_f32_16x16x32_bf16 v[104:107], v[88:91], v[64:67], 0
    v_exp_f32 v49, v49
    v_exp_f32 v50, v50
    v_mfma_f32_16x16x32_bf16 v[108:111], v[92:95], v[64:67], 0
    v_exp_f32 v51, v51
    v_cvt_pk_bf16_f32 v72, v48, v49
    v_mfma_f32_16x16x32_bf16 v[120:123], v[212:215], v[64:67], 0
    v_exp_f32 v52, v52
    v_exp_f32 v53, v53
    v_mfma_f32_16x16x32_bf16 v[112:115], v[88:91], v[68:71], 0
    v_cvt_pk_bf16_f32 v73, v50, v51
    v_exp_f32 v54, v54
    v_mfma_f32_16x16x32_bf16 v[116:119], v[92:95], v[68:71], 0
    v_exp_f32 v55, v55
    v_cvt_pk_bf16_f32 v74, v52, v53
    v_mfma_f32_16x16x32_bf16 v[124:127], v[212:215], v[68:71], 0
    v_exp_f32 v56, v56
    ds_read_b128 v[88:91], v128 offset:18432
    ds_read_b128 v[92:95], v128 offset:19456
    v_exp_f32 v57, v57
    s_waitcnt lgkmcnt(2)
    v_mfma_f32_16x16x32_bf16 v[32:35], v[80:83], v[24:27], v[224:227]
    v_cvt_pk_bf16_f32 v75, v54, v55
    v_exp_f32 v58, v58
    v_mfma_f32_16x16x32_bf16 v[36:39], v[84:87], v[24:27], v[224:227]
    v_exp_f32 v59, v59
    v_cvt_pk_bf16_f32 v76, v56, v57
    v_mfma_f32_16x16x32_bf16 v[40:43], v[80:83], v[28:31], v[224:227]
    v_exp_f32 v60, v60
    v_exp_f32 v61, v61
    v_mfma_f32_16x16x32_bf16 v[44:47], v[84:87], v[28:31], v[224:227]
    v_cvt_pk_bf16_f32 v77, v58, v59
    v_exp_f32 v62, v62
    v_exp_f32 v63, v63
    v_cvt_pk_bf16_f32 v78, v60, v61
    v_cvt_pk_bf16_f32 v79, v62, v63
    s_cmp_eq_u32 s71, 2
    s_cbranch_scc1 Lht_150
    s_cmp_eq_u32 s71, 0
    s_cbranch_scc1 Lht_151
Lhb_149:
    ds_read_b128 v[80:83], v128 offset:8192
    ds_read_b128 v[84:87], v128 offset:9216
    v_exp_f32 v32, v32
    v_mfma_f32_16x16x32_bf16 v[104:107], v[96:99], v[72:75], v[104:107]
    v_exp_f32 v33, v33
    v_exp_f32 v34, v34
    v_mfma_f32_16x16x32_bf16 v[108:111], v[100:103], v[72:75], v[108:111]
    v_exp_f32 v35, v35
    v_cvt_pk_bf16_f32 v64, v32, v33
    v_mfma_f32_16x16x32_bf16 v[120:123], v[212:215], v[72:75], v[120:123]
    v_exp_f32 v36, v36
    v_exp_f32 v37, v37
    v_mfma_f32_16x16x32_bf16 v[112:115], v[96:99], v[76:79], v[112:115]
    v_cvt_pk_bf16_f32 v65, v34, v35
    v_exp_f32 v38, v38
    v_mfma_f32_16x16x32_bf16 v[116:119], v[100:103], v[76:79], v[116:119]
    v_exp_f32 v39, v39
    v_cvt_pk_bf16_f32 v66, v36, v37
    v_mfma_f32_16x16x32_bf16 v[124:127], v[212:215], v[76:79], v[124:127]
    v_exp_f32 v40, v40
    ds_read_b128 v[96:99], v128 offset:10240
    ds_read_b128 v[100:103], v128 offset:11264
    v_exp_f32 v41, v41
    s_waitcnt lgkmcnt(2)
    v_mfma_f32_16x16x32_bf16 v[48:51], v[80:83], v[24:27], v[224:227]
    v_cvt_pk_bf16_f32 v67, v38, v39
    v_exp_f32 v42, v42
    v_mfma_f32_16x16x32_bf16 v[52:55], v[84:87], v[24:27], v[224:227]
    v_exp_f32 v43, v43
    v_cvt_pk_bf16_f32 v68, v40, v41
    v_mfma_f32_16x16x32_bf16 v[56:59], v[80:83], v[28:31], v[224:227]
    v_exp_f32 v44, v44
    v_exp_f32 v45, v45
    v_mfma_f32_16x16x32_bf16 v[60:63], v[84:87], v[28:31], v[224:227]
    v_cvt_pk_bf16_f32 v69, v42, v43
    v_exp_f32 v46, v46
    v_exp_f32 v47, v47
    v_cvt_pk_bf16_f32 v70, v44, v45
    v_cvt_pk_bf16_f32 v71, v46, v47
    s_cmp_eq_u32 s71, 3
    s_cbranch_scc1 Lht_153
    s_cmp_eq_u32 s71, 1
    s_cbranch_scc1 Lht_154
Lhb_152:
    ds_read_b128 v[80:83], v128 offset:0
    ds_read_b128 v[84:87], v128 offset:1024
    v_exp_f32 v48, v48
    v_mfma_f32_16x16x32_bf16 v[104:107], v[88:91], v[64:67], v[104:107]
    v_exp_f32 v49, v49
    v_exp_f32 v50, v50
    v_mfma_f32_16x16x32_bf16 v[108:111], v[92:95], v[64:67], v[108:111]
    v_exp_f32 v51, v51
    v_cvt_pk_bf16_f32 v72, v48, v49
    v_mfma_f32_16x16x32_bf16 v[120:123], v[212:215], v[64:67], v[120:123]
    v_exp_f32 v52, v52
    v_exp_f32 v53, v53
    v_mfma_f32_16x16x32_bf16 v[112:115], v[88:91], v[68:71], v[112:115]
    v_cvt_pk_bf16_f32 v73, v50, v51
    v_exp_f32 v54, v54
    v_mfma_f32_16x16x32_bf16 v[116:119], v[92:95], v[68:71], v[116:119]
    v_exp_f32 v55, v55
    v_cvt_pk_bf16_f32 v74, v52, v53
    v_mfma_f32_16x16x32_bf16 v[124:127], v[212:215], v[68:71], v[124:127]
    v_exp_f32 v56, v56
    ds_read_b128 v[88:91], v128 offset:2048
    ds_read_b128 v[92:95], v128 offset:3072
    v_exp_f32 v57, v57
    s_waitcnt lgkmcnt(2)
    v_mfma_f32_16x16x32_bf16 v[32:35], v[80:83], v[24:27], v[224:227]
    v_cvt_pk_bf16_f32 v75, v54, v55
    v_exp_f32 v58, v58
    v_mfma_f32_16x16x32_bf16 v[36:39], v[84:87], v[24:27], v[224:227]
    v_exp_f32 v59, v59
    v_cvt_pk_bf16_f32 v76, v56, v57
    v_mfma_f32_16x16x32_bf16 v[40:43], v[80:83], v[28:31], v[224:227]
    v_exp_f32 v60, v60
    v_exp_f32 v61, v61
    v_mfma_f32_16x16x32_bf16 v[44:47], v[84:87], v[28:31], v[224:227]
    v_cvt_pk_bf16_f32 v77, v58, v59
    v_exp_f32 v62, v62
    v_exp_f32 v63, v63
    v_cvt_pk_bf16_f32 v78, v60, v61
    v_cvt_pk_bf16_f32 v79, v62, v63
    s_cmp_eq_u32 s71, 2
    s_cbranch_scc1 Lht_156
    s_cmp_eq_u32 s71, 0
    s_cbranch_scc1 Lht_157
Lhb_155:
    ds_read_b128 v[80:83], v129 offset:24576
    ds_read_b128 v[84:87], v129 offset:25600
    v_exp_f32 v32, v32
    v_mfma_f32_16x16x32_bf16 v[104:107], v[96:99], v[72:75], v[104:107]
    v_exp_f32 v33, v33
    v_exp_f32 v34, v34
    v_mfma_f32_16x16x32_bf16 v[108:111], v[100:103], v[72:75], v[108:111]
    v_exp_f32 v35, v35
    v_cvt_pk_bf16_f32 v64, v32, v33
    v_mfma_f32_16x16x32_bf16 v[120:123], v[212:215], v[72:75], v[120:123]
    v_exp_f32 v36, v36
    v_exp_f32 v37, v37
    v_mfma_f32_16x16x32_bf16 v[112:115], v[96:99], v[76:79], v[112:115]
    v_cvt_pk_bf16_f32 v65, v34, v35
    v_exp_f32 v38, v38
    v_mfma_f32_16x16x32_bf16 v[116:119], v[100:103], v[76:79], v[116:119]
    v_exp_f32 v39, v39
    v_cvt_pk_bf16_f32 v66, v36, v37
    v_mfma_f32_16x16x32_bf16 v[124:127], v[212:215], v[76:79], v[124:127]
    v_exp_f32 v40, v40
    ds_read_b128 v[96:99], v129 offset:26624
    ds_read_b128 v[100:103], v129 offset:27648
    v_exp_f32 v41, v41
    s_waitcnt lgkmcnt(2)
    v_mfma_f32_16x16x32_bf16 v[48:51], v[80:83], v[24:27], v[224:227]
    v_cvt_pk_bf16_f32 v67, v38, v39
    v_exp_f32 v42, v42
    v_mfma_f32_16x16x32_bf16 v[52:55], v[84:87], v[24:27], v[224:227]
    v_exp_f32 v43, v43
    v_cvt_pk_bf16_f32 v68, v40, v41
    v_mfma_f32_16x16x32_bf16 v[56:59], v[80:83], v[28:31], v[224:227]
    v_exp_f32 v44, v44
    v_exp_f32 v45, v45
    v_mfma_f32_16x16x32_bf16 v[60:63], v[84:87], v[28:31], v[224:227]
    v_cvt_pk_bf16_f32 v69, v42, v43
    v_exp_f32 v46, v46
    v_exp_f32 v47, v47
    v_cvt_pk_bf16_f32 v70, v44, v45
    v_cvt_pk_bf16_f32 v71, v46, v47
    s_cmp_eq_u32 s71, 3
    s_cbranch_scc1 Lht_159
    s_cmp_eq_u32 s71, 1
    s_cbranch_scc1 Lht_160
Lhb_158:
    ds_read_b128 v[80:83], v129 offset:16384
    ds_read_b128 v[84:87], v129 offset:17408
    v_exp_f32 v48, v48
    v_mfma_f32_16x16x32_bf16 v[104:107], v[88:91], v[64:67], v[104:107]
    v_exp_f32 v49, v49
    v_exp_f32 v50, v50
    v_mfma_f32_16x16x32_bf16 v[108:111], v[92:95], v[64:67], v[108:111]
    v_exp_f32 v51, v51
    v_cvt_pk_bf16_f32 v72, v48, v49
    v_mfma_f32_16x16x32_bf16 v[120:123], v[212:215], v[64:67], v[120:123]
    v_exp_f32 v52, v52
    v_exp_f32 v53, v53
    v_mfma_f32_16x16x32_bf16 v[112:115], v[88:91], v[68:71], v[112:115]
    v_cvt_pk_bf16_f32 v73, v50, v51
    v_exp_f32 v54, v54
    v_mfma_f32_16x16x32_bf16 v[116:119], v[92:95], v[68:71], v[116:119]
    v_exp_f32 v55, v55
    v_cvt_pk_bf16_f32 v74, v52, v53
    v_mfma_f32_16x16x32_bf16 v[124:127], v[212:215], v[68:71], v[124:127]
    v_exp_f32 v56, v56
    ds_read_b128 v[88:91], v129 offset:18432
    ds_read_b128 v[92:95], v129 offset:19456
    v_exp_f32 v57, v57
    s_waitcnt lgkmcnt(2)
    v_mfma_f32_16x16x32_bf16 v[32:35], v[80:83], v[24:27], v[224:227]
    v_cvt_pk_bf16_f32 v75, v54, v55
    v_exp_f32 v58, v58
    v_mfma_f32_16x16x32_bf16 v[36:39], v[84:87], v[24:27], v[224:227]
    v_exp_f32 v59, v59
    v_cvt_pk_bf16_f32 v76, v56, v57
    v_mfma_f32_16x16x32_bf16 v[40:43], v[80:83], v[28:31], v[224:227]
    v_exp_f32 v60, v60
    v_exp_f32 v61, v61
    v_mfma_f32_16x16x32_bf16 v[44:47], v[84:87], v[28:31], v[224:227]
    v_cvt_pk_bf16_f32 v77, v58, v59
    v_exp_f32 v62, v62
    v_exp_f32 v63, v63
    v_cvt_pk_bf16_f32 v78, v60, v61
    v_cvt_pk_bf16_f32 v79, v62, v63
    s_cmp_eq_u32 s71, 2
    s_cbranch_scc1 Lht_162
Lhb_161:
    ds_read_b128 v[80:83], v129 offset:8192
    ds_read_b128 v[84:87], v129 offset:9216
    v_exp_f32 v32, v32
    v_mfma_f32_16x16x32_bf16 v[104:107], v[96:99], v[72:75], v[104:107]
    v_exp_f32 v33, v33
    v_exp_f32 v34, v34
    v_mfma_f32_16x16x32_bf16 v[108:111], v[100:103], v[72:75], v[108:111]
    v_exp_f32 v35, v35
    v_cvt_pk_bf16_f32 v64, v32, v33
    v_mfma_f32_16x16x32_bf16 v[120:123], v[212:215], v[72:75], v[120:123]
    v_exp_f32 v36, v36
    v_exp_f32 v37, v37
    v_mfma_f32_16x16x32_bf16 v[112:115], v[96:99], v[76:79], v[112:115]
    v_cvt_pk_bf16_f32 v65, v34, v35
    v_exp_f32 v38, v38
    v_mfma_f32_16x16x32_bf16 v[116:119], v[100:103], v[76:79], v[116:119]
    v_exp_f32 v39, v39
    v_cvt_pk_bf16_f32 v66, v36, v37
    v_mfma_f32_16x16x32_bf16 v[124:127], v[212:215], v[76:79], v[124:127]
    v_exp_f32 v40, v40
    ds_read_b128 v[96:99], v129 offset:10240
    ds_read_b128 v[100:103], v129 offset:11264
    v_exp_f32 v41, v41
    s_waitcnt lgkmcnt(2)
    v_mfma_f32_16x16x32_bf16 v[48:51], v[80:83], v[24:27], v[224:227]
    v_cvt_pk_bf16_f32 v67, v38, v39
    v_exp_f32 v42, v42
    v_mfma_f32_16x16x32_bf16 v[52:55], v[84:87], v[24:27], v[224:227]
    v_exp_f32 v43, v43
    v_cvt_pk_bf16_f32 v68, v40, v41
    v_mfma_f32_16x16x32_bf16 v[56:59], v[80:83], v[28:31], v[224:227]
    v_exp_f32 v44, v44
    v_exp_f32 v45, v45
    v_mfma_f32_16x16x32_bf16 v[60:63], v[84:87], v[28:31], v[224:227]
    v_cvt_pk_bf16_f32 v69, v42, v43
    v_exp_f32 v46, v46
    v_exp_f32 v47, v47
    v_cvt_pk_bf16_f32 v70, v44, v45
    v_cvt_pk_bf16_f32 v71, v46, v47
    s_cmp_eq_u32 s71, 3
    s_cbranch_scc1 Lht_164
Lhb_163:
    ds_read_b128 v[80:83], v129 offset:0
    ds_read_b128 v[84:87], v129 offset:1024
    v_exp_f32 v48, v48
    v_mfma_f32_16x16x32_bf16 v[104:107], v[88:91], v[64:67], v[104:107]
    v_exp_f32 v49, v49
    v_exp_f32 v50, v50
    v_mfma_f32_16x16x32_bf16 v[108:111], v[92:95], v[64:67], v[108:111]
    v_exp_f32 v51, v51
    v_cvt_pk_bf16_f32 v72, v48, v49
    v_mfma_f32_16x16x32_bf16 v[120:123], v[212:215], v[64:67], v[120:123]
    v_exp_f32 v52, v52
    v_exp_f32 v53, v53
    v_mfma_f32_16x16x32_bf16 v[112:115], v[88:91], v[68:71], v[112:115]
    v_cvt_pk_bf16_f32 v73, v50, v51
    v_exp_f32 v54, v54
    v_mfma_f32_16x16x32_bf16 v[116:119], v[92:95], v[68:71], v[116:119]
    v_exp_f32 v55, v55
    v_cvt_pk_bf16_f32 v74, v52, v53
    v_mfma_f32_16x16x32_bf16 v[124:127], v[212:215], v[68:71], v[124:127]
    v_exp_f32 v56, v56
    ds_read_b128 v[88:91], v129 offset:2048
    ds_read_b128 v[92:95], v129 offset:3072
    v_exp_f32 v57, v57
    s_waitcnt lgkmcnt(2)
    v_mfma_f32_16x16x32_bf16 v[32:35], v[80:83], v[24:27], v[220:223]
    v_cvt_pk_bf16_f32 v75, v54, v55
    v_exp_f32 v58, v58
    v_mfma_f32_16x16x32_bf16 v[36:39], v[84:87], v[24:27], v[224:227]
    v_exp_f32 v59, v59
    v_cvt_pk_bf16_f32 v76, v56, v57
    v_mfma_f32_16x16x32_bf16 v[44:47], v[84:87], v[28:31], v[220:223]
    v_exp_f32 v60, v60
    v_exp_f32 v61, v61
    v_cvt_pk_bf16_f32 v77, v58, v59
    v_exp_f32 v62, v62
    v_exp_f32 v63, v63
    v_cvt_pk_bf16_f32 v78, v60, v61
    v_cvt_pk_bf16_f32 v79, v62, v63
Lhb_165:
    v_mfma_f32_16x16x32_bf16 v[104:107], v[96:99], v[72:75], v[104:107]
    v_exp_f32 v32, v32
    v_exp_f32 v33, v33
    v_mfma_f32_16x16x32_bf16 v[108:111], v[100:103], v[72:75], v[108:111]
    v_exp_f32 v34, v34
    v_exp_f32 v35, v35
    v_mfma_f32_16x16x32_bf16 v[120:123], v[212:215], v[72:75], v[120:123]
    v_cvt_pk_bf16_f32 v64, v32, v33
    v_mfma_f32_16x16x32_bf16 v[112:115], v[96:99], v[76:79], v[112:115]
    v_exp_f32 v36, v36
    v_exp_f32 v37, v37
    v_mfma_f32_16x16x32_bf16 v[116:119], v[100:103], v[76:79], v[116:119]
    v_cvt_pk_bf16_f32 v65, v34, v35
    v_exp_f32 v38, v38
    v_mfma_f32_16x16x32_bf16 v[124:127], v[212:215], v[76:79], v[124:127]
    v_exp_f32 v39, v39
    v_cvt_pk_bf16_f32 v66, v36, v37
    v_exp_f32 v44, v44
    v_exp_f32 v45, v45
    v_cvt_pk_bf16_f32 v67, v38, v39
    v_exp_f32 v46, v46
    v_exp_f32 v47, v47
    v_cvt_pk_bf16_f32 v70, v44, v45
    v_mov_b32 v68, 0
    v_mov_b32 v69, 0
    v_cvt_pk_bf16_f32 v71, v46, v47
    s_waitcnt lgkmcnt(0)
    v_mfma_f32_16x16x32_bf16 v[104:107], v[88:91], v[64:67], v[104:107]
    v_mfma_f32_16x16x32_bf16 v[108:111], v[92:95], v[64:67], v[108:111]
    v_mfma_f32_16x16x32_bf16 v[120:123], v[212:215], v[64:67], v[120:123]
    v_mfma_f32_16x16x32_bf16 v[112:115], v[88:91], v[68:71], v[112:115]
    v_mfma_f32_16x16x32_bf16 v[116:119], v[92:95], v[68:71], v[116:119]
    v_mfma_f32_16x16x32_bf16 v[124:127], v[212:215], v[68:71], v[124:127]
    v_mov_b32 v132, 0
    v_mov_b32 v133, 0
    s_nop 0
    v_maximum3_f32 v132, |v104|, |v105|, v132
    v_maximum3_f32 v133, |v106|, |v107|, v133
    v_maximum3_f32 v132, |v108|, |v109|, v132
    v_maximum3_f32 v133, |v110|, |v111|, v133
    v_maximum3_f32 v132, |v112|, |v113|, v132
    v_maximum3_f32 v133, |v114|, |v115|, v133
    v_maximum3_f32 v132, |v116|, |v117|, v132
    v_maximum3_f32 v133, |v118|, |v119|, v133
    v_min_f32 v134, v120, v124
    v_maximum3_f32 v132, v132, v133, 0
    v_cmp_nle_f32 vcc, 0x21800000, v134
    v_mul_f32 v132, 0x21800000, v132
    s_mov_b64 s[28:29], vcc
    v_maximum3_f32 v132, v132, v120, v124
    v_cmp_nge_f32 vcc, 0x5d800000, v132
    s_nop 0
    s_or_b64 vcc, vcc, s[28:29]
    s_cbranch_vccnz L_exact
L_aok:
    v_rcp_f32 v132, v120
    v_rcp_f32 v134, v124
    v_pk_mul_f32 v[104:105], v[104:105], v[132:133] op_sel_hi:[1,0]
    v_pk_mul_f32 v[112:113], v[112:113], v[134:135] op_sel_hi:[1,0]
    v_pk_mul_f32 v[106:107], v[106:107], v[132:133] op_sel_hi:[1,0]
    v_pk_mul_f32 v[114:115], v[114:115], v[134:135] op_sel_hi:[1,0]
    v_pk_mul_f32 v[108:109], v[108:109], v[132:133] op_sel_hi:[1,0]
    v_pk_mul_f32 v[116:117], v[116:117], v[134:135] op_sel_hi:[1,0]
    v_pk_mul_f32 v[110:111], v[110:111], v[132:133] op_sel_hi:[1,0]
    v_pk_mul_f32 v[118:119], v[118:119], v[134:135] op_sel_hi:[1,0]
    v_add_u32 v104, 0x8000, v104
    v_add_u32 v112, 0x8000, v112
    v_cvt_pk_bf16_f32 v104, v104, v105
    v_cvt_pk_bf16_f32 v112, v112, v113
    v_cvt_pk_bf16_f32 v105, v106, v107
    v_cvt_pk_bf16_f32 v113, v114, v115
    v_cvt_pk_bf16_f32 v106, v108, v109
    v_cvt_pk_bf16_f32 v114, v116, v117
    v_cvt_pk_bf16_f32 v107, v110, v111
    v_cvt_pk_bf16_f32 v115, v118, v119
    v_and_b32 v104, -2, v104
    v_and_b32 v112, -2, v112
    s_cmp_eq_u32 s23, 0
    s_cbranch_scc1 Lwt_166
    buffer_store_dwordx4 v[104:107], v0, s[88:91], s62 offen offset:0
    buffer_store_dwordx4 v[112:115], v0, s[88:91], s62 offen offset:1024
Lwt_167:
    s_cmp_ge_u32 s3, 4
    s_cbranch_scc1 L_lnext
    v_xor_b32 v232, 0, v2
    v_xor_b32 v233, 32, v2
    v_xor_b32 v234, 64, v2
    v_xor_b32 v235, 96, v2
    v_add_u32 v236, 65536, v232
    v_add_u32 v237, 65536, v233
    v_add_u32 v238, 65536, v234
    v_add_u32 v239, 65536, v235
    v_add_u32 v240, 131072, v232
    v_add_u32 v241, 131072, v233
    v_add_u32 v242, 131072, v234
    v_add_u32 v243, 131072, v235
    v_add_u32 v248, s1, v0
    s_lshl_b32 s28, s3, 12
    s_add_u32 s28, s28, 32768
    v_add_u32 v249, s28, v0
    s_lshl_b32 s44, s21, 12
    s_xor_b32 s45, s44, 32768
    s_xor_b32 s46, s44, 4096
    s_xor_b32 s47, s44, 36864
L_g2:
    buffer_load_dwordx4 v[56:59], v248, s[88:91], s44 offen offset:0 sc1
    buffer_load_dwordx4 v[60:63], v248, s[88:91], s44 offen offset:1024 sc1
    buffer_load_dwordx4 v[64:67], v248, s[88:91], s44 offen offset:2048 sc1
    buffer_load_dwordx4 v[68:71], v248, s[88:91], s44 offen offset:3072 sc1
    buffer_load_dwordx4 v[72:75], v248, s[88:91], s45 offen offset:0 sc1
    buffer_load_dwordx4 v[76:79], v248, s[88:91], s45 offen offset:1024 sc1
    buffer_load_dwordx4 v[80:83], v248, s[88:91], s45 offen offset:2048 sc1
    buffer_load_dwordx4 v[84:87], v248, s[88:91], s45 offen offset:3072 sc1
    buffer_load_dwordx4 v[88:91], v248, s[88:91], s46 offen offset:0 sc1
    buffer_load_dwordx4 v[92:95], v248, s[88:91], s46 offen offset:1024 sc1
    ds_read_b64_tr_b16 v[120:121], v232 offset:0
    ds_read_b64_tr_b16 v[122:123], v232 offset:2048
    ds_read_b64_tr_b16 v[124:125], v233 offset:0
    ds_read_b64_tr_b16 v[126:127], v233 offset:2048
    ds_read_b64_tr_b16 v[128:129], v234 offset:0
    ds_read_b64_tr_b16 v[130:131], v234 offset:2048
    ds_read_b64_tr_b16 v[132:133], v235 offset:0
    ds_read_b64_tr_b16 v[134:135], v235 offset:2048
    ds_read_b64_tr_b16 v[136:137], v232 offset:4096
    ds_read_b64_tr_b16 v[138:139], v232 offset:6144
    ds_read_b64_tr_b16 v[140:141], v233 offset:4096
    ds_read_b64_tr_b16 v[142:143], v233 offset:6144
    ds_read_b64_tr_b16 v[144:145], v234 offset:4096
    ds_read_b64_tr_b16 v[146:147], v234 offset:6144
    ds_read_b64_tr_b16 v[148:149], v235 offset:4096
    ds_read_b64_tr_b16 v[150:151], v235 offset:6144
    v_mov_b32 v96, 0
    v_mov_b32 v100, 0
    v_mov_b32 v104, 0
    v_mov_b32 v108, 0
    v_mov_b32 v112, 0
    v_mov_b32 v116, 0
    v_lshlrev_b32 v24, 16, v8
    v_and_b32 v25, 0xffff0000, v8
    v_lshlrev_b32 v26, 16, v9
    v_and_b32 v27, 0xffff0000, v9
    v_lshlrev_b32 v28, 16, v10
    v_and_b32 v29, 0xffff0000, v10
    v_lshlrev_b32 v30, 16, v11
    v_and_b32 v31, 0xffff0000, v11
    v_lshlrev_b32 v32, 16, v12
    v_and_b32 v33, 0xffff0000, v12
    v_lshlrev_b32 v34, 16, v13
    v_and_b32 v35, 0xffff0000, v13
    v_lshlrev_b32 v36, 16, v14
    v_and_b32 v37, 0xffff0000, v14
    v_lshlrev_b32 v38, 16, v15
    v_and_b32 v39, 0xffff0000, v15
    v_lshlrev_b32 v40, 16, v16
    v_and_b32 v41, 0xffff0000, v16
    v_lshlrev_b32 v42, 16, v17
    v_and_b32 v43, 0xffff0000, v17
    v_lshlrev_b32 v44, 16, v18
    v_and_b32 v45, 0xffff0000, v18
    v_lshlrev_b32 v46, 16, v19
    v_and_b32 v47, 0xffff0000, v19
    v_lshlrev_b32 v48, 16, v20
    v_and_b32 v49, 0xffff0000, v20
    v_lshlrev_b32 v50, 16, v21
    v_and_b32 v51, 0xffff0000, v21
    v_lshlrev_b32 v52, 16, v22
    v_and_b32 v53, 0xffff0000, v22
    v_lshlrev_b32 v54, 16, v23
    v_and_b32 v55, 0xffff0000, v23
    s_add_u32 s22, s22, 1
    s_mov_b32 s96, 0
    s_lshr_b32 s27, s3, 1
    s_lshl_b32 s27, s27, 13
    v_add_u32 v200, s27, v0
    v_add_u32 v201, 1024, v200
    v_and_b32 v206, 2147483647, v206
    s_bitcmp1_b32 s22, 0
    s_cselect_b32 s8, s58, s52
    s_cselect_b32 s9, s59, s53
    s_cbranch_scc1 Lmb_168
    v_and_b32 v224, 15, v1
    v_lshrrev_b32 v225, 4, v1
    v_lshlrev_b32 v225, 2, v225
    v_sub_u32 v224, v224, v225
    s_cmp_lt_u32 s20, 2
    s_cselect_b32 s27, 0, -1
    v_subrev_u32 v216, 0, v224
    v_subrev_u32 v217, 1, v224
    v_subrev_u32 v218, 2, v224
    v_subrev_u32 v219, 3, v224
    v_ashrrev_i32 v216, 31, v216
    v_ashrrev_i32 v217, 31, v217
    v_ashrrev_i32 v218, 31, v218
    v_ashrrev_i32 v219, 31, v219
    v_and_b32 v216, 4048155338, v216
    v_and_b32 v217, 4048155338, v217
    v_and_b32 v218, 4048155338, v218
    v_and_b32 v219, 4048155338, v219
    v_and_b32 v220, s27, v216
    v_and_b32 v221, s27, v217
    v_and_b32 v222, s27, v218
    v_and_b32 v223, s27, v219
    v_xor_b32 v220, 4048155338, v220
    v_xor_b32 v221, 4048155338, v221
    v_xor_b32 v222, 4048155338, v222
    v_xor_b32 v223, 4048155338, v223
    v_mov_b32 v224, 0
    v_mov_b32 v225, 0
    v_mov_b32 v226, 0
    v_mov_b32 v227, 0
    s_branch Lmc_169
Lmb_168:
    v_and_b32 v228, 15, v1
    v_lshrrev_b32 v229, 4, v1
    v_lshlrev_b32 v229, 2, v229
    v_sub_u32 v228, v228, v229
    v_subrev_u32 v224, 0, v228
    v_subrev_u32 v225, 1, v228
    v_subrev_u32 v226, 2, v228
    v_subrev_u32 v227, 3, v228
    v_lshlrev_b32 v220, 31, v224
    v_lshlrev_b32 v221, 31, v225
    v_lshlrev_b32 v222, 31, v226
    v_lshlrev_b32 v223, 31, v227
    v_or_b32 v216, v220, v224
    v_not_b32 v224, v224
    v_or_b32 v217, v221, v225
    v_not_b32 v225, v225
    v_or_b32 v218, v222, v226
    v_not_b32 v226, v226
    v_or_b32 v219, v223, v227
    v_not_b32 v227, v227
    v_or_b32 v220, v220, v224
    v_or_b32 v221, v221, v225
    v_or_b32 v222, v222, v226
    v_or_b32 v223, v223, v227
    v_ashrrev_i32 v216, 31, v216
    v_ashrrev_i32 v217, 31, v217
    v_ashrrev_i32 v218, 31, v218
    v_ashrrev_i32 v219, 31, v219
    v_ashrrev_i32 v220, 31, v220
    v_ashrrev_i32 v221, 31, v221
    v_ashrrev_i32 v222, 31, v222
    v_ashrrev_i32 v223, 31, v223
    s_mov_b32 s27, 0xffff
    v_bfi_b32 v224, s27, v220, v221
    v_bfi_b32 v225, s27, v222, v223
    v_bfi_b32 v226, s27, v216, v217
    v_bfi_b32 v227, s27, v218, v219
    v_not_b32 v224, v224
    v_not_b32 v225, v225
    v_not_b32 v226, v226
    v_not_b32 v227, v227
    v_and_b32 v216, 4048155338, v216
    v_and_b32 v217, 4048155338, v217
    v_and_b32 v218, 4048155338, v218
    v_and_b32 v219, 4048155338, v219
    v_and_b32 v220, 4048155338, v220
    v_and_b32 v221, 4048155338, v221
    v_and_b32 v222, 4048155338, v222
    v_and_b32 v223, 4048155338, v223
    s_lshr_b32 s27, s3, 1
    s_or_b32 s27, s27, s20
    s_cmp_eq_u32 s27, 0
    s_cselect_b32 s27, 4048155338, 0
    v_or_b32 v228, s27, v220
    v_or_b32 v229, s27, v221
    v_or_b32 v230, s27, v222
    v_or_b32 v231, s27, v223
Lmc_169:
    s_waitcnt vmcnt(8)
    v_bitop3_b32 v250, v56, v60, 1 bitop3:0xa8
    v_cmp_ne_u32 vcc, 0, v250
    s_nop 0
    s_cbranch_vccnz Lot_171
Look_172:
    s_waitcnt lgkmcnt(8)
    v_mfma_f32_16x16x32_bf16 v[24:27], v[120:123], v[56:59], v[24:27]
    ds_read_b64_tr_b16 v[152:153], v232 offset:8192
    v_mfma_f32_16x16x32_bf16 v[40:43], v[120:123], v[60:63], v[40:43]
    ds_read_b64_tr_b16 v[154:155], v232 offset:10240
    buffer_load_dwordx4 v[96:99], v248, s[88:91], s46 offen offset:2048 sc1
    v_mfma_f32_16x16x32_bf16 v[44:47], v[124:127], v[60:63], v[44:47]
    ds_read_b64_tr_b16 v[156:157], v233 offset:8192
    v_mfma_f32_16x16x32_bf16 v[28:31], v[124:127], v[56:59], v[28:31]
    ds_read_b64_tr_b16 v[158:159], v233 offset:10240
    buffer_load_dwordx4 v[100:103], v248, s[88:91], s46 offen offset:3072 sc1
    v_mfma_f32_16x16x32_bf16 v[32:35], v[128:131], v[56:59], v[32:35]
    ds_read_b64_tr_b16 v[160:161], v234 offset:8192
    s_waitcnt vmcnt(8)
    v_bitop3_b32 v250, v64, v68, 1 bitop3:0xa8
    v_mfma_f32_16x16x32_bf16 v[48:51], v[128:131], v[60:63], v[48:51]
    ds_read_b64_tr_b16 v[162:163], v234 offset:10240
    v_cmp_ne_u32 vcc, 0, v250
    v_mfma_f32_16x16x32_bf16 v[52:55], v[132:135], v[60:63], v[52:55]
    ds_read_b64_tr_b16 v[164:165], v235 offset:8192
    s_cbranch_vccnz Lot_174
Look_175:
    v_mfma_f32_16x16x32_bf16 v[36:39], v[132:135], v[56:59], v[36:39]
    ds_read_b64_tr_b16 v[166:167], v235 offset:10240
    s_waitcnt lgkmcnt(8)
    v_mfma_f32_16x16x32_bf16 v[24:27], v[136:139], v[64:67], v[24:27]
    ds_read_b64_tr_b16 v[120:121], v232 offset:12288
    v_mfma_f32_16x16x32_bf16 v[40:43], v[136:139], v[68:71], v[40:43]
    ds_read_b64_tr_b16 v[122:123], v232 offset:14336
    buffer_load_dwordx4 v[104:107], v248, s[88:91], s47 offen offset:0 sc1
    v_mfma_f32_16x16x32_bf16 v[44:47], v[140:143], v[68:71], v[44:47]
    ds_read_b64_tr_b16 v[124:125], v233 offset:12288
    v_mfma_f32_16x16x32_bf16 v[28:31], v[140:143], v[64:67], v[28:31]
    ds_read_b64_tr_b16 v[126:127], v233 offset:14336
    buffer_load_dwordx4 v[108:111], v248, s[88:91], s47 offen offset:1024 sc1
    v_mfma_f32_16x16x32_bf16 v[32:35], v[144:147], v[64:67], v[32:35]
    ds_read_b64_tr_b16 v[128:129], v234 offset:12288
    s_waitcnt vmcnt(8)
    v_bitop3_b32 v250, v72, v76, 1 bitop3:0xa8
    v_mfma_f32_16x16x32_bf16 v[48:51], v[144:147], v[68:71], v[48:51]
    ds_read_b64_tr_b16 v[130:131], v234 offset:14336
    v_cmp_ne_u32 vcc, 0, v250
    v_mfma_f32_16x16x32_bf16 v[52:55], v[148:151], v[68:71], v[52:55]
    ds_read_b64_tr_b16 v[132:133], v235 offset:12288
    s_cbranch_vccnz Lot_177
Look_178:
    v_mfma_f32_16x16x32_bf16 v[36:39], v[148:151], v[64:67], v[36:39]
    ds_read_b64_tr_b16 v[134:135], v235 offset:14336
    s_waitcnt lgkmcnt(8)
    v_mfma_f32_16x16x32_bf16 v[24:27], v[152:155], v[72:75], v[24:27]
    ds_read_b64_tr_b16 v[136:137], v232 offset:16384
    v_mfma_f32_16x16x32_bf16 v[40:43], v[152:155], v[76:79], v[40:43]
    ds_read_b64_tr_b16 v[138:139], v232 offset:18432
    buffer_load_dwordx4 v[112:115], v248, s[88:91], s47 offen offset:2048 sc1
    v_mfma_f32_16x16x32_bf16 v[44:47], v[156:159], v[76:79], v[44:47]
    ds_read_b64_tr_b16 v[140:141], v233 offset:16384
    v_mfma_f32_16x16x32_bf16 v[28:31], v[156:159], v[72:75], v[28:31]
    ds_read_b64_tr_b16 v[142:143], v233 offset:18432
    buffer_load_dwordx4 v[116:119], v248, s[88:91], s47 offen offset:3072 sc1
    v_mfma_f32_16x16x32_bf16 v[32:35], v[160:163], v[72:75], v[32:35]
    ds_read_b64_tr_b16 v[144:145], v234 offset:16384
    s_waitcnt vmcnt(8)
    v_bitop3_b32 v250, v80, v84, 1 bitop3:0xa8
    v_mfma_f32_16x16x32_bf16 v[48:51], v[160:163], v[76:79], v[48:51]
    ds_read_b64_tr_b16 v[146:147], v234 offset:18432
    v_cmp_ne_u32 vcc, 0, v250
    v_mfma_f32_16x16x32_bf16 v[52:55], v[164:167], v[76:79], v[52:55]
    ds_read_b64_tr_b16 v[148:149], v235 offset:16384
    s_cbranch_vccnz Lot_180
Look_181:
    v_mfma_f32_16x16x32_bf16 v[36:39], v[164:167], v[72:75], v[36:39]
    ds_read_b64_tr_b16 v[150:151], v235 offset:18432
    s_waitcnt lgkmcnt(8)
    v_mfma_f32_16x16x32_bf16 v[24:27], v[120:123], v[80:83], v[24:27]
    ds_read_b64_tr_b16 v[152:153], v232 offset:20480
    s_xor_b32 s44, s44, 8192
    v_mfma_f32_16x16x32_bf16 v[40:43], v[120:123], v[84:87], v[40:43]
    ds_read_b64_tr_b16 v[154:155], v232 offset:22528
    buffer_load_dwordx4 v[56:59], v248, s[88:91], s44 offen offset:0 sc1
    v_mfma_f32_16x16x32_bf16 v[44:47], v[124:127], v[84:87], v[44:47]
    ds_read_b64_tr_b16 v[156:157], v233 offset:20480
    v_mfma_f32_16x16x32_bf16 v[28:31], v[124:127], v[80:83], v[28:31]
    ds_read_b64_tr_b16 v[158:159], v233 offset:22528
    buffer_load_dwordx4 v[60:63], v248, s[88:91], s44 offen offset:1024 sc1
    v_mfma_f32_16x16x32_bf16 v[32:35], v[128:131], v[80:83], v[32:35]
    ds_read_b64_tr_b16 v[160:161], v234 offset:20480
    s_waitcnt vmcnt(8)
    v_bitop3_b32 v250, v88, v92, 1 bitop3:0xa8
    v_mfma_f32_16x16x32_bf16 v[48:51], v[128:131], v[84:87], v[48:51]
    ds_read_b64_tr_b16 v[162:163], v234 offset:22528
    v_cmp_ne_u32 vcc, 0, v250
    v_mfma_f32_16x16x32_bf16 v[52:55], v[132:135], v[84:87], v[52:55]
    ds_read_b64_tr_b16 v[164:165], v235 offset:20480
    s_cbranch_vccnz Lot_183
Look_184:
    v_mfma_f32_16x16x32_bf16 v[36:39], v[132:135], v[80:83], v[36:39]
    ds_read_b64_tr_b16 v[166:167], v235 offset:22528
    s_waitcnt lgkmcnt(8)
    v_mfma_f32_16x16x32_bf16 v[24:27], v[136:139], v[88:91], v[24:27]
    ds_read_b64_tr_b16 v[120:121], v232 offset:24576
    v_mfma_f32_16x16x32_bf16 v[40:43], v[136:139], v[92:95], v[40:43]
    ds_read_b64_tr_b16 v[122:123], v232 offset:26624
    buffer_load_dwordx4 v[64:67], v248, s[88:91], s44 offen offset:2048 sc1
    v_mfma_f32_16x16x32_bf16 v[44:47], v[140:143], v[92:95], v[44:47]
    ds_read_b64_tr_b16 v[124:125], v233 offset:24576
    v_mfma_f32_16x16x32_bf16 v[28:31], v[140:143], v[88:91], v[28:31]
    ds_read_b64_tr_b16 v[126:127], v233 offset:26624
    buffer_load_dwordx4 v[68:71], v248, s[88:91], s44 offen offset:3072 sc1
    v_mfma_f32_16x16x32_bf16 v[32:35], v[144:147], v[88:91], v[32:35]
    ds_read_b64_tr_b16 v[128:129], v234 offset:24576
    s_waitcnt vmcnt(8)
    v_bitop3_b32 v250, v96, v100, 1 bitop3:0xa8
    v_mfma_f32_16x16x32_bf16 v[48:51], v[144:147], v[92:95], v[48:51]
    ds_read_b64_tr_b16 v[130:131], v234 offset:26624
    v_cmp_ne_u32 vcc, 0, v250
    v_mfma_f32_16x16x32_bf16 v[52:55], v[148:151], v[92:95], v[52:55]
    ds_read_b64_tr_b16 v[132:133], v235 offset:24576
    s_cbranch_vccnz Lot_186
Look_187:
    v_mfma_f32_16x16x32_bf16 v[36:39], v[148:151], v[88:91], v[36:39]
    ds_read_b64_tr_b16 v[134:135], v235 offset:26624
    s_waitcnt lgkmcnt(8)
    v_mfma_f32_16x16x32_bf16 v[24:27], v[152:155], v[96:99], v[24:27]
    ds_read_b64_tr_b16 v[136:137], v232 offset:28672
    s_xor_b32 s45, s45, 8192
    v_mfma_f32_16x16x32_bf16 v[40:43], v[152:155], v[100:103], v[40:43]
    ds_read_b64_tr_b16 v[138:139], v232 offset:30720
    buffer_load_dwordx4 v[72:75], v248, s[88:91], s45 offen offset:0 sc1
    v_mfma_f32_16x16x32_bf16 v[44:47], v[156:159], v[100:103], v[44:47]
    ds_read_b64_tr_b16 v[140:141], v233 offset:28672
    v_mfma_f32_16x16x32_bf16 v[28:31], v[156:159], v[96:99], v[28:31]
    ds_read_b64_tr_b16 v[142:143], v233 offset:30720
    buffer_load_dwordx4 v[76:79], v248, s[88:91], s45 offen offset:1024 sc1
    v_mfma_f32_16x16x32_bf16 v[32:35], v[160:163], v[96:99], v[32:35]
    ds_read_b64_tr_b16 v[144:145], v234 offset:28672
    s_waitcnt vmcnt(8)
    v_bitop3_b32 v250, v104, v108, 1 bitop3:0xa8
    v_mfma_f32_16x16x32_bf16 v[48:51], v[160:163], v[100:103], v[48:51]
    ds_read_b64_tr_b16 v[146:147], v234 offset:30720
    v_cmp_ne_u32 vcc, 0, v250
    v_mfma_f32_16x16x32_bf16 v[52:55], v[164:167], v[100:103], v[52:55]
    ds_read_b64_tr_b16 v[148:149], v235 offset:28672
    s_cbranch_vccnz Lot_189
Look_190:
    v_mfma_f32_16x16x32_bf16 v[36:39], v[164:167], v[96:99], v[36:39]
    ds_read_b64_tr_b16 v[150:151], v235 offset:30720
    s_barrier
    s_waitcnt lgkmcnt(8)
    v_mfma_f32_16x16x32_bf16 v[24:27], v[120:123], v[104:107], v[24:27]
    ds_read_b64_tr_b16 v[152:153], v236 offset:0
    v_mfma_f32_16x16x32_bf16 v[40:43], v[120:123], v[108:111], v[40:43]
    ds_read_b64_tr_b16 v[154:155], v236 offset:2048
    buffer_load_dwordx4 v[80:83], v248, s[88:91], s45 offen offset:2048 sc1
    v_mfma_f32_16x16x32_bf16 v[44:47], v[124:127], v[108:111], v[44:47]
    ds_read_b64_tr_b16 v[156:157], v237 offset:0
    v_mfma_f32_16x16x32_bf16 v[28:31], v[124:127], v[104:107], v[28:31]
    ds_read_b64_tr_b16 v[158:159], v237 offset:2048
    buffer_load_dwordx4 v[84:87], v248, s[88:91], s45 offen offset:3072 sc1
    v_mfma_f32_16x16x32_bf16 v[32:35], v[128:131], v[104:107], v[32:35]
    ds_read_b64_tr_b16 v[160:161], v238 offset:0
    s_waitcnt vmcnt(8)
    v_bitop3_b32 v250, v112, v116, 1 bitop3:0xa8
    v_mfma_f32_16x16x32_bf16 v[48:51], v[128:131], v[108:111], v[48:51]
    ds_read_b64_tr_b16 v[162:163], v238 offset:2048
    v_cmp_ne_u32 vcc, 0, v250
    v_mfma_f32_16x16x32_bf16 v[52:55], v[132:135], v[108:111], v[52:55]
    ds_read_b64_tr_b16 v[164:165], v239 offset:0
    s_cbranch_vccnz Lot_192
Look_193:
    v_mfma_f32_16x16x32_bf16 v[36:39], v[132:135], v[104:107], v[36:39]
    ds_read_b64_tr_b16 v[166:167], v239 offset:2048
    s_waitcnt lgkmcnt(8)
    v_mfma_f32_16x16x32_bf16 v[24:27], v[136:139], v[112:115], v[24:27]
    ds_read_b64_tr_b16 v[120:121], v236 offset:4096
    s_xor_b32 s46, s46, 8192
    v_mfma_f32_16x16x32_bf16 v[40:43], v[136:139], v[116:119], v[40:43]
    ds_read_b64_tr_b16 v[122:123], v236 offset:6144
    buffer_load_dwordx4 v[88:91], v248, s[88:91], s46 offen offset:0 sc1
    v_mfma_f32_16x16x32_bf16 v[44:47], v[140:143], v[116:119], v[44:47]
    ds_read_b64_tr_b16 v[124:125], v237 offset:4096
    v_mfma_f32_16x16x32_bf16 v[28:31], v[140:143], v[112:115], v[28:31]
    ds_read_b64_tr_b16 v[126:127], v237 offset:6144
    buffer_load_dwordx4 v[92:95], v248, s[88:91], s46 offen offset:1024 sc1
    v_mfma_f32_16x16x32_bf16 v[32:35], v[144:147], v[112:115], v[32:35]
    ds_read_b64_tr_b16 v[128:129], v238 offset:4096
    s_waitcnt vmcnt(8)
    v_bitop3_b32 v250, v56, v60, 1 bitop3:0xa8
    v_mfma_f32_16x16x32_bf16 v[48:51], v[144:147], v[116:119], v[48:51]
    ds_read_b64_tr_b16 v[130:131], v238 offset:6144
    v_cmp_ne_u32 vcc, 0, v250
    v_mfma_f32_16x16x32_bf16 v[52:55], v[148:151], v[116:119], v[52:55]
    ds_read_b64_tr_b16 v[132:133], v239 offset:4096
    s_cbranch_vccnz Lot_195
Look_196:
    v_mfma_f32_16x16x32_bf16 v[36:39], v[148:151], v[112:115], v[36:39]
    ds_read_b64_tr_b16 v[134:135], v239 offset:6144
    s_waitcnt lgkmcnt(8)
    v_mfma_f32_16x16x32_bf16 v[24:27], v[152:155], v[56:59], v[24:27]
    ds_read_b64_tr_b16 v[136:137], v236 offset:8192
    v_mfma_f32_16x16x32_bf16 v[40:43], v[152:155], v[60:63], v[40:43]
    ds_read_b64_tr_b16 v[138:139], v236 offset:10240
    buffer_load_dwordx4 v[96:99], v248, s[88:91], s46 offen offset:2048 sc1
    v_mfma_f32_16x16x32_bf16 v[44:47], v[156:159], v[60:63], v[44:47]
    ds_read_b64_tr_b16 v[140:141], v237 offset:8192
    v_mfma_f32_16x16x32_bf16 v[28:31], v[156:159], v[56:59], v[28:31]
    ds_read_b64_tr_b16 v[142:143], v237 offset:10240
    buffer_load_dwordx4 v[100:103], v248, s[88:91], s46 offen offset:3072 sc1
    v_mfma_f32_16x16x32_bf16 v[32:35], v[160:163], v[56:59], v[32:35]
    ds_read_b64_tr_b16 v[144:145], v238 offset:8192
    s_waitcnt vmcnt(8)
    v_bitop3_b32 v250, v64, v68, 1 bitop3:0xa8
    v_mfma_f32_16x16x32_bf16 v[48:51], v[160:163], v[60:63], v[48:51]
    ds_read_b64_tr_b16 v[146:147], v238 offset:10240
    v_cmp_ne_u32 vcc, 0, v250
    v_mfma_f32_16x16x32_bf16 v[52:55], v[164:167], v[60:63], v[52:55]
    ds_read_b64_tr_b16 v[148:149], v239 offset:8192
    s_cbranch_vccnz Lot_198
Look_199:
    v_mfma_f32_16x16x32_bf16 v[36:39], v[164:167], v[56:59], v[36:39]
    ds_read_b64_tr_b16 v[150:151], v239 offset:10240
    s_waitcnt lgkmcnt(8)
    v_mfma_f32_16x16x32_bf16 v[24:27], v[120:123], v[64:67], v[24:27]
    ds_read_b64_tr_b16 v[152:153], v236 offset:12288
    s_xor_b32 s47, s47, 8192
    v_mfma_f32_16x16x32_bf16 v[40:43], v[120:123], v[68:71], v[40:43]
    ds_read_b64_tr_b16 v[154:155], v236 offset:14336
    buffer_load_dwordx4 v[104:107], v248, s[88:91], s47 offen offset:0 sc1
    v_mfma_f32_16x16x32_bf16 v[44:47], v[124:127], v[68:71], v[44:47]
    ds_read_b64_tr_b16 v[156:157], v237 offset:12288
    v_mfma_f32_16x16x32_bf16 v[28:31], v[124:127], v[64:67], v[28:31]
    ds_read_b64_tr_b16 v[158:159], v237 offset:14336
    buffer_load_dwordx4 v[108:111], v248, s[88:91], s47 offen offset:1024 sc1
    v_mfma_f32_16x16x32_bf16 v[32:35], v[128:131], v[64:67], v[32:35]
    ds_read_b64_tr_b16 v[160:161], v238 offset:12288
    s_waitcnt vmcnt(8)
    v_bitop3_b32 v250, v72, v76, 1 bitop3:0xa8
    v_mfma_f32_16x16x32_bf16 v[48:51], v[128:131], v[68:71], v[48:51]
    ds_read_b64_tr_b16 v[162:163], v238 offset:14336
    v_cmp_ne_u32 vcc, 0, v250
    v_mfma_f32_16x16x32_bf16 v[52:55], v[132:135], v[68:71], v[52:55]
    ds_read_b64_tr_b16 v[164:165], v239 offset:12288
    s_cbranch_vccnz Lot_201
Look_202:
    v_mfma_f32_16x16x32_bf16 v[36:39], v[132:135], v[64:67], v[36:39]
    ds_read_b64_tr_b16 v[166:167], v239 offset:14336
    s_waitcnt lgkmcnt(8)
    v_mfma_f32_16x16x32_bf16 v[24:27], v[136:139], v[72:75], v[24:27]
    ds_read_b64_tr_b16 v[120:121], v236 offset:16384
    v_mfma_f32_16x16x32_bf16 v[40:43], v[136:139], v[76:79], v[40:43]
    ds_read_b64_tr_b16 v[122:123], v236 offset:18432
    buffer_load_dwordx4 v[112:115], v248, s[88:91], s47 offen offset:2048 sc1
    v_mfma_f32_16x16x32_bf16 v[44:47], v[140:143], v[76:79], v[44:47]
    ds_read_b64_tr_b16 v[124:125], v237 offset:16384
    v_mfma_f32_16x16x32_bf16 v[28:31], v[140:143], v[72:75], v[28:31]
    ds_read_b64_tr_b16 v[126:127], v237 offset:18432
    buffer_load_dwordx4 v[116:119], v248, s[88:91], s47 offen offset:3072 sc1
    v_mfma_f32_16x16x32_bf16 v[32:35], v[144:147], v[72:75], v[32:35]
    ds_read_b64_tr_b16 v[128:129], v238 offset:16384
    s_waitcnt vmcnt(8)
    v_bitop3_b32 v250, v80, v84, 1 bitop3:0xa8
    v_mfma_f32_16x16x32_bf16 v[48:51], v[144:147], v[76:79], v[48:51]
    ds_read_b64_tr_b16 v[130:131], v238 offset:18432
    v_cmp_ne_u32 vcc, 0, v250
    v_mfma_f32_16x16x32_bf16 v[52:55], v[148:151], v[76:79], v[52:55]
    ds_read_b64_tr_b16 v[132:133], v239 offset:16384
    s_cbranch_vccnz Lot_204
Look_205:
    v_mfma_f32_16x16x32_bf16 v[36:39], v[148:151], v[72:75], v[36:39]
    ds_read_b64_tr_b16 v[134:135], v239 offset:18432
    s_waitcnt lgkmcnt(8)
    v_mfma_f32_16x16x32_bf16 v[24:27], v[152:155], v[80:83], v[24:27]
    ds_read_b64_tr_b16 v[136:137], v236 offset:20480
    s_xor_b32 s44, s44, 24576
    v_mfma_f32_16x16x32_bf16 v[40:43], v[152:155], v[84:87], v[40:43]
    ds_read_b64_tr_b16 v[138:139], v236 offset:22528
    buffer_load_dwordx4 v[56:59], v248, s[88:91], s44 offen offset:0 sc1
    v_mfma_f32_16x16x32_bf16 v[44:47], v[156:159], v[84:87], v[44:47]
    ds_read_b64_tr_b16 v[140:141], v237 offset:20480
    v_mfma_f32_16x16x32_bf16 v[28:31], v[156:159], v[80:83], v[28:31]
    ds_read_b64_tr_b16 v[142:143], v237 offset:22528
    buffer_load_dwordx4 v[60:63], v248, s[88:91], s44 offen offset:1024 sc1
    v_mfma_f32_16x16x32_bf16 v[32:35], v[160:163], v[80:83], v[32:35]
    ds_read_b64_tr_b16 v[144:145], v238 offset:20480
    s_waitcnt vmcnt(8)
    v_bitop3_b32 v250, v88, v92, 1 bitop3:0xa8
    v_mfma_f32_16x16x32_bf16 v[48:51], v[160:163], v[84:87], v[48:51]
    ds_read_b64_tr_b16 v[146:147], v238 offset:22528
    v_cmp_ne_u32 vcc, 0, v250
    v_mfma_f32_16x16x32_bf16 v[52:55], v[164:167], v[84:87], v[52:55]
    ds_read_b64_tr_b16 v[148:149], v239 offset:20480
    s_cbranch_vccnz Lot_207
Look_208:
    v_mfma_f32_16x16x32_bf16 v[36:39], v[164:167], v[80:83], v[36:39]
    ds_read_b64_tr_b16 v[150:151], v239 offset:22528
    s_waitcnt lgkmcnt(8)
    v_mfma_f32_16x16x32_bf16 v[24:27], v[120:123], v[88:91], v[24:27]
    ds_read_b64_tr_b16 v[152:153], v236 offset:24576
    v_mfma_f32_16x16x32_bf16 v[40:43], v[120:123], v[92:95], v[40:43]
    ds_read_b64_tr_b16 v[154:155], v236 offset:26624
    buffer_load_dwordx4 v[64:67], v248, s[88:91], s44 offen offset:2048 sc1
    v_mfma_f32_16x16x32_bf16 v[44:47], v[124:127], v[92:95], v[44:47]
    ds_read_b64_tr_b16 v[156:157], v237 offset:24576
    v_mfma_f32_16x16x32_bf16 v[28:31], v[124:127], v[88:91], v[28:31]
    ds_read_b64_tr_b16 v[158:159], v237 offset:26624
    buffer_load_dwordx4 v[68:71], v248, s[88:91], s44 offen offset:3072 sc1
    v_mfma_f32_16x16x32_bf16 v[32:35], v[128:131], v[88:91], v[32:35]
    ds_read_b64_tr_b16 v[160:161], v238 offset:24576
    s_waitcnt vmcnt(8)
    v_bitop3_b32 v250, v96, v100, 1 bitop3:0xa8
    v_mfma_f32_16x16x32_bf16 v[48:51], v[128:131], v[92:95], v[48:51]
    ds_read_b64_tr_b16 v[162:163], v238 offset:26624
    v_cmp_ne_u32 vcc, 0, v250
    v_mfma_f32_16x16x32_bf16 v[52:55], v[132:135], v[92:95], v[52:55]
    ds_read_b64_tr_b16 v[164:165], v239 offset:24576
    s_cbranch_vccnz Lot_210
Look_211:
    v_mfma_f32_16x16x32_bf16 v[36:39], v[132:135], v[88:91], v[36:39]
    ds_read_b64_tr_b16 v[166:167], v239 offset:26624
    s_waitcnt lgkmcnt(8)
    v_mfma_f32_16x16x32_bf16 v[24:27], v[136:139], v[96:99], v[24:27]
    ds_read_b64_tr_b16 v[120:121], v236 offset:28672
    s_xor_b32 s45, s45, 24576
    v_mfma_f32_16x16x32_bf16 v[40:43], v[136:139], v[100:103], v[40:43]
    ds_read_b64_tr_b16 v[122:123], v236 offset:30720
    buffer_load_dwordx4 v[72:75], v248, s[88:91], s45 offen offset:0 sc1
    v_mfma_f32_16x16x32_bf16 v[44:47], v[140:143], v[100:103], v[44:47]
    ds_read_b64_tr_b16 v[124:125], v237 offset:28672
    v_mfma_f32_16x16x32_bf16 v[28:31], v[140:143], v[96:99], v[28:31]
    ds_read_b64_tr_b16 v[126:127], v237 offset:30720
    buffer_load_dwordx4 v[76:79], v248, s[88:91], s45 offen offset:1024 sc1
    v_mfma_f32_16x16x32_bf16 v[32:35], v[144:147], v[96:99], v[32:35]
    ds_read_b64_tr_b16 v[128:129], v238 offset:28672
    s_waitcnt vmcnt(8)
    v_bitop3_b32 v250, v104, v108, 1 bitop3:0xa8
    v_mfma_f32_16x16x32_bf16 v[48:51], v[144:147], v[100:103], v[48:51]
    ds_read_b64_tr_b16 v[130:131], v238 offset:30720
    v_cmp_ne_u32 vcc, 0, v250
    v_mfma_f32_16x16x32_bf16 v[52:55], v[148:151], v[100:103], v[52:55]
    ds_read_b64_tr_b16 v[132:133], v239 offset:28672
    s_cbranch_vccnz Lot_213
Look_214:
    v_mfma_f32_16x16x32_bf16 v[36:39], v[148:151], v[96:99], v[36:39]
    ds_read_b64_tr_b16 v[134:135], v239 offset:30720
    s_waitcnt lgkmcnt(8)
    v_mfma_f32_16x16x32_bf16 v[24:27], v[152:155], v[104:107], v[24:27]
    ds_read_b64_tr_b16 v[136:137], v236 offset:32768
    v_mfma_f32_16x16x32_bf16 v[40:43], v[152:155], v[108:111], v[40:43]
    ds_read_b64_tr_b16 v[138:139], v236 offset:34816
    buffer_load_dwordx4 v[80:83], v248, s[88:91], s45 offen offset:2048 sc1
    v_mfma_f32_16x16x32_bf16 v[44:47], v[156:159], v[108:111], v[44:47]
    ds_read_b64_tr_b16 v[140:141], v237 offset:32768
    v_mfma_f32_16x16x32_bf16 v[28:31], v[156:159], v[104:107], v[28:31]
    ds_read_b64_tr_b16 v[142:143], v237 offset:34816
    buffer_load_dwordx4 v[84:87], v248, s[88:91], s45 offen offset:3072 sc1
    v_mfma_f32_16x16x32_bf16 v[32:35], v[160:163], v[104:107], v[32:35]
    ds_read_b64_tr_b16 v[144:145], v238 offset:32768
    s_waitcnt vmcnt(8)
    v_bitop3_b32 v250, v112, v116, 1 bitop3:0xa8
    v_mfma_f32_16x16x32_bf16 v[48:51], v[160:163], v[108:111], v[48:51]
    ds_read_b64_tr_b16 v[146:147], v238 offset:34816
    v_cmp_ne_u32 vcc, 0, v250
    v_mfma_f32_16x16x32_bf16 v[52:55], v[164:167], v[108:111], v[52:55]
    ds_read_b64_tr_b16 v[148:149], v239 offset:32768
    s_cbranch_vccnz Lot_216
Look_217:
    v_mfma_f32_16x16x32_bf16 v[36:39], v[164:167], v[104:107], v[36:39]
    ds_read_b64_tr_b16 v[150:151], v239 offset:34816
    s_waitcnt lgkmcnt(8)
    v_mfma_f32_16x16x32_bf16 v[24:27], v[120:123], v[112:115], v[24:27]
    ds_read_b64_tr_b16 v[152:153], v236 offset:36864
    s_xor_b32 s46, s46, 24576
    v_mfma_f32_16x16x32_bf16 v[40:43], v[120:123], v[116:119], v[40:43]
    ds_read_b64_tr_b16 v[154:155], v236 offset:38912
    buffer_load_dwordx4 v[88:91], v248, s[88:91], s46 offen offset:0 sc1
    v_mfma_f32_16x16x32_bf16 v[44:47], v[124:127], v[116:119], v[44:47]
    ds_read_b64_tr_b16 v[156:157], v237 offset:36864
    v_mfma_f32_16x16x32_bf16 v[28:31], v[124:127], v[112:115], v[28:31]
    ds_read_b64_tr_b16 v[158:159], v237 offset:38912
    buffer_load_dwordx4 v[92:95], v248, s[88:91], s46 offen offset:1024 sc1
    v_mfma_f32_16x16x32_bf16 v[32:35], v[128:131], v[112:115], v[32:35]
    ds_read_b64_tr_b16 v[160:161], v238 offset:36864
    s_waitcnt vmcnt(8)
    v_bitop3_b32 v250, v56, v60, 1 bitop3:0xa8
    v_mfma_f32_16x16x32_bf16 v[48:51], v[128:131], v[116:119], v[48:51]
    ds_read_b64_tr_b16 v[162:163], v238 offset:38912
    v_cmp_ne_u32 vcc, 0, v250
    v_mfma_f32_16x16x32_bf16 v[52:55], v[132:135], v[116:119], v[52:55]
    ds_read_b64_tr_b16 v[164:165], v239 offset:36864
    s_cbranch_vccnz Lot_219
Look_220:
    v_mfma_f32_16x16x32_bf16 v[36:39], v[132:135], v[112:115], v[36:39]
    ds_read_b64_tr_b16 v[166:167], v239 offset:38912
    s_waitcnt lgkmcnt(8)
    v_mfma_f32_16x16x32_bf16 v[24:27], v[136:139], v[56:59], v[24:27]
    ds_read_b64_tr_b16 v[120:121], v236 offset:40960
    v_mfma_f32_16x16x32_bf16 v[40:43], v[136:139], v[60:63], v[40:43]
    ds_read_b64_tr_b16 v[122:123], v236 offset:43008
    buffer_load_dwordx4 v[96:99], v248, s[88:91], s46 offen offset:2048 sc1
    v_mfma_f32_16x16x32_bf16 v[44:47], v[140:143], v[60:63], v[44:47]
    ds_read_b64_tr_b16 v[124:125], v237 offset:40960
    v_mfma_f32_16x16x32_bf16 v[28:31], v[140:143], v[56:59], v[28:31]
    ds_read_b64_tr_b16 v[126:127], v237 offset:43008
    buffer_load_dwordx4 v[100:103], v248, s[88:91], s46 offen offset:3072 sc1
    v_mfma_f32_16x16x32_bf16 v[32:35], v[144:147], v[56:59], v[32:35]
    ds_read_b64_tr_b16 v[128:129], v238 offset:40960
    s_waitcnt vmcnt(8)
    v_bitop3_b32 v250, v64, v68, 1 bitop3:0xa8
    v_mfma_f32_16x16x32_bf16 v[48:51], v[144:147], v[60:63], v[48:51]
    ds_read_b64_tr_b16 v[130:131], v238 offset:43008
    v_cmp_ne_u32 vcc, 0, v250
    v_mfma_f32_16x16x32_bf16 v[52:55], v[148:151], v[60:63], v[52:55]
    ds_read_b64_tr_b16 v[132:133], v239 offset:40960
    s_cbranch_vccnz Lot_222
Look_223:
    v_mfma_f32_16x16x32_bf16 v[36:39], v[148:151], v[56:59], v[36:39]
    ds_read_b64_tr_b16 v[134:135], v239 offset:43008
    s_waitcnt lgkmcnt(8)
    v_mfma_f32_16x16x32_bf16 v[24:27], v[152:155], v[64:67], v[24:27]
    ds_read_b64_tr_b16 v[136:137], v236 offset:45056
    s_xor_b32 s47, s47, 24576
    v_mfma_f32_16x16x32_bf16 v[40:43], v[152:155], v[68:71], v[40:43]
    ds_read_b64_tr_b16 v[138:139], v236 offset:47104
    buffer_load_dwordx4 v[104:107], v248, s[88:91], s47 offen offset:0 sc1
    v_mfma_f32_16x16x32_bf16 v[44:47], v[156:159], v[68:71], v[44:47]
    ds_read_b64_tr_b16 v[140:141], v237 offset:45056
    v_mfma_f32_16x16x32_bf16 v[28:31], v[156:159], v[64:67], v[28:31]
    ds_read_b64_tr_b16 v[142:143], v237 offset:47104
    buffer_load_dwordx4 v[108:111], v248, s[88:91], s47 offen offset:1024 sc1
    v_mfma_f32_16x16x32_bf16 v[32:35], v[160:163], v[64:67], v[32:35]
    ds_read_b64_tr_b16 v[144:145], v238 offset:45056
    s_waitcnt vmcnt(8)
    v_bitop3_b32 v250, v72, v76, 1 bitop3:0xa8
    v_mfma_f32_16x16x32_bf16 v[48:51], v[160:163], v[68:71], v[48:51]
    ds_read_b64_tr_b16 v[146:147], v238 offset:47104
    v_cmp_ne_u32 vcc, 0, v250
    v_mfma_f32_16x16x32_bf16 v[52:55], v[164:167], v[68:71], v[52:55]
    ds_read_b64_tr_b16 v[148:149], v239 offset:45056
    s_cbranch_vccnz Lot_225
Look_226:
    v_mfma_f32_16x16x32_bf16 v[36:39], v[164:167], v[64:67], v[36:39]
    ds_read_b64_tr_b16 v[150:151], v239 offset:47104
    s_waitcnt lgkmcnt(8)
    v_mfma_f32_16x16x32_bf16 v[24:27], v[120:123], v[72:75], v[24:27]
    ds_read_b64_tr_b16 v[152:153], v236 offset:49152
    v_mfma_f32_16x16x32_bf16 v[40:43], v[120:123], v[76:79], v[40:43]
    ds_read_b64_tr_b16 v[154:155], v236 offset:51200
    buffer_load_dwordx4 v[112:115], v248, s[88:91], s47 offen offset:2048 sc1
    v_mfma_f32_16x16x32_bf16 v[44:47], v[124:127], v[76:79], v[44:47]
    ds_read_b64_tr_b16 v[156:157], v237 offset:49152
    v_mfma_f32_16x16x32_bf16 v[28:31], v[124:127], v[72:75], v[28:31]
    ds_read_b64_tr_b16 v[158:159], v237 offset:51200
    buffer_load_dwordx4 v[116:119], v248, s[88:91], s47 offen offset:3072 sc1
    v_mfma_f32_16x16x32_bf16 v[32:35], v[128:131], v[72:75], v[32:35]
    ds_read_b64_tr_b16 v[160:161], v238 offset:49152
    s_waitcnt vmcnt(8)
    v_bitop3_b32 v250, v80, v84, 1 bitop3:0xa8
    v_mfma_f32_16x16x32_bf16 v[48:51], v[128:131], v[76:79], v[48:51]
    ds_read_b64_tr_b16 v[162:163], v238 offset:51200
    v_cmp_ne_u32 vcc, 0, v250
    v_mfma_f32_16x16x32_bf16 v[52:55], v[132:135], v[76:79], v[52:55]
    ds_read_b64_tr_b16 v[164:165], v239 offset:49152
    s_cbranch_vccnz Lot_228
Look_229:
    v_mfma_f32_16x16x32_bf16 v[36:39], v[132:135], v[72:75], v[36:39]
    ds_read_b64_tr_b16 v[166:167], v239 offset:51200
    s_waitcnt lgkmcnt(8)
    v_mfma_f32_16x16x32_bf16 v[24:27], v[136:139], v[80:83], v[24:27]
    ds_read_b64_tr_b16 v[120:121], v236 offset:53248
    s_xor_b32 s44, s44, 8192
    v_mfma_f32_16x16x32_bf16 v[40:43], v[136:139], v[84:87], v[40:43]
    ds_read_b64_tr_b16 v[122:123], v236 offset:55296
    buffer_load_dwordx4 v[56:59], v248, s[88:91], s44 offen offset:0 sc1
    v_mfma_f32_16x16x32_bf16 v[44:47], v[140:143], v[84:87], v[44:47]
    ds_read_b64_tr_b16 v[124:125], v237 offset:53248
    v_mfma_f32_16x16x32_bf16 v[28:31], v[140:143], v[80:83], v[28:31]
    ds_read_b64_tr_b16 v[126:127], v237 offset:55296
    buffer_load_dwordx4 v[60:63], v248, s[88:91], s44 offen offset:1024 sc1
    v_mfma_f32_16x16x32_bf16 v[32:35], v[144:147], v[80:83], v[32:35]
    ds_read_b64_tr_b16 v[128:129], v238 offset:53248
    s_waitcnt vmcnt(8)
    v_bitop3_b32 v250, v88, v92, 1 bitop3:0xa8
    v_mfma_f32_16x16x32_bf16 v[48:51], v[144:147], v[84:87], v[48:51]
    ds_read_b64_tr_b16 v[130:131], v238 offset:55296
    v_cmp_ne_u32 vcc, 0, v250
    v_mfma_f32_16x16x32_bf16 v[52:55], v[148:151], v[84:87], v[52:55]
    ds_read_b64_tr_b16 v[132:133], v239 offset:53248
    s_cbranch_vccnz Lot_231
Look_232:
    v_mfma_f32_16x16x32_bf16 v[36:39], v[148:151], v[80:83], v[36:39]
    ds_read_b64_tr_b16 v[134:135], v239 offset:55296
    s_waitcnt lgkmcnt(8)
    v_mfma_f32_16x16x32_bf16 v[24:27], v[152:155], v[88:91], v[24:27]
    ds_read_b64_tr_b16 v[136:137], v236 offset:57344
    v_mfma_f32_16x16x32_bf16 v[40:43], v[152:155], v[92:95], v[40:43]
    ds_read_b64_tr_b16 v[138:139], v236 offset:59392
    buffer_load_dwordx4 v[64:67], v248, s[88:91], s44 offen offset:2048 sc1
    v_mfma_f32_16x16x32_bf16 v[44:47], v[156:159], v[92:95], v[44:47]
    ds_read_b64_tr_b16 v[140:141], v237 offset:57344
    v_mfma_f32_16x16x32_bf16 v[28:31], v[156:159], v[88:91], v[28:31]
    ds_read_b64_tr_b16 v[142:143], v237 offset:59392
    buffer_load_dwordx4 v[68:71], v248, s[88:91], s44 offen offset:3072 sc1
    v_mfma_f32_16x16x32_bf16 v[32:35], v[160:163], v[88:91], v[32:35]
    ds_read_b64_tr_b16 v[144:145], v238 offset:57344
    s_waitcnt vmcnt(8)
    v_bitop3_b32 v250, v96, v100, 1 bitop3:0xa8
    v_mfma_f32_16x16x32_bf16 v[48:51], v[160:163], v[92:95], v[48:51]
    ds_read_b64_tr_b16 v[146:147], v238 offset:59392
    v_cmp_ne_u32 vcc, 0, v250
    v_mfma_f32_16x16x32_bf16 v[52:55], v[164:167], v[92:95], v[52:55]
    ds_read_b64_tr_b16 v[148:149], v239 offset:57344
    s_cbranch_vccnz Lot_234
Look_235:
    v_mfma_f32_16x16x32_bf16 v[36:39], v[164:167], v[88:91], v[36:39]
    ds_read_b64_tr_b16 v[150:151], v239 offset:59392
    s_waitcnt lgkmcnt(8)
    v_mfma_f32_16x16x32_bf16 v[24:27], v[120:123], v[96:99], v[24:27]
    ds_read_b64_tr_b16 v[152:153], v236 offset:61440
    s_xor_b32 s45, s45, 8192
    v_mfma_f32_16x16x32_bf16 v[40:43], v[120:123], v[100:103], v[40:43]
    ds_read_b64_tr_b16 v[154:155], v236 offset:63488
    buffer_load_dwordx4 v[72:75], v248, s[88:91], s45 offen offset:0 sc1
    v_mfma_f32_16x16x32_bf16 v[44:47], v[124:127], v[100:103], v[44:47]
    ds_read_b64_tr_b16 v[156:157], v237 offset:61440
    v_mfma_f32_16x16x32_bf16 v[28:31], v[124:127], v[96:99], v[28:31]
    ds_read_b64_tr_b16 v[158:159], v237 offset:63488
    buffer_load_dwordx4 v[76:79], v248, s[88:91], s45 offen offset:1024 sc1
    v_mfma_f32_16x16x32_bf16 v[32:35], v[128:131], v[96:99], v[32:35]
    ds_read_b64_tr_b16 v[160:161], v238 offset:61440
    s_waitcnt vmcnt(8)
    v_bitop3_b32 v250, v104, v108, 1 bitop3:0xa8
    v_mfma_f32_16x16x32_bf16 v[48:51], v[128:131], v[100:103], v[48:51]
    ds_read_b64_tr_b16 v[162:163], v238 offset:63488
    v_cmp_ne_u32 vcc, 0, v250
    v_mfma_f32_16x16x32_bf16 v[52:55], v[132:135], v[100:103], v[52:55]
    ds_read_b64_tr_b16 v[164:165], v239 offset:61440
    s_cbranch_vccnz Lot_237
Look_238:
    v_mfma_f32_16x16x32_bf16 v[36:39], v[132:135], v[96:99], v[36:39]
    ds_read_b64_tr_b16 v[166:167], v239 offset:63488
    s_waitcnt lgkmcnt(8)
    v_mfma_f32_16x16x32_bf16 v[24:27], v[136:139], v[104:107], v[24:27]
    ds_read_b64_tr_b16 v[120:121], v240 offset:0
    v_mfma_f32_16x16x32_bf16 v[40:43], v[136:139], v[108:111], v[40:43]
    ds_read_b64_tr_b16 v[122:123], v240 offset:2048
    buffer_load_dwordx4 v[80:83], v248, s[88:91], s45 offen offset:2048 sc1
    v_mfma_f32_16x16x32_bf16 v[44:47], v[140:143], v[108:111], v[44:47]
    ds_read_b64_tr_b16 v[124:125], v241 offset:0
    v_mfma_f32_16x16x32_bf16 v[28:31], v[140:143], v[104:107], v[28:31]
    ds_read_b64_tr_b16 v[126:127], v241 offset:2048
    buffer_load_dwordx4 v[84:87], v248, s[88:91], s45 offen offset:3072 sc1
    v_mfma_f32_16x16x32_bf16 v[32:35], v[144:147], v[104:107], v[32:35]
    ds_read_b64_tr_b16 v[128:129], v242 offset:0
    s_waitcnt vmcnt(8)
    v_bitop3_b32 v250, v112, v116, 1 bitop3:0xa8
    v_mfma_f32_16x16x32_bf16 v[48:51], v[144:147], v[108:111], v[48:51]
    ds_read_b64_tr_b16 v[130:131], v242 offset:2048
    v_cmp_ne_u32 vcc, 0, v250
    v_mfma_f32_16x16x32_bf16 v[52:55], v[148:151], v[108:111], v[52:55]
    ds_read_b64_tr_b16 v[132:133], v243 offset:0
    s_cbranch_vccnz Lot_240
Look_241:
    v_mfma_f32_16x16x32_bf16 v[36:39], v[148:151], v[104:107], v[36:39]
    ds_read_b64_tr_b16 v[134:135], v243 offset:2048
    s_waitcnt lgkmcnt(8)
    v_mfma_f32_16x16x32_bf16 v[24:27], v[152:155], v[112:115], v[24:27]
    ds_read_b64_tr_b16 v[136:137], v240 offset:4096
    s_xor_b32 s46, s46, 8192
    v_mfma_f32_16x16x32_bf16 v[40:43], v[152:155], v[116:119], v[40:43]
    ds_read_b64_tr_b16 v[138:139], v240 offset:6144
    buffer_load_dwordx4 v[88:91], v248, s[88:91], s46 offen offset:0 sc1
    v_mfma_f32_16x16x32_bf16 v[44:47], v[156:159], v[116:119], v[44:47]
    ds_read_b64_tr_b16 v[140:141], v241 offset:4096
    v_mfma_f32_16x16x32_bf16 v[28:31], v[156:159], v[112:115], v[28:31]
    ds_read_b64_tr_b16 v[142:143], v241 offset:6144
    buffer_load_dwordx4 v[92:95], v248, s[88:91], s46 offen offset:1024 sc1
    v_mfma_f32_16x16x32_bf16 v[32:35], v[160:163], v[112:115], v[32:35]
    ds_read_b64_tr_b16 v[144:145], v242 offset:4096
    s_waitcnt vmcnt(8)
    v_bitop3_b32 v250, v56, v60, 1 bitop3:0xa8
    v_mfma_f32_16x16x32_bf16 v[48:51], v[160:163], v[116:119], v[48:51]
    ds_read_b64_tr_b16 v[146:147], v242 offset:6144
    v_cmp_ne_u32 vcc, 0, v250
    v_mfma_f32_16x16x32_bf16 v[52:55], v[164:167], v[116:119], v[52:55]
    ds_read_b64_tr_b16 v[148:149], v243 offset:4096
    s_cbranch_vccnz Lot_243
Look_244:
    v_mfma_f32_16x16x32_bf16 v[36:39], v[164:167], v[112:115], v[36:39]
    ds_read_b64_tr_b16 v[150:151], v243 offset:6144
    s_waitcnt lgkmcnt(8)
    v_mfma_f32_16x16x32_bf16 v[24:27], v[120:123], v[56:59], v[24:27]
    ds_read_b64_tr_b16 v[152:153], v240 offset:8192
    v_mfma_f32_16x16x32_bf16 v[40:43], v[120:123], v[60:63], v[40:43]
    ds_read_b64_tr_b16 v[154:155], v240 offset:10240
    buffer_load_dwordx4 v[96:99], v248, s[88:91], s46 offen offset:2048 sc1
    v_mfma_f32_16x16x32_bf16 v[44:47], v[124:127], v[60:63], v[44:47]
    ds_read_b64_tr_b16 v[156:157], v241 offset:8192
    v_mfma_f32_16x16x32_bf16 v[28:31], v[124:127], v[56:59], v[28:31]
    ds_read_b64_tr_b16 v[158:159], v241 offset:10240
    buffer_load_dwordx4 v[100:103], v248, s[88:91], s46 offen offset:3072 sc1
    v_mfma_f32_16x16x32_bf16 v[32:35], v[128:131], v[56:59], v[32:35]
    ds_read_b64_tr_b16 v[160:161], v242 offset:8192
    s_waitcnt vmcnt(8)
    v_bitop3_b32 v250, v64, v68, 1 bitop3:0xa8
    v_mfma_f32_16x16x32_bf16 v[48:51], v[128:131], v[60:63], v[48:51]
    ds_read_b64_tr_b16 v[162:163], v242 offset:10240
    v_cmp_ne_u32 vcc, 0, v250
    v_mfma_f32_16x16x32_bf16 v[52:55], v[132:135], v[60:63], v[52:55]
    ds_read_b64_tr_b16 v[164:165], v243 offset:8192
    s_cbranch_vccnz Lot_246
Look_247:
    v_mfma_f32_16x16x32_bf16 v[36:39], v[132:135], v[56:59], v[36:39]
    ds_read_b64_tr_b16 v[166:167], v243 offset:10240
    s_waitcnt lgkmcnt(8)
    v_mfma_f32_16x16x32_bf16 v[24:27], v[136:139], v[64:67], v[24:27]
    ds_read_b64_tr_b16 v[120:121], v240 offset:12288
    s_xor_b32 s47, s47, 8192
    v_mfma_f32_16x16x32_bf16 v[40:43], v[136:139], v[68:71], v[40:43]
    ds_read_b64_tr_b16 v[122:123], v240 offset:14336
    buffer_load_dwordx4 v[104:107], v248, s[88:91], s47 offen offset:0 sc1
    v_mfma_f32_16x16x32_bf16 v[44:47], v[140:143], v[68:71], v[44:47]
    ds_read_b64_tr_b16 v[124:125], v241 offset:12288
    s_barrier
    v_mfma_f32_16x16x32_bf16 v[28:31], v[140:143], v[64:67], v[28:31]
    ds_read_b64_tr_b16 v[126:127], v241 offset:14336
    buffer_load_dwordx4 v[108:111], v248, s[88:91], s47 offen offset:1024 sc1
    v_mfma_f32_16x16x32_bf16 v[32:35], v[144:147], v[64:67], v[32:35]
    ds_read_b64_tr_b16 v[128:129], v242 offset:12288
    s_waitcnt vmcnt(8)
    v_bitop3_b32 v250, v72, v76, 1 bitop3:0xa8
    v_mfma_f32_16x16x32_bf16 v[48:51], v[144:147], v[68:71], v[48:51]
    ds_read_b64_tr_b16 v[130:131], v242 offset:14336
    v_cmp_ne_u32 vcc, 0, v250
    v_mfma_f32_16x16x32_bf16 v[52:55], v[148:151], v[68:71], v[52:55]
    ds_read_b64_tr_b16 v[132:133], v243 offset:12288
    s_cbranch_vccnz Lot_249
Look_250:
    v_mfma_f32_16x16x32_bf16 v[36:39], v[148:151], v[64:67], v[36:39]
    ds_read_b64_tr_b16 v[134:135], v243 offset:14336
    s_waitcnt lgkmcnt(8)
    v_mfma_f32_16x16x32_bf16 v[24:27], v[152:155], v[72:75], v[24:27]
    ds_read_b64_tr_b16 v[136:137], v240 offset:16384
    v_mfma_f32_16x16x32_bf16 v[40:43], v[152:155], v[76:79], v[40:43]
    ds_read_b64_tr_b16 v[138:139], v240 offset:18432
    buffer_load_dwordx4 v[112:115], v248, s[88:91], s47 offen offset:2048 sc1
    v_mfma_f32_16x16x32_bf16 v[44:47], v[156:159], v[76:79], v[44:47]
    ds_read_b64_tr_b16 v[140:141], v241 offset:16384
    v_mfma_f32_16x16x32_bf16 v[28:31], v[156:159], v[72:75], v[28:31]
    ds_read_b64_tr_b16 v[142:143], v241 offset:18432
    buffer_load_dwordx4 v[116:119], v248, s[88:91], s47 offen offset:3072 sc1
    v_mfma_f32_16x16x32_bf16 v[32:35], v[160:163], v[72:75], v[32:35]
    ds_read_b64_tr_b16 v[144:145], v242 offset:16384
    s_waitcnt vmcnt(8)
    v_bitop3_b32 v250, v80, v84, 1 bitop3:0xa8
    v_mfma_f32_16x16x32_bf16 v[48:51], v[160:163], v[76:79], v[48:51]
    ds_read_b64_tr_b16 v[146:147], v242 offset:18432
    v_cmp_ne_u32 vcc, 0, v250
    v_mfma_f32_16x16x32_bf16 v[52:55], v[164:167], v[76:79], v[52:55]
    ds_read_b64_tr_b16 v[148:149], v243 offset:16384
    s_cbranch_vccnz Lot_252
Look_253:
    v_mfma_f32_16x16x32_bf16 v[36:39], v[164:167], v[72:75], v[36:39]
    ds_read_b64_tr_b16 v[150:151], v243 offset:18432
    s_waitcnt lgkmcnt(8)
    v_mfma_f32_16x16x32_bf16 v[24:27], v[120:123], v[80:83], v[24:27]
    ds_read_b64_tr_b16 v[152:153], v240 offset:20480
    v_mfma_f32_16x16x32_bf16 v[40:43], v[120:123], v[84:87], v[40:43]
    ds_read_b64_tr_b16 v[154:155], v240 offset:22528
    v_mfma_f32_16x16x32_bf16 v[44:47], v[124:127], v[84:87], v[44:47]
    ds_read_b64_tr_b16 v[156:157], v241 offset:20480
    v_mfma_f32_16x16x32_bf16 v[28:31], v[124:127], v[80:83], v[28:31]
    ds_read_b64_tr_b16 v[158:159], v241 offset:22528
    v_mfma_f32_16x16x32_bf16 v[32:35], v[128:131], v[80:83], v[32:35]
    ds_read_b64_tr_b16 v[160:161], v242 offset:20480
    s_waitcnt vmcnt(6)
    v_bitop3_b32 v250, v88, v92, 1 bitop3:0xa8
    v_mfma_f32_16x16x32_bf16 v[48:51], v[128:131], v[84:87], v[48:51]
    ds_read_b64_tr_b16 v[162:163], v242 offset:22528
    v_cmp_ne_u32 vcc, 0, v250
    v_mfma_f32_16x16x32_bf16 v[52:55], v[132:135], v[84:87], v[52:55]
    ds_read_b64_tr_b16 v[164:165], v243 offset:20480
    s_cbranch_vccnz Lot_255
Look_256:
    v_mfma_f32_16x16x32_bf16 v[36:39], v[132:135], v[80:83], v[36:39]
    ds_read_b64_tr_b16 v[166:167], v243 offset:22528
    s_waitcnt lgkmcnt(8)
    v_mfma_f32_16x16x32_bf16 v[24:27], v[136:139], v[88:91], v[24:27]
    ds_read_b64_tr_b16 v[120:121], v240 offset:24576
    v_mfma_f32_16x16x32_bf16 v[40:43], v[136:139], v[92:95], v[40:43]
    ds_read_b64_tr_b16 v[122:123], v240 offset:26624
    v_mfma_f32_16x16x32_bf16 v[44:47], v[140:143], v[92:95], v[44:47]
    ds_read_b64_tr_b16 v[124:125], v241 offset:24576
    v_mfma_f32_16x16x32_bf16 v[28:31], v[140:143], v[88:91], v[28:31]
    ds_read_b64_tr_b16 v[126:127], v241 offset:26624
    v_mfma_f32_16x16x32_bf16 v[32:35], v[144:147], v[88:91], v[32:35]
    ds_read_b64_tr_b16 v[128:129], v242 offset:24576
    s_waitcnt vmcnt(4)
    v_bitop3_b32 v250, v96, v100, 1 bitop3:0xa8
    v_mfma_f32_16x16x32_bf16 v[48:51], v[144:147], v[92:95], v[48:51]
    ds_read_b64_tr_b16 v[130:131], v242 offset:26624
    v_cmp_ne_u32 vcc, 0, v250
    v_mfma_f32_16x16x32_bf16 v[52:55], v[148:151], v[92:95], v[52:55]
    ds_read_b64_tr_b16 v[132:133], v243 offset:24576
    s_cbranch_vccnz Lot_258
Look_259:
    v_mfma_f32_16x16x32_bf16 v[36:39], v[148:151], v[88:91], v[36:39]
    ds_read_b64_tr_b16 v[134:135], v243 offset:26624
    s_waitcnt lgkmcnt(8)
    v_mfma_f32_16x16x32_bf16 v[24:27], v[152:155], v[96:99], v[24:27]
    ds_read_b64_tr_b16 v[136:137], v240 offset:28672
    v_mfma_f32_16x16x32_bf16 v[40:43], v[152:155], v[100:103], v[40:43]
    ds_read_b64_tr_b16 v[138:139], v240 offset:30720
    v_mfma_f32_16x16x32_bf16 v[44:47], v[156:159], v[100:103], v[44:47]
    ds_read_b64_tr_b16 v[140:141], v241 offset:28672
    v_mfma_f32_16x16x32_bf16 v[28:31], v[156:159], v[96:99], v[28:31]
    ds_read_b64_tr_b16 v[142:143], v241 offset:30720
    v_mfma_f32_16x16x32_bf16 v[32:35], v[160:163], v[96:99], v[32:35]
    ds_read_b64_tr_b16 v[144:145], v242 offset:28672
    s_waitcnt vmcnt(2)
    v_bitop3_b32 v250, v104, v108, 1 bitop3:0xa8
    v_mfma_f32_16x16x32_bf16 v[48:51], v[160:163], v[100:103], v[48:51]
    ds_read_b64_tr_b16 v[146:147], v242 offset:30720
    v_cmp_ne_u32 vcc, 0, v250
    v_mfma_f32_16x16x32_bf16 v[52:55], v[164:167], v[100:103], v[52:55]
    ds_read_b64_tr_b16 v[148:149], v243 offset:28672
    s_cbranch_vccnz Lot_261
Look_262:
    v_mfma_f32_16x16x32_bf16 v[36:39], v[164:167], v[96:99], v[36:39]
    ds_read_b64_tr_b16 v[150:151], v243 offset:30720
    s_waitcnt lgkmcnt(8)
    v_mfma_f32_16x16x32_bf16 v[24:27], v[120:123], v[104:107], v[24:27]
    v_mfma_f32_16x16x32_bf16 v[40:43], v[120:123], v[108:111], v[40:43]
    v_mfma_f32_16x16x32_bf16 v[44:47], v[124:127], v[108:111], v[44:47]
    v_mfma_f32_16x16x32_bf16 v[28:31], v[124:127], v[104:107], v[28:31]
    v_mfma_f32_16x16x32_bf16 v[32:35], v[128:131], v[104:107], v[32:35]
    s_waitcnt vmcnt(0)
    v_bitop3_b32 v250, v112, v116, 1 bitop3:0xa8
    v_mfma_f32_16x16x32_bf16 v[48:51], v[128:131], v[108:111], v[48:51]
    v_cmp_ne_u32 vcc, 0, v250
    v_mfma_f32_16x16x32_bf16 v[52:55], v[132:135], v[108:111], v[52:55]
    s_cbranch_vccnz Lot_264
Look_265:
    v_mfma_f32_16x16x32_bf16 v[36:39], v[132:135], v[104:107], v[36:39]
    s_waitcnt lgkmcnt(0)
    v_mfma_f32_16x16x32_bf16 v[24:27], v[136:139], v[112:115], v[24:27]
    v_mfma_f32_16x16x32_bf16 v[28:31], v[140:143], v[112:115], v[28:31]
    v_mfma_f32_16x16x32_bf16 v[32:35], v[144:147], v[112:115], v[32:35]
    v_mfma_f32_16x16x32_bf16 v[36:39], v[148:151], v[112:115], v[36:39]
    v_mfma_f32_16x16x32_bf16 v[40:43], v[136:139], v[116:119], v[40:43]
    v_mfma_f32_16x16x32_bf16 v[44:47], v[140:143], v[116:119], v[44:47]
    v_mfma_f32_16x16x32_bf16 v[48:51], v[144:147], v[116:119], v[48:51]
    v_mfma_f32_16x16x32_bf16 v[52:55], v[148:151], v[116:119], v[52:55]
    s_cmp_eq_u32 s22, 4
    s_cbranch_scc1 L_final
    s_cmp_eq_u32 s23, 0
    s_cbranch_scc1 Lwt_266
    v_and_b32 v24, 0xffff0000, v24
    v_cvt_pk_bf16_f32 v9, v26, v27
    v_cvt_pk_bf16_f32 v8, v24, v25
    v_cvt_pk_bf16_f32 v10, v28, v29
    v_cvt_pk_bf16_f32 v11, v30, v31
    v_or_b32 v8, 1, v8
    buffer_store_dwordx4 v[8:11], v0, s[16:19], s0 offen offset:0
    ds_write_b128 v249, v[8:11] offset:0
    v_and_b32 v32, 0xffff0000, v32
    v_cvt_pk_bf16_f32 v13, v34, v35
    v_cvt_pk_bf16_f32 v12, v32, v33
    v_cvt_pk_bf16_f32 v14, v36, v37
    v_cvt_pk_bf16_f32 v15, v38, v39
    v_or_b32 v12, 1, v12
    buffer_store_dwordx4 v[12:15], v0, s[16:19], s0 offen offset:1024
    ds_write_b128 v249, v[12:15] offset:1024
    v_and_b32 v40, 0xffff0000, v40
    v_cvt_pk_bf16_f32 v17, v42, v43
    v_cvt_pk_bf16_f32 v16, v40, v41
    v_cvt_pk_bf16_f32 v18, v44, v45
    v_cvt_pk_bf16_f32 v19, v46, v47
    v_or_b32 v16, 1, v16
    buffer_store_dwordx4 v[16:19], v0, s[16:19], s0 offen offset:2048
    ds_write_b128 v249, v[16:19] offset:2048
    v_and_b32 v48, 0xffff0000, v48
    v_cvt_pk_bf16_f32 v21, v50, v51
    v_cvt_pk_bf16_f32 v20, v48, v49
    v_cvt_pk_bf16_f32 v22, v52, v53
    v_cvt_pk_bf16_f32 v23, v54, v55
    v_or_b32 v20, 1, v20
    buffer_store_dwordx4 v[20:23], v0, s[16:19], s0 offen offset:3072
    ds_write_b128 v249, v[20:23] offset:3072
Lwt_267:
    s_branch L_centry
L_ofix:
    s_waitcnt vmcnt(0)
    v_bitop3_b32 v250, v56, v60, 1 bitop3:0xa8
    v_cmp_ne_u32 vcc, 0, v250
    s_nop 0
    s_cbranch_vccz Lfx_268
    buffer_load_dwordx4 v[56:59], v248, s[88:91], s44 offen offset:0 sc1
    buffer_load_dwordx4 v[60:63], v248, s[88:91], s44 offen offset:1024 sc1
Lfx_268:
    v_bitop3_b32 v250, v64, v68, 1 bitop3:0xa8
    v_cmp_ne_u32 vcc, 0, v250
    s_nop 0
    s_cbranch_vccz Lfx_269
    buffer_load_dwordx4 v[64:67], v248, s[88:91], s44 offen offset:2048 sc1
    buffer_load_dwordx4 v[68:71], v248, s[88:91], s44 offen offset:3072 sc1
Lfx_269:
    v_bitop3_b32 v250, v72, v76, 1 bitop3:0xa8
    v_cmp_ne_u32 vcc, 0, v250
    s_nop 0
    s_cbranch_vccz Lfx_270
    buffer_load_dwordx4 v[72:75], v248, s[88:91], s45 offen offset:0 sc1
    buffer_load_dwordx4 v[76:79], v248, s[88:91], s45 offen offset:1024 sc1
Lfx_270:
    v_bitop3_b32 v250, v80, v84, 1 bitop3:0xa8
    v_cmp_ne_u32 vcc, 0, v250
    s_nop 0
    s_cbranch_vccz Lfx_271
    buffer_load_dwordx4 v[80:83], v248, s[88:91], s45 offen offset:2048 sc1
    buffer_load_dwordx4 v[84:87], v248, s[88:91], s45 offen offset:3072 sc1
Lfx_271:
    v_bitop3_b32 v250, v88, v92, 1 bitop3:0xa8
    v_cmp_ne_u32 vcc, 0, v250
    s_nop 0
    s_cbranch_vccz Lfx_272
    buffer_load_dwordx4 v[88:91], v248, s[88:91], s46 offen offset:0 sc1
    buffer_load_dwordx4 v[92:95], v248, s[88:91], s46 offen offset:1024 sc1
Lfx_272:
    v_bitop3_b32 v250, v96, v100, 1 bitop3:0xa8
    v_cmp_ne_u32 vcc, 0, v250
    s_nop 0
    s_cbranch_vccz Lfx_273
    buffer_load_dwordx4 v[96:99], v248, s[88:91], s46 offen offset:2048 sc1
    buffer_load_dwordx4 v[100:103], v248, s[88:91], s46 offen offset:3072 sc1
Lfx_273:
    v_bitop3_b32 v250, v104, v108, 1 bitop3:0xa8
    v_cmp_ne_u32 vcc, 0, v250
    s_nop 0
    s_cbranch_vccz Lfx_274
    buffer_load_dwordx4 v[104:107], v248, s[88:91], s47 offen offset:0 sc1
    buffer_load_dwordx4 v[108:111], v248, s[88:91], s47 offen offset:1024 sc1
Lfx_274:
    v_bitop3_b32 v250, v112, v116, 1 bitop3:0xa8
    v_cmp_ne_u32 vcc, 0, v250
    s_nop 0
    s_cbranch_vccz Lfx_275
    buffer_load_dwordx4 v[112:115], v248, s[88:91], s47 offen offset:2048 sc1
    buffer_load_dwordx4 v[116:119], v248, s[88:91], s47 offen offset:3072 sc1
Lfx_275:
    s_waitcnt vmcnt(0)
    s_add_u32 s96, s96, 1
    s_cmp_lt_u32 s96, 262144
    s_setpc_b64 s[72:73]
L_h0:
    s_cmp_lt_u32 s71, 2
    s_cbranch_scc0 Lif_276
    s_lshl_b32 m0, s98, 13
    s_add_u32 m0, m0, 0
    s_xor_b32 s36, s76, 0
    buffer_load_dwordx4 v3, s[8:11], s36 offen offset:0 lds
    buffer_load_dwordx4 v4, s[8:11], s36 offen offset:1024 lds
    buffer_load_dwordx4 v5, s[8:11], s36 offen offset:2048 lds
    buffer_load_dwordx4 v211, s[8:11], s36 offen offset:3072 lds
    s_lshl_b32 m0, s98, 13
    s_add_u32 m0, m0, 4096
    s_xor_b32 s36, s76, 65536
    buffer_load_dwordx4 v3, s[8:11], s36 offen offset:0 lds
    buffer_load_dwordx4 v4, s[8:11], s36 offen offset:1024 lds
    buffer_load_dwordx4 v5, s[8:11], s36 offen offset:2048 lds
    buffer_load_dwordx4 v211, s[8:11], s36 offen offset:3072 lds
    s_lshl_b32 s27, s22, 4
    s_add_u32 s28, s27, s21
    s_lshl_b32 s28, s28, 11
    s_add_u32 s28, s28, 786432
    s_add_u32 s27, s27, s20
    s_lshl_b32 s27, s27, 7
    s_add_u32 s27, s27, 663552
    v_bfe_u32 v131, v1, 2, 1
    v_add_u32 v131, s20, v131
    v_subrev_u32 v131, 2, v131
    v_min_u32 v131, s20, v131
    v_and_b32 v132, 3, v1
    v_lshl_add_u32 v131, v131, 4, v132
    v_lshl_add_u32 v131, v131, 3, s28
    v_and_b32 v132, 15, v1
    v_lshl_add_u32 v132, v132, 3, s27
    v_cmp_gt_u32 vcc, 16, v1
    s_nop 1
    v_cndmask_b32 v131, v132, v131, vcc
    buffer_load_dwordx2 v[132:133], v131, s[12:15], 0 offen sc1
    s_waitcnt vmcnt(0)
    v_xor_b32 v134, s24, v132
    v_xor_b32 v135, s25, v133
    v_lshrrev_b32 v135, 4, v135
    v_or_b32 v134, v134, v135
    v_cmp_ne_u32 vcc, 0, v134
    s_nop 0
    s_cbranch_vccnz Lpoll_277
Lok_278:
    s_cmp_eq_u32 s23, 0
    s_cbranch_scc0 Lif_279
    buffer_inv sc1
    s_waitcnt vmcnt(0)
Lif_279:
    s_and_b32 m0, s55, 0x3000
    s_add_u32 m0, m0, 114688
    s_add_u32 s27, s55, 16384
    buffer_load_dwordx4 v0, s[12:15], s27 offen offset:0 sc1 lds
    buffer_load_dwordx4 v0, s[12:15], s27 offen offset:1024 sc1 lds
    buffer_load_dwordx4 v0, s[12:15], s27 offen offset:2048 sc1 lds
    buffer_load_dwordx4 v0, s[12:15], s27 offen offset:3072 sc1 lds
    s_and_b32 m0, s55, 0x3000
    s_add_u32 m0, m0, 98304
    s_add_u32 s27, s55, 0
    buffer_load_dwordx4 v0, s[12:15], s27 offen offset:0 sc1 lds
    buffer_load_dwordx4 v0, s[12:15], s27 offen offset:1024 sc1 lds
    buffer_load_dwordx4 v0, s[12:15], s27 offen offset:2048 sc1 lds
    buffer_load_dwordx4 v0, s[12:15], s27 offen offset:3072 sc1 lds
    s_waitcnt vmcnt(4)
Lif_276:
    s_cmp_eq_u32 s20, 0
    s_cbranch_scc0 Lif_280
    v_mov_b32 v224, 4048155338
    v_mov_b32 v225, 4048155338
    v_mov_b32 v226, 4048155338
    v_mov_b32 v227, 4048155338
Lif_280:
    s_waitcnt lgkmcnt(0)
    s_barrier
    s_cmp_ge_u32 s71, 2
    s_cbranch_scc0 Lif_281
    s_and_b32 m0, s55, 0x3000
    s_add_u32 m0, m0, 49152
    s_add_u32 s27, s55, 16384
    buffer_load_dwordx4 v0, s[12:15], s27 offen offset:0 sc1 lds
    buffer_load_dwordx4 v0, s[12:15], s27 offen offset:1024 sc1 lds
    buffer_load_dwordx4 v0, s[12:15], s27 offen offset:2048 sc1 lds
    buffer_load_dwordx4 v0, s[12:15], s27 offen offset:3072 sc1 lds
    s_and_b32 m0, s55, 0x3000
    s_add_u32 m0, m0, 32768
    s_add_u32 s27, s55, 0
    buffer_load_dwordx4 v0, s[12:15], s27 offen offset:0 sc1 lds
    buffer_load_dwordx4 v0, s[12:15], s27 offen offset:1024 sc1 lds
    buffer_load_dwordx4 v0, s[12:15], s27 offen offset:2048 sc1 lds
    buffer_load_dwordx4 v0, s[12:15], s27 offen offset:3072 sc1 lds
Lif_281:
    s_setpc_b64 s[72:73]
L_h2:
    s_cmp_lt_u32 s71, 2
    s_cbranch_scc0 Lif_282
    s_waitcnt vmcnt(0)
    s_barrier
    s_lshl_b32 m0, s98, 13
    s_add_u32 m0, m0, 65536
    s_xor_b32 s36, s76, 262144
    buffer_load_dwordx4 v3, s[8:11], s36 offen offset:0 lds
    buffer_load_dwordx4 v4, s[8:11], s36 offen offset:1024 lds
    buffer_load_dwordx4 v5, s[8:11], s36 offen offset:2048 lds
    buffer_load_dwordx4 v211, s[8:11], s36 offen offset:3072 lds
    s_lshl_b32 m0, s98, 13
    s_add_u32 m0, m0, 69632
    s_xor_b32 s36, s76, 327680
    buffer_load_dwordx4 v3, s[8:11], s36 offen offset:0 lds
    buffer_load_dwordx4 v4, s[8:11], s36 offen offset:1024 lds
    buffer_load_dwordx4 v5, s[8:11], s36 offen offset:2048 lds
    buffer_load_dwordx4 v211, s[8:11], s36 offen offset:3072 lds
    s_branch Lh2_283
Lif_282:
    s_barrier
    s_lshl_b32 m0, s98, 13
    s_add_u32 m0, m0, 131072
    s_xor_b32 s36, s76, 786432
    buffer_load_dwordx4 v3, s[8:11], s36 offen offset:0 lds
    buffer_load_dwordx4 v4, s[8:11], s36 offen offset:1024 lds
    buffer_load_dwordx4 v5, s[8:11], s36 offen offset:2048 lds
    buffer_load_dwordx4 v211, s[8:11], s36 offen offset:3072 lds
    s_lshl_b32 m0, s98, 13
    s_add_u32 m0, m0, 135168
    s_xor_b32 s36, s76, 851968
    buffer_load_dwordx4 v3, s[8:11], s36 offen offset:0 lds
    buffer_load_dwordx4 v4, s[8:11], s36 offen offset:1024 lds
    buffer_load_dwordx4 v5, s[8:11], s36 offen offset:2048 lds
    buffer_load_dwordx4 v211, s[8:11], s36 offen offset:3072 lds
Lh2_283:
    s_cmp_eq_u32 s22, 0
    s_cbranch_scc0 Lif_284
    s_lshl_b32 s27, s2, 3
    s_add_u32 s27, s27, s3
    v_lshlrev_b32 v131, 7, v1
    s_mov_b32 s40, s58
    s_mov_b32 s41, s59
    s_mov_b32 s42, 2097152
    s_mov_b32 s43, 0x00020000
    s_lshl_b32 s28, s27, 10
    s_mul_i32 s27, s27, 3072
    s_mov_b64 exec, 0xffffff
    buffer_load_dword v255, v131, s[92:95], s27 offen
    s_mov_b64 exec, 0xff
    buffer_load_dword v255, v131, s[40:43], s28 offen
    s_mov_b64 exec, -1
Lif_284:
    s_setpc_b64 s[72:73]
L_h4:
    s_cmp_ge_u32 s71, 2
    s_cbranch_scc0 Lif_285
    s_waitcnt vmcnt(10)
    s_cmp_eq_u32 s22, 0
    s_cbranch_scc1 Lif_285
    s_waitcnt vmcnt(8)
Lif_285:
    s_cmp_eq_u32 s20, 1
    s_cbranch_scc0 Lif_286
    v_mov_b32 v224, 4048155338
    v_mov_b32 v225, 4048155338
    v_mov_b32 v226, 4048155338
    v_mov_b32 v227, 4048155338
Lif_286:
    v_subrev_u32 v129, 32768, v129
    s_waitcnt lgkmcnt(0)
    s_barrier
    s_cmp_ge_u32 s71, 2
    s_cbranch_scc0 Lif_287
    s_lshl_b32 m0, s98, 13
    s_add_u32 m0, m0, 98304
    s_xor_b32 s36, s76, 524288
    buffer_load_dwordx4 v3, s[8:11], s36 offen offset:0 lds
    buffer_load_dwordx4 v4, s[8:11], s36 offen offset:1024 lds
    buffer_load_dwordx4 v5, s[8:11], s36 offen offset:2048 lds
    buffer_load_dwordx4 v211, s[8:11], s36 offen offset:3072 lds
    s_lshl_b32 m0, s98, 13
    s_add_u32 m0, m0, 102400
    s_xor_b32 s36, s76, 589824
    buffer_load_dwordx4 v3, s[8:11], s36 offen offset:0 lds
    buffer_load_dwordx4 v4, s[8:11], s36 offen offset:1024 lds
    buffer_load_dwordx4 v5, s[8:11], s36 offen offset:2048 lds
    buffer_load_dwordx4 v211, s[8:11], s36 offen offset:3072 lds
Lif_287:
    s_setpc_b64 s[72:73]
L_exact:
    s_lshl_b32 s29, s20, 2
    s_add_u32 s29, s29, s71
    s_lshl_b32 s27, s21, 15
    s_and_b32 s28, s54, 4096
    s_add_u32 s27, s27, s28
    s_add_u32 s27, s27, 2621440
    v_add_u32 v128, s27, v0
    v_and_b32 v134, 15, v1
    v_lshrrev_b32 v135, 4, v1
    v_lshlrev_b32 v135, 2, v135
    v_sub_u32 v134, v134, v135
    v_mov_b32 v129, 4048155338
    s_min_u32 s31, s29, 8
    v_mov_b32 v132, 4048155338
    v_mov_b32 v133, 4048155338
    v_mov_b32 v104, 0
    v_mov_b32 v105, 0
    v_mov_b32 v106, 0
    v_mov_b32 v107, 0
    v_mov_b32 v108, 0
    v_mov_b32 v109, 0
    v_mov_b32 v110, 0
    v_mov_b32 v111, 0
    v_mov_b32 v112, 0
    v_mov_b32 v113, 0
    v_mov_b32 v114, 0
    v_mov_b32 v115, 0
    v_mov_b32 v116, 0
    v_mov_b32 v117, 0
    v_mov_b32 v118, 0
    v_mov_b32 v119, 0
    v_mov_b32 v120, 0
    v_mov_b32 v121, 0
    v_mov_b32 v122, 0
    v_mov_b32 v123, 0
    v_mov_b32 v124, 0
    v_mov_b32 v125, 0
    v_mov_b32 v126, 0
    v_mov_b32 v127, 0
    s_mov_b32 s30, 0
L_ex0:
    s_sub_u32 s27, s29, s30
    s_lshr_b32 s28, s27, 2
    s_lshl_b32 s28, s28, 20
    s_and_b32 s27, s27, 3
    s_lshl_b32 s27, s27, 13
    s_add_u32 s27, s27, s28
    buffer_load_dwordx4 v[80:83], v128, s[12:15], s27 offen offset:0 sc1
    buffer_load_dwordx4 v[84:87], v128, s[12:15], s27 offen offset:1024 sc1
    s_lshl_b32 s28, s30, 5
    v_add_u32 v135, s28, v134
    v_add_u32 v48, 0, v135
    v_cmp_gt_u32 vcc, 0x100, v48
    s_nop 1
    v_cndmask_b32 v48, v129, 0, vcc
    v_add_u32 v49, 4294967295, v135
    v_cmp_gt_u32 vcc, 0x100, v49
    s_nop 1
    v_cndmask_b32 v49, v129, 0, vcc
    v_add_u32 v50, 4294967294, v135
    v_cmp_gt_u32 vcc, 0x100, v50
    s_nop 1
    v_cndmask_b32 v50, v129, 0, vcc
    v_add_u32 v51, 4294967293, v135
    v_cmp_gt_u32 vcc, 0x100, v51
    s_nop 1
    v_cndmask_b32 v51, v129, 0, vcc
    v_add_u32 v52, 4294967280, v135
    v_cmp_gt_u32 vcc, 0x100, v52
    s_nop 1
    v_cndmask_b32 v52, v129, 0, vcc
    v_add_u32 v53, 4294967279, v135
    v_cmp_gt_u32 vcc, 0x100, v53
    s_nop 1
    v_cndmask_b32 v53, v129, 0, vcc
    v_add_u32 v54, 4294967278, v135
    v_cmp_gt_u32 vcc, 0x100, v54
    s_nop 1
    v_cndmask_b32 v54, v129, 0, vcc
    v_add_u32 v55, 4294967277, v135
    v_cmp_gt_u32 vcc, 0x100, v55
    s_nop 1
    v_cndmask_b32 v55, v129, 0, vcc
    v_add_u32 v56, 16, v135
    v_cmp_gt_u32 vcc, 0x100, v56
    s_nop 1
    v_cndmask_b32 v56, v129, 0, vcc
    v_add_u32 v57, 15, v135
    v_cmp_gt_u32 vcc, 0x100, v57
    s_nop 1
    v_cndmask_b32 v57, v129, 0, vcc
    v_add_u32 v58, 14, v135
    v_cmp_gt_u32 vcc, 0x100, v58
    s_nop 1
    v_cndmask_b32 v58, v129, 0, vcc
    v_add_u32 v59, 13, v135
    v_cmp_gt_u32 vcc, 0x100, v59
    s_nop 1
    v_cndmask_b32 v59, v129, 0, vcc
    v_add_u32 v60, 0, v135
    v_cmp_gt_u32 vcc, 0x100, v60
    s_nop 1
    v_cndmask_b32 v60, v129, 0, vcc
    v_add_u32 v61, 4294967295, v135
    v_cmp_gt_u32 vcc, 0x100, v61
    s_nop 1
    v_cndmask_b32 v61, v129, 0, vcc
    v_add_u32 v62, 4294967294, v135
    v_cmp_gt_u32 vcc, 0x100, v62
    s_nop 1
    v_cndmask_b32 v62, v129, 0, vcc
    v_add_u32 v63, 4294967293, v135
    v_cmp_gt_u32 vcc, 0x100, v63
    s_nop 1
    v_cndmask_b32 v63, v129, 0, vcc
    s_waitcnt vmcnt(0)
    v_mfma_f32_16x16x32_bf16 v[32:35], v[80:83], v[24:27], v[48:51]
    v_mfma_f32_16x16x32_bf16 v[36:39], v[84:87], v[24:27], v[52:55]
    v_mfma_f32_16x16x32_bf16 v[40:43], v[80:83], v[28:31], v[56:59]
    v_mfma_f32_16x16x32_bf16 v[44:47], v[84:87], v[28:31], v[60:63]
    s_nop 4
    v_max3_f32 v132, v132, v32, v33
    v_max3_f32 v132, v132, v34, v35
    v_max3_f32 v132, v132, v36, v37
    v_max3_f32 v132, v132, v38, v39
    v_max3_f32 v133, v133, v40, v41
    v_max3_f32 v133, v133, v42, v43
    v_max3_f32 v133, v133, v44, v45
    s_nop 0
    v_max3_f32 v133, v133, v46, v47
    s_add_u32 s30, s30, 1
    s_cmp_le_u32 s30, s31
    s_cbranch_scc1 L_ex0
    v_mov_b32 v130, v132
    s_nop 1
    v_permlane16_swap_b32 v132, v130
    v_max_f32 v132, v132, v130
    v_mov_b32 v130, v132
    s_nop 1
    v_permlane32_swap_b32 v132, v130
    v_max_f32 v132, v132, v130
    v_mov_b32 v130, v133
    s_nop 1
    v_permlane16_swap_b32 v133, v130
    v_max_f32 v133, v133, v130
    v_mov_b32 v130, v133
    s_nop 1
    v_permlane32_swap_b32 v133, v130
    v_max_f32 v133, v133, v130
    s_mov_b32 s30, 0
L_ex1:
    s_sub_u32 s27, s29, s30
    s_lshr_b32 s28, s27, 2
    s_lshl_b32 s28, s28, 20
    s_and_b32 s27, s27, 3
    s_lshl_b32 s27, s27, 13
    s_add_u32 s27, s27, s28
    buffer_load_dwordx4 v[80:83], v128, s[12:15], s27 offen offset:0 sc1
    buffer_load_dwordx4 v[84:87], v128, s[12:15], s27 offen offset:1024 sc1
    buffer_load_dwordx4 v[88:91], v128, s[12:15], s27 offen offset:2048 sc1
    buffer_load_dwordx4 v[92:95], v128, s[12:15], s27 offen offset:3072 sc1
    s_lshl_b32 s28, s30, 5
    v_add_u32 v135, s28, v134
    v_add_u32 v48, 0, v135
    v_cmp_gt_u32 vcc, 0x100, v48
    s_nop 1
    v_cndmask_b32 v48, v129, 0, vcc
    v_add_u32 v49, 4294967295, v135
    v_cmp_gt_u32 vcc, 0x100, v49
    s_nop 1
    v_cndmask_b32 v49, v129, 0, vcc
    v_add_u32 v50, 4294967294, v135
    v_cmp_gt_u32 vcc, 0x100, v50
    s_nop 1
    v_cndmask_b32 v50, v129, 0, vcc
    v_add_u32 v51, 4294967293, v135
    v_cmp_gt_u32 vcc, 0x100, v51
    s_nop 1
    v_cndmask_b32 v51, v129, 0, vcc
    v_add_u32 v52, 4294967280, v135
    v_cmp_gt_u32 vcc, 0x100, v52
    s_nop 1
    v_cndmask_b32 v52, v129, 0, vcc
    v_add_u32 v53, 4294967279, v135
    v_cmp_gt_u32 vcc, 0x100, v53
    s_nop 1
    v_cndmask_b32 v53, v129, 0, vcc
    v_add_u32 v54, 4294967278, v135
    v_cmp_gt_u32 vcc, 0x100, v54
    s_nop 1
    v_cndmask_b32 v54, v129, 0, vcc
    v_add_u32 v55, 4294967277, v135
    v_cmp_gt_u32 vcc, 0x100, v55
    s_nop 1
    v_cndmask_b32 v55, v129, 0, vcc
    v_add_u32 v56, 16, v135
    v_cmp_gt_u32 vcc, 0x100, v56
    s_nop 1
    v_cndmask_b32 v56, v129, 0, vcc
    v_add_u32 v57, 15, v135
    v_cmp_gt_u32 vcc, 0x100, v57
    s_nop 1
    v_cndmask_b32 v57, v129, 0, vcc
    v_add_u32 v58, 14, v135
    v_cmp_gt_u32 vcc, 0x100, v58
    s_nop 1
    v_cndmask_b32 v58, v129, 0, vcc
    v_add_u32 v59, 13, v135
    v_cmp_gt_u32 vcc, 0x100, v59
    s_nop 1
    v_cndmask_b32 v59, v129, 0, vcc
    v_add_u32 v60, 0, v135
    v_cmp_gt_u32 vcc, 0x100, v60
    s_nop 1
    v_cndmask_b32 v60, v129, 0, vcc
    v_add_u32 v61, 4294967295, v135
    v_cmp_gt_u32 vcc, 0x100, v61
    s_nop 1
    v_cndmask_b32 v61, v129, 0, vcc
    v_add_u32 v62, 4294967294, v135
    v_cmp_gt_u32 vcc, 0x100, v62
    s_nop 1
    v_cndmask_b32 v62, v129, 0, vcc
    v_add_u32 v63, 4294967293, v135
    v_cmp_gt_u32 vcc, 0x100, v63
    s_nop 1
    v_cndmask_b32 v63, v129, 0, vcc
    s_waitcnt vmcnt(0)
    v_mfma_f32_16x16x32_bf16 v[32:35], v[80:83], v[24:27], v[48:51]
    v_mfma_f32_16x16x32_bf16 v[36:39], v[84:87], v[24:27], v[52:55]
    v_mfma_f32_16x16x32_bf16 v[40:43], v[80:83], v[28:31], v[56:59]
    v_mfma_f32_16x16x32_bf16 v[44:47], v[84:87], v[28:31], v[60:63]
    s_nop 4
    v_sub_f32 v32, v32, v132
    v_sub_f32 v33, v33, v132
    v_sub_f32 v34, v34, v132
    v_sub_f32 v35, v35, v132
    v_sub_f32 v36, v36, v132
    v_sub_f32 v37, v37, v132
    v_sub_f32 v38, v38, v132
    v_sub_f32 v39, v39, v132
    v_sub_f32 v40, v40, v133
    v_sub_f32 v41, v41, v133
    v_sub_f32 v42, v42, v133
    v_sub_f32 v43, v43, v133
    v_sub_f32 v44, v44, v133
    v_sub_f32 v45, v45, v133
    v_sub_f32 v46, v46, v133
    v_sub_f32 v47, v47, v133
    v_exp_f32 v32, v32
    v_exp_f32 v33, v33
    v_exp_f32 v34, v34
    v_exp_f32 v35, v35
    v_exp_f32 v36, v36
    v_exp_f32 v37, v37
    v_exp_f32 v38, v38
    v_exp_f32 v39, v39
    v_exp_f32 v40, v40
    v_exp_f32 v41, v41
    v_exp_f32 v42, v42
    v_exp_f32 v43, v43
    v_exp_f32 v44, v44
    v_exp_f32 v45, v45
    v_exp_f32 v46, v46
    v_exp_f32 v47, v47
    v_cvt_pk_bf16_f32 v64, v32, v33
    v_cvt_pk_bf16_f32 v65, v34, v35
    v_cvt_pk_bf16_f32 v66, v36, v37
    v_cvt_pk_bf16_f32 v67, v38, v39
    v_cvt_pk_bf16_f32 v68, v40, v41
    v_cvt_pk_bf16_f32 v69, v42, v43
    v_cvt_pk_bf16_f32 v70, v44, v45
    v_cvt_pk_bf16_f32 v71, v46, v47
    v_mfma_f32_16x16x32_bf16 v[104:107], v[88:91], v[64:67], v[104:107]
    v_mfma_f32_16x16x32_bf16 v[108:111], v[92:95], v[64:67], v[108:111]
    v_mfma_f32_16x16x32_bf16 v[120:123], v[212:215], v[64:67], v[120:123]
    v_mfma_f32_16x16x32_bf16 v[112:115], v[88:91], v[68:71], v[112:115]
    v_mfma_f32_16x16x32_bf16 v[116:119], v[92:95], v[68:71], v[116:119]
    v_mfma_f32_16x16x32_bf16 v[124:127], v[212:215], v[68:71], v[124:127]
    s_add_u32 s30, s30, 1
    s_cmp_le_u32 s30, s31
    s_cbranch_scc1 L_ex1
    s_nop 7
    s_branch L_aok
L_final:
    s_lshl_b32 s27, s20, 2
    s_add_u32 s27, s27, s3
    s_lshl_b32 s27, s27, 16
    s_lshl_b32 s28, s21, 7
    s_add_u32 s27, s27, s28
    v_and_b32 v160, 15, v1
    v_lshlrev_b32 v160, 11, v160
    v_bfe_u32 v161, v1, 4, 1
    v_lshl_add_u32 v160, v161, 5, v160
    v_lshrrev_b32 v161, 5, v1
    v_lshlrev_b32 v161, 4, v161
    v_add3_u32 v160, v160, v161, s27
    v_add_u32 v161, 32768, v160
    v_cvt_pk_bf16_f32 v8, v24, v25
    v_cvt_pk_bf16_f32 v9, v26, v27
    v_cvt_pk_bf16_f32 v10, v28, v29
    v_cvt_pk_bf16_f32 v11, v30, v31
    v_cvt_pk_bf16_f32 v12, v32, v33
    v_cvt_pk_bf16_f32 v13, v34, v35
    v_cvt_pk_bf16_f32 v14, v36, v37
    v_cvt_pk_bf16_f32 v15, v38, v39
    v_permlane16_swap_b32 v8, v10
    v_permlane16_swap_b32 v9, v11
    v_cvt_pk_bf16_f32 v16, v40, v41
    v_cvt_pk_bf16_f32 v17, v42, v43
    v_cvt_pk_bf16_f32 v18, v44, v45
    v_cvt_pk_bf16_f32 v19, v46, v47
    v_permlane16_swap_b32 v12, v14
    v_permlane16_swap_b32 v13, v15
    v_cvt_pk_bf16_f32 v20, v48, v49
    v_cvt_pk_bf16_f32 v21, v50, v51
    v_cvt_pk_bf16_f32 v22, v52, v53
    v_cvt_pk_bf16_f32 v23, v54, v55
    v_permlane16_swap_b32 v16, v18
    v_permlane16_swap_b32 v17, v19
    v_permlane16_swap_b32 v20, v22
    v_permlane16_swap_b32 v21, v23
    buffer_store_dwordx4 v[8:11], v160, s[16:19], 0 offen offset:0
    buffer_store_dwordx4 v[12:15], v160, s[16:19], 0 offen offset:64
    buffer_store_dwordx4 v[16:19], v161, s[16:19], 0 offen offset:0
    buffer_store_dwordx4 v[20:23], v161, s[16:19], 0 offen offset:64
L_out:
L_end:
    s_endpgm
Lrt_3:
    s_mov_b32 s26, 0
Lrt_3b:
    s_bfe_u32 s27, s74, 262148
    s_lshl_b32 s27, s27, 12
    s_add_u32 m0, s78, 0
    s_nop 0
    buffer_load_dwordx4 v8, s[88:91], s27 offen offset:0 sc1 lds
    buffer_load_dwordx4 v9, s[88:91], s27 offen offset:1024 sc1 lds
    buffer_load_dwordx4 v10, s[88:91], s27 offen offset:2048 sc1 lds
    buffer_load_dwordx4 v11, s[88:91], s27 offen offset:3072 sc1 lds
    s_waitcnt vmcnt(0)
    ds_read_b128 v[24:27], v195 offset:0
    ds_read_b128 v[28:31], v195 offset:1024
    ds_read_b128 v[32:35], v195 offset:2048
    ds_read_b128 v[36:39], v195 offset:3072
    s_waitcnt lgkmcnt(0)
    v_bitop3_b32 v25, v24, v28, v32 bitop3:0x80
    v_bitop3_b32 v25, v25, v36, 1 bitop3:0x80
    v_cmp_eq_u32 vcc, 0, v25
    s_nop 0
    s_cbranch_vccz Lok_4
    s_add_u32 s26, s26, 1
    s_cmp_lt_u32 s26, 262144
    s_cbranch_scc1 Lrt_3b
    s_branch Lok_4
Lwt_436006:
    buffer_store_dwordx2 v[240:241], v190, s[12:15], 0 offen sc1
    s_branch Lwt_436007
Lrt_11:
    s_mov_b32 s26, 0
Lrt_11b:
    s_bfe_u32 s27, s74, 262152
    s_lshl_b32 s27, s27, 12
    s_add_u32 m0, s78, 16384
    s_nop 0
    buffer_load_dwordx4 v8, s[88:91], s27 offen offset:0 sc1 lds
    buffer_load_dwordx4 v9, s[88:91], s27 offen offset:1024 sc1 lds
    buffer_load_dwordx4 v10, s[88:91], s27 offen offset:2048 sc1 lds
    buffer_load_dwordx4 v11, s[88:91], s27 offen offset:3072 sc1 lds
    s_waitcnt vmcnt(0)
    ds_read_b128 v[24:27], v195 offset:16384
    ds_read_b128 v[28:31], v195 offset:17408
    ds_read_b128 v[32:35], v195 offset:18432
    ds_read_b128 v[36:39], v195 offset:19456
    s_waitcnt lgkmcnt(0)
    v_bitop3_b32 v25, v24, v28, v32 bitop3:0x80
    v_bitop3_b32 v25, v25, v36, 1 bitop3:0x80
    v_cmp_eq_u32 vcc, 0, v25
    s_nop 0
    s_cbranch_vccz Lok_12
    s_add_u32 s26, s26, 1
    s_cmp_lt_u32 s26, 262144
    s_cbranch_scc1 Lrt_11b
    s_branch Lok_12
Lrt_17:
    s_mov_b32 s26, 0
Lrt_17b:
    s_bfe_u32 s27, s74, 262156
    s_lshl_b32 s27, s27, 12
    s_add_u32 m0, s78, 32768
    s_nop 0
    buffer_load_dwordx4 v8, s[88:91], s27 offen offset:0 sc1 lds
    buffer_load_dwordx4 v9, s[88:91], s27 offen offset:1024 sc1 lds
    buffer_load_dwordx4 v10, s[88:91], s27 offen offset:2048 sc1 lds
    buffer_load_dwordx4 v11, s[88:91], s27 offen offset:3072 sc1 lds
    s_waitcnt vmcnt(0)
    ds_read_b128 v[24:27], v195 offset:32768
    ds_read_b128 v[28:31], v195 offset:33792
    ds_read_b128 v[32:35], v195 offset:34816
    ds_read_b128 v[36:39], v195 offset:35840
    s_waitcnt lgkmcnt(0)
    v_bitop3_b32 v25, v24, v28, v32 bitop3:0x80
    v_bitop3_b32 v25, v25, v36, 1 bitop3:0x80
    v_cmp_eq_u32 vcc, 0, v25
    s_nop 0
    s_cbranch_vccz Lok_18
    s_add_u32 s26, s26, 1
    s_cmp_lt_u32 s26, 262144
    s_cbranch_scc1 Lrt_17b
    s_branch Lok_18
Lpoll_21:
    s_mov_b32 s26, 0
Lpoll_21b:
    buffer_load_dwordx2 v[244:245], v188, s[12:15], 0 offen sc1
    s_waitcnt vmcnt(0)
    v_xor_b32 v246, s24, v244
    v_xor_b32 v247, s25, v245
    v_lshrrev_b32 v247, 4, v247
    v_or_b32 v246, v246, v247
    v_cmp_ne_u32 vcc, 0, v246
    s_nop 0
    s_cbranch_vccz Lok_22
    s_add_u32 s26, s26, 1
    s_cmp_lt_u32 s26, 262144
    s_cbranch_scc1 Lpoll_21b
    s_branch Lok_22
Lrt_28:
    s_mov_b32 s26, 0
Lrt_28b:
    s_bfe_u32 s27, s74, 262160
    s_lshl_b32 s27, s27, 12
    s_add_u32 m0, s78, 0
    s_nop 0
    buffer_load_dwordx4 v8, s[88:91], s27 offen offset:0 sc1 lds
    buffer_load_dwordx4 v9, s[88:91], s27 offen offset:1024 sc1 lds
    buffer_load_dwordx4 v10, s[88:91], s27 offen offset:2048 sc1 lds
    buffer_load_dwordx4 v11, s[88:91], s27 offen offset:3072 sc1 lds
    s_waitcnt vmcnt(0)
    ds_read_b128 v[24:27], v195 offset:0
    ds_read_b128 v[28:31], v195 offset:1024
    ds_read_b128 v[32:35], v195 offset:2048
    ds_read_b128 v[36:39], v195 offset:3072
    s_waitcnt lgkmcnt(0)
    v_bitop3_b32 v25, v24, v28, v32 bitop3:0x80
    v_bitop3_b32 v25, v25, v36, 1 bitop3:0x80
    v_cmp_eq_u32 vcc, 0, v25
    s_nop 0
    s_cbranch_vccz Lok_29
    s_add_u32 s26, s26, 1
    s_cmp_lt_u32 s26, 262144
    s_cbranch_scc1 Lrt_28b
    s_branch Lok_29
Lwt_31:
    buffer_store_dwordx4 v[124:127], v0, s[40:43], s47 offen offset:0 sc1
    s_branch Lwt_32
Lwt_37:
    buffer_store_dwordx4 v[124:127], v0, s[40:43], s47 offen offset:1024 sc1
    s_branch Lwt_38
Lwt_42:
    buffer_store_dwordx4 v[124:127], v0, s[40:43], s47 offen offset:2048 sc1
    s_branch Lwt_43
Lwt_715045:
    buffer_store_dwordx4 v[76:79], v202, s[12:15], 0 offen sc1
    s_branch Lwt_715046
Lwt_72:
    buffer_store_dwordx4 v[124:127], v0, s[40:43], s47 offen offset:3072 sc1
    s_branch Lwt_73
Lwt_76:
    buffer_store_dwordx4 v[128:131], v0, s[16:19], s47 offen offset:0 sc1
    s_branch Lwt_77
Lwt_82:
    buffer_store_dwordx4 v[128:131], v0, s[16:19], s47 offen offset:1024 sc1
    s_branch Lwt_83
Lwt_86:
    buffer_store_dwordx4 v[128:131], v0, s[16:19], s47 offen offset:2048 sc1
    s_branch Lwt_87
Lwt_91:
    buffer_store_dwordx4 v[128:131], v0, s[16:19], s47 offen offset:3072 sc1
    s_branch Lwt_92
Lpoll_96:
    s_mov_b32 s26, 0
Lpoll_96b:
    buffer_load_dwordx2 v[244:245], v200, s[12:15], 0 offen sc1
    s_waitcnt vmcnt(0)
    v_xor_b32 v246, s24, v244
    v_xor_b32 v247, s25, v245
    v_lshrrev_b32 v247, 4, v247
    v_or_b32 v246, v246, v247
    v_cmp_ne_u32 vcc, 0, v246
    s_nop 0
    s_cbranch_vccz Lok_97
    s_add_u32 s26, s26, 1
    s_cmp_lt_u32 s26, 262144
    s_cbranch_scc1 Lpoll_96b
    s_branch Lok_97
Lrt_100:
    s_mov_b32 s26, 0
Lrt_100b:
    buffer_load_dwordx4 v[72:75], v189, s[12:15], 0 offen sc1
    s_waitcnt vmcnt(0)
    v_xor_b32 v76, s24, v74
    v_xor_b32 v77, s25, v75
    v_lshrrev_b32 v77, 4, v77
    v_or_b32 v76, v76, v77
    v_cmp_ne_u32 vcc, 0, v76
    s_nop 0
    s_cbranch_vccz Lok_101
    s_add_u32 s26, s26, 1
    s_cmp_lt_u32 s26, 262144
    s_cbranch_scc1 Lrt_100b
    s_branch Lok_101
Lwt_120:
    buffer_store_dwordx2 v[240:241], v190, s[12:15], 0 offen sc1
    s_branch Lwt_121
Lwt_125:
    buffer_store_dwordx2 v[240:241], v190, s[12:15], 0 offen sc1
    s_branch Lwt_126
Lrt_128:
    s_mov_b32 s26, 0
Lrt_128b:
    buffer_load_dwordx4 v[32:35], v0, s[12:15], s27 offen sc1
    s_waitcnt vmcnt(0)
    v_cmp_eq_u32 vcc, -1, v32
    s_nop 0
    s_cbranch_vccz Lok_129
    s_add_u32 s26, s26, 1
    s_cmp_lt_u32 s26, 262144
    s_cbranch_scc1 Lrt_128b
    s_branch Lok_129
Lpoll_130:
    s_mov_b32 s26, 0
Lpoll_130b:
    buffer_load_dwordx2 v[244:245], v188, s[12:15], 0 offen sc1
    s_waitcnt vmcnt(0)
    v_xor_b32 v246, s24, v244
    v_xor_b32 v247, s25, v245
    v_lshrrev_b32 v247, 4, v247
    v_or_b32 v246, v246, v247
    v_cmp_ne_u32 vcc, 0, v246
    s_nop 0
    s_cbranch_vccz Lok_131
    s_add_u32 s26, s26, 1
    s_cmp_lt_u32 s26, 262144
    s_cbranch_scc1 Lpoll_130b
    s_branch Lok_131
Lwt_136:
    buffer_store_dwordx2 v[236:237], v206, s[12:15], 0 offen offset:0 sc1
    buffer_store_dwordx2 v[244:245], v206, s[12:15], 0 offen offset:2048 sc1
    s_branch Lwt_137
Lwt_138:
    buffer_store_dwordx2 v[236:237], v206, s[12:15], 0 offen offset:0 sc1
    buffer_store_dwordx2 v[244:245], v206, s[12:15], 0 offen offset:2048 sc1
    s_branch Lwt_139
Lwt_140:
    buffer_store_dwordx4 v[76:79], v0, s[88:91], s27 offen offset:1024 sc1
    buffer_store_dwordx4 v[92:95], v0, s[88:91], s27 offen offset:0 sc1
    s_branch Lwt_141
Lwt_142:
    buffer_store_dwordx4 v[76:79], v0, s[88:91], s62 offen offset:1024 sc1
    buffer_store_dwordx4 v[92:95], v0, s[88:91], s62 offen offset:0 sc1
    s_branch Lwt_143
Lht_146:
    s_call_b64 s[72:73], L_h0
    s_branch Lhb_145
Lht_148:
    s_call_b64 s[72:73], L_h0
    s_branch Lhb_147
Lht_150:
    s_call_b64 s[72:73], L_h0
    s_branch Lhb_149
Lht_151:
    s_call_b64 s[72:73], L_h2
    s_branch Lhb_149
Lht_153:
    s_call_b64 s[72:73], L_h0
    s_branch Lhb_152
Lht_154:
    s_call_b64 s[72:73], L_h2
    s_branch Lhb_152
Lht_156:
    s_call_b64 s[72:73], L_h2
    s_branch Lhb_155
Lht_157:
    s_call_b64 s[72:73], L_h4
    s_branch Lhb_155
Lht_159:
    s_call_b64 s[72:73], L_h2
    s_branch Lhb_158
Lht_160:
    s_call_b64 s[72:73], L_h4
    s_branch Lhb_158
Lht_162:
    s_call_b64 s[72:73], L_h4
    s_branch Lhb_161
Lht_164:
    s_call_b64 s[72:73], L_h4
    s_branch Lhb_163
Lwt_166:
    buffer_store_dwordx4 v[104:107], v0, s[88:91], s62 offen offset:0 sc1
    buffer_store_dwordx4 v[112:115], v0, s[88:91], s62 offen offset:1024 sc1
    s_branch Lwt_167
Lot_171:
    s_call_b64 s[72:73], L_ofix
    s_cbranch_scc0 Look_172
    v_bitop3_b32 v250, v56, v60, 1 bitop3:0xa8
    v_cmp_ne_u32 vcc, 0, v250
    s_nop 0
    s_cbranch_vccnz Lot_171
    s_branch Look_172
Lot_174:
    s_call_b64 s[72:73], L_ofix
    s_cbranch_scc0 Look_175
    v_bitop3_b32 v250, v64, v68, 1 bitop3:0xa8
    v_cmp_ne_u32 vcc, 0, v250
    s_nop 0
    s_cbranch_vccnz Lot_174
    s_branch Look_175
Lot_177:
    s_call_b64 s[72:73], L_ofix
    s_cbranch_scc0 Look_178
    v_bitop3_b32 v250, v72, v76, 1 bitop3:0xa8
    v_cmp_ne_u32 vcc, 0, v250
    s_nop 0
    s_cbranch_vccnz Lot_177
    s_branch Look_178
Lot_180:
    s_call_b64 s[72:73], L_ofix
    s_cbranch_scc0 Look_181
    v_bitop3_b32 v250, v80, v84, 1 bitop3:0xa8
    v_cmp_ne_u32 vcc, 0, v250
    s_nop 0
    s_cbranch_vccnz Lot_180
    s_branch Look_181
Lot_183:
    s_call_b64 s[72:73], L_ofix
    s_cbranch_scc0 Look_184
    v_bitop3_b32 v250, v88, v92, 1 bitop3:0xa8
    v_cmp_ne_u32 vcc, 0, v250
    s_nop 0
    s_cbranch_vccnz Lot_183
    s_branch Look_184
Lot_186:
    s_call_b64 s[72:73], L_ofix
    s_cbranch_scc0 Look_187
    v_bitop3_b32 v250, v96, v100, 1 bitop3:0xa8
    v_cmp_ne_u32 vcc, 0, v250
    s_nop 0
    s_cbranch_vccnz Lot_186
    s_branch Look_187
Lot_189:
    s_call_b64 s[72:73], L_ofix
    s_cbranch_scc0 Look_190
    v_bitop3_b32 v250, v104, v108, 1 bitop3:0xa8
    v_cmp_ne_u32 vcc, 0, v250
    s_nop 0
    s_cbranch_vccnz Lot_189
    s_branch Look_190
Lot_192:
    s_call_b64 s[72:73], L_ofix
    s_cbranch_scc0 Look_193
    v_bitop3_b32 v250, v112, v116, 1 bitop3:0xa8
    v_cmp_ne_u32 vcc, 0, v250
    s_nop 0
    s_cbranch_vccnz Lot_192
    s_branch Look_193
Lot_195:
    s_call_b64 s[72:73], L_ofix
    s_cbranch_scc0 Look_196
    v_bitop3_b32 v250, v56, v60, 1 bitop3:0xa8
    v_cmp_ne_u32 vcc, 0, v250
    s_nop 0
    s_cbranch_vccnz Lot_195
    s_branch Look_196
Lot_198:
    s_call_b64 s[72:73], L_ofix
    s_cbranch_scc0 Look_199
    v_bitop3_b32 v250, v64, v68, 1 bitop3:0xa8
    v_cmp_ne_u32 vcc, 0, v250
    s_nop 0
    s_cbranch_vccnz Lot_198
    s_branch Look_199
Lot_201:
    s_call_b64 s[72:73], L_ofix
    s_cbranch_scc0 Look_202
    v_bitop3_b32 v250, v72, v76, 1 bitop3:0xa8
    v_cmp_ne_u32 vcc, 0, v250
    s_nop 0
    s_cbranch_vccnz Lot_201
    s_branch Look_202
Lot_204:
    s_call_b64 s[72:73], L_ofix
    s_cbranch_scc0 Look_205
    v_bitop3_b32 v250, v80, v84, 1 bitop3:0xa8
    v_cmp_ne_u32 vcc, 0, v250
    s_nop 0
    s_cbranch_vccnz Lot_204
    s_branch Look_205
Lot_207:
    s_call_b64 s[72:73], L_ofix
    s_cbranch_scc0 Look_208
    v_bitop3_b32 v250, v88, v92, 1 bitop3:0xa8
    v_cmp_ne_u32 vcc, 0, v250
    s_nop 0
    s_cbranch_vccnz Lot_207
    s_branch Look_208
Lot_210:
    s_call_b64 s[72:73], L_ofix
    s_cbranch_scc0 Look_211
    v_bitop3_b32 v250, v96, v100, 1 bitop3:0xa8
    v_cmp_ne_u32 vcc, 0, v250
    s_nop 0
    s_cbranch_vccnz Lot_210
    s_branch Look_211
Lot_213:
    s_call_b64 s[72:73], L_ofix
    s_cbranch_scc0 Look_214
    v_bitop3_b32 v250, v104, v108, 1 bitop3:0xa8
    v_cmp_ne_u32 vcc, 0, v250
    s_nop 0
    s_cbranch_vccnz Lot_213
    s_branch Look_214
Lot_216:
    s_call_b64 s[72:73], L_ofix
    s_cbranch_scc0 Look_217
    v_bitop3_b32 v250, v112, v116, 1 bitop3:0xa8
    v_cmp_ne_u32 vcc, 0, v250
    s_nop 0
    s_cbranch_vccnz Lot_216
    s_branch Look_217
Lot_219:
    s_call_b64 s[72:73], L_ofix
    s_cbranch_scc0 Look_220
    v_bitop3_b32 v250, v56, v60, 1 bitop3:0xa8
    v_cmp_ne_u32 vcc, 0, v250
    s_nop 0
    s_cbranch_vccnz Lot_219
    s_branch Look_220
Lot_222:
    s_call_b64 s[72:73], L_ofix
    s_cbranch_scc0 Look_223
    v_bitop3_b32 v250, v64, v68, 1 bitop3:0xa8
    v_cmp_ne_u32 vcc, 0, v250
    s_nop 0
    s_cbranch_vccnz Lot_222
    s_branch Look_223
Lot_225:
    s_call_b64 s[72:73], L_ofix
    s_cbranch_scc0 Look_226
    v_bitop3_b32 v250, v72, v76, 1 bitop3:0xa8
    v_cmp_ne_u32 vcc, 0, v250
    s_nop 0
    s_cbranch_vccnz Lot_225
    s_branch Look_226
Lot_228:
    s_call_b64 s[72:73], L_ofix
    s_cbranch_scc0 Look_229
    v_bitop3_b32 v250, v80, v84, 1 bitop3:0xa8
    v_cmp_ne_u32 vcc, 0, v250
    s_nop 0
    s_cbranch_vccnz Lot_228
    s_branch Look_229
Lot_231:
    s_call_b64 s[72:73], L_ofix
    s_cbranch_scc0 Look_232
    v_bitop3_b32 v250, v88, v92, 1 bitop3:0xa8
    v_cmp_ne_u32 vcc, 0, v250
    s_nop 0
    s_cbranch_vccnz Lot_231
    s_branch Look_232
Lot_234:
    s_call_b64 s[72:73], L_ofix
    s_cbranch_scc0 Look_235
    v_bitop3_b32 v250, v96, v100, 1 bitop3:0xa8
    v_cmp_ne_u32 vcc, 0, v250
    s_nop 0
    s_cbranch_vccnz Lot_234
    s_branch Look_235
Lot_237:
    s_call_b64 s[72:73], L_ofix
    s_cbranch_scc0 Look_238
    v_bitop3_b32 v250, v104, v108, 1 bitop3:0xa8
    v_cmp_ne_u32 vcc, 0, v250
    s_nop 0
    s_cbranch_vccnz Lot_237
    s_branch Look_238
Lot_240:
    s_call_b64 s[72:73], L_ofix
    s_cbranch_scc0 Look_241
    v_bitop3_b32 v250, v112, v116, 1 bitop3:0xa8
    v_cmp_ne_u32 vcc, 0, v250
    s_nop 0
    s_cbranch_vccnz Lot_240
    s_branch Look_241
Lot_243:
    s_call_b64 s[72:73], L_ofix
    s_cbranch_scc0 Look_244
    v_bitop3_b32 v250, v56, v60, 1 bitop3:0xa8
    v_cmp_ne_u32 vcc, 0, v250
    s_nop 0
    s_cbranch_vccnz Lot_243
    s_branch Look_244
Lot_246:
    s_call_b64 s[72:73], L_ofix
    s_cbranch_scc0 Look_247
    v_bitop3_b32 v250, v64, v68, 1 bitop3:0xa8
    v_cmp_ne_u32 vcc, 0, v250
    s_nop 0
    s_cbranch_vccnz Lot_246
    s_branch Look_247
Lot_249:
    s_call_b64 s[72:73], L_ofix
    s_cbranch_scc0 Look_250
    v_bitop3_b32 v250, v72, v76, 1 bitop3:0xa8
    v_cmp_ne_u32 vcc, 0, v250
    s_nop 0
    s_cbranch_vccnz Lot_249
    s_branch Look_250
Lot_252:
    s_call_b64 s[72:73], L_ofix
    s_cbranch_scc0 Look_253
    v_bitop3_b32 v250, v80, v84, 1 bitop3:0xa8
    v_cmp_ne_u32 vcc, 0, v250
    s_nop 0
    s_cbranch_vccnz Lot_252
    s_branch Look_253
Lot_255:
    s_call_b64 s[72:73], L_ofix
    s_cbranch_scc0 Look_256
    v_bitop3_b32 v250, v88, v92, 1 bitop3:0xa8
    v_cmp_ne_u32 vcc, 0, v250
    s_nop 0
    s_cbranch_vccnz Lot_255
    s_branch Look_256
Lot_258:
    s_call_b64 s[72:73], L_ofix
    s_cbranch_scc0 Look_259
    v_bitop3_b32 v250, v96, v100, 1 bitop3:0xa8
    v_cmp_ne_u32 vcc, 0, v250
    s_nop 0
    s_cbranch_vccnz Lot_258
    s_branch Look_259
Lot_261:
    s_call_b64 s[72:73], L_ofix
    s_cbranch_scc0 Look_262
    v_bitop3_b32 v250, v104, v108, 1 bitop3:0xa8
    v_cmp_ne_u32 vcc, 0, v250
    s_nop 0
    s_cbranch_vccnz Lot_261
    s_branch Look_262
Lot_264:
    s_call_b64 s[72:73], L_ofix
    s_cbranch_scc0 Look_265
    v_bitop3_b32 v250, v112, v116, 1 bitop3:0xa8
    v_cmp_ne_u32 vcc, 0, v250
    s_nop 0
    s_cbranch_vccnz Lot_264
    s_branch Look_265
Lwt_266:
    v_and_b32 v24, 0xffff0000, v24
    v_cvt_pk_bf16_f32 v9, v26, v27
    v_cvt_pk_bf16_f32 v8, v24, v25
    v_cvt_pk_bf16_f32 v10, v28, v29
    v_cvt_pk_bf16_f32 v11, v30, v31
    v_or_b32 v8, 1, v8
    buffer_store_dwordx4 v[8:11], v0, s[16:19], s0 offen offset:0 sc1
    ds_write_b128 v249, v[8:11] offset:0
    v_and_b32 v32, 0xffff0000, v32
    v_cvt_pk_bf16_f32 v13, v34, v35
    v_cvt_pk_bf16_f32 v12, v32, v33
    v_cvt_pk_bf16_f32 v14, v36, v37
    v_cvt_pk_bf16_f32 v15, v38, v39
    v_or_b32 v12, 1, v12
    buffer_store_dwordx4 v[12:15], v0, s[16:19], s0 offen offset:1024 sc1
    ds_write_b128 v249, v[12:15] offset:1024
    v_and_b32 v40, 0xffff0000, v40
    v_cvt_pk_bf16_f32 v17, v42, v43
    v_cvt_pk_bf16_f32 v16, v40, v41
    v_cvt_pk_bf16_f32 v18, v44, v45
    v_cvt_pk_bf16_f32 v19, v46, v47
    v_or_b32 v16, 1, v16
    buffer_store_dwordx4 v[16:19], v0, s[16:19], s0 offen offset:2048 sc1
    ds_write_b128 v249, v[16:19] offset:2048
    v_and_b32 v48, 0xffff0000, v48
    v_cvt_pk_bf16_f32 v21, v50, v51
    v_cvt_pk_bf16_f32 v20, v48, v49
    v_cvt_pk_bf16_f32 v22, v52, v53
    v_cvt_pk_bf16_f32 v23, v54, v55
    v_or_b32 v20, 1, v20
    buffer_store_dwordx4 v[20:23], v0, s[16:19], s0 offen offset:3072 sc1
    ds_write_b128 v249, v[20:23] offset:3072
    s_branch Lwt_267
Lpoll_277:
    s_mov_b32 s26, 0
Lpoll_277b:
    buffer_load_dwordx2 v[132:133], v131, s[12:15], 0 offen sc1
    s_waitcnt vmcnt(0)
    v_xor_b32 v134, s24, v132
    v_xor_b32 v135, s25, v133
    v_lshrrev_b32 v135, 4, v135
    v_or_b32 v134, v134, v135
    v_cmp_ne_u32 vcc, 0, v134
    s_nop 0
    s_cbranch_vccz Lok_278
    s_add_u32 s26, s26, 1
    s_cmp_lt_u32 s26, 262144
    s_cbranch_scc1 Lpoll_277b
    s_branch Lok_278
L_last:
    s_endpgm

.section .rodata,"a"
.p2align 6
.amdhsa_kernel interleave_layers__sliding_block__sliding_local_dilated__prompt_kernel
  .amdhsa_next_free_vgpr 256
  .amdhsa_next_free_sgpr 102
  .amdhsa_accum_offset 256
  .amdhsa_group_segment_fixed_size 0
  .amdhsa_kernarg_size 72
  .amdhsa_user_sgpr_count 2
  .amdhsa_user_sgpr_kernarg_segment_ptr 1
  .amdhsa_system_sgpr_workgroup_id_x 1
.end_amdhsa_kernel
```

```asm
; @launch grid=(256,1,1) block=(512,1,1) lds=163840
.amdgcn_target "amdgcn-amd-amdhsa--gfx950"
.text
.globl interleave_layers__sliding_block__sliding_local_dilated__prompt_kernel
.p2align 8
.type interleave_layers__sliding_block__sliding_local_dilated__prompt_kernel,@function
interleave_layers__sliding_block__sliding_local_dilated__prompt_kernel:
    s_cmp_ge_u32 s2, 256
    s_cbranch_scc1 L_end
    s_load_dwordx16 s[48:63], s[0:1], 0
    s_load_dwordx2 s[64:65], s[0:1], 64
    v_lshrrev_b32 v1, 6, v0
    s_nop 0
    v_readfirstlane_b32 s3, v1
    v_and_b32 v1, 63, v0
    v_lshlrev_b32 v0, 4, v1
    s_and_b32 s27, s2, 7
    s_lshl_b32 s20, s27, 1
    s_bfe_u32 s27, s2, 0x10003
    s_add_u32 s20, s20, s27
    s_lshr_b32 s21, s2, 4
    s_mov_b32 s22, 0
    s_cmp_lt_u32 s3, 4
    s_cbranch_scc1 L_cstart
    s_sub_u32 s87, s3, 4
    s_lshl_b32 s78, s87, 12
    s_lshl_b32 s79, s87, 11
    s_lshr_b32 s27, s20, 1
    s_lshl_b32 s27, s27, 3
    s_mov_b32 s28, 1262102808
    s_mov_b32 s29, 259943772
    s_lshr_b64 s[100:101], s[28:29], s27
    s_sub_u32 s27, 60, s27
    s_lshl_b64 s[28:29], s[28:29], s27
    s_or_b64 s[100:101], s[100:101], s[28:29]
    s_lshl_b64 s[100:101], s[100:101], 4
    s_mul_i32 s27, s21, 0x11111111
    s_xor_b32 s100, s100, s27
    s_xor_b32 s101, s101, s27
    s_mov_b64 s[74:75], s[100:101]
    s_mov_b32 s77, 7
    v_lshrrev_b32 v14, 3, v1
    v_and_b32 v15, 6, v14
    v_and_b32 v16, 7, v1
    v_xor_b32 v15, v15, v16
    v_and_b32 v16, 4, v14
    v_add_u32 v14, v14, v16
    s_lshr_b32 s27, s87, 1
    s_lshl_b32 s27, s27, 5
    s_and_b32 s28, s87, 1
    s_lshl_b32 s28, s28, 2
    s_add_u32 s27, s27, s28
    s_mul_i32 s27, s27, 6144
    s_lshl_b32 s28, s21, 7
    s_add_u32 s27, s27, s28
    v_mul_u32_u24 v14, 6144, v14
    v_lshlrev_b32 v15, 4, v15
    v_add3_u32 v12, v14, v15, s27
    v_add_u32 v13, 97280, v12
    v_add_u32 v14, 2048, v12
    v_add_u32 v15, 99328, v12
    v_add_u32 v16, 4096, v12
    v_add_u32 v17, 101376, v12
    s_lshl_b32 s27, s20, 2
    s_add_u32 s27, s27, s87
    s_lshl_b32 s27, s27, 16
    v_lshrrev_b32 v9, 4, v1
    v_and_b32 v10, 7, v1
    v_xor_b32 v9, v9, v10
    v_lshlrev_b32 v9, 4, v9
    v_lshrrev_b32 v10, 3, v1
    v_lshlrev_b32 v10, 11, v10
    v_add3_u32 v8, v9, v10, s27
    v_xor_b32 v9, 64, v8
    v_add_u32 v10, 30720, v8
    v_add_u32 v11, 46080, v9
    v_add_u32 v9, 15360, v9
    s_bfe_u32 s27, s74, 262144
    s_lshl_b32 s84, s27, s77
    s_mul_i32 s85, s27, 393216
    s_waitcnt lgkmcnt(0)
    s_mov_b32 s4, s50
    s_mov_b32 s5, s51
    s_mov_b32 s6, 6291456
    s_mov_b32 s7, 0x00020000
    s_mov_b32 s88, s48
    s_mov_b32 s89, s49
    s_mov_b32 s90, 4194304
    s_mov_b32 s91, 0x00020000
    s_add_u32 m0, s79, 81920
    s_nop 0
    buffer_load_dwordx4 v12, s[4:7], s85 offen offset:0 lds
    buffer_load_dwordx4 v13, s[4:7], s85 offen offset:1024 lds
    s_add_u32 m0, s79, 49152
    s_nop 0
    buffer_load_dwordx4 v14, s[4:7], s85 offen offset:0 lds
    buffer_load_dwordx4 v15, s[4:7], s85 offen offset:1024 lds
    s_add_u32 m0, s79, 57344
    s_nop 0
    buffer_load_dwordx4 v16, s[4:7], s85 offen offset:0 lds
    buffer_load_dwordx4 v17, s[4:7], s85 offen offset:1024 lds
    s_add_u32 m0, s78, 32768
    s_nop 0
    buffer_load_dwordx4 v8, s[88:91], s84 offen offset:0 sc1 lds
    buffer_load_dwordx4 v9, s[88:91], s84 offen offset:1024 sc1 lds
    buffer_load_dwordx4 v10, s[88:91], s84 offen offset:2048 sc1 lds
    buffer_load_dwordx4 v11, s[88:91], s84 offen offset:3072 sc1 lds
    s_mov_b32 s12, s64
    s_mov_b32 s13, s65
    s_mov_b32 s14, 75497472
    s_mov_b32 s15, 0x00020000
    v_mov_b32 v28, 671744
    buffer_load_dwordx2 v[26:27], v28, s[12:15], 0 offen sc1
    s_lshr_b32 s27, s4, 7
    s_sub_u32 s27, 3, s27
    s_and_b32 s27, s27, 7
    s_and_b32 s28, s21, 8
    s_add_u32 s27, s27, s28
    s_bfe_u32 s28, s2, 0x40003
    s_lshl_b32 s28, s28, 2
    s_add_u32 s28, s28, s87
    s_mul_i32 s28, s28, 6144
    s_lshl_b32 s46, s27, 7
    s_add_u32 s46, s46, s28
    s_xor_b32 s27, s27, s21
    s_mul_i32 s27, s27, 0x11111111
    s_xor_b32 s44, s74, s27
    s_xor_b32 s45, s75, s27
    s_bfe_u32 s37, s44, 262148
    s_mul_i32 s37, s37, 393216
    s_add_u32 s37, s37, s46
    s_buffer_load_dwordx2 s[38:39], s[4:7], s37 offset:60
    s_buffer_load_dwordx2 s[38:39], s[4:7], s37 offset:2108
    s_buffer_load_dwordx2 s[38:39], s[4:7], s37 offset:4156
    s_bfe_u32 s37, s44, 262152
    s_mul_i32 s37, s37, 393216
    s_add_u32 s37, s37, s46
    s_buffer_load_dwordx2 s[38:39], s[4:7], s37 offset:60
    s_buffer_load_dwordx2 s[38:39], s[4:7], s37 offset:2108
    s_buffer_load_dwordx2 s[38:39], s[4:7], s37 offset:4156
    s_mov_b32 s12, s64
    s_mov_b32 s13, s65
    s_mov_b32 s14, 75497472
    s_mov_b32 s15, 0x00020000
    s_mov_b32 s8, s52
    s_mov_b32 s9, s53
    s_mov_b32 s10, 2097152
    s_mov_b32 s11, 0x00020000
    s_mov_b32 s40, s60
    s_mov_b32 s41, s61
    s_mov_b32 s42, 4194304
    s_mov_b32 s43, 0x00020000
    s_add_u32 s16, s64, 18874368
    s_addc_u32 s17, s65, 0
    s_mov_b32 s18, 4194304
    s_mov_b32 s19, 0x00020000
    s_mov_b32 s92, s56
    s_mov_b32 s93, s57
    s_mov_b32 s94, 6291456
    s_mov_b32 s95, 0x00020000
    s_mov_b32 s23, 0
    v_mov_b32 v6, 0
    v_mov_b32 v7, 0
    v_mov_b32 v206, 1073741824
    s_lshl_b32 s97, s20, 20
    s_add_u32 s97, s97, 2097152
    s_lshl_b32 s99, s21, 17
    v_bfe_u32 v28, v1, 2, 3
    v_bfe_u32 v29, v1, 1, 1
    v_and_b32 v30, 6, v28
    v_xor_b32 v29, v29, v30
    v_lshlrev_b32 v29, 4, v29
    v_lshlrev_b32 v28, 7, v28
    v_and_b32 v30, 1, v1
    v_lshlrev_b32 v30, 3, v30
    v_add3_u32 v28, v28, v29, v30
    v_lshrrev_b32 v29, 5, v1
    v_lshl_add_u32 v2, v29, 10, v28
    v_lshrrev_b32 v28, 3, v1
    v_and_b32 v29, 6, v28
    v_and_b32 v30, 7, v1
    v_xor_b32 v29, v29, v30
    v_lshlrev_b32 v29, 4, v29
    v_lshlrev_b32 v28, 11, v28
    s_lshl_b32 s27, s21, 7
    v_add3_u32 v3, v28, v29, s27
    v_and_b32 v212, 3, v1
    v_cmp_eq_u32 vcc, 0, v212
    v_mov_b32 v213, 0x3f803f80
    s_nop 0
    v_cndmask_b32 v212, 0, v213, vcc
    v_mov_b32 v213, v212
    v_mov_b32 v214, v212
    v_mov_b32 v215, v212
    s_lshl_b32 s27, s3, 2
    s_lshr_b32 s71, 0x11332200, s27
    s_and_b32 s71, s71, 3
    s_and_b32 s27, s3, 1
    s_lshl_b32 s28, s71, 1
    s_add_u32 s28, s28, s27
    s_and_b32 s98, s28, 3
    s_lshl_b32 s28, s28, 12
    s_add_u32 s54, s28, 98304
    s_lshl_b32 s28, s21, 1
    s_add_u32 s28, s28, s27
    s_lshl_b32 s28, s28, 11
    s_lshl_b32 s29, s71, 16
    s_add_u32 s28, s28, s29
    s_lshl_b32 s29, s20, 18
    s_add_u32 s62, s28, s29
    s_lshr_b32 s28, s71, 1
    s_add_u32 s28, s28, 1
    s_cmp_lt_u32 s20, s28
    s_cselect_b32 s28, 0, s28
    s_lshl_b32 s28, s28, 20
    s_sub_u32 s28, s97, s28
    s_lshl_b32 s29, s21, 3
    s_xor_b32 s27, s98, 2
    s_add_u32 s27, s27, s29
    s_lshl_b32 s27, s27, 12
    s_add_u32 s27, s27, s28
    s_add_u32 s55, s27, 524288
    s_lshl_b32 s28, s98, 3
    s_lshr_b32 s27, 302125056, s28
    s_and_b32 s27, s27, 31
    s_lshl_b32 s27, s27, 16
    s_xor_b32 s76, s99, s27
    s_lshr_b32 s27, s20, 1
    s_lshl_b32 s27, s27, 3
    s_mov_b32 s28, 1262102808
    s_mov_b32 s29, 259943772
    s_lshr_b64 s[100:101], s[28:29], s27
    s_sub_u32 s27, 60, s27
    s_lshl_b64 s[28:29], s[28:29], s27
    s_or_b64 s[100:101], s[100:101], s[28:29]
    s_lshl_b64 s[100:101], s[100:101], 4
    s_mul_i32 s27, s21, 0x11111111
    s_xor_b32 s100, s100, s27
    s_xor_b32 s101, s101, s27
    s_lshl_b32 s27, s87, 14
    v_add_u32 v20, s27, v3
    v_and_b32 v72, 15, v1
    v_lshrrev_b32 v73, 4, v1
    s_lshl_b32 s27, s22, 4
    s_add_u32 s27, s27, s20
    s_lshl_b32 s28, s27, 7
    s_add_u32 s28, s28, 655360
    v_lshl_add_u32 v188, v72, 3, s28
    s_lshl_b32 s29, s21, 3
    s_add_u32 s28, s28, s29
    v_mov_b32 v190, s28
    s_lshl_b32 s27, s27, 11
    s_add_u32 s27, s27, 917504
    s_lshl_b32 s28, s87, 5
    v_and_b32 v74, 31, v1
    v_add_u32 v74, s28, v74
    v_lshl_add_u32 v189, v74, 4, s27
    v_lshrrev_b32 v74, 1, v1
    v_add_u32 v74, s28, v74
    v_lshl_add_u32 v74, v74, 4, s27
    v_and_b32 v75, 1, v1
    v_lshl_add_u32 v192, v75, 2, v74
    s_lshl_b32 s28, s21, 7
    s_add_u32 s27, s27, s28
    v_and_b32 v74, 3, v1
    v_lshrrev_b32 v75, 5, v1
    v_lshl_add_u32 v74, v74, 1, v75
    v_lshl_add_u32 v202, v74, 4, s27
    v_and_b32 v74, 28, v1
    v_lshl_add_u32 v202, v74, 26, v202
    s_lshl_b32 s27, s20, 4
    s_add_u32 s27, s27, s21
    s_lshl_b32 s27, s27, 10
    v_add_u32 v191, s27, v0
    s_lshl_b32 s27, s22, 2
    s_add_u32 s27, s27, s87
    s_lshl_b32 s27, s27, 4
    s_add_u32 s27, s27, s21
    s_lshl_b32 s27, s27, 7
    s_add_u32 s27, s27, 688128
    v_lshl_add_u32 v200, v72, 3, s27
    s_lshl_b32 s28, s20, 3
    s_add_u32 s27, s27, s28
    v_mov_b32 v201, s27
    s_lshl_b32 s27, s22, 4
    s_add_u32 s27, s27, s21
    s_mul_i32 s27, s27, 12288
    s_mul_i32 s28, s87, 192
    s_add_u32 s27, s27, s28
    s_add_u32 s27, s27, 262144
    v_min_u32 v74, 11, v72
    v_lshlrev_b32 v74, 4, v74
    v_add_u32 v194, s28, v74
    v_mul_u32_u24 v75, 3072, v73
    v_add3_u32 v193, v74, v75, s27
    s_mul_i32 s28, s20, 768
    s_add_u32 s27, s27, s28
    v_lshl_add_u32 v199, v1, 2, s27
    v_cmp_gt_u32 vcc, 48, v1
    v_mov_b32 v74, 1073741824
    s_nop 0
    v_cndmask_b32 v199, v74, v199, vcc
    v_add_u32 v195, s78, v0
    s_and_b32 s86, s20, 1
    s_add_u32 s86, s86, 3
    s_add_u32 s27, s20, 1
    s_cmp_eq_u32 s27, 16
    s_cselect_b32 s86, 0, s86
    s_bitcmp1_b32 0x92, s86
    s_mov_b32 s28, 81920
    s_cselect_b32 s28, 65536, s28
    s_mov_b32 s29, 40960
    s_cselect_b32 s29, 90112, s29
    s_bitcmp1_b32 0x124, s86
    s_cselect_b32 s28, 73728, s28
    s_cselect_b32 s29, 106496, s29
    s_mul_i32 s27, s87, 3
    s_add_u32 s27, s27, 0
    s_and_b32 s30, s27, 3
    s_lshl_b32 s30, s30, 5
    v_xor_b32 v196, s30, v2
    s_lshr_b32 s27, s27, 2
    s_lshl_b32 s30, s27, 13
    s_add_u32 s30, s30, s29
    s_cmp_eq_u32 s27, 0
    s_cselect_b32 s30, s28, s30
    v_add_u32 v196, s30, v196
    s_mul_i32 s27, s87, 3
    s_add_u32 s27, s27, 1
    s_and_b32 s30, s27, 3
    s_lshl_b32 s30, s30, 5
    v_xor_b32 v197, s30, v2
    s_lshr_b32 s27, s27, 2
    s_lshl_b32 s30, s27, 13
    s_add_u32 s30, s30, s29
    s_cmp_eq_u32 s27, 0
    s_cselect_b32 s30, s28, s30
    v_add_u32 v197, s30, v197
    s_mul_i32 s27, s87, 3
    s_add_u32 s27, s27, 2
    s_and_b32 s30, s27, 3
    s_lshl_b32 s30, s30, 5
    v_xor_b32 v198, s30, v2
    s_lshr_b32 s27, s27, 2
    s_lshl_b32 s30, s27, 13
    s_add_u32 s30, s30, s29
    s_cmp_eq_u32 s27, 0
    s_cselect_b32 s30, s28, s30
    v_add_u32 v198, s30, v198
    v_mov_b32 v124, -1
    v_mov_b32 v125, -1
    v_mov_b32 v126, -1
    v_mov_b32 v127, -1
    v_mov_b32 v128, 0
    v_mov_b32 v129, 0
    v_mov_b32 v130, 0
    v_mov_b32 v131, 0
    s_lshl_b32 s27, s20, 2
    s_add_u32 s27, s27, s87
    s_lshl_b32 s27, s27, 4
    s_add_u32 s27, s27, s21
    s_lshl_b32 s47, s27, 12
    s_bfe_u32 s27, s74, 262148
    s_lshl_b32 s84, s27, s77
    s_mul_i32 s85, s27, 393216
    s_add_u32 m0, s78, 0
    s_nop 0
    buffer_load_dwordx4 v8, s[88:91], s84 offen offset:0 sc1 lds
    buffer_load_dwordx4 v9, s[88:91], s84 offen offset:1024 sc1 lds
    buffer_load_dwordx4 v10, s[88:91], s84 offen offset:2048 sc1 lds
    buffer_load_dwordx4 v11, s[88:91], s84 offen offset:3072 sc1 lds
    s_add_u32 m0, s79, 65536
    s_nop 0
    buffer_load_dwordx4 v12, s[4:7], s85 offen offset:0 lds
    buffer_load_dwordx4 v13, s[4:7], s85 offen offset:1024 lds
    s_add_u32 m0, s79, 98304
    s_nop 0
    buffer_load_dwordx4 v14, s[4:7], s85 offen offset:0 lds
    buffer_load_dwordx4 v15, s[4:7], s85 offen offset:1024 lds
    s_add_u32 m0, s79, 106496
    s_nop 0
    buffer_load_dwordx4 v16, s[4:7], s85 offen offset:0 lds
    buffer_load_dwordx4 v17, s[4:7], s85 offen offset:1024 lds
    s_bfe_u32 s37, s44, 262156
    s_mul_i32 s37, s37, 393216
    s_add_u32 s37, s37, s46
    s_buffer_load_dwordx2 s[38:39], s[4:7], s37 offset:60
    s_buffer_load_dwordx2 s[38:39], s[4:7], s37 offset:2108
    s_buffer_load_dwordx2 s[38:39], s[4:7], s37 offset:4156
    s_waitcnt vmcnt(10)
    v_readfirstlane_b32 s24, v26
    v_readfirstlane_b32 s25, v27
    s_add_u32 s24, s24, 1
    s_add_u32 s25, s25, 16
    s_and_b32 s25, s25, 0xfffffff0
    s_getreg_b32 s27, hwreg(HW_REG_XCC_ID, 0, 4)
    s_or_b32 s25, s25, s27
    s_barrier
    s_bfe_u32 s37, s44, 262160
    s_mul_i32 s37, s37, 393216
    s_add_u32 s37, s37, s46
    s_buffer_load_dwordx2 s[38:39], s[4:7], s37 offset:60
    s_buffer_load_dwordx2 s[38:39], s[4:7], s37 offset:2108
    s_buffer_load_dwordx2 s[38:39], s[4:7], s37 offset:4156
L_lbody:
    s_cmp_lg_u32 s22, 0
    s_cbranch_scc0 Lif_1
    s_bfe_u32 s27, s74, 262148
    s_lshl_b32 s84, s27, s77
    s_add_u32 m0, s78, 0
    s_nop 0
    buffer_load_dwordx4 v8, s[88:91], s84 offen offset:0 sc1 lds
    buffer_load_dwordx4 v9, s[88:91], s84 offen offset:1024 sc1 lds
    buffer_load_dwordx4 v10, s[88:91], s84 offen offset:2048 sc1 lds
    buffer_load_dwordx4 v11, s[88:91], s84 offen offset:3072 sc1 lds
Lif_1:
    s_bfe_u32 s27, s74, 262152
    s_lshl_b32 s84, s27, s77
    s_mul_i32 s85, s27, 393216
    s_add_u32 m0, s78, 16384
    s_nop 0
    buffer_load_dwordx4 v8, s[88:91], s84 offen offset:0 sc1 lds
    buffer_load_dwordx4 v9, s[88:91], s84 offen offset:1024 sc1 lds
    buffer_load_dwordx4 v10, s[88:91], s84 offen offset:2048 sc1 lds
    buffer_load_dwordx4 v11, s[88:91], s84 offen offset:3072 sc1 lds
    s_cmp_lg_u32 s22, 0
    s_cbranch_scc0 Lif_2
    s_waitcnt vmcnt(4)
    ds_read_b128 v[24:27], v195 offset:0
    ds_read_b128 v[28:31], v195 offset:1024
    ds_read_b128 v[32:35], v195 offset:2048
    ds_read_b128 v[36:39], v195 offset:3072
Lif_2:
    s_add_u32 m0, s79, 73728
    s_nop 0
    buffer_load_dwordx4 v12, s[4:7], s85 offen offset:0 lds
    buffer_load_dwordx4 v13, s[4:7], s85 offen offset:1024 lds
    s_cmp_lg_u32 s22, 0
    s_cbranch_scc0 Lif_3
    s_waitcnt lgkmcnt(0)
    v_bitop3_b32 v25, v24, v28, v32 bitop3:0x80
    v_bitop3_b32 v25, v25, v36, 1 bitop3:0x80
    v_cmp_eq_u32 vcc, 0, v25
    s_nop 0
    s_cbranch_vccnz Lrt_4
Lok_5:
Lif_3:
    s_cmp_eq_u32 s86, 0
    s_cbranch_scc0 Lif_6
    s_call_b64 s[72:73], L_colsum
Lif_6:
    s_waitcnt vmcnt(6)
    s_barrier
    s_cmp_eq_u32 s87, 0
    s_cbranch_scc0 Lon_7
    v_mov_b32 v240, s24
    v_mov_b32 v241, s25
    s_mov_b64 exec, 1
    s_cmp_eq_u32 s23, 0
    s_cbranch_scc1 Lwt_432007
    buffer_store_dwordx2 v[240:241], v190, s[12:15], 0 offen
Lwt_432008:
    s_mov_b64 exec, -1
Lon_7:
    s_add_u32 m0, s79, 114688
    s_nop 0
    buffer_load_dwordx4 v14, s[4:7], s85 offen offset:0 lds
    buffer_load_dwordx4 v15, s[4:7], s85 offen offset:1024 lds
    s_add_u32 m0, s79, 122880
    s_nop 0
    buffer_load_dwordx4 v16, s[4:7], s85 offen offset:0 lds
    buffer_load_dwordx4 v17, s[4:7], s85 offen offset:1024 lds
    s_bfe_u32 s27, s74, 262156
    s_lshl_b32 s84, s27, s77
    s_mul_i32 s85, s27, 393216
    s_add_u32 m0, s78, 32768
    s_nop 0
    buffer_load_dwordx4 v8, s[88:91], s84 offen offset:0 sc1 lds
    buffer_load_dwordx4 v9, s[88:91], s84 offen offset:1024 sc1 lds
    buffer_load_dwordx4 v10, s[88:91], s84 offen offset:2048 sc1 lds
    buffer_load_dwordx4 v11, s[88:91], s84 offen offset:3072 sc1 lds
    s_cmp_lg_u32 s22, 0
    s_cbranch_scc0 Lif_8
    s_waitcnt vmcnt(10)
    ds_read_b128 v[24:27], v195 offset:16384
    ds_read_b128 v[28:31], v195 offset:17408
    ds_read_b128 v[32:35], v195 offset:18432
    ds_read_b128 v[36:39], v195 offset:19456
Lif_8:
    s_add_u32 m0, s79, 81920
    s_nop 0
    buffer_load_dwordx4 v12, s[4:7], s85 offen offset:0 lds
    buffer_load_dwordx4 v13, s[4:7], s85 offen offset:1024 lds
    s_cmp_lg_u32 s22, 0
    s_cbranch_scc0 Lif_10
    s_waitcnt lgkmcnt(0)
    v_bitop3_b32 v25, v24, v28, v32 bitop3:0x80
    v_bitop3_b32 v25, v25, v36, 1 bitop3:0x80
    v_cmp_eq_u32 vcc, 0, v25
    s_nop 0
    s_cbranch_vccnz Lrt_11
Lok_12:
Lif_10:
    s_add_u32 m0, s79, 49152
    s_nop 0
    buffer_load_dwordx4 v14, s[4:7], s85 offen offset:0 lds
    buffer_load_dwordx4 v15, s[4:7], s85 offen offset:1024 lds
    s_add_u32 m0, s79, 57344
    s_nop 0
    buffer_load_dwordx4 v16, s[4:7], s85 offen offset:0 lds
    buffer_load_dwordx4 v17, s[4:7], s85 offen offset:1024 lds
    s_bfe_u32 s37, s44, 262164
    s_mul_i32 s37, s37, 393216
    s_add_u32 s37, s37, s46
    s_buffer_load_dwordx2 s[38:39], s[4:7], s37 offset:60
    s_buffer_load_dwordx2 s[38:39], s[4:7], s37 offset:2108
    s_buffer_load_dwordx2 s[38:39], s[4:7], s37 offset:4156
    s_waitcnt vmcnt(10)
    s_barrier
    buffer_load_dwordx2 v[244:245], v188, s[12:15], 0 offen sc1
    s_bfe_u32 s27, s74, 262160
    s_lshl_b32 s84, s27, s77
    s_mul_i32 s85, s27, 393216
    s_add_u32 m0, s78, 0
    s_nop 0
    buffer_load_dwordx4 v8, s[88:91], s84 offen offset:0 sc1 lds
    buffer_load_dwordx4 v9, s[88:91], s84 offen offset:1024 sc1 lds
    buffer_load_dwordx4 v10, s[88:91], s84 offen offset:2048 sc1 lds
    buffer_load_dwordx4 v11, s[88:91], s84 offen offset:3072 sc1 lds
    s_cmp_lg_u32 s22, 0
    s_cbranch_scc0 Lif_14
    s_waitcnt vmcnt(11)
    ds_read_b128 v[24:27], v195 offset:32768
    ds_read_b128 v[28:31], v195 offset:33792
    ds_read_b128 v[32:35], v195 offset:34816
    ds_read_b128 v[36:39], v195 offset:35840
Lif_14:
    s_add_u32 m0, s79, 65536
    s_nop 0
    buffer_load_dwordx4 v12, s[4:7], s85 offen offset:0 lds
    buffer_load_dwordx4 v13, s[4:7], s85 offen offset:1024 lds
    s_cmp_lg_u32 s22, 0
    s_cbranch_scc0 Lif_16
    s_waitcnt lgkmcnt(0)
    v_bitop3_b32 v25, v24, v28, v32 bitop3:0x80
    v_bitop3_b32 v25, v25, v36, 1 bitop3:0x80
    v_cmp_eq_u32 vcc, 0, v25
    s_nop 0
    s_cbranch_vccnz Lrt_17
Lok_18:
Lif_16:
    s_add_u32 m0, s79, 98304
    s_nop 0
    buffer_load_dwordx4 v14, s[4:7], s85 offen offset:0 lds
    buffer_load_dwordx4 v15, s[4:7], s85 offen offset:1024 lds
    s_add_u32 m0, s79, 106496
    s_nop 0
    buffer_load_dwordx4 v16, s[4:7], s85 offen offset:0 lds
    buffer_load_dwordx4 v17, s[4:7], s85 offen offset:1024 lds
    s_bfe_u32 s37, s44, 262168
    s_mul_i32 s37, s37, 393216
    s_add_u32 s37, s37, s46
    s_buffer_load_dwordx2 s[38:39], s[4:7], s37 offset:60
    s_buffer_load_dwordx2 s[38:39], s[4:7], s37 offset:2108
    s_buffer_load_dwordx2 s[38:39], s[4:7], s37 offset:4156
    s_waitcnt vmcnt(11)
    s_barrier
    s_bfe_u32 s27, s74, 262164
    s_lshl_b32 s84, s27, s77
    s_mul_i32 s85, s27, 393216
    s_add_u32 m0, s79, 73728
    s_nop 0
    buffer_load_dwordx4 v12, s[4:7], s85 offen offset:0 lds
    buffer_load_dwordx4 v13, s[4:7], s85 offen offset:1024 lds
    s_waitcnt vmcnt(12)
    v_xor_b32 v246, s24, v244
    v_xor_b32 v247, s25, v245
    v_lshrrev_b32 v247, 4, v247
    v_or_b32 v246, v246, v247
    v_cmp_ne_u32 vcc, 0, v246
    s_nop 0
    s_cbranch_vccnz Lpoll_21
Lok_22:
    s_cmp_eq_u32 s22, 0
    s_cbranch_scc0 Lif_23
    v_cmp_ne_u32 vcc, s25, v245
    s_nop 0
    s_cmp_eq_u64 vcc, 0
    s_cselect_b32 s23, 1, 0
Lif_23:
    s_cmp_eq_u32 s23, 0
    s_cbranch_scc0 Lif_24
    buffer_inv sc1
    s_waitcnt vmcnt(0)
Lif_24:
    s_add_u32 m0, s79, 114688
    s_nop 0
    buffer_load_dwordx4 v14, s[4:7], s85 offen offset:0 lds
    buffer_load_dwordx4 v15, s[4:7], s85 offen offset:1024 lds
    s_cmp_lg_u32 s22, 0
    s_cbranch_scc0 Lif_25
    s_waitcnt vmcnt(10)
    ds_read_b128 v[24:27], v195 offset:0
    ds_read_b128 v[28:31], v195 offset:1024
    ds_read_b128 v[32:35], v195 offset:2048
    ds_read_b128 v[36:39], v195 offset:3072
Lif_25:
    s_add_u32 m0, s79, 122880
    s_nop 0
    buffer_load_dwordx4 v16, s[4:7], s85 offen offset:0 lds
    buffer_load_dwordx4 v17, s[4:7], s85 offen offset:1024 lds
    s_cmp_lg_u32 s22, 0
    s_cbranch_scc0 Lif_27
    s_waitcnt lgkmcnt(0)
    v_bitop3_b32 v25, v24, v28, v32 bitop3:0x80
    v_bitop3_b32 v25, v25, v36, 1 bitop3:0x80
    v_cmp_eq_u32 vcc, 0, v25
    s_nop 0
    s_cbranch_vccnz Lrt_28
Lok_29:
Lif_27:
    s_add_u32 m0, s78, 16384
    s_nop 0
    buffer_load_dwordx4 v8, s[88:91], s84 offen offset:0 sc1 lds
    buffer_load_dwordx4 v9, s[88:91], s84 offen offset:1024 sc1 lds
    buffer_load_dwordx4 v10, s[88:91], s84 offen offset:2048 sc1 lds
    buffer_load_dwordx4 v11, s[88:91], s84 offen offset:3072 sc1 lds
    s_cmp_eq_u32 s22, 0
    s_cbranch_scc0 Lif_30
    s_cmp_eq_u32 s23, 0
    s_cbranch_scc1 Lwt_31
    buffer_store_dwordx4 v[124:127], v0, s[40:43], s47 offen offset:0
Lwt_32:
    s_lshl_b32 s32, s21, 2
    s_add_u32 s32, s32, s87
    s_lshl_b32 s32, s32, 10
    s_add_u32 s32, s32, s97
    s_add_u32 s32, s32, 0
    buffer_store_dwordx4 v[124:127], v0, s[12:15], s32 offen sc1
Lif_30:
    s_cmp_eq_u32 s86, 3
    s_cbranch_scc0 Lif_33
    s_call_b64 s[72:73], L_colsum
Lif_33:
    s_bfe_u32 s37, s44, 262172
    s_mul_i32 s37, s37, 393216
    s_add_u32 s37, s37, s46
    s_buffer_load_dwordx2 s[38:39], s[4:7], s37 offset:60
    s_buffer_load_dwordx2 s[38:39], s[4:7], s37 offset:2108
    s_buffer_load_dwordx2 s[38:39], s[4:7], s37 offset:4156
    s_waitcnt vmcnt(12)
    s_bitcmp1_b32 1, s22
    s_cbranch_scc1 Lvm_34
    s_waitcnt vmcnt(10)
Lvm_34:
    s_barrier
    s_cmp_eq_u32 s87, 3
    s_cbranch_scc0 Lon_35
    buffer_load_dwordx4 v[72:75], v191, s[12:15], 0 offen sc1
Lon_35:
    s_bfe_u32 s27, s74, 262168
    s_lshl_b32 s84, s27, s77
    s_mul_i32 s85, s27, 393216
    s_add_u32 m0, s78, 32768
    s_nop 0
    buffer_load_dwordx4 v8, s[88:91], s84 offen offset:0 sc1 lds
    buffer_load_dwordx4 v9, s[88:91], s84 offen offset:1024 sc1 lds
    buffer_load_dwordx4 v10, s[88:91], s84 offen offset:2048 sc1 lds
    buffer_load_dwordx4 v11, s[88:91], s84 offen offset:3072 sc1 lds
    s_add_u32 m0, s79, 81920
    s_nop 0
    buffer_load_dwordx4 v12, s[4:7], s85 offen offset:0 lds
    buffer_load_dwordx4 v13, s[4:7], s85 offen offset:1024 lds
    s_add_u32 m0, s79, 49152
    s_nop 0
    buffer_load_dwordx4 v14, s[4:7], s85 offen offset:0 lds
    buffer_load_dwordx4 v15, s[4:7], s85 offen offset:1024 lds
    s_add_u32 m0, s79, 57344
    s_nop 0
    buffer_load_dwordx4 v16, s[4:7], s85 offen offset:0 lds
    buffer_load_dwordx4 v17, s[4:7], s85 offen offset:1024 lds
    s_cmp_eq_u32 s22, 0
    s_cbranch_scc0 Lif_36
    s_cmp_eq_u32 s23, 0
    s_cbranch_scc1 Lwt_37
    buffer_store_dwordx4 v[124:127], v0, s[40:43], s47 offen offset:1024
Lwt_38:
    s_lshl_b32 s32, s21, 2
    s_add_u32 s32, s32, s87
    s_lshl_b32 s32, s32, 10
    s_add_u32 s32, s32, s97
    s_add_u32 s32, s32, 65536
    buffer_store_dwordx4 v[124:127], v0, s[12:15], s32 offen sc1
Lif_36:
    s_cmp_eq_u32 s86, 4
    s_cbranch_scc0 Lif_39
    s_call_b64 s[72:73], L_colsum
Lif_39:
    s_bfe_u32 s37, s45, 262144
    s_mul_i32 s37, s37, 393216
    s_add_u32 s37, s37, s46
    s_buffer_load_dwordx2 s[38:39], s[4:7], s37 offset:60
    s_buffer_load_dwordx2 s[38:39], s[4:7], s37 offset:2108
    s_buffer_load_dwordx2 s[38:39], s[4:7], s37 offset:4156
    s_waitcnt vmcnt(14)
    s_bitcmp1_b32 1, s22
    s_cbranch_scc1 Lvm_40
    s_waitcnt vmcnt(10)
Lvm_40:
    s_barrier
    s_bfe_u32 s27, s74, 262172
    s_lshl_b32 s84, s27, s77
    s_mul_i32 s85, s27, 393216
    s_add_u32 m0, s78, 0
    s_bfe_u32 s37, s45, 262148
    s_mul_i32 s37, s37, 393216
    buffer_load_dwordx4 v8, s[88:91], s84 offen offset:0 sc1 lds
    s_add_u32 s37, s37, s46
    s_buffer_load_dwordx2 s[38:39], s[4:7], s37 offset:60
    buffer_load_dwordx4 v9, s[88:91], s84 offen offset:1024 sc1 lds
    s_buffer_load_dwordx2 s[38:39], s[4:7], s37 offset:2108
    s_buffer_load_dwordx2 s[38:39], s[4:7], s37 offset:4156
    buffer_load_dwordx4 v10, s[88:91], s84 offen offset:2048 sc1 lds
    s_lshl_b32 s27, s22, 4
    s_add_u32 s27, s27, s20
    buffer_load_dwordx4 v11, s[88:91], s84 offen offset:3072 sc1 lds
    s_add_u32 m0, s79, 65536
    s_lshl_b32 s27, s27, 4
    s_add_u32 s27, s27, s21
    buffer_load_dwordx4 v12, s[4:7], s85 offen offset:0 lds
    s_lshl_b32 s27, s27, 7
    s_buffer_load_dwordx2 s[38:39], s[12:15], s27 offset:917564
    buffer_load_dwordx4 v13, s[4:7], s85 offen offset:1024 lds
    s_add_u32 m0, s79, 98304
    s_nop 0
    buffer_load_dwordx4 v14, s[4:7], s85 offen offset:0 lds
    buffer_load_dwordx4 v15, s[4:7], s85 offen offset:1024 lds
    s_add_u32 m0, s79, 106496
    s_nop 0
    buffer_load_dwordx4 v16, s[4:7], s85 offen offset:0 lds
    buffer_load_dwordx4 v17, s[4:7], s85 offen offset:1024 lds
    s_cmp_eq_u32 s22, 0
    s_cbranch_scc0 Lif_41
    s_cmp_eq_u32 s23, 0
    s_cbranch_scc1 Lwt_42
    buffer_store_dwordx4 v[124:127], v0, s[40:43], s47 offen offset:2048
Lwt_43:
Lif_41:
    s_waitcnt vmcnt(13)
    s_bitcmp1_b32 1, s22
    s_cbranch_scc1 Lvm_44
    s_waitcnt vmcnt(10)
Lvm_44:
    s_barrier
    s_bfe_u32 s27, s75, 262144
    s_lshl_b32 s84, s27, s77
    s_mul_i32 s85, s27, 393216
    s_add_u32 m0, s78, 16384
    s_bfe_u32 s37, s45, 262152
    buffer_load_dwordx4 v8, s[88:91], s84 offen offset:0 sc1 lds
    s_cmp_eq_u32 s87, 3
    s_cselect_b64 vcc, -1, 0
    s_mul_i32 s37, s37, 393216
    buffer_load_dwordx4 v9, s[88:91], s84 offen offset:1024 sc1 lds
    s_cbranch_vccz Lu_45
    v_add_f32_dpp v72, v72, v72 row_ror:4 row_mask:0xf bank_mask:0xf
    v_add_f32_dpp v73, v73, v73 row_ror:4 row_mask:0xf bank_mask:0xf
    v_add_f32_dpp v74, v74, v74 row_ror:4 row_mask:0xf bank_mask:0xf
Lu_45:
    s_add_u32 s37, s37, s46
    buffer_load_dwordx4 v10, s[88:91], s84 offen offset:2048 sc1 lds
    s_cbranch_vccz Lu_46
    v_add_f32_dpp v75, v75, v75 row_ror:4 row_mask:0xf bank_mask:0xf
    v_add_f32_dpp v72, v72, v72 row_ror:8 row_mask:0xf bank_mask:0xf
    v_add_f32_dpp v73, v73, v73 row_ror:8 row_mask:0xf bank_mask:0xf
Lu_46:
    s_buffer_load_dwordx2 s[38:39], s[4:7], s37 offset:60
    buffer_load_dwordx4 v11, s[88:91], s84 offen offset:3072 sc1 lds
    s_cbranch_vccz Lu_47
    v_add_f32_dpp v74, v74, v74 row_ror:8 row_mask:0xf bank_mask:0xf
    v_add_f32_dpp v75, v75, v75 row_ror:8 row_mask:0xf bank_mask:0xf
    s_nop 0
    v_permlane32_swap_b32 v72, v74
Lu_47:
    s_add_u32 m0, s79, 73728
    s_buffer_load_dwordx2 s[38:39], s[4:7], s37 offset:2108
    buffer_load_dwordx4 v12, s[4:7], s85 offen offset:0 lds
    s_cbranch_vccz Lu_48
    v_permlane32_swap_b32 v73, v75
    v_add_f32 v72, v72, v74
    v_add_f32 v73, v73, v75
Lu_48:
    s_buffer_load_dwordx2 s[38:39], s[4:7], s37 offset:4156
    buffer_load_dwordx4 v13, s[4:7], s85 offen offset:1024 lds
    s_cbranch_vccz Lu_49
    v_mov_b32 v74, v72
    v_mov_b32 v75, v73
    s_nop 0
    v_permlane16_swap_b32 v72, v74
Lu_49:
    s_add_u32 m0, s79, 114688
    s_nop 0
    buffer_load_dwordx4 v14, s[4:7], s85 offen offset:0 lds
    s_cbranch_vccz Lu_50
    v_permlane16_swap_b32 v73, v75
    v_add_f32 v72, v72, v74
    v_add_f32 v73, v73, v75
Lu_50:
    buffer_load_dwordx4 v15, s[4:7], s85 offen offset:1024 lds
    s_cbranch_vccz Lu_51
    v_mul_f32 v77, 0xba800000, v72
    v_mul_f32 v73, 0x3a800000, v73
    v_fma_f32 v73, -v77, v77, v73
Lu_51:
    s_add_u32 m0, s79, 122880
    s_nop 0
    buffer_load_dwordx4 v16, s[4:7], s85 offen offset:0 lds
    s_cbranch_vccz Lu_52
    v_max_f32 v73, 0, v73
    v_add_f32 v73, 0x3727c5ac, v73
    v_rsq_f32 v76, v73
Lu_52:
    buffer_load_dwordx4 v17, s[4:7], s85 offen offset:1024 lds
    s_cbranch_vccz Lu_53
    v_mov_b32 v78, s24
    v_mov_b32 v79, s25
    v_mul_f32 v77, v77, v76
Lu_53:
    s_cmp_eq_u32 s22, 0
    s_cbranch_scc0 Lif_55
    s_cmp_eq_u32 s23, 0
    s_cbranch_scc1 Lwt_56
    buffer_store_dwordx4 v[124:127], v0, s[40:43], s47 offen offset:3072
Lwt_57:
Lif_55:
    s_waitcnt vmcnt(12)
    s_bitcmp1_b32 1, s22
    s_cbranch_scc1 Lvm_58
    s_waitcnt vmcnt(10)
Lvm_58:
    s_barrier
    s_bfe_u32 s27, s75, 262148
    s_lshl_b32 s84, s27, s77
    s_mul_i32 s85, s27, 393216
    s_add_u32 m0, s78, 32768
    s_bfe_u32 s37, s45, 262156
    buffer_load_dwordx4 v8, s[88:91], s84 offen offset:0 sc1 lds
    s_cbranch_vccz Lu_54
    s_cmp_eq_u32 s23, 0
    s_cbranch_scc1 Lwt_708045
    buffer_store_dwordx4 v[76:79], v202, s[12:15], 0 offen
Lwt_708046:
Lu_54:
    s_mul_i32 s37, s37, 393216
    buffer_load_dwordx4 v9, s[88:91], s84 offen offset:1024 sc1 lds
    s_add_u32 s37, s37, s46
    buffer_load_dwordx4 v10, s[88:91], s84 offen offset:2048 sc1 lds
    s_buffer_load_dwordx2 s[38:39], s[4:7], s37 offset:60
    buffer_load_dwordx4 v11, s[88:91], s84 offen offset:3072 sc1 lds
    s_add_u32 m0, s79, 81920
    s_buffer_load_dwordx2 s[38:39], s[4:7], s37 offset:2108
    buffer_load_dwordx4 v12, s[4:7], s85 offen offset:0 lds
    s_buffer_load_dwordx2 s[38:39], s[4:7], s37 offset:4156
    buffer_load_dwordx4 v13, s[4:7], s85 offen offset:1024 lds
    s_add_u32 m0, s79, 49152
    s_nop 0
    buffer_load_dwordx4 v14, s[4:7], s85 offen offset:0 lds
    buffer_load_dwordx4 v15, s[4:7], s85 offen offset:1024 lds
    s_add_u32 m0, s79, 57344
    s_nop 0
    buffer_load_dwordx4 v16, s[4:7], s85 offen offset:0 lds
    buffer_load_dwordx4 v17, s[4:7], s85 offen offset:1024 lds
    s_cmp_eq_u32 s22, 0
    s_cbranch_scc0 Lif_59
    s_cmp_eq_u32 s23, 0
    s_cbranch_scc1 Lwt_60
    buffer_store_dwordx4 v[128:131], v0, s[16:19], s47 offen offset:0
Lwt_61:
Lif_59:
    s_cmp_lt_u32 s22, 2
    s_cbranch_scc0 Lon_62
    v_mov_b32 v240, s24
    v_mov_b32 v241, s25
    s_mov_b64 exec, 1
    buffer_store_dwordx2 v[240:241], v201, s[12:15], 0 offen sc1
    s_mov_b64 exec, -1
Lon_62:
    s_cmp_eq_u32 s22, 1
    s_cbranch_scc0 Lif_63
    s_or_b32 s32, s2, s87
    s_cmp_lg_u32 s32, 0
    s_cbranch_scc1 Lif_63
    v_mov_b32 v242, 671744
    v_mov_b32 v240, s24
    v_mov_b32 v241, s25
    s_mov_b64 exec, 1
    buffer_store_dwordx2 v[240:241], v242, s[12:15], 0 offen sc1
    s_mov_b64 exec, -1
Lif_63:
    s_waitcnt vmcnt(13)
    s_bitcmp1_b32 1, s22
    s_cbranch_scc1 Lvm_64
    s_waitcnt vmcnt(11)
    s_bitcmp1_b32 2, s22
    s_cbranch_scc1 Lvm_64
    s_waitcnt vmcnt(10)
Lvm_64:
    s_barrier
    s_bfe_u32 s27, s75, 262152
    s_lshl_b32 s84, s27, s77
    s_mul_i32 s85, s27, 393216
    s_add_u32 m0, s78, 0
    s_bfe_u32 s37, s45, 262160
    buffer_load_dwordx4 v8, s[88:91], s84 offen offset:0 sc1 lds
    s_mul_i32 s37, s37, 393216
    buffer_load_dwordx4 v9, s[88:91], s84 offen offset:1024 sc1 lds
    s_add_u32 s37, s37, s46
    buffer_load_dwordx4 v10, s[88:91], s84 offen offset:2048 sc1 lds
    s_buffer_load_dwordx2 s[38:39], s[4:7], s37 offset:60
    buffer_load_dwordx4 v11, s[88:91], s84 offen offset:3072 sc1 lds
    s_add_u32 m0, s79, 65536
    s_buffer_load_dwordx2 s[38:39], s[4:7], s37 offset:2108
    buffer_load_dwordx4 v12, s[4:7], s85 offen offset:0 lds
    s_buffer_load_dwordx2 s[38:39], s[4:7], s37 offset:4156
    buffer_load_dwordx4 v13, s[4:7], s85 offen offset:1024 lds
    s_add_u32 m0, s79, 98304
    s_lshl_b32 s27, s22, 4
    buffer_load_dwordx4 v14, s[4:7], s85 offen offset:0 lds
    s_add_u32 s27, s27, s20
    buffer_load_dwordx4 v15, s[4:7], s85 offen offset:1024 lds
    s_add_u32 m0, s79, 106496
    s_lshl_b32 s27, s27, 7
    buffer_load_dwordx4 v16, s[4:7], s85 offen offset:0 lds
    s_buffer_load_dwordx2 s[38:39], s[12:15], s27 offset:663612
    buffer_load_dwordx4 v17, s[4:7], s85 offen offset:1024 lds
    s_cmp_eq_u32 s22, 0
    s_cbranch_scc0 Lif_65
    s_cmp_eq_u32 s23, 0
    s_cbranch_scc1 Lwt_66
    buffer_store_dwordx4 v[128:131], v0, s[16:19], s47 offen offset:1024
Lwt_67:
Lif_65:
    s_waitcnt vmcnt(13)
    s_bitcmp1_b32 1, s22
    s_cbranch_scc1 Lvm_68
    s_waitcnt vmcnt(11)
    s_bitcmp1_b32 2, s22
    s_cbranch_scc1 Lvm_68
    s_waitcnt vmcnt(10)
Lvm_68:
    s_barrier
    s_bfe_u32 s27, s75, 262156
    s_lshl_b32 s84, s27, s77
    s_mul_i32 s85, s27, 393216
    s_add_u32 m0, s78, 16384
    s_lshr_b32 s28, s8, 7
    s_sub_u32 s28, 3, s28
    s_and_b32 s28, s28, 7
    buffer_load_dwordx4 v8, s[88:91], s84 offen offset:0 sc1 lds
    s_and_b32 s29, s21, 8
    s_add_u32 s28, s28, s29
    s_bfe_u32 s29, s2, 0x40003
    buffer_load_dwordx4 v9, s[88:91], s84 offen offset:1024 sc1 lds
    s_lshl_b32 s29, s29, 2
    s_add_u32 s29, s29, s87
    s_lshl_b32 s28, s28, 7
    buffer_load_dwordx4 v10, s[88:91], s84 offen offset:2048 sc1 lds
    s_lshl_b32 s29, s29, 15
    s_add_u32 s35, s28, s29
    s_buffer_load_dwordx2 s[38:39], s[8:11], s35 offset:60
    buffer_load_dwordx4 v11, s[88:91], s84 offen offset:3072 sc1 lds
    s_add_u32 m0, s79, 73728
    s_buffer_load_dwordx2 s[38:39], s[8:11], s35 offset:8252
    s_buffer_load_dwordx2 s[38:39], s[8:11], s35 offset:16444
    s_buffer_load_dwordx2 s[38:39], s[8:11], s35 offset:24636
    buffer_load_dwordx4 v12, s[4:7], s85 offen offset:0 lds
    s_bfe_u32 s37, s45, 262164
    s_mul_i32 s37, s37, 393216
    s_add_u32 s37, s37, s46
    buffer_load_dwordx4 v13, s[4:7], s85 offen offset:1024 lds
    s_add_u32 m0, s79, 114688
    s_buffer_load_dwordx2 s[38:39], s[4:7], s37 offset:60
    s_buffer_load_dwordx2 s[38:39], s[4:7], s37 offset:2108
    s_buffer_load_dwordx2 s[38:39], s[4:7], s37 offset:4156
    buffer_load_dwordx4 v14, s[4:7], s85 offen offset:0 lds
    buffer_load_dwordx4 v15, s[4:7], s85 offen offset:1024 lds
    s_add_u32 m0, s79, 122880
    s_nop 0
    buffer_load_dwordx4 v16, s[4:7], s85 offen offset:0 lds
    buffer_load_dwordx4 v17, s[4:7], s85 offen offset:1024 lds
    s_cmp_eq_u32 s22, 0
    s_cbranch_scc0 Lif_69
    s_cmp_eq_u32 s23, 0
    s_cbranch_scc1 Lwt_70
    buffer_store_dwordx4 v[128:131], v0, s[16:19], s47 offen offset:2048
Lwt_71:
Lif_69:
    s_waitcnt vmcnt(12)
    s_bitcmp1_b32 1, s22
    s_cbranch_scc1 Lvm_72
    s_waitcnt vmcnt(10)
Lvm_72:
    s_barrier
    buffer_load_dwordx4 v[72:75], v189, s[12:15], 0 offen sc1
    s_cmp_lt_u32 s22, 2
    s_cbranch_scc0 Lon_73
    buffer_load_dwordx2 v[244:245], v200, s[12:15], 0 offen sc1
Lon_73:
    s_bfe_u32 s27, s75, 262160
    s_lshl_b32 s84, s27, s77
    s_mul_i32 s85, s27, 393216
    s_add_u32 m0, s78, 32768
    s_buffer_load_dwordx2 s[38:39], s[8:11], s35 offset:2108
    buffer_load_dwordx4 v8, s[88:91], s84 offen offset:0 sc1 lds
    s_buffer_load_dwordx2 s[38:39], s[8:11], s35 offset:10300
    buffer_load_dwordx4 v9, s[88:91], s84 offen offset:1024 sc1 lds
    s_buffer_load_dwordx2 s[38:39], s[8:11], s35 offset:18492
    buffer_load_dwordx4 v10, s[88:91], s84 offen offset:2048 sc1 lds
    s_buffer_load_dwordx2 s[38:39], s[8:11], s35 offset:26684
    buffer_load_dwordx4 v11, s[88:91], s84 offen offset:3072 sc1 lds
    s_add_u32 m0, s79, 81920
    s_bfe_u32 s37, s45, 262168
    buffer_load_dwordx4 v12, s[4:7], s85 offen offset:0 lds
    s_mul_i32 s37, s37, 393216
    buffer_load_dwordx4 v13, s[4:7], s85 offen offset:1024 lds
    s_add_u32 m0, s79, 49152
    s_add_u32 s37, s37, s46
    buffer_load_dwordx4 v14, s[4:7], s85 offen offset:0 lds
    s_buffer_load_dwordx2 s[38:39], s[4:7], s37 offset:60
    buffer_load_dwordx4 v15, s[4:7], s85 offen offset:1024 lds
    s_add_u32 m0, s79, 57344
    s_buffer_load_dwordx2 s[38:39], s[4:7], s37 offset:2108
    buffer_load_dwordx4 v16, s[4:7], s85 offen offset:0 lds
    s_buffer_load_dwordx2 s[38:39], s[4:7], s37 offset:4156
    buffer_load_dwordx4 v17, s[4:7], s85 offen offset:1024 lds
    s_cmp_eq_u32 s22, 0
    s_cbranch_scc0 Lif_74
    s_cmp_eq_u32 s23, 0
    s_cbranch_scc1 Lwt_75
    buffer_store_dwordx4 v[128:131], v0, s[16:19], s47 offen offset:3072
Lwt_76:
Lif_74:
    s_waitcnt vmcnt(14)
    s_bitcmp1_b32 1, s22
    s_cbranch_scc1 Lvm_77
    s_waitcnt vmcnt(12)
    s_bitcmp1_b32 2, s22
    s_cbranch_scc1 Lvm_77
    s_waitcnt vmcnt(11)
Lvm_77:
    s_barrier
    s_bfe_u32 s27, s75, 262164
    s_lshl_b32 s84, s27, s77
    s_mul_i32 s85, s27, 393216
    s_add_u32 m0, s78, 0
    s_buffer_load_dwordx2 s[38:39], s[8:11], s35 offset:4156
    buffer_load_dwordx4 v8, s[88:91], s84 offen offset:0 sc1 lds
    s_waitcnt vmcnt(13)
    s_bitcmp1_b32 1, s22
    s_cbranch_scc1 Lvm_78
    s_waitcnt vmcnt(12)
    s_bitcmp1_b32 2, s22
    s_cbranch_scc1 Lvm_78
    s_waitcnt vmcnt(11)
Lvm_78:
    s_buffer_load_dwordx2 s[38:39], s[8:11], s35 offset:12348
    buffer_load_dwordx4 v9, s[88:91], s84 offen offset:1024 sc1 lds
    v_xor_b32 v76, s24, v74
    v_xor_b32 v77, s25, v75
    v_lshrrev_b32 v77, 4, v77
    v_or_b32 v76, v76, v77
    v_cmp_ne_u32 vcc, 0, v76
    s_nop 0
    s_cbranch_vccnz Lrt_79
Lok_80:
    s_buffer_load_dwordx2 s[38:39], s[8:11], s35 offset:20540
    buffer_load_dwordx4 v10, s[88:91], s84 offen offset:2048 sc1 lds
    v_lshrrev_b32 v76, 5, v1
    v_lshl_add_u32 v76, v76, 2, v189
    s_buffer_load_dwordx2 s[38:39], s[8:11], s35 offset:28732
    buffer_load_dwordx4 v11, s[88:91], s84 offen offset:3072 sc1 lds
    s_cmp_lt_u32 s22, 2
    s_cbranch_scc0 Lif_81
    s_waitcnt vmcnt(15)
    s_bitcmp1_b32 1, s22
    s_cbranch_scc1 Lvm_82
    s_waitcnt vmcnt(14)
Lvm_82:
    v_xor_b32 v246, s24, v244
    v_xor_b32 v247, s25, v245
    v_lshrrev_b32 v247, 4, v247
    v_or_b32 v246, v246, v247
    v_cmp_ne_u32 vcc, 0, v246
    s_nop 0
    s_cbranch_vccnz Lpoll_83
Lok_84:
    buffer_load_dwordx4 v[88:91], v193, s[12:15], 0 offen offset:0 sc1
    buffer_load_dwordx4 v[92:95], v193, s[12:15], 0 offen offset:768 sc1
    buffer_load_dwordx4 v[96:99], v193, s[12:15], 0 offen offset:1536 sc1
    buffer_load_dwordx4 v[100:103], v193, s[12:15], 0 offen offset:2304 sc1
Lif_81:
    s_add_u32 m0, s79, 65536
    s_bfe_u32 s37, s45, 262172
    buffer_load_dwordx4 v12, s[4:7], s85 offen offset:0 lds
    s_mul_i32 s37, s37, 393216
    buffer_load_dwordx4 v13, s[4:7], s85 offen offset:1024 lds
    s_lshr_b32 s27, s78, 4
    s_add_u32 m0, s27, 90112
    s_nop 0
    buffer_load_dword v76, s[12:15], 0 offen sc1 lds
    s_add_u32 m0, s27, 91136
    s_nop 0
    buffer_load_dword v192, s[12:15], 0 offen sc1 lds
    s_add_u32 m0, s79, 98304
    s_add_u32 s37, s37, s46
    buffer_load_dwordx4 v14, s[4:7], s85 offen offset:0 lds
    s_buffer_load_dwordx2 s[38:39], s[4:7], s37 offset:60
    buffer_load_dwordx4 v15, s[4:7], s85 offen offset:1024 lds
    s_add_u32 m0, s79, 106496
    s_buffer_load_dwordx2 s[38:39], s[4:7], s37 offset:2108
    buffer_load_dwordx4 v16, s[4:7], s85 offen offset:0 lds
    s_buffer_load_dwordx2 s[38:39], s[4:7], s37 offset:4156
    buffer_load_dwordx4 v17, s[4:7], s85 offen offset:1024 lds
    s_waitcnt vmcnt(17)
    s_bitcmp1_b32 1, s22
    s_cbranch_scc1 Lvm_85
    s_waitcnt vmcnt(16)
    s_bitcmp1_b32 2, s22
    s_cbranch_scc1 Lvm_85
    s_waitcnt vmcnt(12)
Lvm_85:
    s_barrier
    s_bfe_u32 s27, s75, 262168
    s_lshl_b32 s84, s27, s77
    s_mul_i32 s85, s27, 393216
    s_add_u32 m0, s78, 16384
    s_buffer_load_dwordx2 s[38:39], s[8:11], s35 offset:6204
    buffer_load_dwordx4 v8, s[88:91], s84 offen offset:0 sc1 lds
    s_buffer_load_dwordx2 s[38:39], s[8:11], s35 offset:14396
    buffer_load_dwordx4 v9, s[88:91], s84 offen offset:1024 sc1 lds
    s_buffer_load_dwordx2 s[38:39], s[8:11], s35 offset:22588
    buffer_load_dwordx4 v10, s[88:91], s84 offen offset:2048 sc1 lds
    s_buffer_load_dwordx2 s[38:39], s[8:11], s35 offset:30780
    buffer_load_dwordx4 v11, s[88:91], s84 offen offset:3072 sc1 lds
    s_add_u32 m0, s79, 73728
    s_nop 0
    buffer_load_dwordx4 v12, s[4:7], s85 offen offset:0 lds
    buffer_load_dwordx4 v13, s[4:7], s85 offen offset:1024 lds
    s_add_u32 m0, s79, 114688
    s_nop 0
    buffer_load_dwordx4 v14, s[4:7], s85 offen offset:0 lds
    buffer_load_dwordx4 v15, s[4:7], s85 offen offset:1024 lds
    s_add_u32 m0, s79, 122880
    s_nop 0
    buffer_load_dwordx4 v16, s[4:7], s85 offen offset:0 lds
    buffer_load_dwordx4 v17, s[4:7], s85 offen offset:1024 lds
    s_waitcnt vmcnt(10)
    s_barrier
    s_bfe_u32 s27, s75, 262172
    s_lshl_b32 s84, s27, s77
    s_mul_i32 s85, s27, 393216
    s_add_u32 m0, s78, 32768
    s_nop 0
    buffer_load_dwordx4 v8, s[88:91], s84 offen offset:0 sc1 lds
    s_cmp_lt_u32 s22, 2
    s_cselect_b64 vcc, -1, 0
    buffer_load_dwordx4 v9, s[88:91], s84 offen offset:1024 sc1 lds
    s_cbranch_vccz Lu_87
    v_add_f32 v88, v88, v96
    v_add_f32 v89, v89, v97
    v_add_f32 v90, v90, v98
    v_add_f32 v91, v91, v99
Lu_87:
    buffer_load_dwordx4 v10, s[88:91], s84 offen offset:2048 sc1 lds
    s_cbranch_vccz Lu_88
    v_add_f32 v92, v92, v100
    v_add_f32 v93, v93, v101
    v_add_f32 v94, v94, v102
    v_add_f32 v95, v95, v103
Lu_88:
    buffer_load_dwordx4 v11, s[88:91], s84 offen offset:3072 sc1 lds
    s_cbranch_vccz Lu_89
    v_add_f32 v232, v88, v92
    v_add_f32 v233, v89, v93
    v_add_f32 v234, v90, v94
    v_add_f32 v235, v91, v95
Lu_89:
    s_add_u32 m0, s79, 81920
    s_nop 0
    buffer_load_dwordx4 v12, s[4:7], s85 offen offset:0 lds
    s_cbranch_vccz Lu_90
    v_mov_b32 v88, v232
    v_mov_b32 v89, v233
    v_mov_b32 v90, v234
    v_mov_b32 v91, v235
Lu_90:
    buffer_load_dwordx4 v13, s[4:7], s85 offen offset:1024 lds
    s_cbranch_vccz Lu_91
    v_permlane16_swap_b32 v232, v88
    v_permlane16_swap_b32 v233, v89
    v_permlane16_swap_b32 v234, v90
    v_permlane16_swap_b32 v235, v91
Lu_91:
    s_add_u32 m0, s79, 49152
    s_nop 0
    buffer_load_dwordx4 v14, s[4:7], s85 offen offset:0 lds
    s_cbranch_vccz Lu_92
    v_add_f32 v232, v232, v88
    v_add_f32 v233, v233, v89
    v_add_f32 v234, v234, v90
    v_add_f32 v235, v235, v91
Lu_92:
    buffer_load_dwordx4 v15, s[4:7], s85 offen offset:1024 lds
    s_cbranch_vccz Lu_93
    v_mov_b32 v88, v232
    v_mov_b32 v89, v233
    v_mov_b32 v90, v234
    v_mov_b32 v91, v235
Lu_93:
    s_add_u32 m0, s79, 57344
    s_nop 0
    buffer_load_dwordx4 v16, s[4:7], s85 offen offset:0 lds
    s_cbranch_vccz Lu_94
    v_permlane32_swap_b32 v232, v88
    v_permlane32_swap_b32 v233, v89
    v_permlane32_swap_b32 v234, v90
    v_permlane32_swap_b32 v235, v91
Lu_94:
    buffer_load_dwordx4 v17, s[4:7], s85 offen offset:1024 lds
    s_cbranch_vccz Lu_95
    v_add_f32 v232, v232, v88
    v_add_f32 v233, v233, v89
    v_add_f32 v234, v234, v90
    v_add_f32 v235, v235, v91
Lu_95:
    s_bitcmp1_b32 s22, 0
    s_cbranch_scc1 L_lB
    s_and_b32 s27, s20, 1
    s_lshl_b32 s27, s27, 2
    s_add_u32 s27, s27, s87
    s_lshl_b32 s27, s27, 13
    s_lshl_b32 s28, s21, 7
    s_add_u32 s27, s27, s28
    s_add_u32 s35, s27, s99
    s_waitcnt vmcnt(10)
    s_barrier
    v_lshrrev_b32 v120, 2, v1
    v_add_u32 v120, 0, v120
    v_and_b32 v121, 1, v120
    v_lshrrev_b32 v122, 2, v120
    v_lshl_add_u32 v121, v122, 1, v121
    v_bfe_u32 v120, v120, 1, 1
    v_lshl_add_u32 v120, v120, 4, v121
    v_lshlrev_b32 v120, 16, v120
    v_xor_b32 v120, s35, v120
    v_and_b32 v121, 3, v1
    v_lshl_add_u32 v120, v121, 11, v120
    s_mov_b32 exec_lo, 4294967295
    s_mov_b32 exec_hi, 0
    buffer_load_dword v255, v120, s[8:11], 0 offen
    s_mov_b64 exec, -1
    v_add_u32 v78, 92160, v194
    v_mov_b32 v79, s23
    v_mov_b32 v80, 92928
    s_cmp_eq_u32 s22, 0
    s_cbranch_scc0 Lif_97
    s_mov_b64 s[88:89], s[40:41]
    v_lshrrev_b32 v14, 3, v1
    v_and_b32 v15, 6, v14
    v_and_b32 v16, 7, v1
    v_xor_b32 v15, v15, v16
    s_lshl_b32 s27, s87, 4
    s_mul_i32 s27, s27, 6144
    s_lshl_b32 s28, s21, 7
    s_add_u32 s27, s27, s28
    v_mul_u32_u24 v14, 6144, v14
    v_lshlrev_b32 v15, 4, v15
    v_add3_u32 v12, v14, v15, s27
    v_add_u32 v13, 48128, v12
    v_add_u32 v14, 2048, v12
    v_add_u32 v15, 50176, v12
    v_add_u32 v16, 4096, v12
    v_add_u32 v17, 52224, v12
Lif_97:
    s_waitcnt vmcnt(1)
    s_barrier
    ds_write_b128 v78, v[232:235]
    ds_write_b32 v80, v79
    v_add_u32 v188, 8192, v188
    v_add_u32 v190, 8192, v190
    s_cmp_eq_u32 s87, 0
    s_cbranch_scc0 Lif_99
    v_mov_b32 v240, s24
    v_mov_b32 v241, s25
    s_mov_b64 exec, 1
    s_cmp_eq_u32 s23, 0
    s_cbranch_scc1 Lwt_100
    buffer_store_dwordx2 v[240:241], v190, s[12:15], 0 offen
Lwt_101:
    s_mov_b64 exec, -1
Lif_99:
    s_waitcnt lgkmcnt(0)
    s_barrier
    v_swap_b32 v232, v236
    v_swap_b32 v233, v237
    v_swap_b32 v234, v238
    v_swap_b32 v235, v239
    v_and_b32 v224, 15, v1
    v_lshrrev_b32 v225, 4, v1
    v_lshlrev_b32 v225, 2, v225
    v_sub_u32 v224, v224, v225
    s_cmp_lt_u32 s20, 2
    s_cselect_b32 s27, 0, -1
    v_subrev_u32 v216, 0, v224
    v_subrev_u32 v217, 1, v224
    v_subrev_u32 v218, 2, v224
    v_subrev_u32 v219, 3, v224
    v_ashrrev_i32 v216, 31, v216
    v_ashrrev_i32 v217, 31, v217
    v_ashrrev_i32 v218, 31, v218
    v_ashrrev_i32 v219, 31, v219
    v_and_b32 v216, 4048155338, v216
    v_and_b32 v217, 4048155338, v217
    v_and_b32 v218, 4048155338, v218
    v_and_b32 v219, 4048155338, v219
    v_and_b32 v220, s27, v216
    v_and_b32 v221, s27, v217
    v_and_b32 v222, s27, v218
    v_and_b32 v223, s27, v219
    v_xor_b32 v220, 4048155338, v220
    v_xor_b32 v221, 4048155338, v221
    v_xor_b32 v222, 4048155338, v222
    v_xor_b32 v223, 4048155338, v223
    v_mov_b32 v224, 0
    v_mov_b32 v225, 0
    v_mov_b32 v226, 0
    v_mov_b32 v227, 0
    v_add_u32 v128, s54, v0
    s_lshl_b32 s28, s3, 11
    s_add_u32 s28, s28, 40960
    v_add_u32 v130, s28, v0
    v_subrev_u32 v129, 32768, v128
    v_add_u32 v4, 15360, v3
    v_add_u32 v5, 30720, v3
    v_add_u32 v211, 46080, v3
    s_setprio 1
    s_branch L_attA
L_lB:
    s_waitcnt vmcnt(10)
    s_barrier
    s_lshl_b32 m0, s87, 10
    s_add_u32 m0, m0, 0
    s_xor_b32 s36, s99, 0
    buffer_load_dwordx4 v20, s[8:11], s36 offen lds
    v_add_u32 v78, 92160, v194
    v_mov_b32 v79, s23
    v_mov_b32 v80, 92928
    s_lshl_b32 m0, s87, 10
    s_add_u32 m0, m0, 4096
    s_xor_b32 s36, s99, 65536
    buffer_load_dwordx4 v20, s[8:11], s36 offen lds
    s_lshl_b32 m0, s87, 10
    s_add_u32 m0, m0, 8192
    s_xor_b32 s36, s99, 1048576
    buffer_load_dwordx4 v20, s[8:11], s36 offen lds
    s_lshl_b32 m0, s87, 10
    s_add_u32 m0, m0, 12288
    s_xor_b32 s36, s99, 1114112
    buffer_load_dwordx4 v20, s[8:11], s36 offen lds
    s_lshl_b32 m0, s87, 10
    s_add_u32 m0, m0, 65536
    s_xor_b32 s36, s99, 262144
    buffer_load_dwordx4 v20, s[8:11], s36 offen lds
    s_lshl_b32 m0, s87, 10
    s_add_u32 m0, m0, 69632
    s_xor_b32 s36, s99, 327680
    buffer_load_dwordx4 v20, s[8:11], s36 offen lds
    s_lshl_b32 m0, s87, 10
    s_add_u32 m0, m0, 98304
    s_xor_b32 s36, s99, 524288
    buffer_load_dwordx4 v20, s[8:11], s36 offen lds
    s_lshl_b32 m0, s87, 10
    s_add_u32 m0, m0, 102400
    s_xor_b32 s36, s99, 589824
    buffer_load_dwordx4 v20, s[8:11], s36 offen lds
    s_lshl_b32 m0, s87, 10
    s_add_u32 m0, m0, 106496
    s_xor_b32 s36, s99, 1572864
    buffer_load_dwordx4 v20, s[8:11], s36 offen lds
    s_lshl_b32 m0, s87, 10
    s_add_u32 m0, m0, 110592
    s_xor_b32 s36, s99, 1638400
    buffer_load_dwordx4 v20, s[8:11], s36 offen lds
    s_waitcnt vmcnt(10)
    s_barrier
    ds_write_b128 v78, v[232:235]
    v_add_u32 v188, 8192, v188
    v_add_u32 v190, 8192, v190
    s_cmp_eq_u32 s87, 0
    s_cbranch_scc0 Lif_104
    v_mov_b32 v240, s24
    v_mov_b32 v241, s25
    s_mov_b64 exec, 1
    s_cmp_eq_u32 s23, 0
    s_cbranch_scc1 Lwt_105
    buffer_store_dwordx2 v[240:241], v190, s[12:15], 0 offen
Lwt_106:
    s_mov_b64 exec, -1
Lif_104:
    s_lshl_b32 m0, s87, 10
    s_add_u32 m0, m0, 16384
    s_xor_b32 s36, s99, 131072
    buffer_load_dwordx4 v20, s[8:11], s36 offen lds
    s_lshl_b32 m0, s87, 10
    s_add_u32 m0, m0, 20480
    s_xor_b32 s36, s99, 196608
    buffer_load_dwordx4 v20, s[8:11], s36 offen lds
    s_lshl_b32 m0, s87, 10
    s_add_u32 m0, m0, 24576
    s_xor_b32 s36, s99, 1179648
    buffer_load_dwordx4 v20, s[8:11], s36 offen lds
    s_lshl_b32 m0, s87, 10
    s_add_u32 m0, m0, 28672
    s_xor_b32 s36, s99, 1245184
    buffer_load_dwordx4 v20, s[8:11], s36 offen lds
    s_lshl_b32 m0, s87, 10
    s_add_u32 m0, m0, 73728
    s_xor_b32 s36, s99, 1310720
    buffer_load_dwordx4 v20, s[8:11], s36 offen lds
    s_lshl_b32 m0, s87, 10
    s_add_u32 m0, m0, 77824
    s_xor_b32 s36, s99, 1376256
    buffer_load_dwordx4 v20, s[8:11], s36 offen lds
    s_lshl_b32 m0, s87, 10
    s_add_u32 m0, m0, 114688
    s_xor_b32 s36, s99, 655360
    buffer_load_dwordx4 v20, s[8:11], s36 offen lds
    s_lshl_b32 m0, s87, 10
    s_add_u32 m0, m0, 118784
    s_xor_b32 s36, s99, 720896
    buffer_load_dwordx4 v20, s[8:11], s36 offen lds
    s_lshl_b32 m0, s87, 10
    s_add_u32 m0, m0, 122880
    s_xor_b32 s36, s99, 1703936
    buffer_load_dwordx4 v20, s[8:11], s36 offen lds
    s_lshl_b32 m0, s87, 10
    s_add_u32 m0, m0, 126976
    s_xor_b32 s36, s99, 1769472
    buffer_load_dwordx4 v20, s[8:11], s36 offen lds
    s_waitcnt lgkmcnt(0)
    s_barrier
    s_lshl_b32 m0, s87, 10
    s_add_u32 m0, m0, 81920
    s_xor_b32 s36, s99, 393216
    buffer_load_dwordx4 v20, s[8:11], s36 offen lds
    s_lshl_b32 m0, s87, 10
    s_add_u32 m0, m0, 86016
    s_xor_b32 s36, s99, 458752
    buffer_load_dwordx4 v20, s[8:11], s36 offen lds
    s_lshl_b32 m0, s87, 10
    s_add_u32 m0, m0, 131072
    s_xor_b32 s36, s99, 786432
    buffer_load_dwordx4 v20, s[8:11], s36 offen lds
    s_lshl_b32 m0, s87, 10
    s_add_u32 m0, m0, 135168
    s_xor_b32 s36, s99, 851968
    buffer_load_dwordx4 v20, s[8:11], s36 offen lds
    s_lshl_b32 m0, s87, 10
    s_add_u32 m0, m0, 139264
    s_xor_b32 s36, s99, 1835008
    buffer_load_dwordx4 v20, s[8:11], s36 offen lds
    s_lshl_b32 m0, s87, 10
    s_add_u32 m0, m0, 143360
    s_xor_b32 s36, s99, 1900544
    buffer_load_dwordx4 v20, s[8:11], s36 offen lds
    s_lshl_b32 m0, s87, 10
    s_add_u32 m0, m0, 147456
    s_xor_b32 s36, s99, 917504
    buffer_load_dwordx4 v20, s[8:11], s36 offen lds
    s_lshl_b32 m0, s87, 10
    s_add_u32 m0, m0, 151552
    s_xor_b32 s36, s99, 983040
    buffer_load_dwordx4 v20, s[8:11], s36 offen lds
    s_lshl_b32 m0, s87, 10
    s_add_u32 m0, m0, 155648
    s_xor_b32 s36, s99, 1966080
    buffer_load_dwordx4 v20, s[8:11], s36 offen lds
    s_lshl_b32 m0, s87, 10
    s_add_u32 m0, m0, 159744
    s_xor_b32 s36, s99, 2031616
    buffer_load_dwordx4 v20, s[8:11], s36 offen lds
    v_swap_b32 v232, v236
    v_swap_b32 v233, v237
    v_swap_b32 v234, v238
    v_swap_b32 v235, v239
    buffer_load_dwordx2 v[244:245], v188, s[12:15], 0 offen sc1
    s_lshl_b32 s27, s87, 10
    s_add_u32 s28, s27, 49152
    v_add_u32 v72, s28, v0
    v_mov_b32 v32, 0
    v_mov_b32 v33, 0
    v_mov_b32 v34, 0
    v_mov_b32 v35, 0
    s_cmp_lg_u32 s20, 0
    s_cbranch_scc0 Lif_107
    s_lshr_b32 s28, s22, 1
    s_lshl_b32 s28, s28, 4
    s_add_u32 s28, s28, s21
    s_lshl_b32 s28, s28, 12
    s_add_u32 s27, s27, s28
    s_add_u32 s27, s27, s97
    s_sub_u32 s27, s27, 1048576
    buffer_load_dwordx4 v[32:35], v0, s[12:15], s27 offen sc1
    s_waitcnt vmcnt(0)
    v_cmp_eq_u32 vcc, -1, v32
    s_nop 0
    s_cbranch_vccnz Lrt_108
Lok_109:
Lif_107:
    ds_write_b128 v72, v[32:35]
    s_waitcnt vmcnt(0)
    v_xor_b32 v246, s24, v244
    v_xor_b32 v247, s25, v245
    v_lshrrev_b32 v247, 4, v247
    v_or_b32 v246, v246, v247
    v_cmp_ne_u32 vcc, 0, v246
    s_nop 0
    s_cbranch_vccnz Lpoll_110
Lok_111:
    s_cmp_eq_u32 s23, 0
    s_cbranch_scc0 Lif_112
    buffer_inv sc1
    s_waitcnt vmcnt(0)
Lif_112:
    s_waitcnt lgkmcnt(0)
    s_barrier
    s_lshl_b32 m0, s87, 10
    s_add_u32 m0, m0, 90112
    s_xor_b32 s36, s99, 1441792
    buffer_load_dwordx4 v20, s[8:11], s36 offen lds
    s_lshl_b32 m0, s87, 10
    s_add_u32 m0, m0, 94208
    s_xor_b32 s36, s99, 1507328
    buffer_load_dwordx4 v20, s[8:11], s36 offen lds
    s_branch L_lnext
L_lnext:
    s_add_u32 s22, s22, 1
    s_setprio 0
    s_cmp_eq_u32 s22, 4
    s_cbranch_scc1 L_lfinal
    s_bitcmp1_b32 s22, 0
    s_cselect_b32 s8, s58, s52
    s_cselect_b32 s9, s59, s53
    s_cselect_b32 s4, s56, s50
    s_cselect_b32 s5, s57, s51
    s_cselect_b32 s92, s50, s56
    s_cselect_b32 s93, s51, s57
    s_xor_b64 s[88:89], s[88:89], s[16:17]
    s_xor_b64 s[16:17], s[88:89], s[16:17]
    s_xor_b64 s[88:89], s[88:89], s[16:17]
    s_waitcnt vmcnt(0)
    s_barrier
    v_add_u32 v188, 4294961152, v188
    v_add_u32 v190, 4294961152, v190
    v_add_u32 v189, 32768, v189
    v_add_u32 v202, 32768, v202
    v_add_u32 v192, 32768, v192
    s_mov_b32 s86, 99
    s_cmp_eq_u32 s22, 1
    s_cbranch_scc0 Lif_113
    v_add_u32 v200, 8192, v200
    v_add_u32 v201, 8192, v201
    v_add_u32 v193, 196608, v193
    v_add_u32 v199, 196608, v199
    s_and_b32 s86, s20, 1
    s_add_u32 s86, s86, 3
    s_add_u32 s27, s20, 1
    s_cmp_eq_u32 s27, 16
    s_cselect_b32 s86, 0, s86
    s_bitcmp1_b32 0x92, s86
    s_mov_b32 s28, 81920
    s_cselect_b32 s28, 65536, s28
    s_mov_b32 s29, 40960
    s_cselect_b32 s29, 90112, s29
    s_bitcmp1_b32 0x124, s86
    s_cselect_b32 s28, 73728, s28
    s_cselect_b32 s29, 106496, s29
    s_mul_i32 s27, s87, 3
    s_add_u32 s27, s27, 0
    s_and_b32 s30, s27, 3
    s_lshl_b32 s30, s30, 5
    v_xor_b32 v196, s30, v2
    s_lshr_b32 s27, s27, 2
    s_lshl_b32 s30, s27, 13
    s_add_u32 s30, s30, s29
    s_cmp_eq_u32 s27, 0
    s_cselect_b32 s30, s28, s30
    v_add_u32 v196, s30, v196
    s_mul_i32 s27, s87, 3
    s_add_u32 s27, s27, 1
    s_and_b32 s30, s27, 3
    s_lshl_b32 s30, s30, 5
    v_xor_b32 v197, s30, v2
    s_lshr_b32 s27, s27, 2
    s_lshl_b32 s30, s27, 13
    s_add_u32 s30, s30, s29
    s_cmp_eq_u32 s27, 0
    s_cselect_b32 s30, s28, s30
    v_add_u32 v197, s30, v197
    s_mul_i32 s27, s87, 3
    s_add_u32 s27, s27, 2
    s_and_b32 s30, s27, 3
    s_lshl_b32 s30, s30, 5
    v_xor_b32 v198, s30, v2
    s_lshr_b32 s27, s27, 2
    s_lshl_b32 s30, s27, 13
    s_add_u32 s30, s30, s29
    s_cmp_eq_u32 s27, 0
    s_cselect_b32 s30, s28, s30
    v_add_u32 v198, s30, v198
    s_lshl_b32 s27, s20, 2
    s_add_u32 s27, s27, s87
    s_lshl_b32 s27, s27, 16
    v_add_u32 v8, s27, v0
    v_add_u32 v9, s27, v0
    v_add_u32 v10, s27, v0
    v_add_u32 v11, s27, v0
    s_mov_b64 s[74:75], s[100:101]
    s_mov_b32 s77, 12
Lif_113:
    s_lshr_b32 s27, s4, 7
    s_sub_u32 s27, 3, s27
    s_and_b32 s27, s27, 7
    s_and_b32 s28, s21, 8
    s_add_u32 s27, s27, s28
    s_bfe_u32 s28, s2, 0x40003
    s_lshl_b32 s28, s28, 2
    s_add_u32 s28, s28, s87
    s_mul_i32 s28, s28, 6144
    s_lshl_b32 s46, s27, 7
    s_add_u32 s46, s46, s28
    s_xor_b32 s27, s27, s21
    s_mul_i32 s27, s27, 0x11111111
    s_xor_b32 s44, s74, s27
    s_xor_b32 s45, s75, s27
    s_bfe_u32 s37, s44, 262144
    s_mul_i32 s37, s37, 393216
    s_add_u32 s37, s37, s46
    s_buffer_load_dwordx2 s[38:39], s[4:7], s37 offset:60
    s_buffer_load_dwordx2 s[38:39], s[4:7], s37 offset:2108
    s_buffer_load_dwordx2 s[38:39], s[4:7], s37 offset:4156
    s_bfe_u32 s37, s44, 262148
    s_mul_i32 s37, s37, 393216
    s_add_u32 s37, s37, s46
    s_buffer_load_dwordx2 s[38:39], s[4:7], s37 offset:60
    s_buffer_load_dwordx2 s[38:39], s[4:7], s37 offset:2108
    s_buffer_load_dwordx2 s[38:39], s[4:7], s37 offset:4156
    s_bfe_u32 s37, s44, 262152
    s_mul_i32 s37, s37, 393216
    s_add_u32 s37, s37, s46
    s_buffer_load_dwordx2 s[38:39], s[4:7], s37 offset:60
    s_buffer_load_dwordx2 s[38:39], s[4:7], s37 offset:2108
    s_buffer_load_dwordx2 s[38:39], s[4:7], s37 offset:4156
    s_bfe_u32 s37, s44, 262156
    s_mul_i32 s37, s37, 393216
    s_add_u32 s37, s37, s46
    s_buffer_load_dwordx2 s[38:39], s[4:7], s37 offset:60
    s_buffer_load_dwordx2 s[38:39], s[4:7], s37 offset:2108
    s_buffer_load_dwordx2 s[38:39], s[4:7], s37 offset:4156
    s_bfe_u32 s37, s44, 262160
    s_mul_i32 s37, s37, 393216
    s_add_u32 s37, s37, s46
    s_buffer_load_dwordx2 s[38:39], s[4:7], s37 offset:60
    s_buffer_load_dwordx2 s[38:39], s[4:7], s37 offset:2108
    s_buffer_load_dwordx2 s[38:39], s[4:7], s37 offset:4156
    v_add_u32 v72, s79, v0
    v_add_u32 v73, 65536, v72
    s_barrier
    s_bfe_u32 s27, s74, 262144
    s_mul_i32 s85, s27, 393216
    s_add_u32 m0, s79, 81920
    s_nop 0
    buffer_load_dwordx4 v12, s[4:7], s85 offen offset:0 lds
    buffer_load_dwordx4 v13, s[4:7], s85 offen offset:1024 lds
    s_add_u32 m0, s79, 49152
    s_nop 0
    buffer_load_dwordx4 v14, s[4:7], s85 offen offset:0 lds
    buffer_load_dwordx4 v15, s[4:7], s85 offen offset:1024 lds
    s_add_u32 m0, s79, 57344
    s_nop 0
    buffer_load_dwordx4 v16, s[4:7], s85 offen offset:0 lds
    buffer_load_dwordx4 v17, s[4:7], s85 offen offset:1024 lds
    s_bfe_u32 s27, s74, 262148
    s_mul_i32 s85, s27, 393216
    s_add_u32 m0, s79, 65536
    s_nop 0
    buffer_load_dwordx4 v12, s[4:7], s85 offen offset:0 lds
    buffer_load_dwordx4 v13, s[4:7], s85 offen offset:1024 lds
    s_add_u32 m0, s79, 98304
    s_nop 0
    buffer_load_dwordx4 v14, s[4:7], s85 offen offset:0 lds
    buffer_load_dwordx4 v15, s[4:7], s85 offen offset:1024 lds
    s_add_u32 m0, s79, 106496
    s_nop 0
    buffer_load_dwordx4 v16, s[4:7], s85 offen offset:0 lds
    buffer_load_dwordx4 v17, s[4:7], s85 offen offset:1024 lds
    s_waitcnt vmcnt(6)
    s_barrier
    s_branch L_lbody
L_lfinal:
    s_waitcnt vmcnt(0)
    s_barrier
    s_lshr_b32 s27, s2, 3
    s_add_u32 s27, s27, s87
    s_cmp_eq_u32 s27, 0
    s_cbranch_scc0 Lif_114
    buffer_wbl2 sc1
Lif_114:
    s_barrier
    s_branch L_out
L_colsum:
    ds_read_b64_tr_b16 v[40:41], v196 offset:0
    ds_read_b64_tr_b16 v[42:43], v196 offset:2048
    ds_read_b64_tr_b16 v[44:45], v196 offset:4096
    ds_read_b64_tr_b16 v[46:47], v196 offset:6144
    ds_read_b64_tr_b16 v[48:49], v197 offset:0
    ds_read_b64_tr_b16 v[50:51], v197 offset:2048
    ds_read_b64_tr_b16 v[52:53], v197 offset:4096
    ds_read_b64_tr_b16 v[54:55], v197 offset:6144
    ds_read_b64_tr_b16 v[56:57], v198 offset:0
    ds_read_b64_tr_b16 v[58:59], v198 offset:2048
    ds_read_b64_tr_b16 v[60:61], v198 offset:4096
    ds_read_b64_tr_b16 v[62:63], v198 offset:6144
    v_and_b32 v88, 15, v1
    v_cmp_eq_u32 vcc, 0, v88
    v_mov_b32 v89, 0x3f803f80
    s_nop 0
    v_cndmask_b32 v88, 0, v89, vcc
    v_mov_b32 v89, v88
    v_mov_b32 v90, v88
    v_mov_b32 v91, v88
    v_and_b32 v92, 15, v1
    v_cmp_eq_u32 vcc, 4, v92
    v_mov_b32 v93, 0x3f803f80
    s_nop 0
    v_cndmask_b32 v92, 0, v93, vcc
    v_mov_b32 v93, v92
    v_mov_b32 v94, v92
    v_mov_b32 v95, v92
    v_and_b32 v96, 15, v1
    v_cmp_eq_u32 vcc, 8, v96
    v_mov_b32 v97, 0x3f803f80
    s_nop 0
    v_cndmask_b32 v96, 0, v97, vcc
    v_mov_b32 v97, v96
    v_mov_b32 v98, v96
    v_mov_b32 v99, v96
    s_waitcnt lgkmcnt(0)
    v_mfma_f32_16x16x32_bf16 v[100:103], v[88:91], v[40:43], 0
    v_mfma_f32_16x16x32_bf16 v[100:103], v[88:91], v[44:47], v[100:103]
    v_mfma_f32_16x16x32_bf16 v[100:103], v[92:95], v[48:51], v[100:103]
    v_mfma_f32_16x16x32_bf16 v[100:103], v[92:95], v[52:55], v[100:103]
    v_mfma_f32_16x16x32_bf16 v[100:103], v[96:99], v[56:59], v[100:103]
    v_mfma_f32_16x16x32_bf16 v[100:103], v[96:99], v[60:63], v[100:103]
    s_nop 7
    buffer_store_dword v100, v199, s[12:15], 0 offen sc1
    s_setpc_b64 s[72:73]
L_cstart:
    s_cmp_eq_u32 s3, 3
    s_cbranch_scc0 Lif_115
    s_getpc_b64 s[40:41]
L_pc:
    s_sub_u32 s40, s40, L_pc - interleave_layers__sliding_block__sliding_local_dilated__prompt_kernel
    s_subb_u32 s41, s41, 0
    s_lshr_b32 s27, s2, 3
    s_mul_i32 s27, s27, 1664
    v_lshlrev_b32 v28, 7, v1
    v_add_u32 v28, s27, v28
    s_mov_b32 s27, L_last - interleave_layers__sliding_block__sliding_local_dilated__prompt_kernel
    v_min_u32 v28, s27, v28
    v_mov_b32 v29, s41
    v_add_co_u32 v28, vcc, s40, v28
    s_nop 1
    v_addc_co_u32 v29, vcc, 0, v29, vcc
    s_mov_b64 exec, 8191
    global_load_dword v255, v[28:29], off
    s_mov_b64 exec, -1
Lif_115:
    s_lshl_b32 s27, s20, 2
    s_add_u32 s27, s27, s3
    s_lshl_b32 s27, s27, 16
    s_lshl_b32 s28, s21, 7
    s_add_u32 s27, s27, s28
    v_and_b32 v24, 15, v1
    v_lshlrev_b32 v24, 11, v24
    v_bfe_u32 v25, v1, 4, 1
    v_lshl_add_u32 v24, v25, 5, v24
    v_lshrrev_b32 v25, 5, v1
    v_lshlrev_b32 v25, 4, v25
    v_add3_u32 v24, v24, v25, s27
    v_add_u32 v25, 32768, v24
    s_waitcnt lgkmcnt(0)
    s_mov_b32 s88, s48
    s_mov_b32 s89, s49
    s_mov_b32 s90, 4194304
    s_mov_b32 s91, 0x00020000
    buffer_load_dwordx4 v[8:11], v24, s[88:91], 0 offen offset:0
    buffer_load_dwordx4 v[12:15], v24, s[88:91], 0 offen offset:64
    buffer_load_dwordx4 v[16:19], v25, s[88:91], 0 offen offset:0
    buffer_load_dwordx4 v[20:23], v25, s[88:91], 0 offen offset:64
    s_mov_b32 s12, s64
    s_mov_b32 s13, s65
    s_mov_b32 s14, 75497472
    s_mov_b32 s15, 0x00020000
    v_mov_b32 v28, 671744
    buffer_load_dwordx2 v[26:27], v28, s[12:15], 0 offen sc1
    s_mov_b32 s12, s64
    s_mov_b32 s13, s65
    s_mov_b32 s14, 75497472
    s_mov_b32 s15, 0x00020000
    s_mov_b32 s8, s52
    s_mov_b32 s9, s53
    s_mov_b32 s10, 2097152
    s_mov_b32 s11, 0x00020000
    s_mov_b32 s40, s60
    s_mov_b32 s41, s61
    s_mov_b32 s42, 4194304
    s_mov_b32 s43, 0x00020000
    s_add_u32 s16, s64, 18874368
    s_addc_u32 s17, s65, 0
    s_mov_b32 s18, 4194304
    s_mov_b32 s19, 0x00020000
    s_mov_b32 s92, s56
    s_mov_b32 s93, s57
    s_mov_b32 s94, 6291456
    s_mov_b32 s95, 0x00020000
    s_mov_b32 s23, 0
    v_mov_b32 v6, 0
    v_mov_b32 v7, 0
    v_mov_b32 v206, 1073741824
    s_lshl_b32 s97, s20, 20
    s_add_u32 s97, s97, 2097152
    s_lshl_b32 s99, s21, 17
    v_bfe_u32 v28, v1, 2, 3
    v_bfe_u32 v29, v1, 1, 1
    v_and_b32 v30, 6, v28
    v_xor_b32 v29, v29, v30
    v_lshlrev_b32 v29, 4, v29
    v_lshlrev_b32 v28, 7, v28
    v_and_b32 v30, 1, v1
    v_lshlrev_b32 v30, 3, v30
    v_add3_u32 v28, v28, v29, v30
    v_lshrrev_b32 v29, 5, v1
    v_lshl_add_u32 v2, v29, 10, v28
    v_lshrrev_b32 v28, 3, v1
    v_and_b32 v29, 6, v28
    v_and_b32 v30, 7, v1
    v_xor_b32 v29, v29, v30
    v_lshlrev_b32 v29, 4, v29
    v_lshlrev_b32 v28, 11, v28
    s_lshl_b32 s27, s21, 7
    v_add3_u32 v3, v28, v29, s27
    v_and_b32 v212, 3, v1
    v_cmp_eq_u32 vcc, 0, v212
    v_mov_b32 v213, 0x3f803f80
    s_nop 0
    v_cndmask_b32 v212, 0, v213, vcc
    v_mov_b32 v213, v212
    v_mov_b32 v214, v212
    v_mov_b32 v215, v212
    s_lshl_b32 s27, s3, 2
    s_lshr_b32 s71, 0x11332200, s27
    s_and_b32 s71, s71, 3
    s_and_b32 s27, s3, 1
    s_lshl_b32 s28, s71, 1
    s_add_u32 s28, s28, s27
    s_and_b32 s98, s28, 3
    s_lshl_b32 s28, s28, 12
    s_add_u32 s54, s28, 98304
    s_lshl_b32 s28, s21, 1
    s_add_u32 s28, s28, s27
    s_lshl_b32 s28, s28, 11
    s_lshl_b32 s29, s71, 16
    s_add_u32 s28, s28, s29
    s_lshl_b32 s29, s20, 18
    s_add_u32 s62, s28, s29
    s_lshr_b32 s28, s71, 1
    s_add_u32 s28, s28, 1
    s_cmp_lt_u32 s20, s28
    s_cselect_b32 s28, 0, s28
    s_lshl_b32 s28, s28, 20
    s_sub_u32 s28, s97, s28
    s_lshl_b32 s29, s21, 3
    s_xor_b32 s27, s98, 2
    s_add_u32 s27, s27, s29
    s_lshl_b32 s27, s27, 12
    s_add_u32 s27, s27, s28
    s_add_u32 s55, s27, 524288
    s_lshl_b32 s28, s98, 3
    s_lshr_b32 s27, 302125056, s28
    s_and_b32 s27, s27, 31
    s_lshl_b32 s27, s27, 16
    s_xor_b32 s76, s99, s27
    s_mov_b32 s4, s50
    s_mov_b32 s5, s51
    s_mov_b32 s6, 6291456
    s_mov_b32 s7, 0x00020000
    s_lshr_b32 s27, s3, 1
    s_lshl_b32 s27, s27, 13
    v_and_b32 v200, 15, v1
    v_bfe_u32 v201, v1, 1, 3
    v_lshrrev_b32 v202, 4, v1
    v_xor_b32 v201, v201, v202
    v_lshlrev_b32 v200, 7, v200
    v_lshlrev_b32 v201, 4, v201
    v_add3_u32 v200, v200, v201, s27
    v_xor_b32 v201, 64, v200
    s_and_b32 s27, s3, 1
    s_lshl_b32 s28, s27, 6
    v_xor_b32 v202, s28, v2
    v_xor_b32 v203, 32, v202
    v_add_u32 v204, 98304, v202
    v_add_u32 v205, 98304, v203
    v_add_u32 v202, 49152, v202
    v_add_u32 v203, 49152, v203
    v_and_b32 v24, 15, v1
    v_lshrrev_b32 v25, 4, v1
    s_lshl_b32 s27, s27, 7
    s_add_u32 s27, s27, 92160
    v_lshl_add_u32 v209, v25, 4, s27
    v_lshl_add_u32 v210, v24, 2, s27
    s_lshr_b32 s27, s3, 1
    s_lshl_b32 s27, s27, 9
    s_add_u32 s28, s27, 90112
    v_lshl_add_u32 v208, v25, 4, s28
    v_lshl_add_u32 v207, v24, 3, s28
    s_lshl_b32 s27, s20, 2
    s_add_u32 s27, s27, s3
    s_lshl_b32 s27, s27, 4
    s_add_u32 s27, s27, s21
    s_lshl_b32 s0, s27, 12
    s_lshr_b32 s27, s27, 4
    s_lshl_b32 s1, s27, 16
    s_lshl_b32 s27, s27, 12
    s_lshl_b32 s28, s21, 6
    s_add_u32 s27, s27, s28
    v_and_b32 v28, 7, v24
    v_lshl_add_u32 v206, v28, 3, s27
    v_lshrrev_b32 v28, 3, v24
    v_lshl_add_u32 v206, v28, 10, v206
    v_lshrrev_b32 v24, 2, v24
    v_cmp_eq_u32 vcc, v24, v25
    v_mov_b32 v24, 1073741824
    s_nop 0
    v_cndmask_b32 v206, v24, v206, vcc
    s_mov_b32 s84, 0xaaaaaaaa
    s_mov_b32 s86, 0xcccccccc
    s_mov_b32 s85, 0xaaaaaaaa
    s_mov_b32 s87, 0xcccccccc
    s_sub_u32 s27, s54, 98304
    s_add_u32 s48, s27, 131072
    s_lshl_b32 s28, s21, 15
    s_add_u32 s27, s27, s28
    s_add_u32 s27, s27, s97
    s_add_u32 s63, s27, 524288
    s_lshl_b32 s27, s21, 1
    s_add_u32 s27, s27, s3
    s_sub_u32 s27, s27, 2
    s_lshl_b32 s27, s27, 11
    s_add_u32 s27, s27, s97
    s_cmp_ge_u32 s3, 2
    s_cselect_b32 s49, s27, 1073741824
    s_mov_b64 s[88:89], s[16:17]
    s_mov_b64 s[16:17], s[40:41]
    s_waitcnt vmcnt(0)
    v_readfirstlane_b32 s24, v26
    v_readfirstlane_b32 s25, v27
    s_add_u32 s24, s24, 1
    s_add_u32 s25, s25, 16
    s_and_b32 s25, s25, 0xfffffff0
    s_getreg_b32 s27, hwreg(HW_REG_XCC_ID, 0, 4)
    s_or_b32 s25, s25, s27
    v_permlane16_swap_b32 v8, v10
    v_permlane16_swap_b32 v9, v11
    v_permlane16_swap_b32 v12, v14
    v_permlane16_swap_b32 v13, v15
    v_permlane16_swap_b32 v16, v18
    v_permlane16_swap_b32 v17, v19
    v_permlane16_swap_b32 v20, v22
    v_permlane16_swap_b32 v21, v23
    v_mfma_f32_16x16x32_bf16 v[232:235], v[8:11], v[8:11], 0
    v_mfma_f32_16x16x32_bf16 v[236:239], v[212:215], v[8:11], 0
    v_mfma_f32_16x16x32_bf16 v[240:243], v[16:19], v[16:19], 0
    v_mfma_f32_16x16x32_bf16 v[244:247], v[212:215], v[16:19], 0
    v_mfma_f32_16x16x32_bf16 v[232:235], v[12:15], v[12:15], v[232:235]
    v_mfma_f32_16x16x32_bf16 v[236:239], v[212:215], v[12:15], v[236:239]
    v_mfma_f32_16x16x32_bf16 v[240:243], v[20:23], v[20:23], v[240:243]
    v_mfma_f32_16x16x32_bf16 v[244:247], v[212:215], v[20:23], v[244:247]
    s_nop 4
    v_cndmask_b32 v232, v232, v233, s[84:85]
    v_cndmask_b32 v234, v234, v235, s[84:85]
    v_cndmask_b32 v240, v240, v241, s[84:85]
    v_cndmask_b32 v242, v242, v243, s[84:85]
    v_cndmask_b32 v237, v232, v234, s[86:87]
    v_cndmask_b32 v245, v240, v242, s[86:87]
    s_cmp_eq_u32 s23, 0
    s_cbranch_scc1 Lwt_116
    buffer_store_dwordx2 v[236:237], v206, s[12:15], 0 offen offset:0
    buffer_store_dwordx2 v[244:245], v206, s[12:15], 0 offen offset:2048
Lwt_117:
    v_or_b32 v206, 2147483648, v206
    s_branch L_cfirst
L_centry:
    v_mfma_f32_16x16x32_bf16 v[232:235], v[8:11], v[8:11], 0
    v_mfma_f32_16x16x32_bf16 v[236:239], v[212:215], v[8:11], 0
    v_mfma_f32_16x16x32_bf16 v[240:243], v[16:19], v[16:19], 0
    v_mfma_f32_16x16x32_bf16 v[244:247], v[212:215], v[16:19], 0
    v_mfma_f32_16x16x32_bf16 v[232:235], v[12:15], v[12:15], v[232:235]
    v_mfma_f32_16x16x32_bf16 v[236:239], v[212:215], v[12:15], v[236:239]
    v_mfma_f32_16x16x32_bf16 v[240:243], v[20:23], v[20:23], v[240:243]
    v_mfma_f32_16x16x32_bf16 v[244:247], v[212:215], v[20:23], v[244:247]
    s_waitcnt lgkmcnt(0)
L_cfirst:
    s_barrier
    ds_read_b128 v[120:123], v200 offset:32768
    ds_read_b64_tr_b16 v[136:137], v202 offset:32768
    ds_read_b64_tr_b16 v[138:139], v202 offset:34816
    ds_read_b128 v[124:127], v200 offset:34816
    ds_read_b128 v[128:131], v200 offset:36864
    ds_read_b128 v[132:135], v200 offset:38912
    ds_read_b64_tr_b16 v[140:141], v203 offset:32768
    ds_read_b64_tr_b16 v[142:143], v203 offset:34816
    ds_read_b64_tr_b16 v[144:145], v202 offset:0
    ds_read_b64_tr_b16 v[146:147], v202 offset:2048
    ds_read_b64_tr_b16 v[148:149], v203 offset:0
    ds_read_b64_tr_b16 v[150:151], v203 offset:2048
    ds_read_b64_tr_b16 v[152:153], v202 offset:8192
    ds_read_b64_tr_b16 v[154:155], v202 offset:10240
    ds_read_b64_tr_b16 v[156:157], v203 offset:8192
    ds_read_b64_tr_b16 v[158:159], v203 offset:10240
    v_cndmask_b32 v232, v232, v233, s[84:85]
    v_cndmask_b32 v234, v234, v235, s[84:85]
    v_cndmask_b32 v240, v240, v241, s[84:85]
    v_cndmask_b32 v242, v242, v243, s[84:85]
    v_cndmask_b32 v237, v232, v234, s[86:87]
    v_cndmask_b32 v245, v240, v242, s[86:87]
    s_cmp_eq_u32 s23, 0
    s_cbranch_scc1 Lwt_118
    buffer_store_dwordx2 v[236:237], v206, s[12:15], 0 offen offset:0
    buffer_store_dwordx2 v[244:245], v206, s[12:15], 0 offen offset:2048
Lwt_119:
    s_waitcnt lgkmcnt(13)
    v_mfma_f32_16x16x32_bf16 v[24:27], v[136:139], v[120:123], 0
    ds_read_b128 v[160:163], v201 offset:32768
    s_waitcnt lgkmcnt(13)
    v_mfma_f32_16x16x32_bf16 v[28:31], v[136:139], v[124:127], 0
    ds_read_b64_tr_b16 v[176:177], v202 offset:36864
    s_waitcnt lgkmcnt(13)
    v_mfma_f32_16x16x32_bf16 v[32:35], v[136:139], v[128:131], 0
    ds_read_b64_tr_b16 v[178:179], v202 offset:38912
    s_waitcnt lgkmcnt(13)
    v_mfma_f32_16x16x32_bf16 v[36:39], v[136:139], v[132:135], 0
    ds_read_b128 v[164:167], v201 offset:34816
    s_waitcnt lgkmcnt(12)
    v_mfma_f32_16x16x32_bf16 v[52:55], v[140:143], v[132:135], 0
    ds_read_b128 v[168:171], v201 offset:36864
    v_mfma_f32_16x16x32_bf16 v[48:51], v[140:143], v[128:131], 0
    ds_read_b128 v[172:175], v201 offset:38912
    v_mfma_f32_16x16x32_bf16 v[44:47], v[140:143], v[124:127], 0
    ds_read_b64_tr_b16 v[180:181], v203 offset:36864
    v_mfma_f32_16x16x32_bf16 v[40:43], v[140:143], v[120:123], 0
    ds_read_b64_tr_b16 v[182:183], v203 offset:38912
    s_waitcnt lgkmcnt(5)
    v_mfma_f32_16x16x32_bf16 v[56:59], v[144:147], v[120:123], 0
    ds_read_b64_tr_b16 v[184:185], v202 offset:4096
    v_mfma_f32_16x16x32_bf16 v[60:63], v[144:147], v[124:127], 0
    ds_read_b64_tr_b16 v[186:187], v202 offset:6144
    v_mfma_f32_16x16x32_bf16 v[64:67], v[144:147], v[128:131], 0
    ds_read_b64_tr_b16 v[188:189], v203 offset:4096
    v_mfma_f32_16x16x32_bf16 v[68:71], v[144:147], v[132:135], 0
    ds_read_b64_tr_b16 v[190:191], v203 offset:6144
    v_mfma_f32_16x16x32_bf16 v[84:87], v[148:151], v[132:135], 0
    ds_read_b64_tr_b16 v[192:193], v202 offset:12288
    v_mfma_f32_16x16x32_bf16 v[80:83], v[148:151], v[128:131], 0
    ds_read_b64_tr_b16 v[194:195], v202 offset:14336
    v_mfma_f32_16x16x32_bf16 v[76:79], v[148:151], v[124:127], 0
    ds_read_b64_tr_b16 v[196:197], v203 offset:12288
    v_mfma_f32_16x16x32_bf16 v[72:75], v[148:151], v[120:123], 0
    ds_read_b64_tr_b16 v[198:199], v203 offset:14336
    v_mfma_f32_16x16x32_bf16 v[88:91], v[120:123], v[152:155], 0
    s_mov_b32 s96, 0
    v_mfma_f32_16x16x32_bf16 v[92:95], v[124:127], v[152:155], 0
    s_xor_b64 s[88:89], s[88:89], s[16:17]
    v_mfma_f32_16x16x32_bf16 v[96:99], v[128:131], v[152:155], 0
    s_xor_b64 s[16:17], s[88:89], s[16:17]
    v_mfma_f32_16x16x32_bf16 v[100:103], v[132:135], v[152:155], 0
    s_xor_b64 s[88:89], s[88:89], s[16:17]
    v_mfma_f32_16x16x32_bf16 v[116:119], v[132:135], v[156:159], 0
    v_mfma_f32_16x16x32_bf16 v[112:115], v[128:131], v[156:159], 0
    v_mfma_f32_16x16x32_bf16 v[108:111], v[124:127], v[156:159], 0
    v_mfma_f32_16x16x32_bf16 v[104:107], v[120:123], v[156:159], 0
    v_mfma_f32_16x16x32_bf16 v[24:27], v[176:179], v[160:163], v[24:27]
    s_waitcnt lgkmcnt(0)
    v_mfma_f32_16x16x32_bf16 v[28:31], v[176:179], v[164:167], v[28:31]
    v_mfma_f32_16x16x32_bf16 v[32:35], v[176:179], v[168:171], v[32:35]
    v_mfma_f32_16x16x32_bf16 v[36:39], v[176:179], v[172:175], v[36:39]
    v_mfma_f32_16x16x32_bf16 v[52:55], v[180:183], v[172:175], v[52:55]
    v_mfma_f32_16x16x32_bf16 v[48:51], v[180:183], v[168:171], v[48:51]
    v_mfma_f32_16x16x32_bf16 v[44:47], v[180:183], v[164:167], v[44:47]
    v_mfma_f32_16x16x32_bf16 v[40:43], v[180:183], v[160:163], v[40:43]
    s_waitcnt vmcnt(0)
    s_barrier
    v_mfma_f32_16x16x32_bf16 v[56:59], v[184:187], v[160:163], v[56:59]
    ds_read_b128 v[120:123], v200 offset:0
    ds_read_b64_tr_b16 v[136:137], v202 offset:16384
    v_mfma_f32_16x16x32_bf16 v[60:63], v[184:187], v[164:167], v[60:63]
    ds_read_b64_tr_b16 v[138:139], v202 offset:18432
    v_mfma_f32_16x16x32_bf16 v[64:67], v[184:187], v[168:171], v[64:67]
    ds_read_b128 v[124:127], v200 offset:2048
    v_mfma_f32_16x16x32_bf16 v[68:71], v[184:187], v[172:175], v[68:71]
    ds_read_b128 v[128:131], v200 offset:4096
    ds_read_b128 v[132:135], v200 offset:6144
    v_mfma_f32_16x16x32_bf16 v[84:87], v[188:191], v[172:175], v[84:87]
    ds_read_b64_tr_b16 v[140:141], v203 offset:16384
    v_mfma_f32_16x16x32_bf16 v[80:83], v[188:191], v[168:171], v[80:83]
    ds_read_b64_tr_b16 v[142:143], v203 offset:18432
    v_mfma_f32_16x16x32_bf16 v[76:79], v[188:191], v[164:167], v[76:79]
    ds_read_b64_tr_b16 v[144:145], v204 offset:0
    ds_read_b64_tr_b16 v[146:147], v204 offset:2048
    v_mfma_f32_16x16x32_bf16 v[72:75], v[188:191], v[160:163], v[72:75]
    ds_read_b64_tr_b16 v[148:149], v205 offset:0
    v_mfma_f32_16x16x32_bf16 v[88:91], v[160:163], v[192:195], v[88:91]
    ds_read_b64_tr_b16 v[150:151], v205 offset:2048
    v_mfma_f32_16x16x32_bf16 v[92:95], v[164:167], v[192:195], v[92:95]
    ds_read_b64_tr_b16 v[152:153], v204 offset:8192
    ds_read_b64_tr_b16 v[154:155], v204 offset:10240
    v_mfma_f32_16x16x32_bf16 v[96:99], v[168:171], v[192:195], v[96:99]
    ds_read_b64_tr_b16 v[156:157], v205 offset:8192
    v_mfma_f32_16x16x32_bf16 v[100:103], v[172:175], v[192:195], v[100:103]
    ds_read_b64_tr_b16 v[158:159], v205 offset:10240
    v_mfma_f32_16x16x32_bf16 v[116:119], v[172:175], v[196:199], v[116:119]
    v_mfma_f32_16x16x32_bf16 v[112:115], v[168:171], v[196:199], v[112:115]
    v_mfma_f32_16x16x32_bf16 v[108:111], v[164:167], v[196:199], v[108:111]
    v_mfma_f32_16x16x32_bf16 v[104:107], v[160:163], v[196:199], v[104:107]
L_cloop:
    s_waitcnt lgkmcnt(0)
    v_mfma_f32_16x16x32_bf16 v[24:27], v[136:139], v[120:123], v[24:27]
    ds_read_b128 v[160:163], v201 offset:0
    v_mfma_f32_16x16x32_bf16 v[28:31], v[136:139], v[124:127], v[28:31]
    ds_read_b64_tr_b16 v[176:177], v202 offset:20480
    v_mfma_f32_16x16x32_bf16 v[32:35], v[136:139], v[128:131], v[32:35]
    ds_read_b64_tr_b16 v[178:179], v202 offset:22528
    v_mfma_f32_16x16x32_bf16 v[36:39], v[136:139], v[132:135], v[36:39]
    ds_read_b128 v[164:167], v201 offset:2048
    v_mfma_f32_16x16x32_bf16 v[52:55], v[140:143], v[132:135], v[52:55]
    ds_read_b128 v[168:171], v201 offset:4096
    v_mfma_f32_16x16x32_bf16 v[48:51], v[140:143], v[128:131], v[48:51]
    ds_read_b128 v[172:175], v201 offset:6144
    v_mfma_f32_16x16x32_bf16 v[44:47], v[140:143], v[124:127], v[44:47]
    ds_read_b64_tr_b16 v[180:181], v203 offset:20480
    v_mfma_f32_16x16x32_bf16 v[40:43], v[140:143], v[120:123], v[40:43]
    ds_read_b64_tr_b16 v[182:183], v203 offset:22528
    v_mfma_f32_16x16x32_bf16 v[56:59], v[144:147], v[120:123], v[56:59]
    ds_read_b64_tr_b16 v[184:185], v204 offset:4096
    v_mfma_f32_16x16x32_bf16 v[60:63], v[144:147], v[124:127], v[60:63]
    ds_read_b64_tr_b16 v[186:187], v204 offset:6144
    v_mfma_f32_16x16x32_bf16 v[64:67], v[144:147], v[128:131], v[64:67]
    ds_read_b64_tr_b16 v[188:189], v205 offset:4096
    v_mfma_f32_16x16x32_bf16 v[68:71], v[144:147], v[132:135], v[68:71]
    ds_read_b64_tr_b16 v[190:191], v205 offset:6144
    v_mfma_f32_16x16x32_bf16 v[84:87], v[148:151], v[132:135], v[84:87]
    ds_read_b64_tr_b16 v[192:193], v204 offset:12288
    v_mfma_f32_16x16x32_bf16 v[80:83], v[148:151], v[128:131], v[80:83]
    ds_read_b64_tr_b16 v[194:195], v204 offset:14336
    v_mfma_f32_16x16x32_bf16 v[76:79], v[148:151], v[124:127], v[76:79]
    ds_read_b64_tr_b16 v[196:197], v205 offset:12288
    v_mfma_f32_16x16x32_bf16 v[72:75], v[148:151], v[120:123], v[72:75]
    ds_read_b64_tr_b16 v[198:199], v205 offset:14336
    v_mfma_f32_16x16x32_bf16 v[88:91], v[120:123], v[152:155], v[88:91]
    v_mfma_f32_16x16x32_bf16 v[92:95], v[124:127], v[152:155], v[92:95]
    v_mfma_f32_16x16x32_bf16 v[96:99], v[128:131], v[152:155], v[96:99]
    v_mfma_f32_16x16x32_bf16 v[100:103], v[132:135], v[152:155], v[100:103]
    v_mfma_f32_16x16x32_bf16 v[116:119], v[132:135], v[156:159], v[116:119]
    v_mfma_f32_16x16x32_bf16 v[112:115], v[128:131], v[156:159], v[112:115]
    v_mfma_f32_16x16x32_bf16 v[108:111], v[124:127], v[156:159], v[108:111]
    v_mfma_f32_16x16x32_bf16 v[104:107], v[120:123], v[156:159], v[104:107]
    s_waitcnt lgkmcnt(0)
    v_mfma_f32_16x16x32_bf16 v[24:27], v[176:179], v[160:163], v[24:27]
    v_mfma_f32_16x16x32_bf16 v[28:31], v[176:179], v[164:167], v[28:31]
    s_barrier
    v_mfma_f32_16x16x32_bf16 v[32:35], v[176:179], v[168:171], v[32:35]
    ds_read_b128 v[120:123], v200 offset:16384
    v_mfma_f32_16x16x32_bf16 v[36:39], v[176:179], v[172:175], v[36:39]
    ds_read_b64_tr_b16 v[136:137], v202 offset:24576
    v_mfma_f32_16x16x32_bf16 v[52:55], v[180:183], v[172:175], v[52:55]
    ds_read_b64_tr_b16 v[138:139], v202 offset:26624
    v_mfma_f32_16x16x32_bf16 v[48:51], v[180:183], v[168:171], v[48:51]
    ds_read_b128 v[124:127], v200 offset:18432
    v_mfma_f32_16x16x32_bf16 v[44:47], v[180:183], v[164:167], v[44:47]
    ds_read_b128 v[128:131], v200 offset:20480
    v_mfma_f32_16x16x32_bf16 v[40:43], v[180:183], v[160:163], v[40:43]
    ds_read_b128 v[132:135], v200 offset:22528
    v_mfma_f32_16x16x32_bf16 v[56:59], v[184:187], v[160:163], v[56:59]
    ds_read_b64_tr_b16 v[140:141], v203 offset:24576
    v_mfma_f32_16x16x32_bf16 v[60:63], v[184:187], v[164:167], v[60:63]
    ds_read_b64_tr_b16 v[142:143], v203 offset:26624
    v_mfma_f32_16x16x32_bf16 v[64:67], v[184:187], v[168:171], v[64:67]
    ds_read_b64_tr_b16 v[144:145], v204 offset:16384
    v_mfma_f32_16x16x32_bf16 v[68:71], v[184:187], v[172:175], v[68:71]
    ds_read_b64_tr_b16 v[146:147], v204 offset:18432
    v_mfma_f32_16x16x32_bf16 v[84:87], v[188:191], v[172:175], v[84:87]
    ds_read_b64_tr_b16 v[148:149], v205 offset:16384
    v_mfma_f32_16x16x32_bf16 v[80:83], v[188:191], v[168:171], v[80:83]
    ds_read_b64_tr_b16 v[150:151], v205 offset:18432
    v_mfma_f32_16x16x32_bf16 v[76:79], v[188:191], v[164:167], v[76:79]
    ds_read_b64_tr_b16 v[152:153], v204 offset:24576
    v_mfma_f32_16x16x32_bf16 v[72:75], v[188:191], v[160:163], v[72:75]
    ds_read_b64_tr_b16 v[154:155], v204 offset:26624
    v_mfma_f32_16x16x32_bf16 v[88:91], v[160:163], v[192:195], v[88:91]
    ds_read_b64_tr_b16 v[156:157], v205 offset:24576
    v_mfma_f32_16x16x32_bf16 v[92:95], v[164:167], v[192:195], v[92:95]
    ds_read_b64_tr_b16 v[158:159], v205 offset:26624
    v_mfma_f32_16x16x32_bf16 v[96:99], v[168:171], v[192:195], v[96:99]
    v_mfma_f32_16x16x32_bf16 v[100:103], v[172:175], v[192:195], v[100:103]
    v_mfma_f32_16x16x32_bf16 v[116:119], v[172:175], v[196:199], v[116:119]
    v_mfma_f32_16x16x32_bf16 v[112:115], v[168:171], v[196:199], v[112:115]
    v_mfma_f32_16x16x32_bf16 v[108:111], v[164:167], v[196:199], v[108:111]
    v_mfma_f32_16x16x32_bf16 v[104:107], v[160:163], v[196:199], v[104:107]
    s_waitcnt lgkmcnt(0)
    v_mfma_f32_16x16x32_bf16 v[24:27], v[136:139], v[120:123], v[24:27]
    ds_read_b128 v[160:163], v201 offset:16384
    v_mfma_f32_16x16x32_bf16 v[28:31], v[136:139], v[124:127], v[28:31]
    ds_read_b64_tr_b16 v[176:177], v202 offset:28672
    v_mfma_f32_16x16x32_bf16 v[32:35], v[136:139], v[128:131], v[32:35]
    ds_read_b64_tr_b16 v[178:179], v202 offset:30720
    v_mfma_f32_16x16x32_bf16 v[36:39], v[136:139], v[132:135], v[36:39]
    ds_read_b128 v[164:167], v201 offset:18432
    v_mfma_f32_16x16x32_bf16 v[52:55], v[140:143], v[132:135], v[52:55]
    ds_read_b128 v[168:171], v201 offset:20480
    v_mfma_f32_16x16x32_bf16 v[48:51], v[140:143], v[128:131], v[48:51]
    ds_read_b128 v[172:175], v201 offset:22528
    v_mfma_f32_16x16x32_bf16 v[44:47], v[140:143], v[124:127], v[44:47]
    ds_read_b64_tr_b16 v[180:181], v203 offset:28672
    v_mfma_f32_16x16x32_bf16 v[40:43], v[140:143], v[120:123], v[40:43]
    ds_read_b64_tr_b16 v[182:183], v203 offset:30720
    v_mfma_f32_16x16x32_bf16 v[56:59], v[144:147], v[120:123], v[56:59]
    ds_read_b64_tr_b16 v[184:185], v204 offset:20480
    v_mfma_f32_16x16x32_bf16 v[60:63], v[144:147], v[124:127], v[60:63]
    ds_read_b64_tr_b16 v[186:187], v204 offset:22528
    v_mfma_f32_16x16x32_bf16 v[64:67], v[144:147], v[128:131], v[64:67]
    ds_read_b64_tr_b16 v[188:189], v205 offset:20480
    v_mfma_f32_16x16x32_bf16 v[68:71], v[144:147], v[132:135], v[68:71]
    ds_read_b64_tr_b16 v[190:191], v205 offset:22528
    v_mfma_f32_16x16x32_bf16 v[84:87], v[148:151], v[132:135], v[84:87]
    ds_read_b64_tr_b16 v[192:193], v204 offset:28672
    v_mfma_f32_16x16x32_bf16 v[80:83], v[148:151], v[128:131], v[80:83]
    ds_read_b64_tr_b16 v[194:195], v204 offset:30720
    v_mfma_f32_16x16x32_bf16 v[76:79], v[148:151], v[124:127], v[76:79]
    ds_read_b64_tr_b16 v[196:197], v205 offset:28672
    v_mfma_f32_16x16x32_bf16 v[72:75], v[148:151], v[120:123], v[72:75]
    ds_read_b64_tr_b16 v[198:199], v205 offset:30720
    v_mfma_f32_16x16x32_bf16 v[88:91], v[120:123], v[152:155], v[88:91]
    v_mfma_f32_16x16x32_bf16 v[92:95], v[124:127], v[152:155], v[92:95]
    v_mfma_f32_16x16x32_bf16 v[96:99], v[128:131], v[152:155], v[96:99]
    v_mfma_f32_16x16x32_bf16 v[100:103], v[132:135], v[152:155], v[100:103]
    v_mfma_f32_16x16x32_bf16 v[116:119], v[132:135], v[156:159], v[116:119]
    v_mfma_f32_16x16x32_bf16 v[112:115], v[128:131], v[156:159], v[112:115]
    v_mfma_f32_16x16x32_bf16 v[108:111], v[124:127], v[156:159], v[108:111]
    v_mfma_f32_16x16x32_bf16 v[104:107], v[120:123], v[156:159], v[104:107]
    s_waitcnt lgkmcnt(0)
    v_mfma_f32_16x16x32_bf16 v[24:27], v[176:179], v[160:163], v[24:27]
    v_mfma_f32_16x16x32_bf16 v[28:31], v[176:179], v[164:167], v[28:31]
    s_waitcnt vmcnt(0)
    s_barrier
    v_mfma_f32_16x16x32_bf16 v[32:35], v[176:179], v[168:171], v[32:35]
    ds_read_b128 v[120:123], v200 offset:32768
    v_mfma_f32_16x16x32_bf16 v[36:39], v[176:179], v[172:175], v[36:39]
    ds_read_b64_tr_b16 v[136:137], v202 offset:32768
    v_mfma_f32_16x16x32_bf16 v[52:55], v[180:183], v[172:175], v[52:55]
    ds_read_b64_tr_b16 v[138:139], v202 offset:34816
    v_mfma_f32_16x16x32_bf16 v[48:51], v[180:183], v[168:171], v[48:51]
    ds_read_b128 v[124:127], v200 offset:34816
    v_mfma_f32_16x16x32_bf16 v[44:47], v[180:183], v[164:167], v[44:47]
    ds_read_b128 v[128:131], v200 offset:36864
    v_mfma_f32_16x16x32_bf16 v[40:43], v[180:183], v[160:163], v[40:43]
    ds_read_b128 v[132:135], v200 offset:38912
    v_mfma_f32_16x16x32_bf16 v[56:59], v[184:187], v[160:163], v[56:59]
    ds_read_b64_tr_b16 v[140:141], v203 offset:32768
    v_mfma_f32_16x16x32_bf16 v[60:63], v[184:187], v[164:167], v[60:63]
    ds_read_b64_tr_b16 v[142:143], v203 offset:34816
    v_mfma_f32_16x16x32_bf16 v[64:67], v[184:187], v[168:171], v[64:67]
    ds_read_b64_tr_b16 v[144:145], v202 offset:0
    v_mfma_f32_16x16x32_bf16 v[68:71], v[184:187], v[172:175], v[68:71]
    ds_read_b64_tr_b16 v[146:147], v202 offset:2048
    v_mfma_f32_16x16x32_bf16 v[84:87], v[188:191], v[172:175], v[84:87]
    ds_read_b64_tr_b16 v[148:149], v203 offset:0
    v_mfma_f32_16x16x32_bf16 v[80:83], v[188:191], v[168:171], v[80:83]
    ds_read_b64_tr_b16 v[150:151], v203 offset:2048
    v_mfma_f32_16x16x32_bf16 v[76:79], v[188:191], v[164:167], v[76:79]
    ds_read_b64_tr_b16 v[152:153], v202 offset:8192
    v_mfma_f32_16x16x32_bf16 v[72:75], v[188:191], v[160:163], v[72:75]
    ds_read_b64_tr_b16 v[154:155], v202 offset:10240
    v_mfma_f32_16x16x32_bf16 v[88:91], v[160:163], v[192:195], v[88:91]
    ds_read_b64_tr_b16 v[156:157], v203 offset:8192
    v_mfma_f32_16x16x32_bf16 v[92:95], v[164:167], v[192:195], v[92:95]
    ds_read_b64_tr_b16 v[158:159], v203 offset:10240
    v_mfma_f32_16x16x32_bf16 v[96:99], v[168:171], v[192:195], v[96:99]
    v_mfma_f32_16x16x32_bf16 v[100:103], v[172:175], v[192:195], v[100:103]
    v_mfma_f32_16x16x32_bf16 v[116:119], v[172:175], v[196:199], v[116:119]
    v_mfma_f32_16x16x32_bf16 v[112:115], v[168:171], v[196:199], v[112:115]
    v_mfma_f32_16x16x32_bf16 v[108:111], v[164:167], v[196:199], v[108:111]
    v_mfma_f32_16x16x32_bf16 v[104:107], v[160:163], v[196:199], v[104:107]
    s_waitcnt lgkmcnt(0)
    v_mfma_f32_16x16x32_bf16 v[24:27], v[136:139], v[120:123], v[24:27]
    ds_read_b128 v[160:163], v201 offset:32768
    v_mfma_f32_16x16x32_bf16 v[28:31], v[136:139], v[124:127], v[28:31]
    ds_read_b64_tr_b16 v[176:177], v202 offset:36864
    v_mfma_f32_16x16x32_bf16 v[32:35], v[136:139], v[128:131], v[32:35]
    ds_read_b64_tr_b16 v[178:179], v202 offset:38912
    v_mfma_f32_16x16x32_bf16 v[36:39], v[136:139], v[132:135], v[36:39]
    ds_read_b128 v[164:167], v201 offset:34816
    v_mfma_f32_16x16x32_bf16 v[52:55], v[140:143], v[132:135], v[52:55]
    ds_read_b128 v[168:171], v201 offset:36864
    v_mfma_f32_16x16x32_bf16 v[48:51], v[140:143], v[128:131], v[48:51]
    ds_read_b128 v[172:175], v201 offset:38912
    v_mfma_f32_16x16x32_bf16 v[44:47], v[140:143], v[124:127], v[44:47]
    ds_read_b64_tr_b16 v[180:181], v203 offset:36864
    v_mfma_f32_16x16x32_bf16 v[40:43], v[140:143], v[120:123], v[40:43]
    ds_read_b64_tr_b16 v[182:183], v203 offset:38912
    v_mfma_f32_16x16x32_bf16 v[56:59], v[144:147], v[120:123], v[56:59]
    ds_read_b64_tr_b16 v[184:185], v202 offset:4096
    v_mfma_f32_16x16x32_bf16 v[60:63], v[144:147], v[124:127], v[60:63]
    ds_read_b64_tr_b16 v[186:187], v202 offset:6144
    v_mfma_f32_16x16x32_bf16 v[64:67], v[144:147], v[128:131], v[64:67]
    ds_read_b64_tr_b16 v[188:189], v203 offset:4096
    v_mfma_f32_16x16x32_bf16 v[68:71], v[144:147], v[132:135], v[68:71]
    ds_read_b64_tr_b16 v[190:191], v203 offset:6144
    v_mfma_f32_16x16x32_bf16 v[84:87], v[148:151], v[132:135], v[84:87]
    ds_read_b64_tr_b16 v[192:193], v202 offset:12288
    v_mfma_f32_16x16x32_bf16 v[80:83], v[148:151], v[128:131], v[80:83]
    ds_read_b64_tr_b16 v[194:195], v202 offset:14336
    v_mfma_f32_16x16x32_bf16 v[76:79], v[148:151], v[124:127], v[76:79]
    ds_read_b64_tr_b16 v[196:197], v203 offset:12288
    v_mfma_f32_16x16x32_bf16 v[72:75], v[148:151], v[120:123], v[72:75]
    ds_read_b64_tr_b16 v[198:199], v203 offset:14336
    v_mfma_f32_16x16x32_bf16 v[88:91], v[120:123], v[152:155], v[88:91]
    v_mfma_f32_16x16x32_bf16 v[92:95], v[124:127], v[152:155], v[92:95]
    v_mfma_f32_16x16x32_bf16 v[96:99], v[128:131], v[152:155], v[96:99]
    v_mfma_f32_16x16x32_bf16 v[100:103], v[132:135], v[152:155], v[100:103]
    v_mfma_f32_16x16x32_bf16 v[116:119], v[132:135], v[156:159], v[116:119]
    v_mfma_f32_16x16x32_bf16 v[112:115], v[128:131], v[156:159], v[112:115]
    v_mfma_f32_16x16x32_bf16 v[108:111], v[124:127], v[156:159], v[108:111]
    v_mfma_f32_16x16x32_bf16 v[104:107], v[120:123], v[156:159], v[104:107]
    s_waitcnt lgkmcnt(0)
    v_mfma_f32_16x16x32_bf16 v[24:27], v[176:179], v[160:163], v[24:27]
    v_mfma_f32_16x16x32_bf16 v[28:31], v[176:179], v[164:167], v[28:31]
    s_barrier
    v_mfma_f32_16x16x32_bf16 v[32:35], v[176:179], v[168:171], v[32:35]
    ds_read_b128 v[120:123], v200 offset:0
    v_mfma_f32_16x16x32_bf16 v[36:39], v[176:179], v[172:175], v[36:39]
    ds_read_b64_tr_b16 v[136:137], v202 offset:16384
    v_mfma_f32_16x16x32_bf16 v[52:55], v[180:183], v[172:175], v[52:55]
    ds_read_b64_tr_b16 v[138:139], v202 offset:18432
    v_mfma_f32_16x16x32_bf16 v[48:51], v[180:183], v[168:171], v[48:51]
    ds_read_b128 v[124:127], v200 offset:2048
    v_mfma_f32_16x16x32_bf16 v[44:47], v[180:183], v[164:167], v[44:47]
    ds_read_b128 v[128:131], v200 offset:4096
    v_mfma_f32_16x16x32_bf16 v[40:43], v[180:183], v[160:163], v[40:43]
    ds_read_b128 v[132:135], v200 offset:6144
    v_mfma_f32_16x16x32_bf16 v[56:59], v[184:187], v[160:163], v[56:59]
    ds_read_b64_tr_b16 v[140:141], v203 offset:16384
    v_mfma_f32_16x16x32_bf16 v[60:63], v[184:187], v[164:167], v[60:63]
    ds_read_b64_tr_b16 v[142:143], v203 offset:18432
    v_mfma_f32_16x16x32_bf16 v[64:67], v[184:187], v[168:171], v[64:67]
    ds_read_b64_tr_b16 v[144:145], v204 offset:0
    v_mfma_f32_16x16x32_bf16 v[68:71], v[184:187], v[172:175], v[68:71]
    ds_read_b64_tr_b16 v[146:147], v204 offset:2048
    v_mfma_f32_16x16x32_bf16 v[84:87], v[188:191], v[172:175], v[84:87]
    ds_read_b64_tr_b16 v[148:149], v205 offset:0
    v_mfma_f32_16x16x32_bf16 v[80:83], v[188:191], v[168:171], v[80:83]
    ds_read_b64_tr_b16 v[150:151], v205 offset:2048
    v_mfma_f32_16x16x32_bf16 v[76:79], v[188:191], v[164:167], v[76:79]
    ds_read_b64_tr_b16 v[152:153], v204 offset:8192
    v_mfma_f32_16x16x32_bf16 v[72:75], v[188:191], v[160:163], v[72:75]
    ds_read_b64_tr_b16 v[154:155], v204 offset:10240
    v_mfma_f32_16x16x32_bf16 v[88:91], v[160:163], v[192:195], v[88:91]
    ds_read_b64_tr_b16 v[156:157], v205 offset:8192
    v_mfma_f32_16x16x32_bf16 v[92:95], v[164:167], v[192:195], v[92:95]
    ds_read_b64_tr_b16 v[158:159], v205 offset:10240
    v_mfma_f32_16x16x32_bf16 v[96:99], v[168:171], v[192:195], v[96:99]
    s_add_u32 s96, s96, 3
    v_mfma_f32_16x16x32_bf16 v[100:103], v[172:175], v[192:195], v[100:103]
    s_cmp_lt_u32 s96, 12
    v_mfma_f32_16x16x32_bf16 v[116:119], v[172:175], v[196:199], v[116:119]
    v_mfma_f32_16x16x32_bf16 v[112:115], v[168:171], v[196:199], v[112:115]
    v_mfma_f32_16x16x32_bf16 v[108:111], v[164:167], v[196:199], v[108:111]
    v_mfma_f32_16x16x32_bf16 v[104:107], v[160:163], v[196:199], v[104:107]
    s_cbranch_scc1 L_cloop
    s_bitcmp1_b32 s22, 0
    s_cbranch_scc1 L_ctailB
    s_waitcnt lgkmcnt(0)
    v_mfma_f32_16x16x32_bf16 v[24:27], v[136:139], v[120:123], v[24:27]
    ds_read_b128 v[160:163], v201 offset:0
    v_mfma_f32_16x16x32_bf16 v[28:31], v[136:139], v[124:127], v[28:31]
    ds_read_b64_tr_b16 v[184:185], v204 offset:4096
    v_mfma_f32_16x16x32_bf16 v[32:35], v[136:139], v[128:131], v[32:35]
    ds_read_b64_tr_b16 v[186:187], v204 offset:6144
    v_mfma_f32_16x16x32_bf16 v[36:39], v[136:139], v[132:135], v[36:39]
    ds_read_b128 v[164:167], v201 offset:2048
    v_mfma_f32_16x16x32_bf16 v[52:55], v[140:143], v[132:135], v[52:55]
    ds_read_b128 v[168:171], v201 offset:4096
    v_mfma_f32_16x16x32_bf16 v[48:51], v[140:143], v[128:131], v[48:51]
    ds_read_b128 v[172:175], v201 offset:6144
    v_mfma_f32_16x16x32_bf16 v[44:47], v[140:143], v[124:127], v[44:47]
    ds_read_b64_tr_b16 v[188:189], v205 offset:4096
    v_mfma_f32_16x16x32_bf16 v[40:43], v[140:143], v[120:123], v[40:43]
    ds_read_b64_tr_b16 v[190:191], v205 offset:6144
    v_mfma_f32_16x16x32_bf16 v[56:59], v[144:147], v[120:123], v[56:59]
    ds_read_b64_tr_b16 v[192:193], v204 offset:12288
    v_mfma_f32_16x16x32_bf16 v[60:63], v[144:147], v[124:127], v[60:63]
    ds_read_b64_tr_b16 v[194:195], v204 offset:14336
    v_mfma_f32_16x16x32_bf16 v[64:67], v[144:147], v[128:131], v[64:67]
    ds_read_b64_tr_b16 v[196:197], v205 offset:12288
    v_mfma_f32_16x16x32_bf16 v[68:71], v[144:147], v[132:135], v[68:71]
    ds_read_b64_tr_b16 v[198:199], v205 offset:14336
    v_mfma_f32_16x16x32_bf16 v[84:87], v[148:151], v[132:135], v[84:87]
    v_and_b32 v224, 15, v1
    v_lshrrev_b32 v225, 4, v1
    v_mfma_f32_16x16x32_bf16 v[80:83], v[148:151], v[128:131], v[80:83]
    v_lshlrev_b32 v225, 2, v225
    v_sub_u32 v224, v224, v225
    v_mfma_f32_16x16x32_bf16 v[76:79], v[148:151], v[124:127], v[76:79]
    s_cmp_lt_u32 s20, 2
    s_cselect_b32 s27, 0, -1
    v_mfma_f32_16x16x32_bf16 v[72:75], v[148:151], v[120:123], v[72:75]
    v_subrev_u32 v216, 0, v224
    v_subrev_u32 v217, 1, v224
    v_mfma_f32_16x16x32_bf16 v[88:91], v[120:123], v[152:155], v[88:91]
    v_subrev_u32 v218, 2, v224
    v_subrev_u32 v219, 3, v224
    v_mfma_f32_16x16x32_bf16 v[92:95], v[124:127], v[152:155], v[92:95]
    v_ashrrev_i32 v216, 31, v216
    v_ashrrev_i32 v217, 31, v217
    v_mfma_f32_16x16x32_bf16 v[96:99], v[128:131], v[152:155], v[96:99]
    v_ashrrev_i32 v218, 31, v218
    v_ashrrev_i32 v219, 31, v219
    v_mfma_f32_16x16x32_bf16 v[100:103], v[132:135], v[152:155], v[100:103]
    v_and_b32 v216, 4048155338, v216
    v_and_b32 v217, 4048155338, v217
    v_mfma_f32_16x16x32_bf16 v[116:119], v[132:135], v[156:159], v[116:119]
    v_and_b32 v218, 4048155338, v218
    v_and_b32 v219, 4048155338, v219
    v_mfma_f32_16x16x32_bf16 v[112:115], v[128:131], v[156:159], v[112:115]
    v_and_b32 v220, s27, v216
    v_and_b32 v221, s27, v217
    v_mfma_f32_16x16x32_bf16 v[108:111], v[124:127], v[156:159], v[108:111]
    v_and_b32 v222, s27, v218
    v_and_b32 v223, s27, v219
    v_mfma_f32_16x16x32_bf16 v[104:107], v[120:123], v[156:159], v[104:107]
    v_xor_b32 v220, 4048155338, v220
    v_xor_b32 v221, 4048155338, v221
    s_waitcnt lgkmcnt(0)
    s_barrier
    v_mfma_f32_16x16x32_bf16 v[56:59], v[184:187], v[160:163], v[56:59]
    ds_read_b128 v[120:123], v200 offset:16384
    v_mfma_f32_16x16x32_bf16 v[60:63], v[184:187], v[164:167], v[60:63]
    ds_read_b64_tr_b16 v[144:145], v204 offset:16384
    v_mfma_f32_16x16x32_bf16 v[64:67], v[184:187], v[168:171], v[64:67]
    ds_read_b64_tr_b16 v[146:147], v204 offset:18432
    v_mfma_f32_16x16x32_bf16 v[68:71], v[184:187], v[172:175], v[68:71]
    ds_read_b128 v[124:127], v200 offset:18432
    v_mfma_f32_16x16x32_bf16 v[84:87], v[188:191], v[172:175], v[84:87]
    ds_read_b128 v[128:131], v200 offset:20480
    v_mfma_f32_16x16x32_bf16 v[80:83], v[188:191], v[168:171], v[80:83]
    ds_read_b128 v[132:135], v200 offset:22528
    v_mfma_f32_16x16x32_bf16 v[76:79], v[188:191], v[164:167], v[76:79]
    ds_read_b64_tr_b16 v[148:149], v205 offset:16384
    v_mfma_f32_16x16x32_bf16 v[72:75], v[188:191], v[160:163], v[72:75]
    ds_read_b64_tr_b16 v[150:151], v205 offset:18432
    v_mfma_f32_16x16x32_bf16 v[88:91], v[160:163], v[192:195], v[88:91]
    ds_read_b64_tr_b16 v[152:153], v204 offset:24576
    v_mfma_f32_16x16x32_bf16 v[92:95], v[164:167], v[192:195], v[92:95]
    ds_read_b64_tr_b16 v[154:155], v204 offset:26624
    v_mfma_f32_16x16x32_bf16 v[96:99], v[168:171], v[192:195], v[96:99]
    ds_read_b64_tr_b16 v[156:157], v205 offset:24576
    v_mfma_f32_16x16x32_bf16 v[100:103], v[172:175], v[192:195], v[100:103]
    ds_read_b64_tr_b16 v[158:159], v205 offset:26624
    v_mfma_f32_16x16x32_bf16 v[116:119], v[172:175], v[196:199], v[116:119]
    v_xor_b32 v222, 4048155338, v222
    v_xor_b32 v223, 4048155338, v223
    v_mfma_f32_16x16x32_bf16 v[112:115], v[168:171], v[196:199], v[112:115]
    v_mov_b32 v224, 0
    v_mov_b32 v225, 0
    v_mfma_f32_16x16x32_bf16 v[108:111], v[164:167], v[196:199], v[108:111]
    v_mov_b32 v226, 0
    v_mov_b32 v227, 0
    v_mfma_f32_16x16x32_bf16 v[104:107], v[160:163], v[196:199], v[104:107]
    s_waitcnt lgkmcnt(1)
    v_mfma_f32_16x16x32_bf16 v[56:59], v[144:147], v[120:123], v[56:59]
    ds_read_b128 v[160:163], v201 offset:16384
    v_mfma_f32_16x16x32_bf16 v[60:63], v[144:147], v[124:127], v[60:63]
    ds_read_b64_tr_b16 v[184:185], v204 offset:20480
    v_mfma_f32_16x16x32_bf16 v[64:67], v[144:147], v[128:131], v[64:67]
    ds_read_b64_tr_b16 v[186:187], v204 offset:22528
    v_mfma_f32_16x16x32_bf16 v[68:71], v[144:147], v[132:135], v[68:71]
    ds_read_b128 v[164:167], v201 offset:18432
    v_mfma_f32_16x16x32_bf16 v[84:87], v[148:151], v[132:135], v[84:87]
    ds_read_b128 v[168:171], v201 offset:20480
    v_mfma_f32_16x16x32_bf16 v[80:83], v[148:151], v[128:131], v[80:83]
    ds_read_b128 v[172:175], v201 offset:22528
    v_mfma_f32_16x16x32_bf16 v[76:79], v[148:151], v[124:127], v[76:79]
    ds_read_b64_tr_b16 v[188:189], v205 offset:20480
    v_mfma_f32_16x16x32_bf16 v[72:75], v[148:151], v[120:123], v[72:75]
    ds_read_b64_tr_b16 v[190:191], v205 offset:22528
    v_mfma_f32_16x16x32_bf16 v[88:91], v[120:123], v[152:155], v[88:91]
    ds_read_b64_tr_b16 v[192:193], v204 offset:28672
    v_mfma_f32_16x16x32_bf16 v[92:95], v[124:127], v[152:155], v[92:95]
    ds_read_b64_tr_b16 v[194:195], v204 offset:30720
    v_mfma_f32_16x16x32_bf16 v[96:99], v[128:131], v[152:155], v[96:99]
    ds_read_b64_tr_b16 v[196:197], v205 offset:28672
    v_mfma_f32_16x16x32_bf16 v[100:103], v[132:135], v[152:155], v[100:103]
    ds_read_b64_tr_b16 v[198:199], v205 offset:30720
    s_waitcnt lgkmcnt(5)
    v_mfma_f32_16x16x32_bf16 v[116:119], v[132:135], v[156:159], v[116:119]
    v_mfma_f32_16x16x32_bf16 v[112:115], v[128:131], v[156:159], v[112:115]
    v_mfma_f32_16x16x32_bf16 v[108:111], v[124:127], v[156:159], v[108:111]
    v_mfma_f32_16x16x32_bf16 v[104:107], v[120:123], v[156:159], v[104:107]
    s_waitcnt lgkmcnt(0)
    s_barrier
    v_mfma_f32_16x16x32_bf16 v[56:59], v[184:187], v[160:163], v[56:59]
    ds_read_b128 v[120:123], v200 offset:32768
    v_mfma_f32_16x16x32_bf16 v[60:63], v[184:187], v[164:167], v[60:63]
    ds_read_b64_tr_b16 v[144:145], v202 offset:0
    v_mfma_f32_16x16x32_bf16 v[64:67], v[184:187], v[168:171], v[64:67]
    ds_read_b64_tr_b16 v[146:147], v202 offset:2048
    v_mfma_f32_16x16x32_bf16 v[68:71], v[184:187], v[172:175], v[68:71]
    ds_read_b128 v[124:127], v200 offset:34816
    v_mfma_f32_16x16x32_bf16 v[84:87], v[188:191], v[172:175], v[84:87]
    ds_read_b128 v[128:131], v200 offset:36864
    v_mfma_f32_16x16x32_bf16 v[80:83], v[188:191], v[168:171], v[80:83]
    ds_read_b128 v[132:135], v200 offset:38912
    v_mfma_f32_16x16x32_bf16 v[76:79], v[188:191], v[164:167], v[76:79]
    ds_read_b64_tr_b16 v[148:149], v203 offset:0
    v_mfma_f32_16x16x32_bf16 v[72:75], v[188:191], v[160:163], v[72:75]
    ds_read_b64_tr_b16 v[150:151], v203 offset:2048
    v_mfma_f32_16x16x32_bf16 v[88:91], v[160:163], v[192:195], v[88:91]
    ds_read_b64_tr_b16 v[152:153], v202 offset:8192
    v_mfma_f32_16x16x32_bf16 v[92:95], v[164:167], v[192:195], v[92:95]
    ds_read_b64_tr_b16 v[154:155], v202 offset:10240
    v_mfma_f32_16x16x32_bf16 v[96:99], v[168:171], v[192:195], v[96:99]
    ds_read_b64_tr_b16 v[156:157], v203 offset:8192
    v_mfma_f32_16x16x32_bf16 v[100:103], v[172:175], v[192:195], v[100:103]
    ds_read_b64_tr_b16 v[158:159], v203 offset:10240
    v_mfma_f32_16x16x32_bf16 v[116:119], v[172:175], v[196:199], v[116:119]
    v_mfma_f32_16x16x32_bf16 v[112:115], v[168:171], v[196:199], v[112:115]
    v_mfma_f32_16x16x32_bf16 v[108:111], v[164:167], v[196:199], v[108:111]
    v_mfma_f32_16x16x32_bf16 v[104:107], v[160:163], v[196:199], v[104:107]
    s_waitcnt lgkmcnt(1)
    v_mfma_f32_16x16x32_bf16 v[56:59], v[144:147], v[120:123], v[56:59]
    ds_read_b128 v[160:163], v201 offset:32768
    v_mfma_f32_16x16x32_bf16 v[60:63], v[144:147], v[124:127], v[60:63]
    ds_read_b64_tr_b16 v[184:185], v202 offset:4096
    v_mfma_f32_16x16x32_bf16 v[64:67], v[144:147], v[128:131], v[64:67]
    ds_read_b64_tr_b16 v[186:187], v202 offset:6144
    v_mfma_f32_16x16x32_bf16 v[68:71], v[144:147], v[132:135], v[68:71]
    ds_read_b128 v[164:167], v201 offset:34816
    v_mfma_f32_16x16x32_bf16 v[84:87], v[148:151], v[132:135], v[84:87]
    ds_read_b128 v[168:171], v201 offset:36864
    v_mfma_f32_16x16x32_bf16 v[80:83], v[148:151], v[128:131], v[80:83]
    ds_read_b128 v[172:175], v201 offset:38912
    v_mfma_f32_16x16x32_bf16 v[76:79], v[148:151], v[124:127], v[76:79]
    ds_read_b64_tr_b16 v[188:189], v203 offset:4096
    v_mfma_f32_16x16x32_bf16 v[72:75], v[148:151], v[120:123], v[72:75]
    ds_read_b64_tr_b16 v[190:191], v203 offset:6144
    v_mfma_f32_16x16x32_bf16 v[88:91], v[120:123], v[152:155], v[88:91]
    ds_read_b64_tr_b16 v[192:193], v202 offset:12288
    v_mfma_f32_16x16x32_bf16 v[92:95], v[124:127], v[152:155], v[92:95]
    ds_read_b64_tr_b16 v[194:195], v202 offset:14336
    v_mfma_f32_16x16x32_bf16 v[96:99], v[128:131], v[152:155], v[96:99]
    ds_read_b64_tr_b16 v[196:197], v203 offset:12288
    v_mfma_f32_16x16x32_bf16 v[100:103], v[132:135], v[152:155], v[100:103]
    ds_read_b64_tr_b16 v[198:199], v203 offset:14336
    s_waitcnt lgkmcnt(5)
    v_mfma_f32_16x16x32_bf16 v[116:119], v[132:135], v[156:159], v[116:119]
    v_add_u32 v176, s48, v0
    v_mfma_f32_16x16x32_bf16 v[112:115], v[128:131], v[156:159], v[112:115]
    s_add_u32 s27, s63, 8192
    v_mfma_f32_16x16x32_bf16 v[108:111], v[124:127], v[156:159], v[108:111]
    v_mov_b32 v255, 92928
    v_mfma_f32_16x16x32_bf16 v[104:107], v[120:123], v[156:159], v[104:107]
    s_waitcnt lgkmcnt(0)
    s_barrier
    v_mfma_f32_16x16x32_bf16 v[56:59], v[184:187], v[160:163], v[56:59]
    ds_read_b32 v255, v255
    ds_read_b128 v[152:155], v209 offset:256
    v_mfma_f32_16x16x32_bf16 v[60:63], v[184:187], v[164:167], v[60:63]
    ds_read_b128 v[156:159], v209 offset:320
    ds_read_b64 v[236:237], v207 offset:1280
    v_mfma_f32_16x16x32_bf16 v[64:67], v[184:187], v[168:171], v[64:67]
    ds_read_b64 v[238:239], v207 offset:1408
    v_mfma_f32_16x16x32_bf16 v[68:71], v[184:187], v[172:175], v[68:71]
    ds_read_b64 v[232:233], v207 offset:1024
    ds_read_b64 v[234:235], v207 offset:1152
    v_mfma_f32_16x16x32_bf16 v[84:87], v[188:191], v[172:175], v[84:87]
    ds_read_b32 v248, v210 offset:512
    v_mfma_f32_16x16x32_bf16 v[80:83], v[188:191], v[168:171], v[80:83]
    ds_read_b32 v249, v210 offset:576
    ds_read_b128 v[128:131], v208 offset:256
    v_mfma_f32_16x16x32_bf16 v[76:79], v[188:191], v[164:167], v[76:79]
    ds_read_b128 v[144:147], v208 offset:384
    ds_read_b128 v[132:135], v208 offset:320
    v_mfma_f32_16x16x32_bf16 v[72:75], v[188:191], v[160:163], v[72:75]
    ds_read_b128 v[148:151], v208 offset:448
    v_mfma_f32_16x16x32_bf16 v[88:91], v[160:163], v[192:195], v[88:91]
    ds_read_b128 v[120:123], v208 offset:0
    ds_read_b128 v[136:139], v208 offset:128
    v_mfma_f32_16x16x32_bf16 v[92:95], v[164:167], v[192:195], v[92:95]
    ds_read_b128 v[124:127], v208 offset:64
    v_mfma_f32_16x16x32_bf16 v[96:99], v[168:171], v[192:195], v[96:99]
    ds_read_b128 v[140:143], v208 offset:192
    ds_read_b128 v[240:243], v209 offset:0
    v_mfma_f32_16x16x32_bf16 v[100:103], v[172:175], v[192:195], v[100:103]
    ds_read_b128 v[244:247], v209 offset:64
    v_mfma_f32_16x16x32_bf16 v[116:119], v[172:175], v[196:199], v[116:119]
    v_mfma_f32_16x16x32_bf16 v[112:115], v[168:171], v[196:199], v[112:115]
    v_mfma_f32_16x16x32_bf16 v[108:111], v[164:167], v[196:199], v[108:111]
    v_mfma_f32_16x16x32_bf16 v[104:107], v[160:163], v[196:199], v[104:107]
    v_mov_b32 v199, v176
    s_waitcnt lgkmcnt(1)
    v_readfirstlane_b32 s23, v255
    v_pk_mul_f32 v[250:251], v[236:237], v[152:153] op_sel:[1,0] op_sel_hi:[1,1]
    v_pk_fma_f32 v[250:251], v[64:65], v[236:237], v[250:251] op_sel_hi:[1,0,1]
    v_pk_mul_f32 v[252:253], v[236:237], v[154:155] op_sel:[1,0] op_sel_hi:[1,1]
    v_cvt_pk_bf16_f32 v64, v250, v251
    v_pk_fma_f32 v[252:253], v[66:67], v[236:237], v[252:253] op_sel_hi:[1,0,1]
    v_pk_mul_f32 v[254:255], v[236:237], v[156:157] op_sel:[1,0] op_sel_hi:[1,1]
    v_cvt_pk_bf16_f32 v65, v252, v253
    v_pk_fma_f32 v[254:255], v[80:81], v[236:237], v[254:255] op_sel_hi:[1,0,1]
    v_pk_mul_f32 v[250:251], v[236:237], v[158:159] op_sel:[1,0] op_sel_hi:[1,1]
    v_cvt_pk_bf16_f32 v66, v254, v255
    v_pk_fma_f32 v[250:251], v[82:83], v[236:237], v[250:251] op_sel_hi:[1,0,1]
    v_pk_mul_f32 v[252:253], v[238:239], v[152:153] op_sel:[1,0] op_sel_hi:[1,1]
    v_cvt_pk_bf16_f32 v67, v250, v251
    v_pk_fma_f32 v[252:253], v[68:69], v[238:239], v[252:253] op_sel_hi:[1,0,1]
    v_pk_mul_f32 v[254:255], v[238:239], v[154:155] op_sel:[1,0] op_sel_hi:[1,1]
    buffer_store_dwordx4 v[64:67], v0, s[12:15], s27 offen offset:0 sc1
    ds_write_b128 v199, v[64:67] offset:8192
    v_cvt_pk_bf16_f32 v68, v252, v253
    v_pk_fma_f32 v[254:255], v[70:71], v[238:239], v[254:255] op_sel_hi:[1,0,1]
    v_pk_mul_f32 v[250:251], v[238:239], v[156:157] op_sel:[1,0] op_sel_hi:[1,1]
    v_cvt_pk_bf16_f32 v69, v254, v255
    v_pk_fma_f32 v[250:251], v[84:85], v[238:239], v[250:251] op_sel_hi:[1,0,1]
    v_pk_mul_f32 v[252:253], v[238:239], v[158:159] op_sel:[1,0] op_sel_hi:[1,1]
    v_cvt_pk_bf16_f32 v70, v250, v251
    v_pk_fma_f32 v[252:253], v[86:87], v[238:239], v[252:253] op_sel_hi:[1,0,1]
    v_pk_mul_f32 v[254:255], v[144:145], v[248:249] op_sel_hi:[1,0]
    v_cvt_pk_bf16_f32 v71, v252, v253
    v_pk_fma_f32 v[254:255], v[96:97], v[128:129], v[254:255]
    v_pk_mul_f32 v[250:251], v[146:147], v[248:249] op_sel_hi:[1,0]
    buffer_store_dwordx4 v[68:71], v0, s[12:15], s27 offen offset:1024 sc1
    ds_write_b128 v199, v[68:71] offset:9216
    v_cvt_pk_bf16_f32 v96, v254, v255
    v_pk_fma_f32 v[250:251], v[98:99], v[130:131], v[250:251]
    v_pk_mul_f32 v[252:253], v[148:149], v[248:249] op_sel_hi:[1,0]
    v_cvt_pk_bf16_f32 v97, v250, v251
    v_pk_fma_f32 v[252:253], v[100:101], v[132:133], v[252:253]
    v_pk_mul_f32 v[254:255], v[150:151], v[248:249] op_sel_hi:[1,0]
    v_cvt_pk_bf16_f32 v98, v252, v253
    v_pk_fma_f32 v[254:255], v[102:103], v[134:135], v[254:255]
    v_pk_mul_f32 v[250:251], v[248:249], v[144:145] op_sel:[1,0] op_sel_hi:[1,1]
    v_cvt_pk_bf16_f32 v99, v254, v255
    v_pk_fma_f32 v[250:251], v[112:113], v[128:129], v[250:251]
    v_pk_mul_f32 v[252:253], v[248:249], v[146:147] op_sel:[1,0] op_sel_hi:[1,1]
    buffer_store_dwordx4 v[96:99], v0, s[12:15], s27 offen offset:2048 sc1
    ds_write_b128 v199, v[96:99] offset:10240
    v_cvt_pk_bf16_f32 v112, v250, v251
    v_pk_fma_f32 v[252:253], v[114:115], v[130:131], v[252:253]
    v_pk_mul_f32 v[254:255], v[248:249], v[148:149] op_sel:[1,0] op_sel_hi:[1,1]
    v_cvt_pk_bf16_f32 v113, v252, v253
    v_pk_fma_f32 v[254:255], v[116:117], v[132:133], v[254:255]
    v_pk_mul_f32 v[250:251], v[248:249], v[150:151] op_sel:[1,0] op_sel_hi:[1,1]
    v_cvt_pk_bf16_f32 v114, v254, v255
    v_pk_fma_f32 v[250:251], v[118:119], v[134:135], v[250:251]
    v_pk_mul_f32 v[252:253], v[232:233], v[152:153] op_sel:[1,0] op_sel_hi:[1,1]
    v_cvt_pk_bf16_f32 v115, v250, v251
    v_pk_fma_f32 v[252:253], v[56:57], v[232:233], v[252:253] op_sel_hi:[1,0,1]
    v_pk_mul_f32 v[254:255], v[232:233], v[154:155] op_sel:[1,0] op_sel_hi:[1,1]
    buffer_store_dwordx4 v[112:115], v0, s[12:15], s27 offen offset:3072 sc1
    ds_write_b128 v199, v[112:115] offset:11264
    v_cvt_pk_bf16_f32 v56, v252, v253
    v_pk_fma_f32 v[254:255], v[58:59], v[232:233], v[254:255] op_sel_hi:[1,0,1]
    v_pk_mul_f32 v[250:251], v[232:233], v[156:157] op_sel:[1,0] op_sel_hi:[1,1]
    v_cvt_pk_bf16_f32 v57, v254, v255
    v_pk_fma_f32 v[250:251], v[72:73], v[232:233], v[250:251] op_sel_hi:[1,0,1]
    v_pk_mul_f32 v[252:253], v[232:233], v[158:159] op_sel:[1,0] op_sel_hi:[1,1]
    v_cvt_pk_bf16_f32 v58, v250, v251
    v_pk_fma_f32 v[252:253], v[74:75], v[232:233], v[252:253] op_sel_hi:[1,0,1]
    v_pk_mul_f32 v[254:255], v[234:235], v[152:153] op_sel:[1,0] op_sel_hi:[1,1]
    v_cvt_pk_bf16_f32 v59, v252, v253
    v_pk_fma_f32 v[254:255], v[60:61], v[234:235], v[254:255] op_sel_hi:[1,0,1]
    v_pk_mul_f32 v[250:251], v[234:235], v[154:155] op_sel:[1,0] op_sel_hi:[1,1]
    buffer_store_dwordx4 v[56:59], v0, s[12:15], s63 offen offset:0 sc1
    ds_write_b128 v199, v[56:59] offset:0
    v_cvt_pk_bf16_f32 v60, v254, v255
    v_pk_fma_f32 v[250:251], v[62:63], v[234:235], v[250:251] op_sel_hi:[1,0,1]
    v_pk_mul_f32 v[252:253], v[234:235], v[156:157] op_sel:[1,0] op_sel_hi:[1,1]
    v_cvt_pk_bf16_f32 v61, v250, v251
    v_pk_fma_f32 v[252:253], v[76:77], v[234:235], v[252:253] op_sel_hi:[1,0,1]
    v_pk_mul_f32 v[254:255], v[234:235], v[158:159] op_sel:[1,0] op_sel_hi:[1,1]
    v_cvt_pk_bf16_f32 v62, v252, v253
    v_pk_fma_f32 v[254:255], v[78:79], v[234:235], v[254:255] op_sel_hi:[1,0,1]
    v_pk_mul_f32 v[250:251], v[136:137], v[248:249] op_sel_hi:[1,0]
    v_cvt_pk_bf16_f32 v63, v254, v255
    v_pk_fma_f32 v[250:251], v[88:89], v[120:121], v[250:251]
    v_pk_mul_f32 v[252:253], v[138:139], v[248:249] op_sel_hi:[1,0]
    buffer_store_dwordx4 v[60:63], v0, s[12:15], s63 offen offset:1024 sc1
    ds_write_b128 v199, v[60:63] offset:1024
    ds_read_b128 v[160:163], v201 offset:0
    ds_read_b64_tr_b16 v[176:177], v202 offset:20480
    ds_read_b64_tr_b16 v[178:179], v202 offset:22528
    ds_read_b128 v[164:167], v201 offset:2048
    ds_read_b128 v[168:171], v201 offset:4096
    ds_read_b128 v[172:175], v201 offset:6144
    ds_read_b64_tr_b16 v[180:181], v203 offset:20480
    ds_read_b64_tr_b16 v[182:183], v203 offset:22528
    v_cvt_pk_bf16_f32 v88, v250, v251
    v_pk_fma_f32 v[252:253], v[90:91], v[122:123], v[252:253]
    v_pk_mul_f32 v[254:255], v[140:141], v[248:249] op_sel_hi:[1,0]
    v_cvt_pk_bf16_f32 v89, v252, v253
    v_pk_fma_f32 v[254:255], v[92:93], v[124:125], v[254:255]
    v_pk_mul_f32 v[250:251], v[142:143], v[248:249] op_sel_hi:[1,0]
    v_cvt_pk_bf16_f32 v90, v254, v255
    v_pk_fma_f32 v[250:251], v[94:95], v[126:127], v[250:251]
    v_pk_mul_f32 v[252:253], v[248:249], v[136:137] op_sel:[1,0] op_sel_hi:[1,1]
    v_cvt_pk_bf16_f32 v91, v250, v251
    v_pk_fma_f32 v[252:253], v[104:105], v[120:121], v[252:253]
    v_pk_mul_f32 v[254:255], v[248:249], v[138:139] op_sel:[1,0] op_sel_hi:[1,1]
    buffer_store_dwordx4 v[88:91], v0, s[12:15], s63 offen offset:2048 sc1
    ds_write_b128 v199, v[88:91] offset:2048
    v_cvt_pk_bf16_f32 v104, v252, v253
    v_pk_fma_f32 v[254:255], v[106:107], v[122:123], v[254:255]
    v_pk_mul_f32 v[250:251], v[248:249], v[140:141] op_sel:[1,0] op_sel_hi:[1,1]
    v_cvt_pk_bf16_f32 v105, v254, v255
    v_pk_fma_f32 v[250:251], v[108:109], v[124:125], v[250:251]
    v_pk_mul_f32 v[252:253], v[248:249], v[142:143] op_sel:[1,0] op_sel_hi:[1,1]
    v_cvt_pk_bf16_f32 v106, v250, v251
    v_pk_fma_f32 v[252:253], v[110:111], v[126:127], v[252:253]
    v_cvt_pk_bf16_f32 v107, v252, v253
    buffer_store_dwordx4 v[104:107], v0, s[12:15], s63 offen offset:3072 sc1
    ds_write_b128 v199, v[104:107] offset:3072
    s_waitcnt lgkmcnt(2)
    v_mfma_f32_16x16x32_bf16 v[24:27], v[176:179], v[160:163], v[24:27]
    ds_read_b128 v[120:123], v200 offset:16384
    v_mfma_f32_16x16x32_bf16 v[28:31], v[176:179], v[164:167], v[28:31]
    ds_read_b64_tr_b16 v[136:137], v202 offset:24576
    v_mfma_f32_16x16x32_bf16 v[32:35], v[176:179], v[168:171], v[32:35]
    ds_read_b64_tr_b16 v[138:139], v202 offset:26624
    v_mfma_f32_16x16x32_bf16 v[36:39], v[176:179], v[172:175], v[36:39]
    ds_read_b128 v[124:127], v200 offset:18432
    v_mfma_f32_16x16x32_bf16 v[52:55], v[180:183], v[172:175], v[52:55]
    ds_read_b128 v[128:131], v200 offset:20480
    v_mfma_f32_16x16x32_bf16 v[48:51], v[180:183], v[168:171], v[48:51]
    ds_read_b128 v[132:135], v200 offset:22528
    v_mfma_f32_16x16x32_bf16 v[44:47], v[180:183], v[164:167], v[44:47]
    ds_read_b64_tr_b16 v[140:141], v203 offset:24576
    v_mfma_f32_16x16x32_bf16 v[40:43], v[180:183], v[160:163], v[40:43]
    ds_read_b64_tr_b16 v[142:143], v203 offset:26624
    s_waitcnt lgkmcnt(5)
    v_mfma_f32_16x16x32_bf16 v[24:27], v[136:139], v[120:123], v[24:27]
    ds_read_b128 v[160:163], v201 offset:16384
    s_waitcnt lgkmcnt(5)
    v_mfma_f32_16x16x32_bf16 v[28:31], v[136:139], v[124:127], v[28:31]
    ds_read_b64_tr_b16 v[176:177], v202 offset:28672
    s_waitcnt lgkmcnt(5)
    v_mfma_f32_16x16x32_bf16 v[32:35], v[136:139], v[128:131], v[32:35]
    ds_read_b64_tr_b16 v[178:179], v202 offset:30720
    s_waitcnt lgkmcnt(5)
    v_mfma_f32_16x16x32_bf16 v[36:39], v[136:139], v[132:135], v[36:39]
    ds_read_b128 v[164:167], v201 offset:18432
    s_waitcnt lgkmcnt(4)
    v_mfma_f32_16x16x32_bf16 v[52:55], v[140:143], v[132:135], v[52:55]
    ds_read_b128 v[168:171], v201 offset:20480
    v_mfma_f32_16x16x32_bf16 v[48:51], v[140:143], v[128:131], v[48:51]
    ds_read_b128 v[172:175], v201 offset:22528
    v_mfma_f32_16x16x32_bf16 v[44:47], v[140:143], v[124:127], v[44:47]
    ds_read_b64_tr_b16 v[180:181], v203 offset:28672
    v_mfma_f32_16x16x32_bf16 v[40:43], v[140:143], v[120:123], v[40:43]
    ds_read_b64_tr_b16 v[182:183], v203 offset:30720
    s_waitcnt lgkmcnt(5)
    v_mfma_f32_16x16x32_bf16 v[24:27], v[176:179], v[160:163], v[24:27]
    ds_read_b128 v[120:123], v200 offset:32768
    s_waitcnt lgkmcnt(5)
    v_mfma_f32_16x16x32_bf16 v[28:31], v[176:179], v[164:167], v[28:31]
    ds_read_b64_tr_b16 v[136:137], v202 offset:32768
    s_waitcnt lgkmcnt(5)
    v_mfma_f32_16x16x32_bf16 v[32:35], v[176:179], v[168:171], v[32:35]
    ds_read_b64_tr_b16 v[138:139], v202 offset:34816
    s_waitcnt lgkmcnt(5)
    v_mfma_f32_16x16x32_bf16 v[36:39], v[176:179], v[172:175], v[36:39]
    ds_read_b128 v[124:127], v200 offset:34816
    s_waitcnt lgkmcnt(4)
    v_mfma_f32_16x16x32_bf16 v[52:55], v[180:183], v[172:175], v[52:55]
    ds_read_b128 v[128:131], v200 offset:36864
    v_mfma_f32_16x16x32_bf16 v[48:51], v[180:183], v[168:171], v[48:51]
    ds_read_b128 v[132:135], v200 offset:38912
    v_mfma_f32_16x16x32_bf16 v[44:47], v[180:183], v[164:167], v[44:47]
    ds_read_b64_tr_b16 v[140:141], v203 offset:32768
    v_mfma_f32_16x16x32_bf16 v[40:43], v[180:183], v[160:163], v[40:43]
    ds_read_b64_tr_b16 v[142:143], v203 offset:34816
    s_waitcnt lgkmcnt(5)
    v_mfma_f32_16x16x32_bf16 v[24:27], v[136:139], v[120:123], v[24:27]
    ds_read_b128 v[160:163], v201 offset:32768
    s_waitcnt lgkmcnt(5)
    v_mfma_f32_16x16x32_bf16 v[28:31], v[136:139], v[124:127], v[28:31]
    ds_read_b64_tr_b16 v[176:177], v202 offset:36864
    s_waitcnt lgkmcnt(5)
    v_mfma_f32_16x16x32_bf16 v[32:35], v[136:139], v[128:131], v[32:35]
    ds_read_b64_tr_b16 v[178:179], v202 offset:38912
    s_waitcnt lgkmcnt(5)
    v_mfma_f32_16x16x32_bf16 v[36:39], v[136:139], v[132:135], v[36:39]
    ds_read_b128 v[164:167], v201 offset:34816
    s_waitcnt lgkmcnt(4)
    v_mfma_f32_16x16x32_bf16 v[52:55], v[140:143], v[132:135], v[52:55]
    ds_read_b128 v[168:171], v201 offset:36864
    v_mfma_f32_16x16x32_bf16 v[48:51], v[140:143], v[128:131], v[48:51]
    ds_read_b128 v[172:175], v201 offset:38912
    v_mfma_f32_16x16x32_bf16 v[44:47], v[140:143], v[124:127], v[44:47]
    ds_read_b64_tr_b16 v[180:181], v203 offset:36864
    v_mfma_f32_16x16x32_bf16 v[40:43], v[140:143], v[120:123], v[40:43]
    ds_read_b64_tr_b16 v[182:183], v203 offset:38912
    s_waitcnt lgkmcnt(3)
    v_mfma_f32_16x16x32_bf16 v[32:35], v[176:179], v[168:171], v[32:35]
    v_mul_f32 v232, 1048744942, v232
    v_mul_f32 v233, 1048744942, v233
    s_waitcnt lgkmcnt(0)
    v_mfma_f32_16x16x32_bf16 v[48:51], v[180:183], v[168:171], v[48:51]
    v_mul_f32 v234, 1048744942, v234
    v_mul_f32 v235, 1048744942, v235
    v_mfma_f32_16x16x32_bf16 v[52:55], v[180:183], v[172:175], v[52:55]
    v_mul_f32 v236, 1048744942, v236
    v_mul_f32 v237, 1048744942, v237
    v_mfma_f32_16x16x32_bf16 v[36:39], v[176:179], v[172:175], v[36:39]
    v_mul_f32 v238, 1048744942, v238
    v_mul_f32 v239, 1048744942, v239
    v_mfma_f32_16x16x32_bf16 v[24:27], v[176:179], v[160:163], v[24:27]
    s_xor_b32 s27, s3, 2
    s_lshl_b32 s27, s27, 11
    v_mfma_f32_16x16x32_bf16 v[40:43], v[180:183], v[160:163], v[40:43]
    s_add_u32 s27, s27, 49152
    v_add_u32 v199, s27, v0
    v_mfma_f32_16x16x32_bf16 v[44:47], v[180:183], v[164:167], v[44:47]
    v_mfma_f32_16x16x32_bf16 v[28:31], v[176:179], v[164:167], v[28:31]
    v_add_u32 v128, s54, v0
    s_lshl_b32 s28, s3, 11
    s_add_u32 s28, s28, 40960
    v_add_u32 v130, s28, v0
    v_subrev_u32 v129, 32768, v128
    v_add_u32 v4, 15360, v3
    v_add_u32 v5, 30720, v3
    v_add_u32 v211, 46080, v3
    v_pk_mul_f32 v[250:251], v[236:237], v[240:241] op_sel:[1,0] op_sel_hi:[1,1]
    v_pk_fma_f32 v[250:251], v[32:33], v[236:237], v[250:251] op_sel_hi:[1,0,1]
    v_pk_mul_f32 v[252:253], v[236:237], v[242:243] op_sel:[1,0] op_sel_hi:[1,1]
    v_cvt_pk_bf16_f32 v32, v250, v251
    v_pk_fma_f32 v[252:253], v[34:35], v[236:237], v[252:253] op_sel_hi:[1,0,1]
    v_pk_mul_f32 v[254:255], v[236:237], v[244:245] op_sel:[1,0] op_sel_hi:[1,1]
    v_cvt_pk_bf16_f32 v33, v252, v253
    v_pk_fma_f32 v[254:255], v[48:49], v[236:237], v[254:255] op_sel_hi:[1,0,1]
    v_pk_mul_f32 v[250:251], v[236:237], v[246:247] op_sel:[1,0] op_sel_hi:[1,1]
    v_cvt_pk_bf16_f32 v34, v254, v255
    v_pk_fma_f32 v[250:251], v[50:51], v[236:237], v[250:251] op_sel_hi:[1,0,1]
    v_pk_mul_f32 v[252:253], v[238:239], v[240:241] op_sel:[1,0] op_sel_hi:[1,1]
    v_cvt_pk_bf16_f32 v35, v250, v251
    v_pk_fma_f32 v[252:253], v[36:37], v[238:239], v[252:253] op_sel_hi:[1,0,1]
    v_pk_mul_f32 v[254:255], v[238:239], v[242:243] op_sel:[1,0] op_sel_hi:[1,1]
    ds_write_b128 v199, v[32:35]
    v_cvt_pk_bf16_f32 v36, v252, v253
    v_pk_fma_f32 v[254:255], v[38:39], v[238:239], v[254:255] op_sel_hi:[1,0,1]
    v_pk_mul_f32 v[250:251], v[238:239], v[244:245] op_sel:[1,0] op_sel_hi:[1,1]
    v_cvt_pk_bf16_f32 v37, v254, v255
    v_pk_fma_f32 v[250:251], v[52:53], v[238:239], v[250:251] op_sel_hi:[1,0,1]
    v_pk_mul_f32 v[252:253], v[238:239], v[246:247] op_sel:[1,0] op_sel_hi:[1,1]
    v_cvt_pk_bf16_f32 v38, v250, v251
    v_pk_fma_f32 v[252:253], v[54:55], v[238:239], v[252:253] op_sel_hi:[1,0,1]
    v_pk_mul_f32 v[254:255], v[232:233], v[240:241] op_sel:[1,0] op_sel_hi:[1,1]
    v_cvt_pk_bf16_f32 v39, v252, v253
    v_pk_fma_f32 v[254:255], v[24:25], v[232:233], v[254:255] op_sel_hi:[1,0,1]
    v_pk_mul_f32 v[250:251], v[232:233], v[242:243] op_sel:[1,0] op_sel_hi:[1,1]
    ds_write_b128 v199, v[36:39] offset:1024
    v_cvt_pk_bf16_f32 v24, v254, v255
    v_pk_fma_f32 v[250:251], v[26:27], v[232:233], v[250:251] op_sel_hi:[1,0,1]
    v_pk_mul_f32 v[252:253], v[232:233], v[244:245] op_sel:[1,0] op_sel_hi:[1,1]
    v_cvt_pk_bf16_f32 v25, v250, v251
    v_pk_fma_f32 v[252:253], v[40:41], v[232:233], v[252:253] op_sel_hi:[1,0,1]
    v_pk_mul_f32 v[254:255], v[232:233], v[246:247] op_sel:[1,0] op_sel_hi:[1,1]
    v_cvt_pk_bf16_f32 v26, v252, v253
    v_pk_fma_f32 v[254:255], v[42:43], v[232:233], v[254:255] op_sel_hi:[1,0,1]
    v_pk_mul_f32 v[250:251], v[234:235], v[240:241] op_sel:[1,0] op_sel_hi:[1,1]
    v_cvt_pk_bf16_f32 v27, v254, v255
    v_pk_fma_f32 v[250:251], v[28:29], v[234:235], v[250:251] op_sel_hi:[1,0,1]
    v_pk_mul_f32 v[252:253], v[234:235], v[242:243] op_sel:[1,0] op_sel_hi:[1,1]
    v_cvt_pk_bf16_f32 v28, v250, v251
    v_pk_fma_f32 v[252:253], v[30:31], v[234:235], v[252:253] op_sel_hi:[1,0,1]
    v_pk_mul_f32 v[254:255], v[234:235], v[244:245] op_sel:[1,0] op_sel_hi:[1,1]
    v_cvt_pk_bf16_f32 v29, v252, v253
    v_pk_fma_f32 v[254:255], v[44:45], v[234:235], v[254:255] op_sel_hi:[1,0,1]
    v_pk_mul_f32 v[250:251], v[234:235], v[246:247] op_sel:[1,0] op_sel_hi:[1,1]
    v_cvt_pk_bf16_f32 v30, v254, v255
    v_pk_fma_f32 v[250:251], v[46:47], v[234:235], v[250:251] op_sel_hi:[1,0,1]
    v_cvt_pk_bf16_f32 v31, v250, v251
    s_lshl_b32 s28, s22, 4
    s_add_u32 s28, s28, s21
    s_lshl_b32 s28, s28, 4
    s_add_u32 s28, s28, s20
    s_lshl_b32 s28, s28, 4
    s_add_u32 s28, s28, s3
    s_lshl_b32 s28, s28, 3
    s_add_u32 s28, s28, 786432
    v_mov_b32 v184, s28
    s_waitcnt vmcnt(0)
    v_mov_b32 v186, s24
    v_mov_b32 v187, s25
    s_mov_b64 exec, 1
    buffer_store_dwordx2 v[186:187], v184, s[12:15], 0 offen sc1
    s_mov_b64 exec, -1
    s_branch L_attA
L_ctailB:
    s_waitcnt lgkmcnt(0)
    v_mfma_f32_16x16x32_bf16 v[24:27], v[136:139], v[120:123], v[24:27]
    ds_read_b128 v[160:163], v201 offset:0
    v_mfma_f32_16x16x32_bf16 v[28:31], v[136:139], v[124:127], v[28:31]
    ds_read_b64_tr_b16 v[176:177], v202 offset:20480
    v_mfma_f32_16x16x32_bf16 v[32:35], v[136:139], v[128:131], v[32:35]
    ds_read_b64_tr_b16 v[178:179], v202 offset:22528
    v_mfma_f32_16x16x32_bf16 v[36:39], v[136:139], v[132:135], v[36:39]
    ds_read_b128 v[164:167], v201 offset:2048
    v_mfma_f32_16x16x32_bf16 v[52:55], v[140:143], v[132:135], v[52:55]
    ds_read_b128 v[168:171], v201 offset:4096
    v_mfma_f32_16x16x32_bf16 v[48:51], v[140:143], v[128:131], v[48:51]
    ds_read_b128 v[172:175], v201 offset:6144
    v_mfma_f32_16x16x32_bf16 v[44:47], v[140:143], v[124:127], v[44:47]
    ds_read_b64_tr_b16 v[180:181], v203 offset:20480
    v_mfma_f32_16x16x32_bf16 v[40:43], v[140:143], v[120:123], v[40:43]
    ds_read_b64_tr_b16 v[182:183], v203 offset:22528
    v_mfma_f32_16x16x32_bf16 v[56:59], v[144:147], v[120:123], v[56:59]
    ds_read_b64_tr_b16 v[184:185], v204 offset:4096
    v_mfma_f32_16x16x32_bf16 v[60:63], v[144:147], v[124:127], v[60:63]
    ds_read_b64_tr_b16 v[186:187], v204 offset:6144
    v_mfma_f32_16x16x32_bf16 v[64:67], v[144:147], v[128:131], v[64:67]
    ds_read_b64_tr_b16 v[188:189], v205 offset:4096
    v_mfma_f32_16x16x32_bf16 v[68:71], v[144:147], v[132:135], v[68:71]
    ds_read_b64_tr_b16 v[190:191], v205 offset:6144
    v_mfma_f32_16x16x32_bf16 v[84:87], v[148:151], v[132:135], v[84:87]
    ds_read_b64_tr_b16 v[192:193], v204 offset:12288
    v_mfma_f32_16x16x32_bf16 v[80:83], v[148:151], v[128:131], v[80:83]
    ds_read_b64_tr_b16 v[194:195], v204 offset:14336
    v_mfma_f32_16x16x32_bf16 v[76:79], v[148:151], v[124:127], v[76:79]
    ds_read_b64_tr_b16 v[196:197], v205 offset:12288
    v_mfma_f32_16x16x32_bf16 v[72:75], v[148:151], v[120:123], v[72:75]
    ds_read_b64_tr_b16 v[198:199], v205 offset:14336
    v_mfma_f32_16x16x32_bf16 v[88:91], v[120:123], v[152:155], v[88:91]
    v_and_b32 v228, 15, v1
    v_lshrrev_b32 v229, 4, v1
    v_mfma_f32_16x16x32_bf16 v[92:95], v[124:127], v[152:155], v[92:95]
    v_lshlrev_b32 v229, 2, v229
    v_sub_u32 v228, v228, v229
    v_mfma_f32_16x16x32_bf16 v[96:99], v[128:131], v[152:155], v[96:99]
    v_subrev_u32 v224, 0, v228
    v_subrev_u32 v225, 1, v228
    v_mfma_f32_16x16x32_bf16 v[100:103], v[132:135], v[152:155], v[100:103]
    v_subrev_u32 v226, 2, v228
    v_subrev_u32 v227, 3, v228
    v_mfma_f32_16x16x32_bf16 v[116:119], v[132:135], v[156:159], v[116:119]
    v_lshlrev_b32 v220, 31, v224
    v_lshlrev_b32 v221, 31, v225
    v_mfma_f32_16x16x32_bf16 v[112:115], v[128:131], v[156:159], v[112:115]
    v_lshlrev_b32 v222, 31, v226
    v_lshlrev_b32 v223, 31, v227
    v_mfma_f32_16x16x32_bf16 v[108:111], v[124:127], v[156:159], v[108:111]
    v_or_b32 v216, v220, v224
    v_not_b32 v224, v224
    v_mfma_f32_16x16x32_bf16 v[104:107], v[120:123], v[156:159], v[104:107]
    v_or_b32 v217, v221, v225
    v_not_b32 v225, v225
    s_waitcnt lgkmcnt(0)
    v_mfma_f32_16x16x32_bf16 v[24:27], v[176:179], v[160:163], v[24:27]
    v_mfma_f32_16x16x32_bf16 v[28:31], v[176:179], v[164:167], v[28:31]
    s_barrier
    v_mfma_f32_16x16x32_bf16 v[32:35], v[176:179], v[168:171], v[32:35]
    ds_read_b128 v[120:123], v200 offset:16384
    v_mfma_f32_16x16x32_bf16 v[36:39], v[176:179], v[172:175], v[36:39]
    ds_read_b64_tr_b16 v[136:137], v202 offset:24576
    v_mfma_f32_16x16x32_bf16 v[52:55], v[180:183], v[172:175], v[52:55]
    ds_read_b64_tr_b16 v[138:139], v202 offset:26624
    v_mfma_f32_16x16x32_bf16 v[48:51], v[180:183], v[168:171], v[48:51]
    ds_read_b128 v[124:127], v200 offset:18432
    v_mfma_f32_16x16x32_bf16 v[44:47], v[180:183], v[164:167], v[44:47]
    ds_read_b128 v[128:131], v200 offset:20480
    v_mfma_f32_16x16x32_bf16 v[40:43], v[180:183], v[160:163], v[40:43]
    ds_read_b128 v[132:135], v200 offset:22528
    v_mfma_f32_16x16x32_bf16 v[56:59], v[184:187], v[160:163], v[56:59]
    ds_read_b64_tr_b16 v[140:141], v203 offset:24576
    v_mfma_f32_16x16x32_bf16 v[60:63], v[184:187], v[164:167], v[60:63]
    ds_read_b64_tr_b16 v[142:143], v203 offset:26624
    v_mfma_f32_16x16x32_bf16 v[64:67], v[184:187], v[168:171], v[64:67]
    ds_read_b64_tr_b16 v[144:145], v204 offset:16384
    v_mfma_f32_16x16x32_bf16 v[68:71], v[184:187], v[172:175], v[68:71]
    ds_read_b64_tr_b16 v[146:147], v204 offset:18432
    v_mfma_f32_16x16x32_bf16 v[84:87], v[188:191], v[172:175], v[84:87]
    ds_read_b64_tr_b16 v[148:149], v205 offset:16384
    v_mfma_f32_16x16x32_bf16 v[80:83], v[188:191], v[168:171], v[80:83]
    ds_read_b64_tr_b16 v[150:151], v205 offset:18432
    v_mfma_f32_16x16x32_bf16 v[76:79], v[188:191], v[164:167], v[76:79]
    ds_read_b64_tr_b16 v[152:153], v204 offset:24576
    v_mfma_f32_16x16x32_bf16 v[72:75], v[188:191], v[160:163], v[72:75]
    ds_read_b64_tr_b16 v[154:155], v204 offset:26624
    v_mfma_f32_16x16x32_bf16 v[88:91], v[160:163], v[192:195], v[88:91]
    ds_read_b64_tr_b16 v[156:157], v205 offset:24576
    v_mfma_f32_16x16x32_bf16 v[92:95], v[164:167], v[192:195], v[92:95]
    ds_read_b64_tr_b16 v[158:159], v205 offset:26624
    v_mfma_f32_16x16x32_bf16 v[96:99], v[168:171], v[192:195], v[96:99]
    v_or_b32 v218, v222, v226
    v_not_b32 v226, v226
    v_mfma_f32_16x16x32_bf16 v[100:103], v[172:175], v[192:195], v[100:103]
    v_or_b32 v219, v223, v227
    v_not_b32 v227, v227
    v_mfma_f32_16x16x32_bf16 v[116:119], v[172:175], v[196:199], v[116:119]
    v_or_b32 v220, v220, v224
    v_or_b32 v221, v221, v225
    v_mfma_f32_16x16x32_bf16 v[112:115], v[168:171], v[196:199], v[112:115]
    v_or_b32 v222, v222, v226
    v_or_b32 v223, v223, v227
    v_mfma_f32_16x16x32_bf16 v[108:111], v[164:167], v[196:199], v[108:111]
    v_ashrrev_i32 v216, 31, v216
    v_ashrrev_i32 v217, 31, v217
    v_mfma_f32_16x16x32_bf16 v[104:107], v[160:163], v[196:199], v[104:107]
    v_ashrrev_i32 v218, 31, v218
    v_ashrrev_i32 v219, 31, v219
    s_waitcnt lgkmcnt(0)
    v_mfma_f32_16x16x32_bf16 v[24:27], v[136:139], v[120:123], v[24:27]
    ds_read_b128 v[160:163], v201 offset:16384
    v_mfma_f32_16x16x32_bf16 v[28:31], v[136:139], v[124:127], v[28:31]
    ds_read_b64_tr_b16 v[176:177], v202 offset:28672
    v_mfma_f32_16x16x32_bf16 v[32:35], v[136:139], v[128:131], v[32:35]
    ds_read_b64_tr_b16 v[178:179], v202 offset:30720
    v_mfma_f32_16x16x32_bf16 v[36:39], v[136:139], v[132:135], v[36:39]
    ds_read_b128 v[164:167], v201 offset:18432
    v_mfma_f32_16x16x32_bf16 v[52:55], v[140:143], v[132:135], v[52:55]
    ds_read_b128 v[168:171], v201 offset:20480
    v_mfma_f32_16x16x32_bf16 v[48:51], v[140:143], v[128:131], v[48:51]
    ds_read_b128 v[172:175], v201 offset:22528
    v_mfma_f32_16x16x32_bf16 v[44:47], v[140:143], v[124:127], v[44:47]
    ds_read_b64_tr_b16 v[180:181], v203 offset:28672
    v_mfma_f32_16x16x32_bf16 v[40:43], v[140:143], v[120:123], v[40:43]
    ds_read_b64_tr_b16 v[182:183], v203 offset:30720
    v_mfma_f32_16x16x32_bf16 v[56:59], v[144:147], v[120:123], v[56:59]
    ds_read_b64_tr_b16 v[184:185], v204 offset:20480
    v_mfma_f32_16x16x32_bf16 v[60:63], v[144:147], v[124:127], v[60:63]
    ds_read_b64_tr_b16 v[186:187], v204 offset:22528
    v_mfma_f32_16x16x32_bf16 v[64:67], v[144:147], v[128:131], v[64:67]
    ds_read_b64_tr_b16 v[188:189], v205 offset:20480
    v_mfma_f32_16x16x32_bf16 v[68:71], v[144:147], v[132:135], v[68:71]
    ds_read_b64_tr_b16 v[190:191], v205 offset:22528
    v_mfma_f32_16x16x32_bf16 v[84:87], v[148:151], v[132:135], v[84:87]
    ds_read_b64_tr_b16 v[192:193], v204 offset:28672
    v_mfma_f32_16x16x32_bf16 v[80:83], v[148:151], v[128:131], v[80:83]
    ds_read_b64_tr_b16 v[194:195], v204 offset:30720
    v_mfma_f32_16x16x32_bf16 v[76:79], v[148:151], v[124:127], v[76:79]
    ds_read_b64_tr_b16 v[196:197], v205 offset:28672
    v_mfma_f32_16x16x32_bf16 v[72:75], v[148:151], v[120:123], v[72:75]
    ds_read_b64_tr_b16 v[198:199], v205 offset:30720
    v_mfma_f32_16x16x32_bf16 v[88:91], v[120:123], v[152:155], v[88:91]
    v_ashrrev_i32 v220, 31, v220
    v_ashrrev_i32 v221, 31, v221
    v_mfma_f32_16x16x32_bf16 v[92:95], v[124:127], v[152:155], v[92:95]
    v_ashrrev_i32 v222, 31, v222
    v_ashrrev_i32 v223, 31, v223
    v_mfma_f32_16x16x32_bf16 v[96:99], v[128:131], v[152:155], v[96:99]
    s_mov_b32 s27, 0xffff
    v_bfi_b32 v224, s27, v220, v221
    v_mfma_f32_16x16x32_bf16 v[100:103], v[132:135], v[152:155], v[100:103]
    v_bfi_b32 v225, s27, v222, v223
    v_bfi_b32 v226, s27, v216, v217
    v_mfma_f32_16x16x32_bf16 v[116:119], v[132:135], v[156:159], v[116:119]
    v_bfi_b32 v227, s27, v218, v219
    v_not_b32 v224, v224
    v_mfma_f32_16x16x32_bf16 v[112:115], v[128:131], v[156:159], v[112:115]
    v_not_b32 v225, v225
    v_not_b32 v226, v226
    v_mfma_f32_16x16x32_bf16 v[108:111], v[124:127], v[156:159], v[108:111]
    v_not_b32 v227, v227
    v_and_b32 v216, 4048155338, v216
    v_mfma_f32_16x16x32_bf16 v[104:107], v[120:123], v[156:159], v[104:107]
    v_and_b32 v217, 4048155338, v217
    v_and_b32 v218, 4048155338, v218
    s_waitcnt lgkmcnt(0)
    v_mfma_f32_16x16x32_bf16 v[24:27], v[176:179], v[160:163], v[24:27]
    v_mfma_f32_16x16x32_bf16 v[28:31], v[176:179], v[164:167], v[28:31]
    s_barrier
    v_mfma_f32_16x16x32_bf16 v[32:35], v[176:179], v[168:171], v[32:35]
    ds_read_b128 v[120:123], v200 offset:32768
    v_mfma_f32_16x16x32_bf16 v[36:39], v[176:179], v[172:175], v[36:39]
    ds_read_b64_tr_b16 v[136:137], v202 offset:32768
    v_mfma_f32_16x16x32_bf16 v[52:55], v[180:183], v[172:175], v[52:55]
    ds_read_b64_tr_b16 v[138:139], v202 offset:34816
    v_mfma_f32_16x16x32_bf16 v[48:51], v[180:183], v[168:171], v[48:51]
    ds_read_b128 v[124:127], v200 offset:34816
    v_mfma_f32_16x16x32_bf16 v[44:47], v[180:183], v[164:167], v[44:47]
    ds_read_b128 v[128:131], v200 offset:36864
    v_mfma_f32_16x16x32_bf16 v[40:43], v[180:183], v[160:163], v[40:43]
    ds_read_b128 v[132:135], v200 offset:38912
    v_mfma_f32_16x16x32_bf16 v[56:59], v[184:187], v[160:163], v[56:59]
    ds_read_b64_tr_b16 v[140:141], v203 offset:32768
    v_mfma_f32_16x16x32_bf16 v[60:63], v[184:187], v[164:167], v[60:63]
    ds_read_b64_tr_b16 v[142:143], v203 offset:34816
    v_mfma_f32_16x16x32_bf16 v[64:67], v[184:187], v[168:171], v[64:67]
    ds_read_b64_tr_b16 v[144:145], v202 offset:0
    v_mfma_f32_16x16x32_bf16 v[68:71], v[184:187], v[172:175], v[68:71]
    ds_read_b64_tr_b16 v[146:147], v202 offset:2048
    v_mfma_f32_16x16x32_bf16 v[84:87], v[188:191], v[172:175], v[84:87]
    ds_read_b64_tr_b16 v[148:149], v203 offset:0
    v_mfma_f32_16x16x32_bf16 v[80:83], v[188:191], v[168:171], v[80:83]
    ds_read_b64_tr_b16 v[150:151], v203 offset:2048
    v_mfma_f32_16x16x32_bf16 v[76:79], v[188:191], v[164:167], v[76:79]
    ds_read_b64_tr_b16 v[152:153], v202 offset:8192
    v_mfma_f32_16x16x32_bf16 v[72:75], v[188:191], v[160:163], v[72:75]
    ds_read_b64_tr_b16 v[154:155], v202 offset:10240
    v_mfma_f32_16x16x32_bf16 v[88:91], v[160:163], v[192:195], v[88:91]
    ds_read_b64_tr_b16 v[156:157], v203 offset:8192
    v_mfma_f32_16x16x32_bf16 v[92:95], v[164:167], v[192:195], v[92:95]
    ds_read_b64_tr_b16 v[158:159], v203 offset:10240
    v_mfma_f32_16x16x32_bf16 v[96:99], v[168:171], v[192:195], v[96:99]
    v_and_b32 v219, 4048155338, v219
    v_and_b32 v220, 4048155338, v220
    v_mfma_f32_16x16x32_bf16 v[100:103], v[172:175], v[192:195], v[100:103]
    v_and_b32 v221, 4048155338, v221
    v_and_b32 v222, 4048155338, v222
    v_mfma_f32_16x16x32_bf16 v[116:119], v[172:175], v[196:199], v[116:119]
    v_and_b32 v223, 4048155338, v223
    s_lshr_b32 s27, s3, 1
    v_mfma_f32_16x16x32_bf16 v[112:115], v[168:171], v[196:199], v[112:115]
    s_or_b32 s27, s27, s20
    s_cmp_eq_u32 s27, 0
    v_mfma_f32_16x16x32_bf16 v[108:111], v[164:167], v[196:199], v[108:111]
    s_cselect_b32 s27, 4048155338, 0
    v_or_b32 v228, s27, v220
    v_mfma_f32_16x16x32_bf16 v[104:107], v[160:163], v[196:199], v[104:107]
    v_or_b32 v229, s27, v221
    v_or_b32 v230, s27, v222
    s_waitcnt lgkmcnt(0)
    v_mfma_f32_16x16x32_bf16 v[24:27], v[136:139], v[120:123], v[24:27]
    ds_read_b128 v[160:163], v201 offset:32768
    v_mfma_f32_16x16x32_bf16 v[28:31], v[136:139], v[124:127], v[28:31]
    ds_read_b64_tr_b16 v[176:177], v202 offset:36864
    v_mfma_f32_16x16x32_bf16 v[32:35], v[136:139], v[128:131], v[32:35]
    ds_read_b64_tr_b16 v[178:179], v202 offset:38912
    v_mfma_f32_16x16x32_bf16 v[36:39], v[136:139], v[132:135], v[36:39]
    ds_read_b128 v[164:167], v201 offset:34816
    v_mfma_f32_16x16x32_bf16 v[52:55], v[140:143], v[132:135], v[52:55]
    ds_read_b128 v[168:171], v201 offset:36864
    v_mfma_f32_16x16x32_bf16 v[48:51], v[140:143], v[128:131], v[48:51]
    ds_read_b128 v[172:175], v201 offset:38912
    v_mfma_f32_16x16x32_bf16 v[44:47], v[140:143], v[124:127], v[44:47]
    ds_read_b64_tr_b16 v[180:181], v203 offset:36864
    v_mfma_f32_16x16x32_bf16 v[40:43], v[140:143], v[120:123], v[40:43]
    ds_read_b64_tr_b16 v[182:183], v203 offset:38912
    v_mfma_f32_16x16x32_bf16 v[56:59], v[144:147], v[120:123], v[56:59]
    ds_read_b64_tr_b16 v[184:185], v202 offset:4096
    v_mfma_f32_16x16x32_bf16 v[60:63], v[144:147], v[124:127], v[60:63]
    ds_read_b64_tr_b16 v[186:187], v202 offset:6144
    v_mfma_f32_16x16x32_bf16 v[64:67], v[144:147], v[128:131], v[64:67]
    ds_read_b64_tr_b16 v[188:189], v203 offset:4096
    v_mfma_f32_16x16x32_bf16 v[68:71], v[144:147], v[132:135], v[68:71]
    ds_read_b64_tr_b16 v[190:191], v203 offset:6144
    v_mfma_f32_16x16x32_bf16 v[84:87], v[148:151], v[132:135], v[84:87]
    ds_read_b64_tr_b16 v[192:193], v202 offset:12288
    v_mfma_f32_16x16x32_bf16 v[80:83], v[148:151], v[128:131], v[80:83]
    ds_read_b64_tr_b16 v[194:195], v202 offset:14336
    v_mfma_f32_16x16x32_bf16 v[76:79], v[148:151], v[124:127], v[76:79]
    ds_read_b64_tr_b16 v[196:197], v203 offset:12288
    v_mfma_f32_16x16x32_bf16 v[72:75], v[148:151], v[120:123], v[72:75]
    ds_read_b64_tr_b16 v[198:199], v203 offset:14336
    v_mfma_f32_16x16x32_bf16 v[88:91], v[120:123], v[152:155], v[88:91]
    v_or_b32 v231, s27, v223
    s_lshl_b32 s27, s3, 11
    v_mfma_f32_16x16x32_bf16 v[92:95], v[124:127], v[152:155], v[92:95]
    s_add_u32 s27, s27, 49152
    v_add_u32 v4, s27, v0
    v_mfma_f32_16x16x32_bf16 v[96:99], v[128:131], v[152:155], v[96:99]
    v_add_u32 v5, s49, v0
    s_add_u32 s49, s49, 65536
    v_mfma_f32_16x16x32_bf16 v[100:103], v[132:135], v[152:155], v[100:103]
    v_mfma_f32_16x16x32_bf16 v[116:119], v[132:135], v[156:159], v[116:119]
    v_mfma_f32_16x16x32_bf16 v[112:115], v[128:131], v[156:159], v[112:115]
    v_mfma_f32_16x16x32_bf16 v[108:111], v[124:127], v[156:159], v[108:111]
    v_mfma_f32_16x16x32_bf16 v[104:107], v[120:123], v[156:159], v[104:107]
    s_waitcnt lgkmcnt(0)
    s_barrier
    v_mfma_f32_16x16x32_bf16 v[68:71], v[184:187], v[172:175], v[68:71]
    ds_read_b128 v[152:155], v209 offset:256
    v_mfma_f32_16x16x32_bf16 v[84:87], v[188:191], v[172:175], v[84:87]
    ds_read_b128 v[156:159], v209 offset:320
    v_mfma_f32_16x16x32_bf16 v[100:103], v[172:175], v[192:195], v[100:103]
    ds_read_b64 v[238:239], v207 offset:1408
    v_mfma_f32_16x16x32_bf16 v[116:119], v[172:175], v[196:199], v[116:119]
    ds_read_b32 v248, v210 offset:512
    v_mfma_f32_16x16x32_bf16 v[112:115], v[168:171], v[196:199], v[112:115]
    ds_read_b32 v249, v210 offset:576
    v_mfma_f32_16x16x32_bf16 v[108:111], v[164:167], v[196:199], v[108:111]
    ds_read_b128 v[132:135], v208 offset:320
    v_mfma_f32_16x16x32_bf16 v[104:107], v[160:163], v[196:199], v[104:107]
    ds_read_b128 v[148:151], v208 offset:448
    v_mfma_f32_16x16x32_bf16 v[88:91], v[160:163], v[192:195], v[88:91]
    ds_read_b64 v[236:237], v207 offset:1280
    v_mfma_f32_16x16x32_bf16 v[92:95], v[164:167], v[192:195], v[92:95]
    ds_read_b64 v[234:235], v207 offset:1152
    v_mfma_f32_16x16x32_bf16 v[96:99], v[168:171], v[192:195], v[96:99]
    ds_read_b128 v[128:131], v208 offset:256
    v_mfma_f32_16x16x32_bf16 v[80:83], v[188:191], v[168:171], v[80:83]
    ds_read_b128 v[144:147], v208 offset:384
    v_mfma_f32_16x16x32_bf16 v[76:79], v[188:191], v[164:167], v[76:79]
    ds_read_b128 v[124:127], v208 offset:64
    v_mfma_f32_16x16x32_bf16 v[72:75], v[188:191], v[160:163], v[72:75]
    ds_read_b128 v[140:143], v208 offset:192
    v_mfma_f32_16x16x32_bf16 v[56:59], v[184:187], v[160:163], v[56:59]
    ds_read_b128 v[240:243], v209 offset:0
    v_mfma_f32_16x16x32_bf16 v[60:63], v[184:187], v[164:167], v[60:63]
    ds_read_b128 v[244:247], v209 offset:64
    v_mfma_f32_16x16x32_bf16 v[64:67], v[184:187], v[168:171], v[64:67]
    ds_read_b64 v[232:233], v207 offset:1024
    v_mfma_f32_16x16x32_bf16 v[24:27], v[176:179], v[160:163], v[24:27]
    ds_read_b128 v[120:123], v208 offset:0
    v_mfma_f32_16x16x32_bf16 v[28:31], v[176:179], v[164:167], v[28:31]
    ds_read_b128 v[136:139], v208 offset:128
    v_mfma_f32_16x16x32_bf16 v[32:35], v[176:179], v[168:171], v[32:35]
    v_mfma_f32_16x16x32_bf16 v[36:39], v[176:179], v[172:175], v[36:39]
    v_mfma_f32_16x16x32_bf16 v[52:55], v[180:183], v[172:175], v[52:55]
    v_mfma_f32_16x16x32_bf16 v[48:51], v[180:183], v[168:171], v[48:51]
    v_mfma_f32_16x16x32_bf16 v[44:47], v[180:183], v[164:167], v[44:47]
    v_mfma_f32_16x16x32_bf16 v[40:43], v[180:183], v[160:163], v[40:43]
    s_waitcnt lgkmcnt(0)
    v_pk_mul_f32 v[250:251], v[238:239], v[152:153] op_sel:[1,0] op_sel_hi:[1,1]
    v_pk_fma_f32 v[250:251], v[68:69], v[238:239], v[250:251] op_sel_hi:[1,0,1]
    v_pk_mul_f32 v[252:253], v[238:239], v[154:155] op_sel:[1,0] op_sel_hi:[1,1]
    v_cvt_pk_bf16_f32 v68, v250, v251
    v_pk_fma_f32 v[252:253], v[70:71], v[238:239], v[252:253] op_sel_hi:[1,0,1]
    v_pk_mul_f32 v[254:255], v[238:239], v[156:157] op_sel:[1,0] op_sel_hi:[1,1]
    v_cvt_pk_bf16_f32 v69, v252, v253
    v_pk_fma_f32 v[254:255], v[84:85], v[238:239], v[254:255] op_sel_hi:[1,0,1]
    v_pk_mul_f32 v[250:251], v[238:239], v[158:159] op_sel:[1,0] op_sel_hi:[1,1]
    v_cvt_pk_bf16_f32 v70, v254, v255
    v_pk_fma_f32 v[250:251], v[86:87], v[238:239], v[250:251] op_sel_hi:[1,0,1]
    v_pk_mul_f32 v[252:253], v[148:149], v[248:249] op_sel_hi:[1,0]
    v_cvt_pk_bf16_f32 v71, v250, v251
    v_pk_fma_f32 v[252:253], v[100:101], v[132:133], v[252:253]
    v_pk_mul_f32 v[254:255], v[150:151], v[248:249] op_sel_hi:[1,0]
    v_min_u32 v68, -2, v68
    buffer_store_dwordx4 v[68:71], v5, s[12:15], 0 offen offset:0 sc1
    ds_write_b128 v4, v[68:71] offset:4096
    v_mul_f32 v238, 1048744942, v238
    v_mul_f32 v239, 1048744942, v239
    v_cvt_pk_bf16_f32 v100, v252, v253
    v_pk_fma_f32 v[254:255], v[102:103], v[134:135], v[254:255]
    v_pk_mul_f32 v[250:251], v[248:249], v[148:149] op_sel:[1,0] op_sel_hi:[1,1]
    v_cvt_pk_bf16_f32 v101, v254, v255
    v_pk_fma_f32 v[250:251], v[116:117], v[132:133], v[250:251]
    v_pk_mul_f32 v[252:253], v[248:249], v[150:151] op_sel:[1,0] op_sel_hi:[1,1]
    v_cvt_pk_bf16_f32 v102, v250, v251
    v_pk_fma_f32 v[252:253], v[118:119], v[134:135], v[252:253]
    v_pk_mul_f32 v[254:255], v[236:237], v[152:153] op_sel:[1,0] op_sel_hi:[1,1]
    v_cvt_pk_bf16_f32 v103, v252, v253
    v_pk_fma_f32 v[254:255], v[64:65], v[236:237], v[254:255] op_sel_hi:[1,0,1]
    v_pk_mul_f32 v[250:251], v[236:237], v[154:155] op_sel:[1,0] op_sel_hi:[1,1]
    v_min_u32 v100, -2, v100
    buffer_store_dwordx4 v[100:103], v5, s[12:15], 0 offen offset:1024 sc1
    ds_write_b128 v4, v[100:103] offset:5120
    v_mov_b32 v168, v100
    v_mov_b32 v169, v101
    v_mov_b32 v178, v102
    v_mov_b32 v179, v103
    v_cvt_pk_bf16_f32 v64, v254, v255
    v_pk_fma_f32 v[250:251], v[66:67], v[236:237], v[250:251] op_sel_hi:[1,0,1]
    v_pk_mul_f32 v[252:253], v[236:237], v[156:157] op_sel:[1,0] op_sel_hi:[1,1]
    v_cvt_pk_bf16_f32 v65, v250, v251
    v_pk_fma_f32 v[252:253], v[80:81], v[236:237], v[252:253] op_sel_hi:[1,0,1]
    v_pk_mul_f32 v[254:255], v[236:237], v[158:159] op_sel:[1,0] op_sel_hi:[1,1]
    v_cvt_pk_bf16_f32 v66, v252, v253
    v_pk_fma_f32 v[254:255], v[82:83], v[236:237], v[254:255] op_sel_hi:[1,0,1]
    v_pk_mul_f32 v[250:251], v[234:235], v[152:153] op_sel:[1,0] op_sel_hi:[1,1]
    v_cvt_pk_bf16_f32 v67, v254, v255
    v_pk_fma_f32 v[250:251], v[60:61], v[234:235], v[250:251] op_sel_hi:[1,0,1]
    v_pk_mul_f32 v[252:253], v[234:235], v[154:155] op_sel:[1,0] op_sel_hi:[1,1]
    v_mul_f32 v236, 1048744942, v236
    v_mul_f32 v237, 1048744942, v237
    v_cvt_pk_bf16_f32 v60, v250, v251
    v_pk_fma_f32 v[252:253], v[62:63], v[234:235], v[252:253] op_sel_hi:[1,0,1]
    v_pk_mul_f32 v[254:255], v[234:235], v[156:157] op_sel:[1,0] op_sel_hi:[1,1]
    v_cvt_pk_bf16_f32 v61, v252, v253
    v_pk_fma_f32 v[254:255], v[76:77], v[234:235], v[254:255] op_sel_hi:[1,0,1]
    v_pk_mul_f32 v[250:251], v[234:235], v[158:159] op_sel:[1,0] op_sel_hi:[1,1]
    v_cvt_pk_bf16_f32 v62, v254, v255
    v_pk_fma_f32 v[250:251], v[78:79], v[234:235], v[250:251] op_sel_hi:[1,0,1]
    v_pk_mul_f32 v[252:253], v[238:239], v[240:241] op_sel:[1,0] op_sel_hi:[1,1]
    v_cvt_pk_bf16_f32 v63, v250, v251
    v_pk_fma_f32 v[252:253], v[36:37], v[238:239], v[252:253] op_sel_hi:[1,0,1]
    v_pk_mul_f32 v[254:255], v[238:239], v[242:243] op_sel:[1,0] op_sel_hi:[1,1]
    v_mul_f32 v234, 1048744942, v234
    v_mul_f32 v235, 1048744942, v235
    v_cvt_pk_bf16_f32 v36, v252, v253
    v_pk_fma_f32 v[254:255], v[38:39], v[238:239], v[254:255] op_sel_hi:[1,0,1]
    v_pk_mul_f32 v[250:251], v[238:239], v[244:245] op_sel:[1,0] op_sel_hi:[1,1]
    v_cvt_pk_bf16_f32 v37, v254, v255
    v_pk_fma_f32 v[250:251], v[52:53], v[238:239], v[250:251] op_sel_hi:[1,0,1]
    v_pk_mul_f32 v[252:253], v[238:239], v[246:247] op_sel:[1,0] op_sel_hi:[1,1]
    v_cvt_pk_bf16_f32 v38, v250, v251
    v_pk_fma_f32 v[252:253], v[54:55], v[238:239], v[252:253] op_sel_hi:[1,0,1]
    v_pk_mul_f32 v[254:255], v[236:237], v[240:241] op_sel:[1,0] op_sel_hi:[1,1]
    v_cvt_pk_bf16_f32 v39, v252, v253
    v_pk_fma_f32 v[254:255], v[32:33], v[236:237], v[254:255] op_sel_hi:[1,0,1]
    v_pk_mul_f32 v[250:251], v[236:237], v[242:243] op_sel:[1,0] op_sel_hi:[1,1]
    v_cvt_pk_bf16_f32 v32, v254, v255
    v_pk_fma_f32 v[250:251], v[34:35], v[236:237], v[250:251] op_sel_hi:[1,0,1]
    v_pk_mul_f32 v[252:253], v[236:237], v[244:245] op_sel:[1,0] op_sel_hi:[1,1]
    v_cvt_pk_bf16_f32 v33, v250, v251
    v_pk_fma_f32 v[252:253], v[48:49], v[236:237], v[252:253] op_sel_hi:[1,0,1]
    v_pk_mul_f32 v[254:255], v[236:237], v[246:247] op_sel:[1,0] op_sel_hi:[1,1]
    v_cvt_pk_bf16_f32 v34, v252, v253
    v_pk_fma_f32 v[254:255], v[50:51], v[236:237], v[254:255] op_sel_hi:[1,0,1]
    v_pk_mul_f32 v[250:251], v[144:145], v[248:249] op_sel_hi:[1,0]
    v_cvt_pk_bf16_f32 v35, v254, v255
    v_pk_fma_f32 v[250:251], v[96:97], v[128:129], v[250:251]
    v_pk_mul_f32 v[252:253], v[146:147], v[248:249] op_sel_hi:[1,0]
    v_cvt_pk_bf16_f32 v166, v250, v251
    v_pk_fma_f32 v[252:253], v[98:99], v[130:131], v[252:253]
    v_pk_mul_f32 v[254:255], v[248:249], v[144:145] op_sel:[1,0] op_sel_hi:[1,1]
    v_cvt_pk_bf16_f32 v167, v252, v253
    v_pk_fma_f32 v[254:255], v[112:113], v[128:129], v[254:255]
    v_pk_mul_f32 v[250:251], v[248:249], v[146:147] op_sel:[1,0] op_sel_hi:[1,1]
    v_cvt_pk_bf16_f32 v176, v254, v255
    v_pk_fma_f32 v[250:251], v[114:115], v[130:131], v[250:251]
    v_pk_mul_f32 v[252:253], v[140:141], v[248:249] op_sel_hi:[1,0]
    v_cvt_pk_bf16_f32 v177, v250, v251
    v_pk_fma_f32 v[252:253], v[92:93], v[124:125], v[252:253]
    v_pk_mul_f32 v[254:255], v[142:143], v[248:249] op_sel_hi:[1,0]
    v_cvt_pk_bf16_f32 v164, v252, v253
    v_pk_fma_f32 v[254:255], v[94:95], v[126:127], v[254:255]
    v_pk_mul_f32 v[250:251], v[248:249], v[140:141] op_sel:[1,0] op_sel_hi:[1,1]
    v_cvt_pk_bf16_f32 v165, v254, v255
    v_pk_fma_f32 v[250:251], v[108:109], v[124:125], v[250:251]
    v_pk_mul_f32 v[252:253], v[248:249], v[142:143] op_sel:[1,0] op_sel_hi:[1,1]
    v_cvt_pk_bf16_f32 v174, v250, v251
    v_pk_fma_f32 v[252:253], v[110:111], v[126:127], v[252:253]
    v_cvt_pk_bf16_f32 v175, v252, v253
    s_waitcnt lgkmcnt(0)
    s_add_u32 s27, s62, 65536
    v_mfma_f32_16x16x32_bf16 v[184:187], v[68:71], v[36:39], v[216:219]
    v_mfma_f32_16x16x32_bf16 v[188:191], v[64:67], v[36:39], v[220:223]
    v_mfma_f32_16x16x32_bf16 v[192:195], v[64:67], v[32:35], v[216:219]
    v_mfma_f32_16x16x32_bf16 v[196:199], v[60:63], v[32:35], v[220:223]
    v_pk_mul_f32 v[250:251], v[232:233], v[152:153] op_sel:[1,0] op_sel_hi:[1,1]
    v_pk_fma_f32 v[250:251], v[56:57], v[232:233], v[250:251] op_sel_hi:[1,0,1]
    v_pk_mul_f32 v[252:253], v[232:233], v[154:155] op_sel:[1,0] op_sel_hi:[1,1]
    v_cvt_pk_bf16_f32 v56, v250, v251
    v_pk_fma_f32 v[252:253], v[58:59], v[232:233], v[252:253] op_sel_hi:[1,0,1]
    v_pk_mul_f32 v[254:255], v[232:233], v[156:157] op_sel:[1,0] op_sel_hi:[1,1]
    v_max3_f32 v84, v184, v185, v188
    v_cvt_pk_bf16_f32 v57, v252, v253
    v_max3_f32 v100, v192, v193, v196
    v_max3_f32 v85, v186, v187, v190
    v_max3_f32 v101, v194, v195, v198
    v_max_f32 v84, v84, v189
    v_max_f32 v100, v100, v197
    v_max_f32 v85, v85, v191
    v_max_f32 v101, v101, v199
    v_max_f32 v86, v84, v85
    v_max_f32 v102, v100, v101
    v_pk_fma_f32 v[254:255], v[72:73], v[232:233], v[254:255] op_sel_hi:[1,0,1]
    v_pk_mul_f32 v[250:251], v[232:233], v[158:159] op_sel:[1,0] op_sel_hi:[1,1]
    v_permlane16_swap_b32 v86, v102
    v_cvt_pk_bf16_f32 v58, v254, v255
    v_max_f32 v86, v86, v102
    v_pk_fma_f32 v[250:251], v[74:75], v[232:233], v[250:251] op_sel_hi:[1,0,1]
    v_mov_b32 v102, v86
    v_pk_mul_f32 v[252:253], v[136:137], v[248:249] op_sel_hi:[1,0]
    v_cvt_pk_bf16_f32 v59, v250, v251
    v_permlane32_swap_b32 v86, v102
    v_pk_fma_f32 v[252:253], v[88:89], v[120:121], v[252:253]
    v_max_f32 v86, v86, v102
    v_pk_mul_f32 v[254:255], v[138:139], v[248:249] op_sel_hi:[1,0]
    v_mov_b32 v102, v86
    v_mul_f32 v232, 1048744942, v232
    v_mul_f32 v233, 1048744942, v233
    v_permlane16_swap_b32 v86, v102
    v_cvt_pk_bf16_f32 v162, v252, v253
    v_sub_f32 v84, v84, v86
    v_sub_f32 v100, v100, v102
    v_sub_f32 v85, v85, v86
    v_sub_f32 v101, v101, v102
    v_exp_f32 v84, v84
    v_exp_f32 v100, v100
    v_exp_f32 v85, v85
    v_exp_f32 v101, v101
    v_cvt_pk_bf16_f32 v84, v84, v84
    v_cvt_pk_bf16_f32 v100, v100, v100
    v_cvt_pk_bf16_f32 v85, v85, v85
    v_cvt_pk_bf16_f32 v101, v101, v101
    v_and_b32 v48, v84, v224
    v_and_b32 v52, v100, v224
    v_and_b32 v49, v85, v225
    v_and_b32 v53, v101, v225
    v_and_b32 v50, v84, v226
    v_and_b32 v54, v100, v226
    v_and_b32 v51, v85, v227
    v_and_b32 v55, v101, v227
    v_pk_fma_f32 v[254:255], v[90:91], v[122:123], v[254:255]
    v_mfma_f32_16x16x32_bf16 v[108:111], v[212:215], v[48:51], 0
    v_mfma_f32_16x16x32_bf16 v[76:79], v[166:169], v[48:51], 0
    v_mfma_f32_16x16x32_bf16 v[80:83], v[176:179], v[48:51], 0
    v_mfma_f32_16x16x32_bf16 v[112:115], v[212:215], v[52:55], 0
    v_mfma_f32_16x16x32_bf16 v[92:95], v[164:167], v[52:55], 0
    v_mfma_f32_16x16x32_bf16 v[96:99], v[174:177], v[52:55], 0
    v_pk_mul_f32 v[250:251], v[248:249], v[136:137] op_sel:[1,0] op_sel_hi:[1,1]
    v_cvt_pk_bf16_f32 v163, v254, v255
    v_pk_fma_f32 v[250:251], v[104:105], v[120:121], v[250:251]
    v_rcp_f32 v84, v108
    v_pk_mul_f32 v[252:253], v[248:249], v[138:139] op_sel:[1,0] op_sel_hi:[1,1]
    v_cvt_pk_bf16_f32 v172, v250, v251
    v_rcp_f32 v100, v112
    v_pk_mul_f32 v[76:77], v[76:77], v[84:85] op_sel_hi:[1,0]
    v_pk_mul_f32 v[92:93], v[92:93], v[100:101] op_sel_hi:[1,0]
    v_pk_mul_f32 v[78:79], v[78:79], v[84:85] op_sel_hi:[1,0]
    v_pk_mul_f32 v[94:95], v[94:95], v[100:101] op_sel_hi:[1,0]
    v_pk_mul_f32 v[80:81], v[80:81], v[84:85] op_sel_hi:[1,0]
    v_pk_mul_f32 v[96:97], v[96:97], v[100:101] op_sel_hi:[1,0]
    v_pk_mul_f32 v[82:83], v[82:83], v[84:85] op_sel_hi:[1,0]
    v_pk_mul_f32 v[98:99], v[98:99], v[100:101] op_sel_hi:[1,0]
    v_add_u32 v76, 0x8000, v76
    v_add_u32 v92, 0x8000, v92
    v_cvt_pk_bf16_f32 v76, v76, v77
    v_cvt_pk_bf16_f32 v92, v92, v93
    v_cvt_pk_bf16_f32 v77, v78, v79
    v_cvt_pk_bf16_f32 v93, v94, v95
    v_cvt_pk_bf16_f32 v78, v80, v81
    v_cvt_pk_bf16_f32 v94, v96, v97
    v_cvt_pk_bf16_f32 v79, v82, v83
    v_cvt_pk_bf16_f32 v95, v98, v99
    v_and_b32 v76, -2, v76
    v_and_b32 v92, -2, v92
    v_pk_fma_f32 v[252:253], v[106:107], v[122:123], v[252:253]
    v_pk_mul_f32 v[254:255], v[234:235], v[240:241] op_sel:[1,0] op_sel_hi:[1,1]
    v_cvt_pk_bf16_f32 v173, v252, v253
    v_pk_fma_f32 v[254:255], v[28:29], v[234:235], v[254:255] op_sel_hi:[1,0,1]
    v_pk_mul_f32 v[250:251], v[234:235], v[242:243] op_sel:[1,0] op_sel_hi:[1,1]
    v_cvt_pk_bf16_f32 v28, v254, v255
    v_pk_fma_f32 v[250:251], v[30:31], v[234:235], v[250:251] op_sel_hi:[1,0,1]
    v_pk_mul_f32 v[252:253], v[234:235], v[244:245] op_sel:[1,0] op_sel_hi:[1,1]
    v_cvt_pk_bf16_f32 v29, v250, v251
    v_pk_fma_f32 v[252:253], v[44:45], v[234:235], v[252:253] op_sel_hi:[1,0,1]
    v_pk_mul_f32 v[254:255], v[234:235], v[246:247] op_sel:[1,0] op_sel_hi:[1,1]
    v_cvt_pk_bf16_f32 v30, v252, v253
    v_pk_fma_f32 v[254:255], v[46:47], v[234:235], v[254:255] op_sel_hi:[1,0,1]
    v_pk_mul_f32 v[250:251], v[232:233], v[240:241] op_sel:[1,0] op_sel_hi:[1,1]
    v_cvt_pk_bf16_f32 v31, v254, v255
    v_pk_fma_f32 v[250:251], v[24:25], v[232:233], v[250:251] op_sel_hi:[1,0,1]
    v_pk_mul_f32 v[252:253], v[232:233], v[242:243] op_sel:[1,0] op_sel_hi:[1,1]
    v_cvt_pk_bf16_f32 v24, v250, v251
    v_pk_fma_f32 v[252:253], v[26:27], v[232:233], v[252:253] op_sel_hi:[1,0,1]
    v_pk_mul_f32 v[254:255], v[232:233], v[244:245] op_sel:[1,0] op_sel_hi:[1,1]
    v_cvt_pk_bf16_f32 v25, v252, v253
    v_pk_fma_f32 v[254:255], v[40:41], v[232:233], v[254:255] op_sel_hi:[1,0,1]
    v_pk_mul_f32 v[250:251], v[232:233], v[246:247] op_sel:[1,0] op_sel_hi:[1,1]
    v_cvt_pk_bf16_f32 v26, v254, v255
    v_pk_fma_f32 v[250:251], v[42:43], v[232:233], v[250:251] op_sel_hi:[1,0,1]
    v_cvt_pk_bf16_f32 v27, v250, v251
    s_barrier
    ds_read_b128 v[180:183], v4
    ds_read_b64 v[160:161], v4 offset:1024
    ds_read_b64 v[170:171], v4 offset:1032
    v_mfma_f32_16x16x32_bf16 v[184:187], v[60:63], v[28:31], v[216:219]
    v_mfma_f32_16x16x32_bf16 v[188:191], v[56:59], v[28:31], v[220:223]
    v_mfma_f32_16x16x32_bf16 v[192:195], v[56:59], v[24:27], v[216:219]
    s_cmp_eq_u32 s23, 0
    s_cbranch_scc1 Lwt_120
    buffer_store_dwordx4 v[76:79], v0, s[88:91], s27 offen offset:1024
    buffer_store_dwordx4 v[92:95], v0, s[88:91], s27 offen offset:0
Lwt_121:
    s_waitcnt lgkmcnt(0)
    v_mfma_f32_16x16x32_bf16 v[196:199], v[180:183], v[24:27], v[228:231]
    v_xor_b32 v232, 0, v2
    v_xor_b32 v233, 32, v2
    v_xor_b32 v234, 64, v2
    v_xor_b32 v235, 96, v2
    v_add_u32 v236, 65536, v232
    v_max3_f32 v84, v184, v185, v188
    v_add_u32 v237, 65536, v233
    v_add_u32 v238, 65536, v234
    v_max3_f32 v100, v192, v193, v196
    v_max3_f32 v85, v186, v187, v190
    v_max3_f32 v101, v194, v195, v198
    v_max_f32 v84, v84, v189
    v_max_f32 v100, v100, v197
    v_max_f32 v85, v85, v191
    v_max_f32 v101, v101, v199
    v_max_f32 v86, v84, v85
    v_max_f32 v102, v100, v101
    v_add_u32 v239, 65536, v235
    v_add_u32 v240, 131072, v232
    v_permlane16_swap_b32 v86, v102
    v_add_u32 v241, 131072, v233
    v_max_f32 v86, v86, v102
    v_add_u32 v242, 131072, v234
    v_mov_b32 v102, v86
    v_add_u32 v243, 131072, v235
    v_add_u32 v248, s1, v0
    v_permlane32_swap_b32 v86, v102
    s_lshl_b32 s28, s3, 12
    v_max_f32 v86, v86, v102
    s_add_u32 s28, s28, 32768
    v_mov_b32 v102, v86
    v_add_u32 v249, s28, v0
    s_lshl_b32 s44, s21, 12
    v_permlane16_swap_b32 v86, v102
    s_xor_b32 s45, s44, 32768
    v_sub_f32 v84, v84, v86
    v_sub_f32 v100, v100, v102
    v_sub_f32 v85, v85, v86
    v_sub_f32 v101, v101, v102
    v_exp_f32 v84, v84
    v_exp_f32 v100, v100
    v_exp_f32 v85, v85
    v_exp_f32 v101, v101
    v_cvt_pk_bf16_f32 v84, v84, v84
    v_cvt_pk_bf16_f32 v100, v100, v100
    v_cvt_pk_bf16_f32 v85, v85, v85
    v_cvt_pk_bf16_f32 v101, v101, v101
    v_and_b32 v48, v84, v224
    v_and_b32 v52, v100, v224
    v_and_b32 v49, v85, v225
    v_and_b32 v53, v101, v225
    v_and_b32 v50, v84, v226
    v_and_b32 v54, v100, v226
    v_and_b32 v51, v85, v227
    v_and_b32 v55, v101, v227
    s_xor_b32 s46, s44, 4096
    v_mfma_f32_16x16x32_bf16 v[108:111], v[212:215], v[48:51], 0
    v_mfma_f32_16x16x32_bf16 v[76:79], v[162:165], v[48:51], 0
    v_mfma_f32_16x16x32_bf16 v[80:83], v[172:175], v[48:51], 0
    v_mfma_f32_16x16x32_bf16 v[112:115], v[212:215], v[52:55], 0
    v_mfma_f32_16x16x32_bf16 v[92:95], v[160:163], v[52:55], 0
    v_mfma_f32_16x16x32_bf16 v[96:99], v[170:173], v[52:55], 0
    s_xor_b32 s47, s44, 36864
    s_nop 1
    v_rcp_f32 v84, v108
    s_nop 1
    v_rcp_f32 v100, v112
    v_pk_mul_f32 v[76:77], v[76:77], v[84:85] op_sel_hi:[1,0]
    v_pk_mul_f32 v[92:93], v[92:93], v[100:101] op_sel_hi:[1,0]
    v_pk_mul_f32 v[78:79], v[78:79], v[84:85] op_sel_hi:[1,0]
    v_pk_mul_f32 v[94:95], v[94:95], v[100:101] op_sel_hi:[1,0]
    v_pk_mul_f32 v[80:81], v[80:81], v[84:85] op_sel_hi:[1,0]
    v_pk_mul_f32 v[96:97], v[96:97], v[100:101] op_sel_hi:[1,0]
    v_pk_mul_f32 v[82:83], v[82:83], v[84:85] op_sel_hi:[1,0]
    v_pk_mul_f32 v[98:99], v[98:99], v[100:101] op_sel_hi:[1,0]
    v_add_u32 v76, 0x8000, v76
    v_add_u32 v92, 0x8000, v92
    v_cvt_pk_bf16_f32 v76, v76, v77
    v_cvt_pk_bf16_f32 v92, v92, v93
    v_cvt_pk_bf16_f32 v77, v78, v79
    v_cvt_pk_bf16_f32 v93, v94, v95
    v_cvt_pk_bf16_f32 v78, v80, v81
    v_cvt_pk_bf16_f32 v94, v96, v97
    v_cvt_pk_bf16_f32 v79, v82, v83
    v_cvt_pk_bf16_f32 v95, v98, v99
    v_and_b32 v76, -2, v76
    v_and_b32 v92, -2, v92
    s_cmp_eq_u32 s23, 0
    s_cbranch_scc1 Lwt_122
    buffer_store_dwordx4 v[76:79], v0, s[88:91], s62 offen offset:1024
    buffer_store_dwordx4 v[92:95], v0, s[88:91], s62 offen offset:0
Lwt_123:
    s_branch L_g2
L_attA:
    s_waitcnt lgkmcnt(0)
    s_barrier
    s_cmp_ge_u32 s3, 4
    s_cbranch_scc0 Lif_124
    ds_read_b128 v[24:27], v130 offset:0
    ds_read_b128 v[28:31], v130 offset:1024
Lif_124:
    ds_read_b128 v[80:83], v128 offset:32768
    ds_read_b128 v[84:87], v128 offset:33792
    ds_read_b128 v[88:91], v128 offset:34816
    ds_read_b128 v[92:95], v128 offset:35840
    v_mov_b32 v66, 0
    v_mov_b32 v67, 0
    s_waitcnt lgkmcnt(3)
    v_mfma_f32_16x16x32_bf16 v[32:35], v[80:83], v[24:27], v[216:219]
    v_mfma_f32_16x16x32_bf16 v[40:43], v[80:83], v[28:31], 0
    s_waitcnt lgkmcnt(2)
    v_mfma_f32_16x16x32_bf16 v[44:47], v[84:87], v[28:31], v[216:219]
    s_cmp_eq_u32 s71, 0
    s_cbranch_scc1 Lht_126
Lhb_125:
    ds_read_b128 v[80:83], v128 offset:24576
    ds_read_b128 v[84:87], v128 offset:25600
    s_nop 0
    v_exp_f32 v32, v32
    v_exp_f32 v33, v33
    v_exp_f32 v34, v34
    v_exp_f32 v35, v35
    v_cvt_pk_bf16_f32 v64, v32, v33
    v_exp_f32 v40, v40
    v_exp_f32 v41, v41
    v_cvt_pk_bf16_f32 v65, v34, v35
    v_exp_f32 v42, v42
    ds_read_b128 v[96:99], v128 offset:26624
    ds_read_b128 v[100:103], v128 offset:27648
    s_waitcnt lgkmcnt(3)
    v_mfma_f32_16x16x32_bf16 v[48:51], v[80:83], v[24:27], v[224:227]
    v_exp_f32 v43, v43
    v_cvt_pk_bf16_f32 v68, v40, v41
    s_waitcnt lgkmcnt(2)
    v_mfma_f32_16x16x32_bf16 v[52:55], v[84:87], v[24:27], v[224:227]
    v_exp_f32 v44, v44
    v_mfma_f32_16x16x32_bf16 v[56:59], v[80:83], v[28:31], v[224:227]
    v_exp_f32 v45, v45
    v_cvt_pk_bf16_f32 v69, v42, v43
    v_mfma_f32_16x16x32_bf16 v[60:63], v[84:87], v[28:31], v[224:227]
    v_exp_f32 v46, v46
    v_exp_f32 v47, v47
    v_cvt_pk_bf16_f32 v70, v44, v45
    v_cvt_pk_bf16_f32 v71, v46, v47
    s_cmp_eq_u32 s71, 1
    s_cbranch_scc1 Lht_128
Lhb_127:
    ds_read_b128 v[80:83], v128 offset:16384
    ds_read_b128 v[84:87], v128 offset:17408
    v_exp_f32 v48, v48
    v_mfma_f32_16x16x32_bf16 v[104:107], v[88:91], v[64:67], 0
    v_exp_f32 v49, v49
    v_exp_f32 v50, v50
    v_mfma_f32_16x16x32_bf16 v[108:111], v[92:95], v[64:67], 0
    v_exp_f32 v51, v51
    v_cvt_pk_bf16_f32 v72, v48, v49
    v_mfma_f32_16x16x32_bf16 v[120:123], v[212:215], v[64:67], 0
    v_exp_f32 v52, v52
    v_exp_f32 v53, v53
    v_mfma_f32_16x16x32_bf16 v[112:115], v[88:91], v[68:71], 0
    v_cvt_pk_bf16_f32 v73, v50, v51
    v_exp_f32 v54, v54
    v_mfma_f32_16x16x32_bf16 v[116:119], v[92:95], v[68:71], 0
    v_exp_f32 v55, v55
    v_cvt_pk_bf16_f32 v74, v52, v53
    v_mfma_f32_16x16x32_bf16 v[124:127], v[212:215], v[68:71], 0
    v_exp_f32 v56, v56
    ds_read_b128 v[88:91], v128 offset:18432
    ds_read_b128 v[92:95], v128 offset:19456
    v_exp_f32 v57, v57
    s_waitcnt lgkmcnt(2)
    v_mfma_f32_16x16x32_bf16 v[32:35], v[80:83], v[24:27], v[224:227]
    v_cvt_pk_bf16_f32 v75, v54, v55
    v_exp_f32 v58, v58
    v_mfma_f32_16x16x32_bf16 v[36:39], v[84:87], v[24:27], v[224:227]
    v_exp_f32 v59, v59
    v_cvt_pk_bf16_f32 v76, v56, v57
    v_mfma_f32_16x16x32_bf16 v[40:43], v[80:83], v[28:31], v[224:227]
    v_exp_f32 v60, v60
    v_exp_f32 v61, v61
    v_mfma_f32_16x16x32_bf16 v[44:47], v[84:87], v[28:31], v[224:227]
    v_cvt_pk_bf16_f32 v77, v58, v59
    v_exp_f32 v62, v62
    v_exp_f32 v63, v63
    v_cvt_pk_bf16_f32 v78, v60, v61
    v_cvt_pk_bf16_f32 v79, v62, v63
    s_cmp_eq_u32 s71, 2
    s_cbranch_scc1 Lht_130
    s_cmp_eq_u32 s71, 0
    s_cbranch_scc1 Lht_131
Lhb_129:
    ds_read_b128 v[80:83], v128 offset:8192
    ds_read_b128 v[84:87], v128 offset:9216
    v_exp_f32 v32, v32
    v_mfma_f32_16x16x32_bf16 v[104:107], v[96:99], v[72:75], v[104:107]
    v_exp_f32 v33, v33
    v_exp_f32 v34, v34
    v_mfma_f32_16x16x32_bf16 v[108:111], v[100:103], v[72:75], v[108:111]
    v_exp_f32 v35, v35
    v_cvt_pk_bf16_f32 v64, v32, v33
    v_mfma_f32_16x16x32_bf16 v[120:123], v[212:215], v[72:75], v[120:123]
    v_exp_f32 v36, v36
    v_exp_f32 v37, v37
    v_mfma_f32_16x16x32_bf16 v[112:115], v[96:99], v[76:79], v[112:115]
    v_cvt_pk_bf16_f32 v65, v34, v35
    v_exp_f32 v38, v38
    v_mfma_f32_16x16x32_bf16 v[116:119], v[100:103], v[76:79], v[116:119]
    v_exp_f32 v39, v39
    v_cvt_pk_bf16_f32 v66, v36, v37
    v_mfma_f32_16x16x32_bf16 v[124:127], v[212:215], v[76:79], v[124:127]
    v_exp_f32 v40, v40
    ds_read_b128 v[96:99], v128 offset:10240
    ds_read_b128 v[100:103], v128 offset:11264
    v_exp_f32 v41, v41
    s_waitcnt lgkmcnt(2)
    v_mfma_f32_16x16x32_bf16 v[48:51], v[80:83], v[24:27], v[224:227]
    v_cvt_pk_bf16_f32 v67, v38, v39
    v_exp_f32 v42, v42
    v_mfma_f32_16x16x32_bf16 v[52:55], v[84:87], v[24:27], v[224:227]
    v_exp_f32 v43, v43
    v_cvt_pk_bf16_f32 v68, v40, v41
    v_mfma_f32_16x16x32_bf16 v[56:59], v[80:83], v[28:31], v[224:227]
    v_exp_f32 v44, v44
    v_exp_f32 v45, v45
    v_mfma_f32_16x16x32_bf16 v[60:63], v[84:87], v[28:31], v[224:227]
    v_cvt_pk_bf16_f32 v69, v42, v43
    v_exp_f32 v46, v46
    v_exp_f32 v47, v47
    v_cvt_pk_bf16_f32 v70, v44, v45
    v_cvt_pk_bf16_f32 v71, v46, v47
    s_cmp_eq_u32 s71, 3
    s_cbranch_scc1 Lht_133
    s_cmp_eq_u32 s71, 1
    s_cbranch_scc1 Lht_134
Lhb_132:
    ds_read_b128 v[80:83], v128 offset:0
    ds_read_b128 v[84:87], v128 offset:1024
    v_exp_f32 v48, v48
    v_mfma_f32_16x16x32_bf16 v[104:107], v[88:91], v[64:67], v[104:107]
    v_exp_f32 v49, v49
    v_exp_f32 v50, v50
    v_mfma_f32_16x16x32_bf16 v[108:111], v[92:95], v[64:67], v[108:111]
    v_exp_f32 v51, v51
    v_cvt_pk_bf16_f32 v72, v48, v49
    v_mfma_f32_16x16x32_bf16 v[120:123], v[212:215], v[64:67], v[120:123]
    v_exp_f32 v52, v52
    v_exp_f32 v53, v53
    v_mfma_f32_16x16x32_bf16 v[112:115], v[88:91], v[68:71], v[112:115]
    v_cvt_pk_bf16_f32 v73, v50, v51
    v_exp_f32 v54, v54
    v_mfma_f32_16x16x32_bf16 v[116:119], v[92:95], v[68:71], v[116:119]
    v_exp_f32 v55, v55
    v_cvt_pk_bf16_f32 v74, v52, v53
    v_mfma_f32_16x16x32_bf16 v[124:127], v[212:215], v[68:71], v[124:127]
    v_exp_f32 v56, v56
    ds_read_b128 v[88:91], v128 offset:2048
    ds_read_b128 v[92:95], v128 offset:3072
    v_exp_f32 v57, v57
    s_waitcnt lgkmcnt(2)
    v_mfma_f32_16x16x32_bf16 v[32:35], v[80:83], v[24:27], v[224:227]
    v_cvt_pk_bf16_f32 v75, v54, v55
    v_exp_f32 v58, v58
    v_mfma_f32_16x16x32_bf16 v[36:39], v[84:87], v[24:27], v[224:227]
    v_exp_f32 v59, v59
    v_cvt_pk_bf16_f32 v76, v56, v57
    v_mfma_f32_16x16x32_bf16 v[40:43], v[80:83], v[28:31], v[224:227]
    v_exp_f32 v60, v60
    v_exp_f32 v61, v61
    v_mfma_f32_16x16x32_bf16 v[44:47], v[84:87], v[28:31], v[224:227]
    v_cvt_pk_bf16_f32 v77, v58, v59
    v_exp_f32 v62, v62
    v_exp_f32 v63, v63
    v_cvt_pk_bf16_f32 v78, v60, v61
    v_cvt_pk_bf16_f32 v79, v62, v63
    s_cmp_eq_u32 s71, 2
    s_cbranch_scc1 Lht_136
    s_cmp_eq_u32 s71, 0
    s_cbranch_scc1 Lht_137
Lhb_135:
    ds_read_b128 v[80:83], v129 offset:24576
    ds_read_b128 v[84:87], v129 offset:25600
    v_exp_f32 v32, v32
    v_mfma_f32_16x16x32_bf16 v[104:107], v[96:99], v[72:75], v[104:107]
    v_exp_f32 v33, v33
    v_exp_f32 v34, v34
    v_mfma_f32_16x16x32_bf16 v[108:111], v[100:103], v[72:75], v[108:111]
    v_exp_f32 v35, v35
    v_cvt_pk_bf16_f32 v64, v32, v33
    v_mfma_f32_16x16x32_bf16 v[120:123], v[212:215], v[72:75], v[120:123]
    v_exp_f32 v36, v36
    v_exp_f32 v37, v37
    v_mfma_f32_16x16x32_bf16 v[112:115], v[96:99], v[76:79], v[112:115]
    v_cvt_pk_bf16_f32 v65, v34, v35
    v_exp_f32 v38, v38
    v_mfma_f32_16x16x32_bf16 v[116:119], v[100:103], v[76:79], v[116:119]
    v_exp_f32 v39, v39
    v_cvt_pk_bf16_f32 v66, v36, v37
    v_mfma_f32_16x16x32_bf16 v[124:127], v[212:215], v[76:79], v[124:127]
    v_exp_f32 v40, v40
    ds_read_b128 v[96:99], v129 offset:26624
    ds_read_b128 v[100:103], v129 offset:27648
    v_exp_f32 v41, v41
    s_waitcnt lgkmcnt(2)
    v_mfma_f32_16x16x32_bf16 v[48:51], v[80:83], v[24:27], v[224:227]
    v_cvt_pk_bf16_f32 v67, v38, v39
    v_exp_f32 v42, v42
    v_mfma_f32_16x16x32_bf16 v[52:55], v[84:87], v[24:27], v[224:227]
    v_exp_f32 v43, v43
    v_cvt_pk_bf16_f32 v68, v40, v41
    v_mfma_f32_16x16x32_bf16 v[56:59], v[80:83], v[28:31], v[224:227]
    v_exp_f32 v44, v44
    v_exp_f32 v45, v45
    v_mfma_f32_16x16x32_bf16 v[60:63], v[84:87], v[28:31], v[224:227]
    v_cvt_pk_bf16_f32 v69, v42, v43
    v_exp_f32 v46, v46
    v_exp_f32 v47, v47
    v_cvt_pk_bf16_f32 v70, v44, v45
    v_cvt_pk_bf16_f32 v71, v46, v47
    s_cmp_eq_u32 s71, 3
    s_cbranch_scc1 Lht_139
    s_cmp_eq_u32 s71, 1
    s_cbranch_scc1 Lht_140
Lhb_138:
    ds_read_b128 v[80:83], v129 offset:16384
    ds_read_b128 v[84:87], v129 offset:17408
    v_exp_f32 v48, v48
    v_mfma_f32_16x16x32_bf16 v[104:107], v[88:91], v[64:67], v[104:107]
    v_exp_f32 v49, v49
    v_exp_f32 v50, v50
    v_mfma_f32_16x16x32_bf16 v[108:111], v[92:95], v[64:67], v[108:111]
    v_exp_f32 v51, v51
    v_cvt_pk_bf16_f32 v72, v48, v49
    v_mfma_f32_16x16x32_bf16 v[120:123], v[212:215], v[64:67], v[120:123]
    v_exp_f32 v52, v52
    v_exp_f32 v53, v53
    v_mfma_f32_16x16x32_bf16 v[112:115], v[88:91], v[68:71], v[112:115]
    v_cvt_pk_bf16_f32 v73, v50, v51
    v_exp_f32 v54, v54
    v_mfma_f32_16x16x32_bf16 v[116:119], v[92:95], v[68:71], v[116:119]
    v_exp_f32 v55, v55
    v_cvt_pk_bf16_f32 v74, v52, v53
    v_mfma_f32_16x16x32_bf16 v[124:127], v[212:215], v[68:71], v[124:127]
    v_exp_f32 v56, v56
    ds_read_b128 v[88:91], v129 offset:18432
    ds_read_b128 v[92:95], v129 offset:19456
    v_exp_f32 v57, v57
    s_waitcnt lgkmcnt(2)
    v_mfma_f32_16x16x32_bf16 v[32:35], v[80:83], v[24:27], v[224:227]
    v_cvt_pk_bf16_f32 v75, v54, v55
    v_exp_f32 v58, v58
    v_mfma_f32_16x16x32_bf16 v[36:39], v[84:87], v[24:27], v[224:227]
    v_exp_f32 v59, v59
    v_cvt_pk_bf16_f32 v76, v56, v57
    v_mfma_f32_16x16x32_bf16 v[40:43], v[80:83], v[28:31], v[224:227]
    v_exp_f32 v60, v60
    v_exp_f32 v61, v61
    v_mfma_f32_16x16x32_bf16 v[44:47], v[84:87], v[28:31], v[224:227]
    v_cvt_pk_bf16_f32 v77, v58, v59
    v_exp_f32 v62, v62
    v_exp_f32 v63, v63
    v_cvt_pk_bf16_f32 v78, v60, v61
    v_cvt_pk_bf16_f32 v79, v62, v63
    s_cmp_eq_u32 s71, 2
    s_cbranch_scc1 Lht_142
Lhb_141:
    ds_read_b128 v[80:83], v129 offset:8192
    ds_read_b128 v[84:87], v129 offset:9216
    v_exp_f32 v32, v32
    v_mfma_f32_16x16x32_bf16 v[104:107], v[96:99], v[72:75], v[104:107]
    v_exp_f32 v33, v33
    v_exp_f32 v34, v34
    v_mfma_f32_16x16x32_bf16 v[108:111], v[100:103], v[72:75], v[108:111]
    v_exp_f32 v35, v35
    v_cvt_pk_bf16_f32 v64, v32, v33
    v_mfma_f32_16x16x32_bf16 v[120:123], v[212:215], v[72:75], v[120:123]
    v_exp_f32 v36, v36
    v_exp_f32 v37, v37
    v_mfma_f32_16x16x32_bf16 v[112:115], v[96:99], v[76:79], v[112:115]
    v_cvt_pk_bf16_f32 v65, v34, v35
    v_exp_f32 v38, v38
    v_mfma_f32_16x16x32_bf16 v[116:119], v[100:103], v[76:79], v[116:119]
    v_exp_f32 v39, v39
    v_cvt_pk_bf16_f32 v66, v36, v37
    v_mfma_f32_16x16x32_bf16 v[124:127], v[212:215], v[76:79], v[124:127]
    v_exp_f32 v40, v40
    ds_read_b128 v[96:99], v129 offset:10240
    ds_read_b128 v[100:103], v129 offset:11264
    v_exp_f32 v41, v41
    s_waitcnt lgkmcnt(2)
    v_mfma_f32_16x16x32_bf16 v[48:51], v[80:83], v[24:27], v[224:227]
    v_cvt_pk_bf16_f32 v67, v38, v39
    v_exp_f32 v42, v42
    v_mfma_f32_16x16x32_bf16 v[52:55], v[84:87], v[24:27], v[224:227]
    v_exp_f32 v43, v43
    v_cvt_pk_bf16_f32 v68, v40, v41
    v_mfma_f32_16x16x32_bf16 v[56:59], v[80:83], v[28:31], v[224:227]
    v_exp_f32 v44, v44
    v_exp_f32 v45, v45
    v_mfma_f32_16x16x32_bf16 v[60:63], v[84:87], v[28:31], v[224:227]
    v_cvt_pk_bf16_f32 v69, v42, v43
    v_exp_f32 v46, v46
    v_exp_f32 v47, v47
    v_cvt_pk_bf16_f32 v70, v44, v45
    v_cvt_pk_bf16_f32 v71, v46, v47
    s_cmp_eq_u32 s71, 3
    s_cbranch_scc1 Lht_144
Lhb_143:
    ds_read_b128 v[80:83], v129 offset:0
    ds_read_b128 v[84:87], v129 offset:1024
    v_exp_f32 v48, v48
    v_mfma_f32_16x16x32_bf16 v[104:107], v[88:91], v[64:67], v[104:107]
    v_exp_f32 v49, v49
    v_exp_f32 v50, v50
    v_mfma_f32_16x16x32_bf16 v[108:111], v[92:95], v[64:67], v[108:111]
    v_exp_f32 v51, v51
    v_cvt_pk_bf16_f32 v72, v48, v49
    v_mfma_f32_16x16x32_bf16 v[120:123], v[212:215], v[64:67], v[120:123]
    v_exp_f32 v52, v52
    v_exp_f32 v53, v53
    v_mfma_f32_16x16x32_bf16 v[112:115], v[88:91], v[68:71], v[112:115]
    v_cvt_pk_bf16_f32 v73, v50, v51
    v_exp_f32 v54, v54
    v_mfma_f32_16x16x32_bf16 v[116:119], v[92:95], v[68:71], v[116:119]
    v_exp_f32 v55, v55
    v_cvt_pk_bf16_f32 v74, v52, v53
    v_mfma_f32_16x16x32_bf16 v[124:127], v[212:215], v[68:71], v[124:127]
    v_exp_f32 v56, v56
    ds_read_b128 v[88:91], v129 offset:2048
    ds_read_b128 v[92:95], v129 offset:3072
    v_exp_f32 v57, v57
    s_waitcnt lgkmcnt(2)
    v_mfma_f32_16x16x32_bf16 v[32:35], v[80:83], v[24:27], v[220:223]
    v_cvt_pk_bf16_f32 v75, v54, v55
    v_exp_f32 v58, v58
    v_mfma_f32_16x16x32_bf16 v[36:39], v[84:87], v[24:27], v[224:227]
    v_exp_f32 v59, v59
    v_cvt_pk_bf16_f32 v76, v56, v57
    v_mfma_f32_16x16x32_bf16 v[44:47], v[84:87], v[28:31], v[220:223]
    v_exp_f32 v60, v60
    v_exp_f32 v61, v61
    v_cvt_pk_bf16_f32 v77, v58, v59
    v_exp_f32 v62, v62
    v_exp_f32 v63, v63
    v_cvt_pk_bf16_f32 v78, v60, v61
    v_cvt_pk_bf16_f32 v79, v62, v63
Lhb_145:
    v_mfma_f32_16x16x32_bf16 v[104:107], v[96:99], v[72:75], v[104:107]
    v_exp_f32 v32, v32
    v_exp_f32 v33, v33
    v_mfma_f32_16x16x32_bf16 v[108:111], v[100:103], v[72:75], v[108:111]
    v_exp_f32 v34, v34
    v_exp_f32 v35, v35
    v_mfma_f32_16x16x32_bf16 v[120:123], v[212:215], v[72:75], v[120:123]
    v_cvt_pk_bf16_f32 v64, v32, v33
    v_mfma_f32_16x16x32_bf16 v[112:115], v[96:99], v[76:79], v[112:115]
    v_exp_f32 v36, v36
    v_exp_f32 v37, v37
    v_mfma_f32_16x16x32_bf16 v[116:119], v[100:103], v[76:79], v[116:119]
    v_cvt_pk_bf16_f32 v65, v34, v35
    v_exp_f32 v38, v38
    v_mfma_f32_16x16x32_bf16 v[124:127], v[212:215], v[76:79], v[124:127]
    v_exp_f32 v39, v39
    v_cvt_pk_bf16_f32 v66, v36, v37
    v_exp_f32 v44, v44
    v_exp_f32 v45, v45
    v_cvt_pk_bf16_f32 v67, v38, v39
    v_exp_f32 v46, v46
    v_exp_f32 v47, v47
    v_cvt_pk_bf16_f32 v70, v44, v45
    v_mov_b32 v68, 0
    v_mov_b32 v69, 0
    v_cvt_pk_bf16_f32 v71, v46, v47
    s_waitcnt lgkmcnt(0)
    v_mfma_f32_16x16x32_bf16 v[104:107], v[88:91], v[64:67], v[104:107]
    v_mfma_f32_16x16x32_bf16 v[108:111], v[92:95], v[64:67], v[108:111]
    v_mfma_f32_16x16x32_bf16 v[120:123], v[212:215], v[64:67], v[120:123]
    v_mfma_f32_16x16x32_bf16 v[112:115], v[88:91], v[68:71], v[112:115]
    v_mfma_f32_16x16x32_bf16 v[116:119], v[92:95], v[68:71], v[116:119]
    v_mfma_f32_16x16x32_bf16 v[124:127], v[212:215], v[68:71], v[124:127]
    v_mov_b32 v132, 0
    v_mov_b32 v133, 0
    s_nop 0
    v_maximum3_f32 v132, |v104|, |v105|, v132
    v_maximum3_f32 v133, |v106|, |v107|, v133
    v_maximum3_f32 v132, |v108|, |v109|, v132
    v_maximum3_f32 v133, |v110|, |v111|, v133
    v_maximum3_f32 v132, |v112|, |v113|, v132
    v_maximum3_f32 v133, |v114|, |v115|, v133
    v_maximum3_f32 v132, |v116|, |v117|, v132
    v_maximum3_f32 v133, |v118|, |v119|, v133
    v_min_f32 v134, v120, v124
    v_maximum3_f32 v132, v132, v133, 0
    v_cmp_nle_f32 vcc, 0x21800000, v134
    v_mul_f32 v132, 0x21800000, v132
    s_mov_b64 s[28:29], vcc
    v_maximum3_f32 v132, v132, v120, v124
    v_cmp_nge_f32 vcc, 0x5d800000, v132
    s_nop 0
    s_or_b64 vcc, vcc, s[28:29]
    s_cbranch_vccnz L_exact
L_aok:
    v_rcp_f32 v132, v120
    v_rcp_f32 v134, v124
    v_mul_f32 v104, v104, v132
    v_mul_f32 v112, v112, v134
    v_mul_f32 v105, v105, v132
    v_mul_f32 v113, v113, v134
    v_mul_f32 v106, v106, v132
    v_mul_f32 v114, v114, v134
    v_mul_f32 v107, v107, v132
    v_mul_f32 v115, v115, v134
    v_mul_f32 v108, v108, v132
    v_mul_f32 v116, v116, v134
    v_mul_f32 v109, v109, v132
    v_mul_f32 v117, v117, v134
    v_mul_f32 v110, v110, v132
    v_mul_f32 v118, v118, v134
    v_mul_f32 v111, v111, v132
    v_mul_f32 v119, v119, v134
    v_add_u32 v104, 0x8000, v104
    v_add_u32 v112, 0x8000, v112
    v_cvt_pk_bf16_f32 v104, v104, v105
    v_cvt_pk_bf16_f32 v112, v112, v113
    v_cvt_pk_bf16_f32 v105, v106, v107
    v_cvt_pk_bf16_f32 v113, v114, v115
    v_cvt_pk_bf16_f32 v106, v108, v109
    v_cvt_pk_bf16_f32 v114, v116, v117
    v_cvt_pk_bf16_f32 v107, v110, v111
    v_cvt_pk_bf16_f32 v115, v118, v119
    v_and_b32 v104, -2, v104
    v_and_b32 v112, -2, v112
    s_cmp_eq_u32 s23, 0
    s_cbranch_scc1 Lwt_146
    buffer_store_dwordx4 v[104:107], v0, s[88:91], s62 offen offset:0
    buffer_store_dwordx4 v[112:115], v0, s[88:91], s62 offen offset:1024
Lwt_147:
    s_cmp_ge_u32 s3, 4
    s_cbranch_scc1 L_lnext
    v_xor_b32 v232, 0, v2
    v_xor_b32 v233, 32, v2
    v_xor_b32 v234, 64, v2
    v_xor_b32 v235, 96, v2
    v_add_u32 v236, 65536, v232
    v_add_u32 v237, 65536, v233
    v_add_u32 v238, 65536, v234
    v_add_u32 v239, 65536, v235
    v_add_u32 v240, 131072, v232
    v_add_u32 v241, 131072, v233
    v_add_u32 v242, 131072, v234
    v_add_u32 v243, 131072, v235
    v_add_u32 v248, s1, v0
    s_lshl_b32 s28, s3, 12
    s_add_u32 s28, s28, 32768
    v_add_u32 v249, s28, v0
    s_lshl_b32 s44, s21, 12
    s_xor_b32 s45, s44, 32768
    s_xor_b32 s46, s44, 4096
    s_xor_b32 s47, s44, 36864
L_g2:
    buffer_load_dwordx4 v[56:59], v248, s[88:91], s44 offen offset:0 sc1
    buffer_load_dwordx4 v[60:63], v248, s[88:91], s44 offen offset:1024 sc1
    buffer_load_dwordx4 v[64:67], v248, s[88:91], s44 offen offset:2048 sc1
    ds_read_b64_tr_b16 v[120:121], v232 offset:0
    ds_read_b64_tr_b16 v[122:123], v232 offset:2048
    ds_read_b64_tr_b16 v[124:125], v233 offset:0
    ds_read_b64_tr_b16 v[126:127], v233 offset:2048
    ds_read_b64_tr_b16 v[128:129], v234 offset:0
    ds_read_b64_tr_b16 v[130:131], v234 offset:2048
    buffer_load_dwordx4 v[68:71], v248, s[88:91], s44 offen offset:3072 sc1
    ds_read_b64_tr_b16 v[132:133], v235 offset:0
    ds_read_b64_tr_b16 v[134:135], v235 offset:2048
    v_mov_b32 v104, 0
    v_mov_b32 v108, 0
    v_mov_b32 v112, 0
    v_mov_b32 v116, 0
    buffer_load_dwordx4 v[72:75], v248, s[88:91], s45 offen offset:0 sc1
    ds_read_b64_tr_b16 v[136:137], v232 offset:4096
    ds_read_b64_tr_b16 v[138:139], v232 offset:6144
    ds_read_b64_tr_b16 v[140:141], v233 offset:4096
    ds_read_b64_tr_b16 v[142:143], v233 offset:6144
    ds_read_b64_tr_b16 v[144:145], v234 offset:4096
    ds_read_b64_tr_b16 v[146:147], v234 offset:6144
    buffer_load_dwordx4 v[76:79], v248, s[88:91], s45 offen offset:1024 sc1
    ds_read_b64_tr_b16 v[148:149], v235 offset:4096
    ds_read_b64_tr_b16 v[150:151], v235 offset:6144
    v_lshlrev_b32 v24, 16, v8
    v_and_b32 v25, 0xffff0000, v8
    v_lshlrev_b32 v26, 16, v9
    v_and_b32 v27, 0xffff0000, v9
    buffer_load_dwordx4 v[80:83], v248, s[88:91], s45 offen offset:2048 sc1
    v_lshlrev_b32 v28, 16, v10
    v_and_b32 v29, 0xffff0000, v10
    v_lshlrev_b32 v30, 16, v11
    v_and_b32 v31, 0xffff0000, v11
    v_lshlrev_b32 v32, 16, v12
    v_and_b32 v33, 0xffff0000, v12
    buffer_load_dwordx4 v[84:87], v248, s[88:91], s45 offen offset:3072 sc1
    v_lshlrev_b32 v34, 16, v13
    v_and_b32 v35, 0xffff0000, v13
    v_lshlrev_b32 v36, 16, v14
    v_and_b32 v37, 0xffff0000, v14
    v_lshlrev_b32 v38, 16, v15
    v_and_b32 v39, 0xffff0000, v15
    buffer_load_dwordx4 v[88:91], v248, s[88:91], s46 offen offset:0 sc1
    v_lshlrev_b32 v40, 16, v16
    v_and_b32 v41, 0xffff0000, v16
    v_lshlrev_b32 v42, 16, v17
    v_and_b32 v43, 0xffff0000, v17
    v_lshlrev_b32 v44, 16, v18
    v_and_b32 v45, 0xffff0000, v18
    buffer_load_dwordx4 v[92:95], v248, s[88:91], s46 offen offset:1024 sc1
    v_lshlrev_b32 v46, 16, v19
    v_and_b32 v47, 0xffff0000, v19
    v_lshlrev_b32 v48, 16, v20
    v_and_b32 v49, 0xffff0000, v20
    v_lshlrev_b32 v50, 16, v21
    v_and_b32 v51, 0xffff0000, v21
    buffer_load_dwordx4 v[96:99], v248, s[88:91], s46 offen offset:2048 sc1
    v_lshlrev_b32 v52, 16, v22
    v_and_b32 v53, 0xffff0000, v22
    v_lshlrev_b32 v54, 16, v23
    v_and_b32 v55, 0xffff0000, v23
    buffer_load_dwordx4 v[100:103], v248, s[88:91], s46 offen offset:3072 sc1
    s_add_u32 s22, s22, 1
    s_mov_b32 s96, 0
    s_lshr_b32 s27, s3, 1
    s_lshl_b32 s27, s27, 13
    v_add_u32 v200, s27, v0
    v_add_u32 v201, 1024, v200
    v_and_b32 v206, 2147483647, v206
    s_bitcmp1_b32 s22, 0
    s_cselect_b32 s8, s58, s52
    s_cselect_b32 s9, s59, s53
    s_waitcnt vmcnt(8)
    v_or3_b32 v250, v56, v60, v64
    v_bitop3_b32 v250, v250, v68, 1 bitop3:0xa8
    v_cmp_ne_u32 vcc, 0, v250
    s_nop 0
    s_cbranch_vccnz Lot_149
Look_150:
    s_waitcnt lgkmcnt(8)
    v_mfma_f32_16x16x32_bf16 v[24:27], v[120:123], v[56:59], v[24:27]
    ds_read_b64_tr_b16 v[152:153], v232 offset:8192
    v_mfma_f32_16x16x32_bf16 v[40:43], v[120:123], v[60:63], v[40:43]
    ds_read_b64_tr_b16 v[154:155], v232 offset:10240
    buffer_load_dwordx4 v[104:107], v248, s[88:91], s47 offen offset:0 sc1
    v_mfma_f32_16x16x32_bf16 v[44:47], v[124:127], v[60:63], v[44:47]
    ds_read_b64_tr_b16 v[156:157], v233 offset:8192
    v_mfma_f32_16x16x32_bf16 v[28:31], v[124:127], v[56:59], v[28:31]
    ds_read_b64_tr_b16 v[158:159], v233 offset:10240
    v_mfma_f32_16x16x32_bf16 v[32:35], v[128:131], v[56:59], v[32:35]
    ds_read_b64_tr_b16 v[160:161], v234 offset:8192
    buffer_load_dwordx4 v[108:111], v248, s[88:91], s47 offen offset:1024 sc1
    v_mfma_f32_16x16x32_bf16 v[48:51], v[128:131], v[60:63], v[48:51]
    ds_read_b64_tr_b16 v[162:163], v234 offset:10240
    v_mfma_f32_16x16x32_bf16 v[52:55], v[132:135], v[60:63], v[52:55]
    ds_read_b64_tr_b16 v[164:165], v235 offset:8192
    v_mfma_f32_16x16x32_bf16 v[36:39], v[132:135], v[56:59], v[36:39]
    ds_read_b64_tr_b16 v[166:167], v235 offset:10240
    s_waitcnt lgkmcnt(8)
    v_mfma_f32_16x16x32_bf16 v[24:27], v[136:139], v[64:67], v[24:27]
    ds_read_b64_tr_b16 v[120:121], v232 offset:12288
    buffer_load_dwordx4 v[112:115], v248, s[88:91], s47 offen offset:2048 sc1
    v_mfma_f32_16x16x32_bf16 v[40:43], v[136:139], v[68:71], v[40:43]
    ds_read_b64_tr_b16 v[122:123], v232 offset:14336
    s_waitcnt vmcnt(7)
    v_mfma_f32_16x16x32_bf16 v[44:47], v[140:143], v[68:71], v[44:47]
    ds_read_b64_tr_b16 v[124:125], v233 offset:12288
    v_or3_b32 v250, v72, v76, v80
    v_mfma_f32_16x16x32_bf16 v[28:31], v[140:143], v[64:67], v[28:31]
    ds_read_b64_tr_b16 v[126:127], v233 offset:14336
    v_bitop3_b32 v250, v250, v84, 1 bitop3:0xa8
    v_mfma_f32_16x16x32_bf16 v[32:35], v[144:147], v[64:67], v[32:35]
    ds_read_b64_tr_b16 v[128:129], v234 offset:12288
    buffer_load_dwordx4 v[116:119], v248, s[88:91], s47 offen offset:3072 sc1
    v_mfma_f32_16x16x32_bf16 v[48:51], v[144:147], v[68:71], v[48:51]
    ds_read_b64_tr_b16 v[130:131], v234 offset:14336
    v_cmp_ne_u32 vcc, 0, v250
    v_mfma_f32_16x16x32_bf16 v[52:55], v[148:151], v[68:71], v[52:55]
    ds_read_b64_tr_b16 v[132:133], v235 offset:12288
    s_cbranch_vccnz Lot_152
Look_153:
    v_mfma_f32_16x16x32_bf16 v[36:39], v[148:151], v[64:67], v[36:39]
    ds_read_b64_tr_b16 v[134:135], v235 offset:14336
    s_waitcnt lgkmcnt(8)
    v_mfma_f32_16x16x32_bf16 v[24:27], v[152:155], v[72:75], v[24:27]
    ds_read_b64_tr_b16 v[136:137], v232 offset:16384
    s_xor_b32 s44, s44, 8192
    v_mfma_f32_16x16x32_bf16 v[40:43], v[152:155], v[76:79], v[40:43]
    ds_read_b64_tr_b16 v[138:139], v232 offset:18432
    buffer_load_dwordx4 v[56:59], v248, s[88:91], s44 offen offset:0 sc1
    v_mfma_f32_16x16x32_bf16 v[44:47], v[156:159], v[76:79], v[44:47]
    ds_read_b64_tr_b16 v[140:141], v233 offset:16384
    v_mfma_f32_16x16x32_bf16 v[28:31], v[156:159], v[72:75], v[28:31]
    ds_read_b64_tr_b16 v[142:143], v233 offset:18432
    v_mfma_f32_16x16x32_bf16 v[32:35], v[160:163], v[72:75], v[32:35]
    ds_read_b64_tr_b16 v[144:145], v234 offset:16384
    buffer_load_dwordx4 v[60:63], v248, s[88:91], s44 offen offset:1024 sc1
    v_mfma_f32_16x16x32_bf16 v[48:51], v[160:163], v[76:79], v[48:51]
    ds_read_b64_tr_b16 v[146:147], v234 offset:18432
    v_mfma_f32_16x16x32_bf16 v[52:55], v[164:167], v[76:79], v[52:55]
    ds_read_b64_tr_b16 v[148:149], v235 offset:16384
    v_mfma_f32_16x16x32_bf16 v[36:39], v[164:167], v[72:75], v[36:39]
    ds_read_b64_tr_b16 v[150:151], v235 offset:18432
    s_waitcnt lgkmcnt(8)
    v_mfma_f32_16x16x32_bf16 v[24:27], v[120:123], v[80:83], v[24:27]
    ds_read_b64_tr_b16 v[152:153], v232 offset:20480
    buffer_load_dwordx4 v[64:67], v248, s[88:91], s44 offen offset:2048 sc1
    v_mfma_f32_16x16x32_bf16 v[40:43], v[120:123], v[84:87], v[40:43]
    ds_read_b64_tr_b16 v[154:155], v232 offset:22528
    s_waitcnt vmcnt(7)
    v_mfma_f32_16x16x32_bf16 v[44:47], v[124:127], v[84:87], v[44:47]
    ds_read_b64_tr_b16 v[156:157], v233 offset:20480
    v_or3_b32 v250, v88, v92, v96
    v_mfma_f32_16x16x32_bf16 v[28:31], v[124:127], v[80:83], v[28:31]
    ds_read_b64_tr_b16 v[158:159], v233 offset:22528
    v_bitop3_b32 v250, v250, v100, 1 bitop3:0xa8
    v_mfma_f32_16x16x32_bf16 v[32:35], v[128:131], v[80:83], v[32:35]
    ds_read_b64_tr_b16 v[160:161], v234 offset:20480
    buffer_load_dwordx4 v[68:71], v248, s[88:91], s44 offen offset:3072 sc1
    v_mfma_f32_16x16x32_bf16 v[48:51], v[128:131], v[84:87], v[48:51]
    ds_read_b64_tr_b16 v[162:163], v234 offset:22528
    v_cmp_ne_u32 vcc, 0, v250
    v_mfma_f32_16x16x32_bf16 v[52:55], v[132:135], v[84:87], v[52:55]
    ds_read_b64_tr_b16 v[164:165], v235 offset:20480
    s_cbranch_vccnz Lot_155
Look_156:
    v_mfma_f32_16x16x32_bf16 v[36:39], v[132:135], v[80:83], v[36:39]
    ds_read_b64_tr_b16 v[166:167], v235 offset:22528
    s_waitcnt lgkmcnt(8)
    v_mfma_f32_16x16x32_bf16 v[24:27], v[136:139], v[88:91], v[24:27]
    ds_read_b64_tr_b16 v[120:121], v232 offset:24576
    s_xor_b32 s45, s45, 8192
    v_mfma_f32_16x16x32_bf16 v[40:43], v[136:139], v[92:95], v[40:43]
    ds_read_b64_tr_b16 v[122:123], v232 offset:26624
    buffer_load_dwordx4 v[72:75], v248, s[88:91], s45 offen offset:0 sc1
    v_mfma_f32_16x16x32_bf16 v[44:47], v[140:143], v[92:95], v[44:47]
    ds_read_b64_tr_b16 v[124:125], v233 offset:24576
    v_mfma_f32_16x16x32_bf16 v[28:31], v[140:143], v[88:91], v[28:31]
    ds_read_b64_tr_b16 v[126:127], v233 offset:26624
    v_mfma_f32_16x16x32_bf16 v[32:35], v[144:147], v[88:91], v[32:35]
    ds_read_b64_tr_b16 v[128:129], v234 offset:24576
    buffer_load_dwordx4 v[76:79], v248, s[88:91], s45 offen offset:1024 sc1
    v_mfma_f32_16x16x32_bf16 v[48:51], v[144:147], v[92:95], v[48:51]
    ds_read_b64_tr_b16 v[130:131], v234 offset:26624
    v_mfma_f32_16x16x32_bf16 v[52:55], v[148:151], v[92:95], v[52:55]
    ds_read_b64_tr_b16 v[132:133], v235 offset:24576
    v_mfma_f32_16x16x32_bf16 v[36:39], v[148:151], v[88:91], v[36:39]
    ds_read_b64_tr_b16 v[134:135], v235 offset:26624
    s_waitcnt lgkmcnt(8)
    v_mfma_f32_16x16x32_bf16 v[24:27], v[152:155], v[96:99], v[24:27]
    ds_read_b64_tr_b16 v[136:137], v232 offset:28672
    buffer_load_dwordx4 v[80:83], v248, s[88:91], s45 offen offset:2048 sc1
    v_mfma_f32_16x16x32_bf16 v[40:43], v[152:155], v[100:103], v[40:43]
    ds_read_b64_tr_b16 v[138:139], v232 offset:30720
    s_waitcnt vmcnt(7)
    v_mfma_f32_16x16x32_bf16 v[44:47], v[156:159], v[100:103], v[44:47]
    ds_read_b64_tr_b16 v[140:141], v233 offset:28672
    v_or3_b32 v250, v104, v108, v112
    v_mfma_f32_16x16x32_bf16 v[28:31], v[156:159], v[96:99], v[28:31]
    ds_read_b64_tr_b16 v[142:143], v233 offset:30720
    v_bitop3_b32 v250, v250, v116, 1 bitop3:0xa8
    v_mfma_f32_16x16x32_bf16 v[32:35], v[160:163], v[96:99], v[32:35]
    ds_read_b64_tr_b16 v[144:145], v234 offset:28672
    buffer_load_dwordx4 v[84:87], v248, s[88:91], s45 offen offset:3072 sc1
    v_mfma_f32_16x16x32_bf16 v[48:51], v[160:163], v[100:103], v[48:51]
    ds_read_b64_tr_b16 v[146:147], v234 offset:30720
    v_cmp_ne_u32 vcc, 0, v250
    v_mfma_f32_16x16x32_bf16 v[52:55], v[164:167], v[100:103], v[52:55]
    ds_read_b64_tr_b16 v[148:149], v235 offset:28672
    s_cbranch_vccnz Lot_158
Look_159:
    v_mfma_f32_16x16x32_bf16 v[36:39], v[164:167], v[96:99], v[36:39]
    ds_read_b64_tr_b16 v[150:151], v235 offset:30720
    s_barrier
    s_waitcnt lgkmcnt(8)
    v_mfma_f32_16x16x32_bf16 v[24:27], v[120:123], v[104:107], v[24:27]
    ds_read_b64_tr_b16 v[152:153], v236 offset:0
    s_xor_b32 s46, s46, 8192
    v_mfma_f32_16x16x32_bf16 v[40:43], v[120:123], v[108:111], v[40:43]
    ds_read_b64_tr_b16 v[154:155], v236 offset:2048
    buffer_load_dwordx4 v[88:91], v248, s[88:91], s46 offen offset:0 sc1
    v_mfma_f32_16x16x32_bf16 v[44:47], v[124:127], v[108:111], v[44:47]
    ds_read_b64_tr_b16 v[156:157], v237 offset:0
    v_mfma_f32_16x16x32_bf16 v[28:31], v[124:127], v[104:107], v[28:31]
    ds_read_b64_tr_b16 v[158:159], v237 offset:2048
    v_mfma_f32_16x16x32_bf16 v[32:35], v[128:131], v[104:107], v[32:35]
    ds_read_b64_tr_b16 v[160:161], v238 offset:0
    buffer_load_dwordx4 v[92:95], v248, s[88:91], s46 offen offset:1024 sc1
    v_mfma_f32_16x16x32_bf16 v[48:51], v[128:131], v[108:111], v[48:51]
    ds_read_b64_tr_b16 v[162:163], v238 offset:2048
    v_mfma_f32_16x16x32_bf16 v[52:55], v[132:135], v[108:111], v[52:55]
    ds_read_b64_tr_b16 v[164:165], v239 offset:0
    v_mfma_f32_16x16x32_bf16 v[36:39], v[132:135], v[104:107], v[36:39]
    ds_read_b64_tr_b16 v[166:167], v239 offset:2048
    s_waitcnt lgkmcnt(8)
    v_mfma_f32_16x16x32_bf16 v[24:27], v[136:139], v[112:115], v[24:27]
    ds_read_b64_tr_b16 v[120:121], v236 offset:4096
    buffer_load_dwordx4 v[96:99], v248, s[88:91], s46 offen offset:2048 sc1
    v_mfma_f32_16x16x32_bf16 v[40:43], v[136:139], v[116:119], v[40:43]
    ds_read_b64_tr_b16 v[122:123], v236 offset:6144
    s_waitcnt vmcnt(7)
    v_mfma_f32_16x16x32_bf16 v[44:47], v[140:143], v[116:119], v[44:47]
    ds_read_b64_tr_b16 v[124:125], v237 offset:4096
    v_or3_b32 v250, v56, v60, v64
    v_mfma_f32_16x16x32_bf16 v[28:31], v[140:143], v[112:115], v[28:31]
    ds_read_b64_tr_b16 v[126:127], v237 offset:6144
    v_bitop3_b32 v250, v250, v68, 1 bitop3:0xa8
    v_mfma_f32_16x16x32_bf16 v[32:35], v[144:147], v[112:115], v[32:35]
    ds_read_b64_tr_b16 v[128:129], v238 offset:4096
    buffer_load_dwordx4 v[100:103], v248, s[88:91], s46 offen offset:3072 sc1
    v_mfma_f32_16x16x32_bf16 v[48:51], v[144:147], v[116:119], v[48:51]
    ds_read_b64_tr_b16 v[130:131], v238 offset:6144
    v_cmp_ne_u32 vcc, 0, v250
    v_mfma_f32_16x16x32_bf16 v[52:55], v[148:151], v[116:119], v[52:55]
    ds_read_b64_tr_b16 v[132:133], v239 offset:4096
    s_cbranch_vccnz Lot_161
Look_162:
    v_mfma_f32_16x16x32_bf16 v[36:39], v[148:151], v[112:115], v[36:39]
    ds_read_b64_tr_b16 v[134:135], v239 offset:6144
    s_waitcnt lgkmcnt(8)
    v_mfma_f32_16x16x32_bf16 v[24:27], v[152:155], v[56:59], v[24:27]
    ds_read_b64_tr_b16 v[136:137], v236 offset:8192
    s_xor_b32 s47, s47, 8192
    v_mfma_f32_16x16x32_bf16 v[40:43], v[152:155], v[60:63], v[40:43]
    ds_read_b64_tr_b16 v[138:139], v236 offset:10240
    buffer_load_dwordx4 v[104:107], v248, s[88:91], s47 offen offset:0 sc1
    v_mfma_f32_16x16x32_bf16 v[44:47], v[156:159], v[60:63], v[44:47]
    ds_read_b64_tr_b16 v[140:141], v237 offset:8192
    v_mfma_f32_16x16x32_bf16 v[28:31], v[156:159], v[56:59], v[28:31]
    ds_read_b64_tr_b16 v[142:143], v237 offset:10240
    v_mfma_f32_16x16x32_bf16 v[32:35], v[160:163], v[56:59], v[32:35]
    ds_read_b64_tr_b16 v[144:145], v238 offset:8192
    buffer_load_dwordx4 v[108:111], v248, s[88:91], s47 offen offset:1024 sc1
    v_mfma_f32_16x16x32_bf16 v[48:51], v[160:163], v[60:63], v[48:51]
    ds_read_b64_tr_b16 v[146:147], v238 offset:10240
    v_mfma_f32_16x16x32_bf16 v[52:55], v[164:167], v[60:63], v[52:55]
    ds_read_b64_tr_b16 v[148:149], v239 offset:8192
    v_mfma_f32_16x16x32_bf16 v[36:39], v[164:167], v[56:59], v[36:39]
    ds_read_b64_tr_b16 v[150:151], v239 offset:10240
    s_waitcnt lgkmcnt(8)
    v_mfma_f32_16x16x32_bf16 v[24:27], v[120:123], v[64:67], v[24:27]
    ds_read_b64_tr_b16 v[152:153], v236 offset:12288
    buffer_load_dwordx4 v[112:115], v248, s[88:91], s47 offen offset:2048 sc1
    v_mfma_f32_16x16x32_bf16 v[40:43], v[120:123], v[68:71], v[40:43]
    ds_read_b64_tr_b16 v[154:155], v236 offset:14336
    s_waitcnt vmcnt(7)
    v_mfma_f32_16x16x32_bf16 v[44:47], v[124:127], v[68:71], v[44:47]
    ds_read_b64_tr_b16 v[156:157], v237 offset:12288
    v_or3_b32 v250, v72, v76, v80
    v_mfma_f32_16x16x32_bf16 v[28:31], v[124:127], v[64:67], v[28:31]
    ds_read_b64_tr_b16 v[158:159], v237 offset:14336
    v_bitop3_b32 v250, v250, v84, 1 bitop3:0xa8
    v_mfma_f32_16x16x32_bf16 v[32:35], v[128:131], v[64:67], v[32:35]
    ds_read_b64_tr_b16 v[160:161], v238 offset:12288
    buffer_load_dwordx4 v[116:119], v248, s[88:91], s47 offen offset:3072 sc1
    v_mfma_f32_16x16x32_bf16 v[48:51], v[128:131], v[68:71], v[48:51]
    ds_read_b64_tr_b16 v[162:163], v238 offset:14336
    v_cmp_ne_u32 vcc, 0, v250
    v_mfma_f32_16x16x32_bf16 v[52:55], v[132:135], v[68:71], v[52:55]
    ds_read_b64_tr_b16 v[164:165], v239 offset:12288
    s_cbranch_vccnz Lot_164
Look_165:
    v_mfma_f32_16x16x32_bf16 v[36:39], v[132:135], v[64:67], v[36:39]
    ds_read_b64_tr_b16 v[166:167], v239 offset:14336
    s_waitcnt lgkmcnt(8)
    v_mfma_f32_16x16x32_bf16 v[24:27], v[136:139], v[72:75], v[24:27]
    ds_read_b64_tr_b16 v[120:121], v236 offset:16384
    s_xor_b32 s44, s44, 24576
    v_mfma_f32_16x16x32_bf16 v[40:43], v[136:139], v[76:79], v[40:43]
    ds_read_b64_tr_b16 v[122:123], v236 offset:18432
    buffer_load_dwordx4 v[56:59], v248, s[88:91], s44 offen offset:0 sc1
    v_mfma_f32_16x16x32_bf16 v[44:47], v[140:143], v[76:79], v[44:47]
    ds_read_b64_tr_b16 v[124:125], v237 offset:16384
    v_mfma_f32_16x16x32_bf16 v[28:31], v[140:143], v[72:75], v[28:31]
    ds_read_b64_tr_b16 v[126:127], v237 offset:18432
    v_mfma_f32_16x16x32_bf16 v[32:35], v[144:147], v[72:75], v[32:35]
    ds_read_b64_tr_b16 v[128:129], v238 offset:16384
    buffer_load_dwordx4 v[60:63], v248, s[88:91], s44 offen offset:1024 sc1
    v_mfma_f32_16x16x32_bf16 v[48:51], v[144:147], v[76:79], v[48:51]
    ds_read_b64_tr_b16 v[130:131], v238 offset:18432
    v_mfma_f32_16x16x32_bf16 v[52:55], v[148:151], v[76:79], v[52:55]
    ds_read_b64_tr_b16 v[132:133], v239 offset:16384
    v_mfma_f32_16x16x32_bf16 v[36:39], v[148:151], v[72:75], v[36:39]
    ds_read_b64_tr_b16 v[134:135], v239 offset:18432
    s_waitcnt lgkmcnt(8)
    v_mfma_f32_16x16x32_bf16 v[24:27], v[152:155], v[80:83], v[24:27]
    ds_read_b64_tr_b16 v[136:137], v236 offset:20480
    buffer_load_dwordx4 v[64:67], v248, s[88:91], s44 offen offset:2048 sc1
    v_mfma_f32_16x16x32_bf16 v[40:43], v[152:155], v[84:87], v[40:43]
    ds_read_b64_tr_b16 v[138:139], v236 offset:22528
    s_waitcnt vmcnt(7)
    v_mfma_f32_16x16x32_bf16 v[44:47], v[156:159], v[84:87], v[44:47]
    ds_read_b64_tr_b16 v[140:141], v237 offset:20480
    v_or3_b32 v250, v88, v92, v96
    v_mfma_f32_16x16x32_bf16 v[28:31], v[156:159], v[80:83], v[28:31]
    ds_read_b64_tr_b16 v[142:143], v237 offset:22528
    v_bitop3_b32 v250, v250, v100, 1 bitop3:0xa8
    v_mfma_f32_16x16x32_bf16 v[32:35], v[160:163], v[80:83], v[32:35]
    ds_read_b64_tr_b16 v[144:145], v238 offset:20480
    buffer_load_dwordx4 v[68:71], v248, s[88:91], s44 offen offset:3072 sc1
    v_mfma_f32_16x16x32_bf16 v[48:51], v[160:163], v[84:87], v[48:51]
    ds_read_b64_tr_b16 v[146:147], v238 offset:22528
    v_cmp_ne_u32 vcc, 0, v250
    v_mfma_f32_16x16x32_bf16 v[52:55], v[164:167], v[84:87], v[52:55]
    ds_read_b64_tr_b16 v[148:149], v239 offset:20480
    s_cbranch_vccnz Lot_167
Look_168:
    v_mfma_f32_16x16x32_bf16 v[36:39], v[164:167], v[80:83], v[36:39]
    ds_read_b64_tr_b16 v[150:151], v239 offset:22528
    s_waitcnt lgkmcnt(8)
    v_mfma_f32_16x16x32_bf16 v[24:27], v[120:123], v[88:91], v[24:27]
    ds_read_b64_tr_b16 v[152:153], v236 offset:24576
    s_xor_b32 s45, s45, 24576
    v_mfma_f32_16x16x32_bf16 v[40:43], v[120:123], v[92:95], v[40:43]
    ds_read_b64_tr_b16 v[154:155], v236 offset:26624
    buffer_load_dwordx4 v[72:75], v248, s[88:91], s45 offen offset:0 sc1
    v_mfma_f32_16x16x32_bf16 v[44:47], v[124:127], v[92:95], v[44:47]
    ds_read_b64_tr_b16 v[156:157], v237 offset:24576
    v_mfma_f32_16x16x32_bf16 v[28:31], v[124:127], v[88:91], v[28:31]
    ds_read_b64_tr_b16 v[158:159], v237 offset:26624
    v_mfma_f32_16x16x32_bf16 v[32:35], v[128:131], v[88:91], v[32:35]
    ds_read_b64_tr_b16 v[160:161], v238 offset:24576
    buffer_load_dwordx4 v[76:79], v248, s[88:91], s45 offen offset:1024 sc1
    v_mfma_f32_16x16x32_bf16 v[48:51], v[128:131], v[92:95], v[48:51]
    ds_read_b64_tr_b16 v[162:163], v238 offset:26624
    v_mfma_f32_16x16x32_bf16 v[52:55], v[132:135], v[92:95], v[52:55]
    ds_read_b64_tr_b16 v[164:165], v239 offset:24576
    v_mfma_f32_16x16x32_bf16 v[36:39], v[132:135], v[88:91], v[36:39]
    ds_read_b64_tr_b16 v[166:167], v239 offset:26624
    s_waitcnt lgkmcnt(8)
    v_mfma_f32_16x16x32_bf16 v[24:27], v[136:139], v[96:99], v[24:27]
    ds_read_b64_tr_b16 v[120:121], v236 offset:28672
    buffer_load_dwordx4 v[80:83], v248, s[88:91], s45 offen offset:2048 sc1
    v_mfma_f32_16x16x32_bf16 v[40:43], v[136:139], v[100:103], v[40:43]
    ds_read_b64_tr_b16 v[122:123], v236 offset:30720
    s_waitcnt vmcnt(7)
    v_mfma_f32_16x16x32_bf16 v[44:47], v[140:143], v[100:103], v[44:47]
    ds_read_b64_tr_b16 v[124:125], v237 offset:28672
    v_or3_b32 v250, v104, v108, v112
    v_mfma_f32_16x16x32_bf16 v[28:31], v[140:143], v[96:99], v[28:31]
    ds_read_b64_tr_b16 v[126:127], v237 offset:30720
    v_bitop3_b32 v250, v250, v116, 1 bitop3:0xa8
    v_mfma_f32_16x16x32_bf16 v[32:35], v[144:147], v[96:99], v[32:35]
    ds_read_b64_tr_b16 v[128:129], v238 offset:28672
    buffer_load_dwordx4 v[84:87], v248, s[88:91], s45 offen offset:3072 sc1
    v_mfma_f32_16x16x32_bf16 v[48:51], v[144:147], v[100:103], v[48:51]
    ds_read_b64_tr_b16 v[130:131], v238 offset:30720
    v_cmp_ne_u32 vcc, 0, v250
    v_mfma_f32_16x16x32_bf16 v[52:55], v[148:151], v[100:103], v[52:55]
    ds_read_b64_tr_b16 v[132:133], v239 offset:28672
    s_cbranch_vccnz Lot_170
Look_171:
    v_mfma_f32_16x16x32_bf16 v[36:39], v[148:151], v[96:99], v[36:39]
    ds_read_b64_tr_b16 v[134:135], v239 offset:30720
    s_waitcnt lgkmcnt(8)
    v_mfma_f32_16x16x32_bf16 v[24:27], v[152:155], v[104:107], v[24:27]
    ds_read_b64_tr_b16 v[136:137], v236 offset:32768
    s_xor_b32 s46, s46, 24576
    v_mfma_f32_16x16x32_bf16 v[40:43], v[152:155], v[108:111], v[40:43]
    ds_read_b64_tr_b16 v[138:139], v236 offset:34816
    buffer_load_dwordx4 v[88:91], v248, s[88:91], s46 offen offset:0 sc1
    v_mfma_f32_16x16x32_bf16 v[44:47], v[156:159], v[108:111], v[44:47]
    ds_read_b64_tr_b16 v[140:141], v237 offset:32768
    v_mfma_f32_16x16x32_bf16 v[28:31], v[156:159], v[104:107], v[28:31]
    ds_read_b64_tr_b16 v[142:143], v237 offset:34816
    v_mfma_f32_16x16x32_bf16 v[32:35], v[160:163], v[104:107], v[32:35]
    ds_read_b64_tr_b16 v[144:145], v238 offset:32768
    buffer_load_dwordx4 v[92:95], v248, s[88:91], s46 offen offset:1024 sc1
    v_mfma_f32_16x16x32_bf16 v[48:51], v[160:163], v[108:111], v[48:51]
    ds_read_b64_tr_b16 v[146:147], v238 offset:34816
    v_mfma_f32_16x16x32_bf16 v[52:55], v[164:167], v[108:111], v[52:55]
    ds_read_b64_tr_b16 v[148:149], v239 offset:32768
    v_mfma_f32_16x16x32_bf16 v[36:39], v[164:167], v[104:107], v[36:39]
    ds_read_b64_tr_b16 v[150:151], v239 offset:34816
    s_waitcnt lgkmcnt(8)
    v_mfma_f32_16x16x32_bf16 v[24:27], v[120:123], v[112:115], v[24:27]
    ds_read_b64_tr_b16 v[152:153], v236 offset:36864
    buffer_load_dwordx4 v[96:99], v248, s[88:91], s46 offen offset:2048 sc1
    v_mfma_f32_16x16x32_bf16 v[40:43], v[120:123], v[116:119], v[40:43]
    ds_read_b64_tr_b16 v[154:155], v236 offset:38912
    s_waitcnt vmcnt(7)
    v_mfma_f32_16x16x32_bf16 v[44:47], v[124:127], v[116:119], v[44:47]
    ds_read_b64_tr_b16 v[156:157], v237 offset:36864
    v_or3_b32 v250, v56, v60, v64
    v_mfma_f32_16x16x32_bf16 v[28:31], v[124:127], v[112:115], v[28:31]
    ds_read_b64_tr_b16 v[158:159], v237 offset:38912
    v_bitop3_b32 v250, v250, v68, 1 bitop3:0xa8
    v_mfma_f32_16x16x32_bf16 v[32:35], v[128:131], v[112:115], v[32:35]
    ds_read_b64_tr_b16 v[160:161], v238 offset:36864
    buffer_load_dwordx4 v[100:103], v248, s[88:91], s46 offen offset:3072 sc1
    v_mfma_f32_16x16x32_bf16 v[48:51], v[128:131], v[116:119], v[48:51]
    ds_read_b64_tr_b16 v[162:163], v238 offset:38912
    v_cmp_ne_u32 vcc, 0, v250
    v_mfma_f32_16x16x32_bf16 v[52:55], v[132:135], v[116:119], v[52:55]
    ds_read_b64_tr_b16 v[164:165], v239 offset:36864
    s_cbranch_vccnz Lot_173
Look_174:
    v_mfma_f32_16x16x32_bf16 v[36:39], v[132:135], v[112:115], v[36:39]
    ds_read_b64_tr_b16 v[166:167], v239 offset:38912
    s_waitcnt lgkmcnt(8)
    v_mfma_f32_16x16x32_bf16 v[24:27], v[136:139], v[56:59], v[24:27]
    ds_read_b64_tr_b16 v[120:121], v236 offset:40960
    s_xor_b32 s47, s47, 24576
    v_mfma_f32_16x16x32_bf16 v[40:43], v[136:139], v[60:63], v[40:43]
    ds_read_b64_tr_b16 v[122:123], v236 offset:43008
    buffer_load_dwordx4 v[104:107], v248, s[88:91], s47 offen offset:0 sc1
    v_mfma_f32_16x16x32_bf16 v[44:47], v[140:143], v[60:63], v[44:47]
    ds_read_b64_tr_b16 v[124:125], v237 offset:40960
    v_mfma_f32_16x16x32_bf16 v[28:31], v[140:143], v[56:59], v[28:31]
    ds_read_b64_tr_b16 v[126:127], v237 offset:43008
    v_mfma_f32_16x16x32_bf16 v[32:35], v[144:147], v[56:59], v[32:35]
    ds_read_b64_tr_b16 v[128:129], v238 offset:40960
    buffer_load_dwordx4 v[108:111], v248, s[88:91], s47 offen offset:1024 sc1
    v_mfma_f32_16x16x32_bf16 v[48:51], v[144:147], v[60:63], v[48:51]
    ds_read_b64_tr_b16 v[130:131], v238 offset:43008
    v_mfma_f32_16x16x32_bf16 v[52:55], v[148:151], v[60:63], v[52:55]
    ds_read_b64_tr_b16 v[132:133], v239 offset:40960
    v_mfma_f32_16x16x32_bf16 v[36:39], v[148:151], v[56:59], v[36:39]
    ds_read_b64_tr_b16 v[134:135], v239 offset:43008
    s_waitcnt lgkmcnt(8)
    v_mfma_f32_16x16x32_bf16 v[24:27], v[152:155], v[64:67], v[24:27]
    ds_read_b64_tr_b16 v[136:137], v236 offset:45056
    buffer_load_dwordx4 v[112:115], v248, s[88:91], s47 offen offset:2048 sc1
    v_mfma_f32_16x16x32_bf16 v[40:43], v[152:155], v[68:71], v[40:43]
    ds_read_b64_tr_b16 v[138:139], v236 offset:47104
    s_waitcnt vmcnt(7)
    v_mfma_f32_16x16x32_bf16 v[44:47], v[156:159], v[68:71], v[44:47]
    ds_read_b64_tr_b16 v[140:141], v237 offset:45056
    v_or3_b32 v250, v72, v76, v80
    v_mfma_f32_16x16x32_bf16 v[28:31], v[156:159], v[64:67], v[28:31]
    ds_read_b64_tr_b16 v[142:143], v237 offset:47104
    v_bitop3_b32 v250, v250, v84, 1 bitop3:0xa8
    v_mfma_f32_16x16x32_bf16 v[32:35], v[160:163], v[64:67], v[32:35]
    ds_read_b64_tr_b16 v[144:145], v238 offset:45056
    buffer_load_dwordx4 v[116:119], v248, s[88:91], s47 offen offset:3072 sc1
    v_mfma_f32_16x16x32_bf16 v[48:51], v[160:163], v[68:71], v[48:51]
    ds_read_b64_tr_b16 v[146:147], v238 offset:47104
    v_cmp_ne_u32 vcc, 0, v250
    v_mfma_f32_16x16x32_bf16 v[52:55], v[164:167], v[68:71], v[52:55]
    ds_read_b64_tr_b16 v[148:149], v239 offset:45056
    s_cbranch_vccnz Lot_176
Look_177:
    v_mfma_f32_16x16x32_bf16 v[36:39], v[164:167], v[64:67], v[36:39]
    ds_read_b64_tr_b16 v[150:151], v239 offset:47104
    s_waitcnt lgkmcnt(8)
    v_mfma_f32_16x16x32_bf16 v[24:27], v[120:123], v[72:75], v[24:27]
    ds_read_b64_tr_b16 v[152:153], v236 offset:49152
    s_xor_b32 s44, s44, 8192
    v_mfma_f32_16x16x32_bf16 v[40:43], v[120:123], v[76:79], v[40:43]
    ds_read_b64_tr_b16 v[154:155], v236 offset:51200
    buffer_load_dwordx4 v[56:59], v248, s[88:91], s44 offen offset:0 sc1
    v_mfma_f32_16x16x32_bf16 v[44:47], v[124:127], v[76:79], v[44:47]
    ds_read_b64_tr_b16 v[156:157], v237 offset:49152
    v_mfma_f32_16x16x32_bf16 v[28:31], v[124:127], v[72:75], v[28:31]
    ds_read_b64_tr_b16 v[158:159], v237 offset:51200
    v_mfma_f32_16x16x32_bf16 v[32:35], v[128:131], v[72:75], v[32:35]
    ds_read_b64_tr_b16 v[160:161], v238 offset:49152
    buffer_load_dwordx4 v[60:63], v248, s[88:91], s44 offen offset:1024 sc1
    v_mfma_f32_16x16x32_bf16 v[48:51], v[128:131], v[76:79], v[48:51]
    ds_read_b64_tr_b16 v[162:163], v238 offset:51200
    v_mfma_f32_16x16x32_bf16 v[52:55], v[132:135], v[76:79], v[52:55]
    ds_read_b64_tr_b16 v[164:165], v239 offset:49152
    v_mfma_f32_16x16x32_bf16 v[36:39], v[132:135], v[72:75], v[36:39]
    ds_read_b64_tr_b16 v[166:167], v239 offset:51200
    s_waitcnt lgkmcnt(8)
    v_mfma_f32_16x16x32_bf16 v[24:27], v[136:139], v[80:83], v[24:27]
    ds_read_b64_tr_b16 v[120:121], v236 offset:53248
    buffer_load_dwordx4 v[64:67], v248, s[88:91], s44 offen offset:2048 sc1
    v_mfma_f32_16x16x32_bf16 v[40:43], v[136:139], v[84:87], v[40:43]
    ds_read_b64_tr_b16 v[122:123], v236 offset:55296
    s_waitcnt vmcnt(7)
    v_mfma_f32_16x16x32_bf16 v[44:47], v[140:143], v[84:87], v[44:47]
    ds_read_b64_tr_b16 v[124:125], v237 offset:53248
    v_or3_b32 v250, v88, v92, v96
    v_mfma_f32_16x16x32_bf16 v[28:31], v[140:143], v[80:83], v[28:31]
    ds_read_b64_tr_b16 v[126:127], v237 offset:55296
    v_bitop3_b32 v250, v250, v100, 1 bitop3:0xa8
    v_mfma_f32_16x16x32_bf16 v[32:35], v[144:147], v[80:83], v[32:35]
    ds_read_b64_tr_b16 v[128:129], v238 offset:53248
    buffer_load_dwordx4 v[68:71], v248, s[88:91], s44 offen offset:3072 sc1
    v_mfma_f32_16x16x32_bf16 v[48:51], v[144:147], v[84:87], v[48:51]
    ds_read_b64_tr_b16 v[130:131], v238 offset:55296
    v_cmp_ne_u32 vcc, 0, v250
    v_mfma_f32_16x16x32_bf16 v[52:55], v[148:151], v[84:87], v[52:55]
    ds_read_b64_tr_b16 v[132:133], v239 offset:53248
    s_cbranch_vccnz Lot_179
Look_180:
    v_mfma_f32_16x16x32_bf16 v[36:39], v[148:151], v[80:83], v[36:39]
    ds_read_b64_tr_b16 v[134:135], v239 offset:55296
    s_waitcnt lgkmcnt(8)
    v_mfma_f32_16x16x32_bf16 v[24:27], v[152:155], v[88:91], v[24:27]
    ds_read_b64_tr_b16 v[136:137], v236 offset:57344
    s_xor_b32 s45, s45, 8192
    v_mfma_f32_16x16x32_bf16 v[40:43], v[152:155], v[92:95], v[40:43]
    ds_read_b64_tr_b16 v[138:139], v236 offset:59392
    buffer_load_dwordx4 v[72:75], v248, s[88:91], s45 offen offset:0 sc1
    v_mfma_f32_16x16x32_bf16 v[44:47], v[156:159], v[92:95], v[44:47]
    ds_read_b64_tr_b16 v[140:141], v237 offset:57344
    v_mfma_f32_16x16x32_bf16 v[28:31], v[156:159], v[88:91], v[28:31]
    ds_read_b64_tr_b16 v[142:143], v237 offset:59392
    v_mfma_f32_16x16x32_bf16 v[32:35], v[160:163], v[88:91], v[32:35]
    ds_read_b64_tr_b16 v[144:145], v238 offset:57344
    buffer_load_dwordx4 v[76:79], v248, s[88:91], s45 offen offset:1024 sc1
    v_mfma_f32_16x16x32_bf16 v[48:51], v[160:163], v[92:95], v[48:51]
    ds_read_b64_tr_b16 v[146:147], v238 offset:59392
    v_mfma_f32_16x16x32_bf16 v[52:55], v[164:167], v[92:95], v[52:55]
    ds_read_b64_tr_b16 v[148:149], v239 offset:57344
    v_mfma_f32_16x16x32_bf16 v[36:39], v[164:167], v[88:91], v[36:39]
    ds_read_b64_tr_b16 v[150:151], v239 offset:59392
    s_waitcnt lgkmcnt(8)
    v_mfma_f32_16x16x32_bf16 v[24:27], v[120:123], v[96:99], v[24:27]
    ds_read_b64_tr_b16 v[152:153], v236 offset:61440
    buffer_load_dwordx4 v[80:83], v248, s[88:91], s45 offen offset:2048 sc1
    v_mfma_f32_16x16x32_bf16 v[40:43], v[120:123], v[100:103], v[40:43]
    ds_read_b64_tr_b16 v[154:155], v236 offset:63488
    s_waitcnt vmcnt(7)
    v_mfma_f32_16x16x32_bf16 v[44:47], v[124:127], v[100:103], v[44:47]
    ds_read_b64_tr_b16 v[156:157], v237 offset:61440
    v_or3_b32 v250, v104, v108, v112
    v_mfma_f32_16x16x32_bf16 v[28:31], v[124:127], v[96:99], v[28:31]
    ds_read_b64_tr_b16 v[158:159], v237 offset:63488
    v_bitop3_b32 v250, v250, v116, 1 bitop3:0xa8
    v_mfma_f32_16x16x32_bf16 v[32:35], v[128:131], v[96:99], v[32:35]
    ds_read_b64_tr_b16 v[160:161], v238 offset:61440
    buffer_load_dwordx4 v[84:87], v248, s[88:91], s45 offen offset:3072 sc1
    v_mfma_f32_16x16x32_bf16 v[48:51], v[128:131], v[100:103], v[48:51]
    ds_read_b64_tr_b16 v[162:163], v238 offset:63488
    v_cmp_ne_u32 vcc, 0, v250
    v_mfma_f32_16x16x32_bf16 v[52:55], v[132:135], v[100:103], v[52:55]
    ds_read_b64_tr_b16 v[164:165], v239 offset:61440
    s_cbranch_vccnz Lot_182
Look_183:
    v_mfma_f32_16x16x32_bf16 v[36:39], v[132:135], v[96:99], v[36:39]
    ds_read_b64_tr_b16 v[166:167], v239 offset:63488
    s_waitcnt lgkmcnt(8)
    v_mfma_f32_16x16x32_bf16 v[24:27], v[136:139], v[104:107], v[24:27]
    ds_read_b64_tr_b16 v[120:121], v240 offset:0
    s_xor_b32 s46, s46, 8192
    v_mfma_f32_16x16x32_bf16 v[40:43], v[136:139], v[108:111], v[40:43]
    ds_read_b64_tr_b16 v[122:123], v240 offset:2048
    buffer_load_dwordx4 v[88:91], v248, s[88:91], s46 offen offset:0 sc1
    v_mfma_f32_16x16x32_bf16 v[44:47], v[140:143], v[108:111], v[44:47]
    ds_read_b64_tr_b16 v[124:125], v241 offset:0
    v_mfma_f32_16x16x32_bf16 v[28:31], v[140:143], v[104:107], v[28:31]
    ds_read_b64_tr_b16 v[126:127], v241 offset:2048
    v_mfma_f32_16x16x32_bf16 v[32:35], v[144:147], v[104:107], v[32:35]
    ds_read_b64_tr_b16 v[128:129], v242 offset:0
    buffer_load_dwordx4 v[92:95], v248, s[88:91], s46 offen offset:1024 sc1
    v_mfma_f32_16x16x32_bf16 v[48:51], v[144:147], v[108:111], v[48:51]
    ds_read_b64_tr_b16 v[130:131], v242 offset:2048
    v_mfma_f32_16x16x32_bf16 v[52:55], v[148:151], v[108:111], v[52:55]
    ds_read_b64_tr_b16 v[132:133], v243 offset:0
    v_mfma_f32_16x16x32_bf16 v[36:39], v[148:151], v[104:107], v[36:39]
    ds_read_b64_tr_b16 v[134:135], v243 offset:2048
    s_waitcnt lgkmcnt(8)
    v_mfma_f32_16x16x32_bf16 v[24:27], v[152:155], v[112:115], v[24:27]
    ds_read_b64_tr_b16 v[136:137], v240 offset:4096
    buffer_load_dwordx4 v[96:99], v248, s[88:91], s46 offen offset:2048 sc1
    v_mfma_f32_16x16x32_bf16 v[40:43], v[152:155], v[116:119], v[40:43]
    ds_read_b64_tr_b16 v[138:139], v240 offset:6144
    s_waitcnt vmcnt(7)
    v_mfma_f32_16x16x32_bf16 v[44:47], v[156:159], v[116:119], v[44:47]
    ds_read_b64_tr_b16 v[140:141], v241 offset:4096
    v_or3_b32 v250, v56, v60, v64
    v_mfma_f32_16x16x32_bf16 v[28:31], v[156:159], v[112:115], v[28:31]
    ds_read_b64_tr_b16 v[142:143], v241 offset:6144
    v_bitop3_b32 v250, v250, v68, 1 bitop3:0xa8
    v_mfma_f32_16x16x32_bf16 v[32:35], v[160:163], v[112:115], v[32:35]
    ds_read_b64_tr_b16 v[144:145], v242 offset:4096
    buffer_load_dwordx4 v[100:103], v248, s[88:91], s46 offen offset:3072 sc1
    v_mfma_f32_16x16x32_bf16 v[48:51], v[160:163], v[116:119], v[48:51]
    ds_read_b64_tr_b16 v[146:147], v242 offset:6144
    v_cmp_ne_u32 vcc, 0, v250
    v_mfma_f32_16x16x32_bf16 v[52:55], v[164:167], v[116:119], v[52:55]
    ds_read_b64_tr_b16 v[148:149], v243 offset:4096
    s_cbranch_vccnz Lot_185
Look_186:
    v_mfma_f32_16x16x32_bf16 v[36:39], v[164:167], v[112:115], v[36:39]
    ds_read_b64_tr_b16 v[150:151], v243 offset:6144
    s_waitcnt lgkmcnt(8)
    v_mfma_f32_16x16x32_bf16 v[24:27], v[120:123], v[56:59], v[24:27]
    ds_read_b64_tr_b16 v[152:153], v240 offset:8192
    s_xor_b32 s47, s47, 8192
    v_mfma_f32_16x16x32_bf16 v[40:43], v[120:123], v[60:63], v[40:43]
    ds_read_b64_tr_b16 v[154:155], v240 offset:10240
    buffer_load_dwordx4 v[104:107], v248, s[88:91], s47 offen offset:0 sc1
    v_mfma_f32_16x16x32_bf16 v[44:47], v[124:127], v[60:63], v[44:47]
    ds_read_b64_tr_b16 v[156:157], v241 offset:8192
    s_barrier
    v_mfma_f32_16x16x32_bf16 v[28:31], v[124:127], v[56:59], v[28:31]
    ds_read_b64_tr_b16 v[158:159], v241 offset:10240
    v_mfma_f32_16x16x32_bf16 v[32:35], v[128:131], v[56:59], v[32:35]
    ds_read_b64_tr_b16 v[160:161], v242 offset:8192
    buffer_load_dwordx4 v[108:111], v248, s[88:91], s47 offen offset:1024 sc1
    v_mfma_f32_16x16x32_bf16 v[48:51], v[128:131], v[60:63], v[48:51]
    ds_read_b64_tr_b16 v[162:163], v242 offset:10240
    v_mfma_f32_16x16x32_bf16 v[52:55], v[132:135], v[60:63], v[52:55]
    ds_read_b64_tr_b16 v[164:165], v243 offset:8192
    v_mfma_f32_16x16x32_bf16 v[36:39], v[132:135], v[56:59], v[36:39]
    ds_read_b64_tr_b16 v[166:167], v243 offset:10240
    s_waitcnt lgkmcnt(8)
    v_mfma_f32_16x16x32_bf16 v[24:27], v[136:139], v[64:67], v[24:27]
    ds_read_b64_tr_b16 v[120:121], v240 offset:12288
    buffer_load_dwordx4 v[112:115], v248, s[88:91], s47 offen offset:2048 sc1
    v_mfma_f32_16x16x32_bf16 v[40:43], v[136:139], v[68:71], v[40:43]
    ds_read_b64_tr_b16 v[122:123], v240 offset:14336
    s_waitcnt vmcnt(7)
    v_mfma_f32_16x16x32_bf16 v[44:47], v[140:143], v[68:71], v[44:47]
    ds_read_b64_tr_b16 v[124:125], v241 offset:12288
    v_or3_b32 v250, v72, v76, v80
    v_mfma_f32_16x16x32_bf16 v[28:31], v[140:143], v[64:67], v[28:31]
    ds_read_b64_tr_b16 v[126:127], v241 offset:14336
    v_bitop3_b32 v250, v250, v84, 1 bitop3:0xa8
    v_mfma_f32_16x16x32_bf16 v[32:35], v[144:147], v[64:67], v[32:35]
    ds_read_b64_tr_b16 v[128:129], v242 offset:12288
    buffer_load_dwordx4 v[116:119], v248, s[88:91], s47 offen offset:3072 sc1
    v_mfma_f32_16x16x32_bf16 v[48:51], v[144:147], v[68:71], v[48:51]
    ds_read_b64_tr_b16 v[130:131], v242 offset:14336
    v_cmp_ne_u32 vcc, 0, v250
    v_mfma_f32_16x16x32_bf16 v[52:55], v[148:151], v[68:71], v[52:55]
    ds_read_b64_tr_b16 v[132:133], v243 offset:12288
    s_cbranch_vccnz Lot_188
Look_189:
    v_mfma_f32_16x16x32_bf16 v[36:39], v[148:151], v[64:67], v[36:39]
    ds_read_b64_tr_b16 v[134:135], v243 offset:14336
    s_waitcnt lgkmcnt(8)
    v_mfma_f32_16x16x32_bf16 v[24:27], v[152:155], v[72:75], v[24:27]
    ds_read_b64_tr_b16 v[136:137], v240 offset:16384
    v_mfma_f32_16x16x32_bf16 v[40:43], v[152:155], v[76:79], v[40:43]
    ds_read_b64_tr_b16 v[138:139], v240 offset:18432
    v_mfma_f32_16x16x32_bf16 v[44:47], v[156:159], v[76:79], v[44:47]
    ds_read_b64_tr_b16 v[140:141], v241 offset:16384
    v_mfma_f32_16x16x32_bf16 v[28:31], v[156:159], v[72:75], v[28:31]
    ds_read_b64_tr_b16 v[142:143], v241 offset:18432
    v_mfma_f32_16x16x32_bf16 v[32:35], v[160:163], v[72:75], v[32:35]
    ds_read_b64_tr_b16 v[144:145], v242 offset:16384
    v_mfma_f32_16x16x32_bf16 v[48:51], v[160:163], v[76:79], v[48:51]
    ds_read_b64_tr_b16 v[146:147], v242 offset:18432
    v_mfma_f32_16x16x32_bf16 v[52:55], v[164:167], v[76:79], v[52:55]
    ds_read_b64_tr_b16 v[148:149], v243 offset:16384
    v_mfma_f32_16x16x32_bf16 v[36:39], v[164:167], v[72:75], v[36:39]
    ds_read_b64_tr_b16 v[150:151], v243 offset:18432
    s_waitcnt lgkmcnt(8)
    v_mfma_f32_16x16x32_bf16 v[24:27], v[120:123], v[80:83], v[24:27]
    ds_read_b64_tr_b16 v[152:153], v240 offset:20480
    v_mfma_f32_16x16x32_bf16 v[40:43], v[120:123], v[84:87], v[40:43]
    ds_read_b64_tr_b16 v[154:155], v240 offset:22528
    s_waitcnt vmcnt(4)
    v_mfma_f32_16x16x32_bf16 v[44:47], v[124:127], v[84:87], v[44:47]
    ds_read_b64_tr_b16 v[156:157], v241 offset:20480
    v_or3_b32 v250, v88, v92, v96
    v_mfma_f32_16x16x32_bf16 v[28:31], v[124:127], v[80:83], v[28:31]
    ds_read_b64_tr_b16 v[158:159], v241 offset:22528
    v_bitop3_b32 v250, v250, v100, 1 bitop3:0xa8
    v_mfma_f32_16x16x32_bf16 v[32:35], v[128:131], v[80:83], v[32:35]
    ds_read_b64_tr_b16 v[160:161], v242 offset:20480
    v_mfma_f32_16x16x32_bf16 v[48:51], v[128:131], v[84:87], v[48:51]
    ds_read_b64_tr_b16 v[162:163], v242 offset:22528
    v_cmp_ne_u32 vcc, 0, v250
    v_mfma_f32_16x16x32_bf16 v[52:55], v[132:135], v[84:87], v[52:55]
    ds_read_b64_tr_b16 v[164:165], v243 offset:20480
    s_cbranch_vccnz Lot_191
Look_192:
    v_mfma_f32_16x16x32_bf16 v[36:39], v[132:135], v[80:83], v[36:39]
    ds_read_b64_tr_b16 v[166:167], v243 offset:22528
    s_waitcnt lgkmcnt(8)
    v_mfma_f32_16x16x32_bf16 v[24:27], v[136:139], v[88:91], v[24:27]
    ds_read_b64_tr_b16 v[120:121], v240 offset:24576
    v_mfma_f32_16x16x32_bf16 v[40:43], v[136:139], v[92:95], v[40:43]
    ds_read_b64_tr_b16 v[122:123], v240 offset:26624
    v_mfma_f32_16x16x32_bf16 v[44:47], v[140:143], v[92:95], v[44:47]
    ds_read_b64_tr_b16 v[124:125], v241 offset:24576
    v_mfma_f32_16x16x32_bf16 v[28:31], v[140:143], v[88:91], v[28:31]
    ds_read_b64_tr_b16 v[126:127], v241 offset:26624
    v_mfma_f32_16x16x32_bf16 v[32:35], v[144:147], v[88:91], v[32:35]
    ds_read_b64_tr_b16 v[128:129], v242 offset:24576
    v_mfma_f32_16x16x32_bf16 v[48:51], v[144:147], v[92:95], v[48:51]
    ds_read_b64_tr_b16 v[130:131], v242 offset:26624
    v_mfma_f32_16x16x32_bf16 v[52:55], v[148:151], v[92:95], v[52:55]
    ds_read_b64_tr_b16 v[132:133], v243 offset:24576
    v_mfma_f32_16x16x32_bf16 v[36:39], v[148:151], v[88:91], v[36:39]
    ds_read_b64_tr_b16 v[134:135], v243 offset:26624
    s_waitcnt lgkmcnt(8)
    v_mfma_f32_16x16x32_bf16 v[24:27], v[152:155], v[96:99], v[24:27]
    ds_read_b64_tr_b16 v[136:137], v240 offset:28672
    v_mfma_f32_16x16x32_bf16 v[40:43], v[152:155], v[100:103], v[40:43]
    ds_read_b64_tr_b16 v[138:139], v240 offset:30720
    s_waitcnt vmcnt(0)
    v_mfma_f32_16x16x32_bf16 v[44:47], v[156:159], v[100:103], v[44:47]
    ds_read_b64_tr_b16 v[140:141], v241 offset:28672
    v_or3_b32 v250, v104, v108, v112
    v_mfma_f32_16x16x32_bf16 v[28:31], v[156:159], v[96:99], v[28:31]
    ds_read_b64_tr_b16 v[142:143], v241 offset:30720
    v_bitop3_b32 v250, v250, v116, 1 bitop3:0xa8
    v_mfma_f32_16x16x32_bf16 v[32:35], v[160:163], v[96:99], v[32:35]
    ds_read_b64_tr_b16 v[144:145], v242 offset:28672
    v_mfma_f32_16x16x32_bf16 v[48:51], v[160:163], v[100:103], v[48:51]
    ds_read_b64_tr_b16 v[146:147], v242 offset:30720
    v_cmp_ne_u32 vcc, 0, v250
    v_mfma_f32_16x16x32_bf16 v[52:55], v[164:167], v[100:103], v[52:55]
    ds_read_b64_tr_b16 v[148:149], v243 offset:28672
    s_cbranch_vccnz Lot_194
Look_195:
    v_mfma_f32_16x16x32_bf16 v[36:39], v[164:167], v[96:99], v[36:39]
    ds_read_b64_tr_b16 v[150:151], v243 offset:30720
    s_waitcnt lgkmcnt(8)
    v_mfma_f32_16x16x32_bf16 v[24:27], v[120:123], v[104:107], v[24:27]
    v_mfma_f32_16x16x32_bf16 v[40:43], v[120:123], v[108:111], v[40:43]
    v_mfma_f32_16x16x32_bf16 v[44:47], v[124:127], v[108:111], v[44:47]
    v_mfma_f32_16x16x32_bf16 v[28:31], v[124:127], v[104:107], v[28:31]
    v_mfma_f32_16x16x32_bf16 v[32:35], v[128:131], v[104:107], v[32:35]
    v_mfma_f32_16x16x32_bf16 v[48:51], v[128:131], v[108:111], v[48:51]
    v_mfma_f32_16x16x32_bf16 v[52:55], v[132:135], v[108:111], v[52:55]
    v_mfma_f32_16x16x32_bf16 v[36:39], v[132:135], v[104:107], v[36:39]
    s_waitcnt lgkmcnt(0)
    v_mfma_f32_16x16x32_bf16 v[24:27], v[136:139], v[112:115], v[24:27]
    v_mfma_f32_16x16x32_bf16 v[28:31], v[140:143], v[112:115], v[28:31]
    v_mfma_f32_16x16x32_bf16 v[32:35], v[144:147], v[112:115], v[32:35]
    v_mfma_f32_16x16x32_bf16 v[36:39], v[148:151], v[112:115], v[36:39]
    v_mfma_f32_16x16x32_bf16 v[40:43], v[136:139], v[116:119], v[40:43]
    v_mfma_f32_16x16x32_bf16 v[44:47], v[140:143], v[116:119], v[44:47]
    v_mfma_f32_16x16x32_bf16 v[48:51], v[144:147], v[116:119], v[48:51]
    v_mfma_f32_16x16x32_bf16 v[52:55], v[148:151], v[116:119], v[52:55]
    s_cmp_eq_u32 s22, 4
    s_cbranch_scc1 L_final
    s_cmp_eq_u32 s23, 0
    s_cbranch_scc1 Lwt_196
    v_and_b32 v24, 0xffff0000, v24
    v_cvt_pk_bf16_f32 v9, v26, v27
    v_cvt_pk_bf16_f32 v8, v24, v25
    v_cvt_pk_bf16_f32 v10, v28, v29
    v_cvt_pk_bf16_f32 v11, v30, v31
    v_or_b32 v8, 1, v8
    buffer_store_dwordx4 v[8:11], v0, s[16:19], s0 offen offset:0
    ds_write_b128 v249, v[8:11] offset:0
    v_and_b32 v32, 0xffff0000, v32
    v_cvt_pk_bf16_f32 v13, v34, v35
    v_cvt_pk_bf16_f32 v12, v32, v33
    v_cvt_pk_bf16_f32 v14, v36, v37
    v_cvt_pk_bf16_f32 v15, v38, v39
    v_or_b32 v12, 1, v12
    buffer_store_dwordx4 v[12:15], v0, s[16:19], s0 offen offset:1024
    ds_write_b128 v249, v[12:15] offset:1024
    v_and_b32 v40, 0xffff0000, v40
    v_cvt_pk_bf16_f32 v17, v42, v43
    v_cvt_pk_bf16_f32 v16, v40, v41
    v_cvt_pk_bf16_f32 v18, v44, v45
    v_cvt_pk_bf16_f32 v19, v46, v47
    v_or_b32 v16, 1, v16
    buffer_store_dwordx4 v[16:19], v0, s[16:19], s0 offen offset:2048
    ds_write_b128 v249, v[16:19] offset:2048
    v_and_b32 v48, 0xffff0000, v48
    v_cvt_pk_bf16_f32 v21, v50, v51
    v_cvt_pk_bf16_f32 v20, v48, v49
    v_cvt_pk_bf16_f32 v22, v52, v53
    v_cvt_pk_bf16_f32 v23, v54, v55
    v_or_b32 v20, 1, v20
    buffer_store_dwordx4 v[20:23], v0, s[16:19], s0 offen offset:3072
    ds_write_b128 v249, v[20:23] offset:3072
Lwt_197:
    s_branch L_centry
L_ofix:
    s_waitcnt vmcnt(0)
    v_bitop3_b32 v250, v56, v60, 1 bitop3:0xa8
    v_cmp_ne_u32 vcc, 0, v250
    s_nop 0
    s_cbranch_vccz Lfx_198
    buffer_load_dwordx4 v[56:59], v248, s[88:91], s44 offen offset:0 sc1
    buffer_load_dwordx4 v[60:63], v248, s[88:91], s44 offen offset:1024 sc1
Lfx_198:
    v_bitop3_b32 v250, v64, v68, 1 bitop3:0xa8
    v_cmp_ne_u32 vcc, 0, v250
    s_nop 0
    s_cbranch_vccz Lfx_199
    buffer_load_dwordx4 v[64:67], v248, s[88:91], s44 offen offset:2048 sc1
    buffer_load_dwordx4 v[68:71], v248, s[88:91], s44 offen offset:3072 sc1
Lfx_199:
    v_bitop3_b32 v250, v72, v76, 1 bitop3:0xa8
    v_cmp_ne_u32 vcc, 0, v250
    s_nop 0
    s_cbranch_vccz Lfx_200
    buffer_load_dwordx4 v[72:75], v248, s[88:91], s45 offen offset:0 sc1
    buffer_load_dwordx4 v[76:79], v248, s[88:91], s45 offen offset:1024 sc1
Lfx_200:
    v_bitop3_b32 v250, v80, v84, 1 bitop3:0xa8
    v_cmp_ne_u32 vcc, 0, v250
    s_nop 0
    s_cbranch_vccz Lfx_201
    buffer_load_dwordx4 v[80:83], v248, s[88:91], s45 offen offset:2048 sc1
    buffer_load_dwordx4 v[84:87], v248, s[88:91], s45 offen offset:3072 sc1
Lfx_201:
    v_bitop3_b32 v250, v88, v92, 1 bitop3:0xa8
    v_cmp_ne_u32 vcc, 0, v250
    s_nop 0
    s_cbranch_vccz Lfx_202
    buffer_load_dwordx4 v[88:91], v248, s[88:91], s46 offen offset:0 sc1
    buffer_load_dwordx4 v[92:95], v248, s[88:91], s46 offen offset:1024 sc1
Lfx_202:
    v_bitop3_b32 v250, v96, v100, 1 bitop3:0xa8
    v_cmp_ne_u32 vcc, 0, v250
    s_nop 0
    s_cbranch_vccz Lfx_203
    buffer_load_dwordx4 v[96:99], v248, s[88:91], s46 offen offset:2048 sc1
    buffer_load_dwordx4 v[100:103], v248, s[88:91], s46 offen offset:3072 sc1
Lfx_203:
    v_bitop3_b32 v250, v104, v108, 1 bitop3:0xa8
    v_cmp_ne_u32 vcc, 0, v250
    s_nop 0
    s_cbranch_vccz Lfx_204
    buffer_load_dwordx4 v[104:107], v248, s[88:91], s47 offen offset:0 sc1
    buffer_load_dwordx4 v[108:111], v248, s[88:91], s47 offen offset:1024 sc1
Lfx_204:
    v_bitop3_b32 v250, v112, v116, 1 bitop3:0xa8
    v_cmp_ne_u32 vcc, 0, v250
    s_nop 0
    s_cbranch_vccz Lfx_205
    buffer_load_dwordx4 v[112:115], v248, s[88:91], s47 offen offset:2048 sc1
    buffer_load_dwordx4 v[116:119], v248, s[88:91], s47 offen offset:3072 sc1
Lfx_205:
    s_waitcnt vmcnt(0)
    s_add_u32 s96, s96, 1
    s_cmp_lt_u32 s96, 262144
    s_setpc_b64 s[72:73]
L_h0:
    s_cmp_lt_u32 s71, 2
    s_cbranch_scc0 Lif_206
    s_lshl_b32 m0, s98, 13
    s_add_u32 m0, m0, 0
    s_xor_b32 s36, s76, 0
    buffer_load_dwordx4 v3, s[8:11], s36 offen offset:0 lds
    buffer_load_dwordx4 v4, s[8:11], s36 offen offset:1024 lds
    buffer_load_dwordx4 v5, s[8:11], s36 offen offset:2048 lds
    buffer_load_dwordx4 v211, s[8:11], s36 offen offset:3072 lds
    s_lshl_b32 m0, s98, 13
    s_add_u32 m0, m0, 4096
    s_xor_b32 s36, s76, 65536
    buffer_load_dwordx4 v3, s[8:11], s36 offen offset:0 lds
    buffer_load_dwordx4 v4, s[8:11], s36 offen offset:1024 lds
    buffer_load_dwordx4 v5, s[8:11], s36 offen offset:2048 lds
    buffer_load_dwordx4 v211, s[8:11], s36 offen offset:3072 lds
    s_lshl_b32 s27, s22, 4
    s_add_u32 s28, s27, s21
    s_lshl_b32 s28, s28, 11
    s_add_u32 s28, s28, 786432
    s_add_u32 s27, s27, s20
    s_lshl_b32 s27, s27, 7
    s_add_u32 s27, s27, 663552
    v_bfe_u32 v131, v1, 2, 1
    v_add_u32 v131, s20, v131
    v_subrev_u32 v131, 2, v131
    v_min_u32 v131, s20, v131
    v_and_b32 v132, 3, v1
    v_lshl_add_u32 v131, v131, 4, v132
    v_lshl_add_u32 v131, v131, 3, s28
    v_and_b32 v132, 15, v1
    v_lshl_add_u32 v132, v132, 3, s27
    v_cmp_gt_u32 vcc, 16, v1
    s_nop 1
    v_cndmask_b32 v131, v132, v131, vcc
    buffer_load_dwordx2 v[132:133], v131, s[12:15], 0 offen sc1
    s_waitcnt vmcnt(0)
    v_xor_b32 v134, s24, v132
    v_xor_b32 v135, s25, v133
    v_lshrrev_b32 v135, 4, v135
    v_or_b32 v134, v134, v135
    v_cmp_ne_u32 vcc, 0, v134
    s_nop 0
    s_cbranch_vccnz Lpoll_207
Lok_208:
    s_cmp_eq_u32 s23, 0
    s_cbranch_scc0 Lif_209
    buffer_inv sc1
    s_waitcnt vmcnt(0)
Lif_209:
    s_and_b32 m0, s55, 0x3000
    s_add_u32 m0, m0, 114688
    s_add_u32 s27, s55, 16384
    buffer_load_dwordx4 v0, s[12:15], s27 offen offset:0 sc1 lds
    buffer_load_dwordx4 v0, s[12:15], s27 offen offset:1024 sc1 lds
    buffer_load_dwordx4 v0, s[12:15], s27 offen offset:2048 sc1 lds
    buffer_load_dwordx4 v0, s[12:15], s27 offen offset:3072 sc1 lds
    s_and_b32 m0, s55, 0x3000
    s_add_u32 m0, m0, 98304
    s_add_u32 s27, s55, 0
    buffer_load_dwordx4 v0, s[12:15], s27 offen offset:0 sc1 lds
    buffer_load_dwordx4 v0, s[12:15], s27 offen offset:1024 sc1 lds
    buffer_load_dwordx4 v0, s[12:15], s27 offen offset:2048 sc1 lds
    buffer_load_dwordx4 v0, s[12:15], s27 offen offset:3072 sc1 lds
    s_waitcnt vmcnt(4)
Lif_206:
    s_cmp_eq_u32 s20, 0
    s_cbranch_scc0 Lif_210
    v_mov_b32 v224, 4048155338
    v_mov_b32 v225, 4048155338
    v_mov_b32 v226, 4048155338
    v_mov_b32 v227, 4048155338
Lif_210:
    s_waitcnt lgkmcnt(0)
    s_barrier
    s_cmp_ge_u32 s71, 2
    s_cbranch_scc0 Lif_211
    s_and_b32 m0, s55, 0x3000
    s_add_u32 m0, m0, 49152
    s_add_u32 s27, s55, 16384
    buffer_load_dwordx4 v0, s[12:15], s27 offen offset:0 sc1 lds
    buffer_load_dwordx4 v0, s[12:15], s27 offen offset:1024 sc1 lds
    buffer_load_dwordx4 v0, s[12:15], s27 offen offset:2048 sc1 lds
    buffer_load_dwordx4 v0, s[12:15], s27 offen offset:3072 sc1 lds
    s_and_b32 m0, s55, 0x3000
    s_add_u32 m0, m0, 32768
    s_add_u32 s27, s55, 0
    buffer_load_dwordx4 v0, s[12:15], s27 offen offset:0 sc1 lds
    buffer_load_dwordx4 v0, s[12:15], s27 offen offset:1024 sc1 lds
    buffer_load_dwordx4 v0, s[12:15], s27 offen offset:2048 sc1 lds
    buffer_load_dwordx4 v0, s[12:15], s27 offen offset:3072 sc1 lds
Lif_211:
    s_setpc_b64 s[72:73]
L_h2:
    s_cmp_lt_u32 s71, 2
    s_cbranch_scc0 Lif_212
    s_waitcnt vmcnt(0)
    s_barrier
    s_lshl_b32 m0, s98, 13
    s_add_u32 m0, m0, 65536
    s_xor_b32 s36, s76, 262144
    buffer_load_dwordx4 v3, s[8:11], s36 offen offset:0 lds
    buffer_load_dwordx4 v4, s[8:11], s36 offen offset:1024 lds
    buffer_load_dwordx4 v5, s[8:11], s36 offen offset:2048 lds
    buffer_load_dwordx4 v211, s[8:11], s36 offen offset:3072 lds
    s_lshl_b32 m0, s98, 13
    s_add_u32 m0, m0, 69632
    s_xor_b32 s36, s76, 327680
    buffer_load_dwordx4 v3, s[8:11], s36 offen offset:0 lds
    buffer_load_dwordx4 v4, s[8:11], s36 offen offset:1024 lds
    buffer_load_dwordx4 v5, s[8:11], s36 offen offset:2048 lds
    buffer_load_dwordx4 v211, s[8:11], s36 offen offset:3072 lds
    s_branch Lh2_213
Lif_212:
    s_barrier
    s_lshl_b32 m0, s98, 13
    s_add_u32 m0, m0, 131072
    s_xor_b32 s36, s76, 786432
    buffer_load_dwordx4 v3, s[8:11], s36 offen offset:0 lds
    buffer_load_dwordx4 v4, s[8:11], s36 offen offset:1024 lds
    buffer_load_dwordx4 v5, s[8:11], s36 offen offset:2048 lds
    buffer_load_dwordx4 v211, s[8:11], s36 offen offset:3072 lds
    s_lshl_b32 m0, s98, 13
    s_add_u32 m0, m0, 135168
    s_xor_b32 s36, s76, 851968
    buffer_load_dwordx4 v3, s[8:11], s36 offen offset:0 lds
    buffer_load_dwordx4 v4, s[8:11], s36 offen offset:1024 lds
    buffer_load_dwordx4 v5, s[8:11], s36 offen offset:2048 lds
    buffer_load_dwordx4 v211, s[8:11], s36 offen offset:3072 lds
Lh2_213:
    s_cmp_eq_u32 s22, 0
    s_cbranch_scc0 Lif_214
    s_lshl_b32 s27, s2, 3
    s_add_u32 s27, s27, s3
    v_lshlrev_b32 v131, 7, v1
    s_mov_b32 s40, s58
    s_mov_b32 s41, s59
    s_mov_b32 s42, 2097152
    s_mov_b32 s43, 0x00020000
    s_lshl_b32 s28, s27, 10
    s_mul_i32 s27, s27, 3072
    s_mov_b64 exec, 0xffffff
    buffer_load_dword v255, v131, s[92:95], s27 offen
    s_mov_b64 exec, 0xff
    buffer_load_dword v255, v131, s[40:43], s28 offen
    s_mov_b64 exec, -1
Lif_214:
    s_setpc_b64 s[72:73]
L_h4:
    s_cmp_ge_u32 s71, 2
    s_cbranch_scc0 Lif_215
    s_waitcnt vmcnt(10)
    s_cmp_eq_u32 s22, 0
    s_cbranch_scc1 Lif_215
    s_waitcnt vmcnt(8)
Lif_215:
    s_cmp_eq_u32 s20, 1
    s_cbranch_scc0 Lif_216
    v_mov_b32 v224, 4048155338
    v_mov_b32 v225, 4048155338
    v_mov_b32 v226, 4048155338
    v_mov_b32 v227, 4048155338
Lif_216:
    v_subrev_u32 v129, 32768, v129
    s_waitcnt lgkmcnt(0)
    s_barrier
    s_cmp_ge_u32 s71, 2
    s_cbranch_scc0 Lif_217
    s_lshl_b32 m0, s98, 13
    s_add_u32 m0, m0, 98304
    s_xor_b32 s36, s76, 524288
    buffer_load_dwordx4 v3, s[8:11], s36 offen offset:0 lds
    buffer_load_dwordx4 v4, s[8:11], s36 offen offset:1024 lds
    buffer_load_dwordx4 v5, s[8:11], s36 offen offset:2048 lds
    buffer_load_dwordx4 v211, s[8:11], s36 offen offset:3072 lds
    s_lshl_b32 m0, s98, 13
    s_add_u32 m0, m0, 102400
    s_xor_b32 s36, s76, 589824
    buffer_load_dwordx4 v3, s[8:11], s36 offen offset:0 lds
    buffer_load_dwordx4 v4, s[8:11], s36 offen offset:1024 lds
    buffer_load_dwordx4 v5, s[8:11], s36 offen offset:2048 lds
    buffer_load_dwordx4 v211, s[8:11], s36 offen offset:3072 lds
Lif_217:
    s_setpc_b64 s[72:73]
L_exact:
    s_lshl_b32 s29, s20, 2
    s_add_u32 s29, s29, s71
    s_lshl_b32 s27, s21, 15
    s_and_b32 s28, s54, 4096
    s_add_u32 s27, s27, s28
    s_add_u32 s27, s27, 2621440
    v_add_u32 v128, s27, v0
    v_and_b32 v134, 15, v1
    v_lshrrev_b32 v135, 4, v1
    v_lshlrev_b32 v135, 2, v135
    v_sub_u32 v134, v134, v135
    v_mov_b32 v129, 4048155338
    s_min_u32 s31, s29, 8
    v_mov_b32 v132, 4048155338
    v_mov_b32 v133, 4048155338
    v_mov_b32 v104, 0
    v_mov_b32 v105, 0
    v_mov_b32 v106, 0
    v_mov_b32 v107, 0
    v_mov_b32 v108, 0
    v_mov_b32 v109, 0
    v_mov_b32 v110, 0
    v_mov_b32 v111, 0
    v_mov_b32 v112, 0
    v_mov_b32 v113, 0
    v_mov_b32 v114, 0
    v_mov_b32 v115, 0
    v_mov_b32 v116, 0
    v_mov_b32 v117, 0
    v_mov_b32 v118, 0
    v_mov_b32 v119, 0
    v_mov_b32 v120, 0
    v_mov_b32 v121, 0
    v_mov_b32 v122, 0
    v_mov_b32 v123, 0
    v_mov_b32 v124, 0
    v_mov_b32 v125, 0
    v_mov_b32 v126, 0
    v_mov_b32 v127, 0
    s_mov_b32 s30, 0
L_ex0:
    s_sub_u32 s27, s29, s30
    s_lshr_b32 s28, s27, 2
    s_lshl_b32 s28, s28, 20
    s_and_b32 s27, s27, 3
    s_lshl_b32 s27, s27, 13
    s_add_u32 s27, s27, s28
    buffer_load_dwordx4 v[80:83], v128, s[12:15], s27 offen offset:0 sc1
    buffer_load_dwordx4 v[84:87], v128, s[12:15], s27 offen offset:1024 sc1
    s_lshl_b32 s28, s30, 5
    v_add_u32 v135, s28, v134
    v_add_u32 v48, 0, v135
    v_cmp_gt_u32 vcc, 0x100, v48
    s_nop 1
    v_cndmask_b32 v48, v129, 0, vcc
    v_add_u32 v49, 4294967295, v135
    v_cmp_gt_u32 vcc, 0x100, v49
    s_nop 1
    v_cndmask_b32 v49, v129, 0, vcc
    v_add_u32 v50, 4294967294, v135
    v_cmp_gt_u32 vcc, 0x100, v50
    s_nop 1
    v_cndmask_b32 v50, v129, 0, vcc
    v_add_u32 v51, 4294967293, v135
    v_cmp_gt_u32 vcc, 0x100, v51
    s_nop 1
    v_cndmask_b32 v51, v129, 0, vcc
    v_add_u32 v52, 4294967280, v135
    v_cmp_gt_u32 vcc, 0x100, v52
    s_nop 1
    v_cndmask_b32 v52, v129, 0, vcc
    v_add_u32 v53, 4294967279, v135
    v_cmp_gt_u32 vcc, 0x100, v53
    s_nop 1
    v_cndmask_b32 v53, v129, 0, vcc
    v_add_u32 v54, 4294967278, v135
    v_cmp_gt_u32 vcc, 0x100, v54
    s_nop 1
    v_cndmask_b32 v54, v129, 0, vcc
    v_add_u32 v55, 4294967277, v135
    v_cmp_gt_u32 vcc, 0x100, v55
    s_nop 1
    v_cndmask_b32 v55, v129, 0, vcc
    v_add_u32 v56, 16, v135
    v_cmp_gt_u32 vcc, 0x100, v56
    s_nop 1
    v_cndmask_b32 v56, v129, 0, vcc
    v_add_u32 v57, 15, v135
    v_cmp_gt_u32 vcc, 0x100, v57
    s_nop 1
    v_cndmask_b32 v57, v129, 0, vcc
    v_add_u32 v58, 14, v135
    v_cmp_gt_u32 vcc, 0x100, v58
    s_nop 1
    v_cndmask_b32 v58, v129, 0, vcc
    v_add_u32 v59, 13, v135
    v_cmp_gt_u32 vcc, 0x100, v59
    s_nop 1
    v_cndmask_b32 v59, v129, 0, vcc
    v_add_u32 v60, 0, v135
    v_cmp_gt_u32 vcc, 0x100, v60
    s_nop 1
    v_cndmask_b32 v60, v129, 0, vcc
    v_add_u32 v61, 4294967295, v135
    v_cmp_gt_u32 vcc, 0x100, v61
    s_nop 1
    v_cndmask_b32 v61, v129, 0, vcc
    v_add_u32 v62, 4294967294, v135
    v_cmp_gt_u32 vcc, 0x100, v62
    s_nop 1
    v_cndmask_b32 v62, v129, 0, vcc
    v_add_u32 v63, 4294967293, v135
    v_cmp_gt_u32 vcc, 0x100, v63
    s_nop 1
    v_cndmask_b32 v63, v129, 0, vcc
    s_waitcnt vmcnt(0)
    v_mfma_f32_16x16x32_bf16 v[32:35], v[80:83], v[24:27], v[48:51]
    v_mfma_f32_16x16x32_bf16 v[36:39], v[84:87], v[24:27], v[52:55]
    v_mfma_f32_16x16x32_bf16 v[40:43], v[80:83], v[28:31], v[56:59]
    v_mfma_f32_16x16x32_bf16 v[44:47], v[84:87], v[28:31], v[60:63]
    s_nop 4
    v_max3_f32 v132, v132, v32, v33
    v_max3_f32 v132, v132, v34, v35
    v_max3_f32 v132, v132, v36, v37
    v_max3_f32 v132, v132, v38, v39
    v_max3_f32 v133, v133, v40, v41
    v_max3_f32 v133, v133, v42, v43
    v_max3_f32 v133, v133, v44, v45
    s_nop 0
    v_max3_f32 v133, v133, v46, v47
    s_add_u32 s30, s30, 1
    s_cmp_le_u32 s30, s31
    s_cbranch_scc1 L_ex0
    v_mov_b32 v130, v132
    s_nop 1
    v_permlane16_swap_b32 v132, v130
    v_max_f32 v132, v132, v130
    v_mov_b32 v130, v132
    s_nop 1
    v_permlane32_swap_b32 v132, v130
    v_max_f32 v132, v132, v130
    v_mov_b32 v130, v133
    s_nop 1
    v_permlane16_swap_b32 v133, v130
    v_max_f32 v133, v133, v130
    v_mov_b32 v130, v133
    s_nop 1
    v_permlane32_swap_b32 v133, v130
    v_max_f32 v133, v133, v130
    s_mov_b32 s30, 0
L_ex1:
    s_sub_u32 s27, s29, s30
    s_lshr_b32 s28, s27, 2
    s_lshl_b32 s28, s28, 20
    s_and_b32 s27, s27, 3
    s_lshl_b32 s27, s27, 13
    s_add_u32 s27, s27, s28
    buffer_load_dwordx4 v[80:83], v128, s[12:15], s27 offen offset:0 sc1
    buffer_load_dwordx4 v[84:87], v128, s[12:15], s27 offen offset:1024 sc1
    buffer_load_dwordx4 v[88:91], v128, s[12:15], s27 offen offset:2048 sc1
    buffer_load_dwordx4 v[92:95], v128, s[12:15], s27 offen offset:3072 sc1
    s_lshl_b32 s28, s30, 5
    v_add_u32 v135, s28, v134
    v_add_u32 v48, 0, v135
    v_cmp_gt_u32 vcc, 0x100, v48
    s_nop 1
    v_cndmask_b32 v48, v129, 0, vcc
    v_add_u32 v49, 4294967295, v135
    v_cmp_gt_u32 vcc, 0x100, v49
    s_nop 1
    v_cndmask_b32 v49, v129, 0, vcc
    v_add_u32 v50, 4294967294, v135
    v_cmp_gt_u32 vcc, 0x100, v50
    s_nop 1
    v_cndmask_b32 v50, v129, 0, vcc
    v_add_u32 v51, 4294967293, v135
    v_cmp_gt_u32 vcc, 0x100, v51
    s_nop 1
    v_cndmask_b32 v51, v129, 0, vcc
    v_add_u32 v52, 4294967280, v135
    v_cmp_gt_u32 vcc, 0x100, v52
    s_nop 1
    v_cndmask_b32 v52, v129, 0, vcc
    v_add_u32 v53, 4294967279, v135
    v_cmp_gt_u32 vcc, 0x100, v53
    s_nop 1
    v_cndmask_b32 v53, v129, 0, vcc
    v_add_u32 v54, 4294967278, v135
    v_cmp_gt_u32 vcc, 0x100, v54
    s_nop 1
    v_cndmask_b32 v54, v129, 0, vcc
    v_add_u32 v55, 4294967277, v135
    v_cmp_gt_u32 vcc, 0x100, v55
    s_nop 1
    v_cndmask_b32 v55, v129, 0, vcc
    v_add_u32 v56, 16, v135
    v_cmp_gt_u32 vcc, 0x100, v56
    s_nop 1
    v_cndmask_b32 v56, v129, 0, vcc
    v_add_u32 v57, 15, v135
    v_cmp_gt_u32 vcc, 0x100, v57
    s_nop 1
    v_cndmask_b32 v57, v129, 0, vcc
    v_add_u32 v58, 14, v135
    v_cmp_gt_u32 vcc, 0x100, v58
    s_nop 1
    v_cndmask_b32 v58, v129, 0, vcc
    v_add_u32 v59, 13, v135
    v_cmp_gt_u32 vcc, 0x100, v59
    s_nop 1
    v_cndmask_b32 v59, v129, 0, vcc
    v_add_u32 v60, 0, v135
    v_cmp_gt_u32 vcc, 0x100, v60
    s_nop 1
    v_cndmask_b32 v60, v129, 0, vcc
    v_add_u32 v61, 4294967295, v135
    v_cmp_gt_u32 vcc, 0x100, v61
    s_nop 1
    v_cndmask_b32 v61, v129, 0, vcc
    v_add_u32 v62, 4294967294, v135
    v_cmp_gt_u32 vcc, 0x100, v62
    s_nop 1
    v_cndmask_b32 v62, v129, 0, vcc
    v_add_u32 v63, 4294967293, v135
    v_cmp_gt_u32 vcc, 0x100, v63
    s_nop 1
    v_cndmask_b32 v63, v129, 0, vcc
    s_waitcnt vmcnt(0)
    v_mfma_f32_16x16x32_bf16 v[32:35], v[80:83], v[24:27], v[48:51]
    v_mfma_f32_16x16x32_bf16 v[36:39], v[84:87], v[24:27], v[52:55]
    v_mfma_f32_16x16x32_bf16 v[40:43], v[80:83], v[28:31], v[56:59]
    v_mfma_f32_16x16x32_bf16 v[44:47], v[84:87], v[28:31], v[60:63]
    s_nop 4
    v_sub_f32 v32, v32, v132
    v_sub_f32 v33, v33, v132
    v_sub_f32 v34, v34, v132
    v_sub_f32 v35, v35, v132
    v_sub_f32 v36, v36, v132
    v_sub_f32 v37, v37, v132
    v_sub_f32 v38, v38, v132
    v_sub_f32 v39, v39, v132
    v_sub_f32 v40, v40, v133
    v_sub_f32 v41, v41, v133
    v_sub_f32 v42, v42, v133
    v_sub_f32 v43, v43, v133
    v_sub_f32 v44, v44, v133
    v_sub_f32 v45, v45, v133
    v_sub_f32 v46, v46, v133
    v_sub_f32 v47, v47, v133
    v_exp_f32 v32, v32
    v_exp_f32 v33, v33
    v_exp_f32 v34, v34
    v_exp_f32 v35, v35
    v_exp_f32 v36, v36
    v_exp_f32 v37, v37
    v_exp_f32 v38, v38
    v_exp_f32 v39, v39
    v_exp_f32 v40, v40
    v_exp_f32 v41, v41
    v_exp_f32 v42, v42
    v_exp_f32 v43, v43
    v_exp_f32 v44, v44
    v_exp_f32 v45, v45
    v_exp_f32 v46, v46
    v_exp_f32 v47, v47
    v_cvt_pk_bf16_f32 v64, v32, v33
    v_cvt_pk_bf16_f32 v65, v34, v35
    v_cvt_pk_bf16_f32 v66, v36, v37
    v_cvt_pk_bf16_f32 v67, v38, v39
    v_cvt_pk_bf16_f32 v68, v40, v41
    v_cvt_pk_bf16_f32 v69, v42, v43
    v_cvt_pk_bf16_f32 v70, v44, v45
    v_cvt_pk_bf16_f32 v71, v46, v47
    v_mfma_f32_16x16x32_bf16 v[104:107], v[88:91], v[64:67], v[104:107]
    v_mfma_f32_16x16x32_bf16 v[108:111], v[92:95], v[64:67], v[108:111]
    v_mfma_f32_16x16x32_bf16 v[120:123], v[212:215], v[64:67], v[120:123]
    v_mfma_f32_16x16x32_bf16 v[112:115], v[88:91], v[68:71], v[112:115]
    v_mfma_f32_16x16x32_bf16 v[116:119], v[92:95], v[68:71], v[116:119]
    v_mfma_f32_16x16x32_bf16 v[124:127], v[212:215], v[68:71], v[124:127]
    s_add_u32 s30, s30, 1
    s_cmp_le_u32 s30, s31
    s_cbranch_scc1 L_ex1
    s_nop 7
    s_branch L_aok
L_final:
    s_lshl_b32 s27, s20, 2
    s_add_u32 s27, s27, s3
    s_lshl_b32 s27, s27, 16
    s_lshl_b32 s28, s21, 7
    s_add_u32 s27, s27, s28
    v_and_b32 v160, 15, v1
    v_lshlrev_b32 v160, 11, v160
    v_bfe_u32 v161, v1, 4, 1
    v_lshl_add_u32 v160, v161, 5, v160
    v_lshrrev_b32 v161, 5, v1
    v_lshlrev_b32 v161, 4, v161
    v_add3_u32 v160, v160, v161, s27
    v_add_u32 v161, 32768, v160
    v_cvt_pk_bf16_f32 v8, v24, v25
    v_cvt_pk_bf16_f32 v9, v26, v27
    v_cvt_pk_bf16_f32 v10, v28, v29
    v_cvt_pk_bf16_f32 v11, v30, v31
    v_cvt_pk_bf16_f32 v12, v32, v33
    v_cvt_pk_bf16_f32 v13, v34, v35
    v_cvt_pk_bf16_f32 v14, v36, v37
    v_cvt_pk_bf16_f32 v15, v38, v39
    v_permlane16_swap_b32 v8, v10
    v_permlane16_swap_b32 v9, v11
    v_cvt_pk_bf16_f32 v16, v40, v41
    v_cvt_pk_bf16_f32 v17, v42, v43
    v_cvt_pk_bf16_f32 v18, v44, v45
    v_cvt_pk_bf16_f32 v19, v46, v47
    v_permlane16_swap_b32 v12, v14
    v_permlane16_swap_b32 v13, v15
    v_cvt_pk_bf16_f32 v20, v48, v49
    v_cvt_pk_bf16_f32 v21, v50, v51
    v_cvt_pk_bf16_f32 v22, v52, v53
    v_cvt_pk_bf16_f32 v23, v54, v55
    v_permlane16_swap_b32 v16, v18
    v_permlane16_swap_b32 v17, v19
    v_permlane16_swap_b32 v20, v22
    v_permlane16_swap_b32 v21, v23
    buffer_store_dwordx4 v[8:11], v160, s[16:19], 0 offen offset:0
    buffer_store_dwordx4 v[12:15], v160, s[16:19], 0 offen offset:64
    buffer_store_dwordx4 v[16:19], v161, s[16:19], 0 offen offset:0
    buffer_store_dwordx4 v[20:23], v161, s[16:19], 0 offen offset:64
L_out:
L_end:
    s_endpgm
Lrt_4:
    s_mov_b32 s26, 0
Lrt_4b:
    s_bfe_u32 s27, s74, 262148
    s_lshl_b32 s27, s27, 12
    s_add_u32 m0, s78, 0
    s_nop 0
    buffer_load_dwordx4 v8, s[88:91], s27 offen offset:0 sc1 lds
    buffer_load_dwordx4 v9, s[88:91], s27 offen offset:1024 sc1 lds
    buffer_load_dwordx4 v10, s[88:91], s27 offen offset:2048 sc1 lds
    buffer_load_dwordx4 v11, s[88:91], s27 offen offset:3072 sc1 lds
    s_waitcnt vmcnt(0)
    ds_read_b128 v[24:27], v195 offset:0
    ds_read_b128 v[28:31], v195 offset:1024
    ds_read_b128 v[32:35], v195 offset:2048
    ds_read_b128 v[36:39], v195 offset:3072
    s_waitcnt lgkmcnt(0)
    v_bitop3_b32 v25, v24, v28, v32 bitop3:0x80
    v_bitop3_b32 v25, v25, v36, 1 bitop3:0x80
    v_cmp_eq_u32 vcc, 0, v25
    s_nop 0
    s_cbranch_vccz Lok_5
    s_add_u32 s26, s26, 1
    s_cmp_lt_u32 s26, 262144
    s_cbranch_scc1 Lrt_4b
    s_branch Lok_5
Lwt_432007:
    buffer_store_dwordx2 v[240:241], v190, s[12:15], 0 offen sc1
    s_branch Lwt_432008
Lrt_11:
    s_mov_b32 s26, 0
Lrt_11b:
    s_bfe_u32 s27, s74, 262152
    s_lshl_b32 s27, s27, 12
    s_add_u32 m0, s78, 16384
    s_nop 0
    buffer_load_dwordx4 v8, s[88:91], s27 offen offset:0 sc1 lds
    buffer_load_dwordx4 v9, s[88:91], s27 offen offset:1024 sc1 lds
    buffer_load_dwordx4 v10, s[88:91], s27 offen offset:2048 sc1 lds
    buffer_load_dwordx4 v11, s[88:91], s27 offen offset:3072 sc1 lds
    s_waitcnt vmcnt(0)
    ds_read_b128 v[24:27], v195 offset:16384
    ds_read_b128 v[28:31], v195 offset:17408
    ds_read_b128 v[32:35], v195 offset:18432
    ds_read_b128 v[36:39], v195 offset:19456
    s_waitcnt lgkmcnt(0)
    v_bitop3_b32 v25, v24, v28, v32 bitop3:0x80
    v_bitop3_b32 v25, v25, v36, 1 bitop3:0x80
    v_cmp_eq_u32 vcc, 0, v25
    s_nop 0
    s_cbranch_vccz Lok_12
    s_add_u32 s26, s26, 1
    s_cmp_lt_u32 s26, 262144
    s_cbranch_scc1 Lrt_11b
    s_branch Lok_12
Lrt_17:
    s_mov_b32 s26, 0
Lrt_17b:
    s_bfe_u32 s27, s74, 262156
    s_lshl_b32 s27, s27, 12
    s_add_u32 m0, s78, 32768
    s_nop 0
    buffer_load_dwordx4 v8, s[88:91], s27 offen offset:0 sc1 lds
    buffer_load_dwordx4 v9, s[88:91], s27 offen offset:1024 sc1 lds
    buffer_load_dwordx4 v10, s[88:91], s27 offen offset:2048 sc1 lds
    buffer_load_dwordx4 v11, s[88:91], s27 offen offset:3072 sc1 lds
    s_waitcnt vmcnt(0)
    ds_read_b128 v[24:27], v195 offset:32768
    ds_read_b128 v[28:31], v195 offset:33792
    ds_read_b128 v[32:35], v195 offset:34816
    ds_read_b128 v[36:39], v195 offset:35840
    s_waitcnt lgkmcnt(0)
    v_bitop3_b32 v25, v24, v28, v32 bitop3:0x80
    v_bitop3_b32 v25, v25, v36, 1 bitop3:0x80
    v_cmp_eq_u32 vcc, 0, v25
    s_nop 0
    s_cbranch_vccz Lok_18
    s_add_u32 s26, s26, 1
    s_cmp_lt_u32 s26, 262144
    s_cbranch_scc1 Lrt_17b
    s_branch Lok_18
Lpoll_21:
    s_mov_b32 s26, 0
Lpoll_21b:
    buffer_load_dwordx2 v[244:245], v188, s[12:15], 0 offen sc1
    s_waitcnt vmcnt(0)
    v_xor_b32 v246, s24, v244
    v_xor_b32 v247, s25, v245
    v_lshrrev_b32 v247, 4, v247
    v_or_b32 v246, v246, v247
    v_cmp_ne_u32 vcc, 0, v246
    s_nop 0
    s_cbranch_vccz Lok_22
    s_add_u32 s26, s26, 1
    s_cmp_lt_u32 s26, 262144
    s_cbranch_scc1 Lpoll_21b
    s_branch Lok_22
Lrt_28:
    s_mov_b32 s26, 0
Lrt_28b:
    s_bfe_u32 s27, s74, 262160
    s_lshl_b32 s27, s27, 12
    s_add_u32 m0, s78, 0
    s_nop 0
    buffer_load_dwordx4 v8, s[88:91], s27 offen offset:0 sc1 lds
    buffer_load_dwordx4 v9, s[88:91], s27 offen offset:1024 sc1 lds
    buffer_load_dwordx4 v10, s[88:91], s27 offen offset:2048 sc1 lds
    buffer_load_dwordx4 v11, s[88:91], s27 offen offset:3072 sc1 lds
    s_waitcnt vmcnt(0)
    ds_read_b128 v[24:27], v195 offset:0
    ds_read_b128 v[28:31], v195 offset:1024
    ds_read_b128 v[32:35], v195 offset:2048
    ds_read_b128 v[36:39], v195 offset:3072
    s_waitcnt lgkmcnt(0)
    v_bitop3_b32 v25, v24, v28, v32 bitop3:0x80
    v_bitop3_b32 v25, v25, v36, 1 bitop3:0x80
    v_cmp_eq_u32 vcc, 0, v25
    s_nop 0
    s_cbranch_vccz Lok_29
    s_add_u32 s26, s26, 1
    s_cmp_lt_u32 s26, 262144
    s_cbranch_scc1 Lrt_28b
    s_branch Lok_29
Lwt_31:
    buffer_store_dwordx4 v[124:127], v0, s[40:43], s47 offen offset:0 sc1
    s_branch Lwt_32
Lwt_37:
    buffer_store_dwordx4 v[124:127], v0, s[40:43], s47 offen offset:1024 sc1
    s_branch Lwt_38
Lwt_42:
    buffer_store_dwordx4 v[124:127], v0, s[40:43], s47 offen offset:2048 sc1
    s_branch Lwt_43
Lwt_708045:
    buffer_store_dwordx4 v[76:79], v202, s[12:15], 0 offen sc1
    s_branch Lwt_708046
Lwt_56:
    buffer_store_dwordx4 v[124:127], v0, s[40:43], s47 offen offset:3072 sc1
    s_branch Lwt_57
Lwt_60:
    buffer_store_dwordx4 v[128:131], v0, s[16:19], s47 offen offset:0 sc1
    s_branch Lwt_61
Lwt_66:
    buffer_store_dwordx4 v[128:131], v0, s[16:19], s47 offen offset:1024 sc1
    s_branch Lwt_67
Lwt_70:
    buffer_store_dwordx4 v[128:131], v0, s[16:19], s47 offen offset:2048 sc1
    s_branch Lwt_71
Lwt_75:
    buffer_store_dwordx4 v[128:131], v0, s[16:19], s47 offen offset:3072 sc1
    s_branch Lwt_76
Lrt_79:
    s_mov_b32 s26, 0
Lrt_79b:
    buffer_load_dwordx4 v[72:75], v189, s[12:15], 0 offen sc1
    s_waitcnt vmcnt(0)
    v_xor_b32 v76, s24, v74
    v_xor_b32 v77, s25, v75
    v_lshrrev_b32 v77, 4, v77
    v_or_b32 v76, v76, v77
    v_cmp_ne_u32 vcc, 0, v76
    s_nop 0
    s_cbranch_vccz Lok_80
    s_add_u32 s26, s26, 1
    s_cmp_lt_u32 s26, 262144
    s_cbranch_scc1 Lrt_79b
    s_branch Lok_80
Lpoll_83:
    s_mov_b32 s26, 0
Lpoll_83b:
    buffer_load_dwordx2 v[244:245], v200, s[12:15], 0 offen sc1
    s_waitcnt vmcnt(0)
    v_xor_b32 v246, s24, v244
    v_xor_b32 v247, s25, v245
    v_lshrrev_b32 v247, 4, v247
    v_or_b32 v246, v246, v247
    v_cmp_ne_u32 vcc, 0, v246
    s_nop 0
    s_cbranch_vccz Lok_84
    s_add_u32 s26, s26, 1
    s_cmp_lt_u32 s26, 262144
    s_cbranch_scc1 Lpoll_83b
    s_branch Lok_84
Lwt_100:
    buffer_store_dwordx2 v[240:241], v190, s[12:15], 0 offen sc1
    s_branch Lwt_101
Lwt_105:
    buffer_store_dwordx2 v[240:241], v190, s[12:15], 0 offen sc1
    s_branch Lwt_106
Lrt_108:
    s_mov_b32 s26, 0
Lrt_108b:
    buffer_load_dwordx4 v[32:35], v0, s[12:15], s27 offen sc1
    s_waitcnt vmcnt(0)
    v_cmp_eq_u32 vcc, -1, v32
    s_nop 0
    s_cbranch_vccz Lok_109
    s_add_u32 s26, s26, 1
    s_cmp_lt_u32 s26, 262144
    s_cbranch_scc1 Lrt_108b
    s_branch Lok_109
Lpoll_110:
    s_mov_b32 s26, 0
Lpoll_110b:
    buffer_load_dwordx2 v[244:245], v188, s[12:15], 0 offen sc1
    s_waitcnt vmcnt(0)
    v_xor_b32 v246, s24, v244
    v_xor_b32 v247, s25, v245
    v_lshrrev_b32 v247, 4, v247
    v_or_b32 v246, v246, v247
    v_cmp_ne_u32 vcc, 0, v246
    s_nop 0
    s_cbranch_vccz Lok_111
    s_add_u32 s26, s26, 1
    s_cmp_lt_u32 s26, 262144
    s_cbranch_scc1 Lpoll_110b
    s_branch Lok_111
Lwt_116:
    buffer_store_dwordx2 v[236:237], v206, s[12:15], 0 offen offset:0 sc1
    buffer_store_dwordx2 v[244:245], v206, s[12:15], 0 offen offset:2048 sc1
    s_branch Lwt_117
Lwt_118:
    buffer_store_dwordx2 v[236:237], v206, s[12:15], 0 offen offset:0 sc1
    buffer_store_dwordx2 v[244:245], v206, s[12:15], 0 offen offset:2048 sc1
    s_branch Lwt_119
Lwt_120:
    buffer_store_dwordx4 v[76:79], v0, s[88:91], s27 offen offset:1024 sc1
    buffer_store_dwordx4 v[92:95], v0, s[88:91], s27 offen offset:0 sc1
    s_branch Lwt_121
Lwt_122:
    buffer_store_dwordx4 v[76:79], v0, s[88:91], s62 offen offset:1024 sc1
    buffer_store_dwordx4 v[92:95], v0, s[88:91], s62 offen offset:0 sc1
    s_branch Lwt_123
Lht_126:
    s_call_b64 s[72:73], L_h0
    s_branch Lhb_125
Lht_128:
    s_call_b64 s[72:73], L_h0
    s_branch Lhb_127
Lht_130:
    s_call_b64 s[72:73], L_h0
    s_branch Lhb_129
Lht_131:
    s_call_b64 s[72:73], L_h2
    s_branch Lhb_129
Lht_133:
    s_call_b64 s[72:73], L_h0
    s_branch Lhb_132
Lht_134:
    s_call_b64 s[72:73], L_h2
    s_branch Lhb_132
Lht_136:
    s_call_b64 s[72:73], L_h2
    s_branch Lhb_135
Lht_137:
    s_call_b64 s[72:73], L_h4
    s_branch Lhb_135
Lht_139:
    s_call_b64 s[72:73], L_h2
    s_branch Lhb_138
Lht_140:
    s_call_b64 s[72:73], L_h4
    s_branch Lhb_138
Lht_142:
    s_call_b64 s[72:73], L_h4
    s_branch Lhb_141
Lht_144:
    s_call_b64 s[72:73], L_h4
    s_branch Lhb_143
Lwt_146:
    buffer_store_dwordx4 v[104:107], v0, s[88:91], s62 offen offset:0 sc1
    buffer_store_dwordx4 v[112:115], v0, s[88:91], s62 offen offset:1024 sc1
    s_branch Lwt_147
Lot_149:
    s_call_b64 s[72:73], L_ofix
    s_cbranch_scc0 Look_150
    v_or3_b32 v250, v56, v60, v64
    v_bitop3_b32 v250, v250, v68, 1 bitop3:0xa8
    v_cmp_ne_u32 vcc, 0, v250
    s_nop 0
    s_cbranch_vccnz Lot_149
    s_branch Look_150
Lot_152:
    s_call_b64 s[72:73], L_ofix
    s_cbranch_scc0 Look_153
    v_or3_b32 v250, v72, v76, v80
    v_bitop3_b32 v250, v250, v84, 1 bitop3:0xa8
    v_cmp_ne_u32 vcc, 0, v250
    s_nop 0
    s_cbranch_vccnz Lot_152
    s_branch Look_153
Lot_155:
    s_call_b64 s[72:73], L_ofix
    s_cbranch_scc0 Look_156
    v_or3_b32 v250, v88, v92, v96
    v_bitop3_b32 v250, v250, v100, 1 bitop3:0xa8
    v_cmp_ne_u32 vcc, 0, v250
    s_nop 0
    s_cbranch_vccnz Lot_155
    s_branch Look_156
Lot_158:
    s_call_b64 s[72:73], L_ofix
    s_cbranch_scc0 Look_159
    v_or3_b32 v250, v104, v108, v112
    v_bitop3_b32 v250, v250, v116, 1 bitop3:0xa8
    v_cmp_ne_u32 vcc, 0, v250
    s_nop 0
    s_cbranch_vccnz Lot_158
    s_branch Look_159
Lot_161:
    s_call_b64 s[72:73], L_ofix
    s_cbranch_scc0 Look_162
    v_or3_b32 v250, v56, v60, v64
    v_bitop3_b32 v250, v250, v68, 1 bitop3:0xa8
    v_cmp_ne_u32 vcc, 0, v250
    s_nop 0
    s_cbranch_vccnz Lot_161
    s_branch Look_162
Lot_164:
    s_call_b64 s[72:73], L_ofix
    s_cbranch_scc0 Look_165
    v_or3_b32 v250, v72, v76, v80
    v_bitop3_b32 v250, v250, v84, 1 bitop3:0xa8
    v_cmp_ne_u32 vcc, 0, v250
    s_nop 0
    s_cbranch_vccnz Lot_164
    s_branch Look_165
Lot_167:
    s_call_b64 s[72:73], L_ofix
    s_cbranch_scc0 Look_168
    v_or3_b32 v250, v88, v92, v96
    v_bitop3_b32 v250, v250, v100, 1 bitop3:0xa8
    v_cmp_ne_u32 vcc, 0, v250
    s_nop 0
    s_cbranch_vccnz Lot_167
    s_branch Look_168
Lot_170:
    s_call_b64 s[72:73], L_ofix
    s_cbranch_scc0 Look_171
    v_or3_b32 v250, v104, v108, v112
    v_bitop3_b32 v250, v250, v116, 1 bitop3:0xa8
    v_cmp_ne_u32 vcc, 0, v250
    s_nop 0
    s_cbranch_vccnz Lot_170
    s_branch Look_171
Lot_173:
    s_call_b64 s[72:73], L_ofix
    s_cbranch_scc0 Look_174
    v_or3_b32 v250, v56, v60, v64
    v_bitop3_b32 v250, v250, v68, 1 bitop3:0xa8
    v_cmp_ne_u32 vcc, 0, v250
    s_nop 0
    s_cbranch_vccnz Lot_173
    s_branch Look_174
Lot_176:
    s_call_b64 s[72:73], L_ofix
    s_cbranch_scc0 Look_177
    v_or3_b32 v250, v72, v76, v80
    v_bitop3_b32 v250, v250, v84, 1 bitop3:0xa8
    v_cmp_ne_u32 vcc, 0, v250
    s_nop 0
    s_cbranch_vccnz Lot_176
    s_branch Look_177
Lot_179:
    s_call_b64 s[72:73], L_ofix
    s_cbranch_scc0 Look_180
    v_or3_b32 v250, v88, v92, v96
    v_bitop3_b32 v250, v250, v100, 1 bitop3:0xa8
    v_cmp_ne_u32 vcc, 0, v250
    s_nop 0
    s_cbranch_vccnz Lot_179
    s_branch Look_180
Lot_182:
    s_call_b64 s[72:73], L_ofix
    s_cbranch_scc0 Look_183
    v_or3_b32 v250, v104, v108, v112
    v_bitop3_b32 v250, v250, v116, 1 bitop3:0xa8
    v_cmp_ne_u32 vcc, 0, v250
    s_nop 0
    s_cbranch_vccnz Lot_182
    s_branch Look_183
Lot_185:
    s_call_b64 s[72:73], L_ofix
    s_cbranch_scc0 Look_186
    v_or3_b32 v250, v56, v60, v64
    v_bitop3_b32 v250, v250, v68, 1 bitop3:0xa8
    v_cmp_ne_u32 vcc, 0, v250
    s_nop 0
    s_cbranch_vccnz Lot_185
    s_branch Look_186
Lot_188:
    s_call_b64 s[72:73], L_ofix
    s_cbranch_scc0 Look_189
    v_or3_b32 v250, v72, v76, v80
    v_bitop3_b32 v250, v250, v84, 1 bitop3:0xa8
    v_cmp_ne_u32 vcc, 0, v250
    s_nop 0
    s_cbranch_vccnz Lot_188
    s_branch Look_189
Lot_191:
    s_call_b64 s[72:73], L_ofix
    s_cbranch_scc0 Look_192
    v_or3_b32 v250, v88, v92, v96
    v_bitop3_b32 v250, v250, v100, 1 bitop3:0xa8
    v_cmp_ne_u32 vcc, 0, v250
    s_nop 0
    s_cbranch_vccnz Lot_191
    s_branch Look_192
Lot_194:
    s_call_b64 s[72:73], L_ofix
    s_cbranch_scc0 Look_195
    v_or3_b32 v250, v104, v108, v112
    v_bitop3_b32 v250, v250, v116, 1 bitop3:0xa8
    v_cmp_ne_u32 vcc, 0, v250
    s_nop 0
    s_cbranch_vccnz Lot_194
    s_branch Look_195
Lwt_196:
    v_and_b32 v24, 0xffff0000, v24
    v_cvt_pk_bf16_f32 v9, v26, v27
    v_cvt_pk_bf16_f32 v8, v24, v25
    v_cvt_pk_bf16_f32 v10, v28, v29
    v_cvt_pk_bf16_f32 v11, v30, v31
    v_or_b32 v8, 1, v8
    buffer_store_dwordx4 v[8:11], v0, s[16:19], s0 offen offset:0 sc1
    ds_write_b128 v249, v[8:11] offset:0
    v_and_b32 v32, 0xffff0000, v32
    v_cvt_pk_bf16_f32 v13, v34, v35
    v_cvt_pk_bf16_f32 v12, v32, v33
    v_cvt_pk_bf16_f32 v14, v36, v37
    v_cvt_pk_bf16_f32 v15, v38, v39
    v_or_b32 v12, 1, v12
    buffer_store_dwordx4 v[12:15], v0, s[16:19], s0 offen offset:1024 sc1
    ds_write_b128 v249, v[12:15] offset:1024
    v_and_b32 v40, 0xffff0000, v40
    v_cvt_pk_bf16_f32 v17, v42, v43
    v_cvt_pk_bf16_f32 v16, v40, v41
    v_cvt_pk_bf16_f32 v18, v44, v45
    v_cvt_pk_bf16_f32 v19, v46, v47
    v_or_b32 v16, 1, v16
    buffer_store_dwordx4 v[16:19], v0, s[16:19], s0 offen offset:2048 sc1
    ds_write_b128 v249, v[16:19] offset:2048
    v_and_b32 v48, 0xffff0000, v48
    v_cvt_pk_bf16_f32 v21, v50, v51
    v_cvt_pk_bf16_f32 v20, v48, v49
    v_cvt_pk_bf16_f32 v22, v52, v53
    v_cvt_pk_bf16_f32 v23, v54, v55
    v_or_b32 v20, 1, v20
    buffer_store_dwordx4 v[20:23], v0, s[16:19], s0 offen offset:3072 sc1
    ds_write_b128 v249, v[20:23] offset:3072
    s_branch Lwt_197
Lpoll_207:
    s_mov_b32 s26, 0
Lpoll_207b:
    buffer_load_dwordx2 v[132:133], v131, s[12:15], 0 offen sc1
    s_waitcnt vmcnt(0)
    v_xor_b32 v134, s24, v132
    v_xor_b32 v135, s25, v133
    v_lshrrev_b32 v135, 4, v135
    v_or_b32 v134, v134, v135
    v_cmp_ne_u32 vcc, 0, v134
    s_nop 0
    s_cbranch_vccz Lok_208
    s_add_u32 s26, s26, 1
    s_cmp_lt_u32 s26, 262144
    s_cbranch_scc1 Lpoll_207b
    s_branch Lok_208
L_last:
    s_endpgm

.section .rodata,"a"
.p2align 6
.amdhsa_kernel interleave_layers__sliding_block__sliding_local_dilated__prompt_kernel
  .amdhsa_next_free_vgpr 256
  .amdhsa_next_free_sgpr 102
  .amdhsa_accum_offset 256
  .amdhsa_group_segment_fixed_size 0
  .amdhsa_kernarg_size 72
  .amdhsa_user_sgpr_count 2
  .amdhsa_user_sgpr_kernarg_segment_ptr 1
  .amdhsa_system_sgpr_workgroup_id_x 1
.end_amdhsa_kernel
```
